```python
import torch

def _softmax(x, axis=-1):
    return torch.softmax(x, dim=axis)
def _gelu(x):
    return torch.nn.functional.gelu(x, approximate="tanh")
def _silu(x):
    return torch.nn.functional.silu(x)
def _sigmoid(x):
    return torch.sigmoid(x)
def _layernorm(x, axis=-1, eps=1e-5):
    m = x.mean(dim=axis, keepdim=True)
    v = x.var(dim=axis, keepdim=True, unbiased=False)
    return (x - m) / torch.sqrt(v + eps)
def _scatter_add(tgt, idx, src, axis=0):
    return tgt.clone().index_add_(axis, idx, src)
def _segment_sum(src, seg, n):
    out = torch.zeros((n,) + src.shape[1:], dtype=src.dtype)
    return out.index_add_(0, seg, src)
def _pad(x, pw):
    flat = tuple(v for pair in reversed(pw) for v in pair)
    return torch.nn.functional.pad(x, flat)

kernel_name = 'interleave_layers__spectral_gfnet__linear_attn_block__prompt'

def setup_inputs():

    _w = (lambda a: (lambda t: t.to(torch.bfloat16) if t.is_floating_point() else t)(torch.as_tensor(a)))
    def _A_setup():
        B, S, D = 1, 2048, 640
        Df = D // 2 + 1
        return {
            "x": _w((lambda *s: torch.randn(*s, dtype=torch.bfloat16) * 0.05)(B, S, D)),
            "w_r": _w((lambda *s: torch.randn(*s, dtype=torch.bfloat16) * 0.4)(S, Df) * 0.02),
            "w_i": _w((lambda *s: torch.randn(*s, dtype=torch.bfloat16) * 0.4)(S, Df) * 0.02),
        }
    _A_in = _A_setup()

    def _B_setup():
        B, S, D = 1, 2048, 640
        return {
            "x": _w((lambda *s: torch.randn(*s, dtype=torch.bfloat16) * 0.05)(B, S, D)),
            "wqkv": _w((lambda *s: torch.randn(*s, dtype=torch.bfloat16) * 0.05)(D, 3 * D)),
            "wo": _w((lambda *s: torch.randn(*s, dtype=torch.bfloat16) * 0.05)(D, D)),
        }
    _B_in = _B_setup()

    return {
        "A_x": _A_in["x"],
        "A_w_r": _A_in["w_r"],
        "A_w_i": _A_in["w_i"],
        "B_x": _B_in["x"],
        "B_wqkv": _B_in["wqkv"],
        "B_wo": _B_in["wo"],
    }

def reference(A_x, A_w_r, A_w_i, B_x, B_wqkv, B_wo):
    def _A_ref(x, w_r, w_i):
        B, S, D = x.shape
        X = (lambda x, axes=(-2,-1): torch.fft.rfft2(x.float(), dim=axes))(x, axes=(-2, -1))
        W = w_r + 1j * w_i
        X = X * W
        y = (lambda x, s, axes=(-2,-1): torch.fft.irfft2(x, s=s, dim=axes).to(torch.bfloat16))(X, (S, D), axes=(-2, -1))
        return y

    def _B_ref(x, wqkv, wo):
        B, S, D = x.shape
        H = 32; Dh = D // H
        qkv = (lambda x, *d: x.permute(*d))((x @ wqkv).reshape(B, S, 3, H, Dh), 2, 0, 3, 1, 4)
        q, k, v = qkv[0], qkv[1], qkv[2]
        phi = lambda t: torch.where(t > 0, t + 1, torch.exp(t)) + 1e-6
        pq, pk = phi(q), phi(k)
        kv = torch.einsum("bhsd,bhse->bhde", pk, v)
        z = torch.einsum("bhsd->bhd", pk)
        num = torch.einsum("bhqd,bhde->bhqe", pq, kv)
        den = torch.einsum("bhqd,bhd->bhq", pq, z)[..., None] + 1e-6
        o = num / den
        return (lambda x, *d: x.permute(*d))(o, 0, 2, 1, 3).reshape(B, S, D) @ wo

    x = A_x
    x = x + _A_ref(_layernorm(x, axis=-1), A_w_r, A_w_i)
    x = x + _B_ref(_layernorm(x, axis=-1), B_wqkv, B_wo)
    x = x + _A_ref(_layernorm(x, axis=-1), A_w_r, A_w_i)
    x = x + _B_ref(_layernorm(x, axis=-1), B_wqkv, B_wo)
    return x
```

```asm
; @launch kernel=k1_kernel grid=(256,1,1) block=(256,1,1) lds=41216
; @launch kernel=k2_kernel grid=(248,1,1) block=(512,1,1) lds=132352
; @launch kernel=k3_kernel grid=(256,1,1) block=(512,1,1) lds=141312
; @launch kernel=k4_kernel grid=(256,1,1) block=(640,1,1) lds=135168
; @launch kernel=k5_kernel grid=(176,1,1) block=(512,1,1) lds=132352
; @launch kernel=k6_kernel grid=(256,1,1) block=(512,1,1) lds=141312
; @launch kernel=k7_kernel grid=(256,1,1) block=(640,1,1) lds=135168
.amdgcn_target "amdgcn-amd-amdhsa--gfx950"
.text
.globl k1_kernel
.p2align 8
.type k1_kernel,@function
k1_kernel:
  s_cmp_ge_u32 s2, 256
  s_cbranch_scc1 k1_exit
  s_load_dwordx2 s[4:5], s[0:1], 64
  s_mov_b32 s6, 28360704
  s_mov_b32 s7, 0x20000
  s_load_dwordx2 s[44:45], s[0:1], 32
  s_mov_b32 s46, 2457600
  s_mov_b32 s47, 0x20000
  s_load_dwordx2 s[48:49], s[0:1], 40
  s_mov_b32 s50, 819200
  s_mov_b32 s51, 0x20000
  s_cmp_ge_u32 s2, 128
  s_cbranch_scc1 k1_f
  s_load_dwordx2 s[8:9], s[0:1], 0
  s_mov_b32 s10, 2621440
  s_mov_b32 s11, 0x20000
  s_getpc_b64 s[12:13]
  s_add_u32 s12, s12, tabs@rel32@lo+4
  s_addc_u32 s13, s13, tabs@rel32@hi+12
  s_mov_b32 s14, 102160
  s_mov_b32 s15, 0x20000
  v_and_b32 v1, 63, v0
  v_lshrrev_b32 v2, 6, v0
  s_nop 0
  v_readfirstlane_b32 s20, v2
  v_lshrrev_b32 v3, 4, v0
  v_and_b32 v4, 15, v0
  s_lshl_b32 s21, s2, 4
  s_mul_i32 s22, s21, 1280
  v_mul_u32_u24 v5, 1280, v3
  v_lshl_add_u32 v5, v4, 4, v5
  v_mul_u32_u24 v6, 1296, v3
  v_lshl_add_u32 v6, v4, 4, v6
  v_lshlrev_b32 v7, 4, v1
  s_waitcnt lgkmcnt(0)
  buffer_load_dwordx4 v[140:143], v5, s[8:11], s22 offen offset:0
  buffer_load_dwordx4 v[144:147], v5, s[8:11], s22 offen offset:256
  buffer_load_dwordx4 v[148:151], v5, s[8:11], s22 offen offset:512
  buffer_load_dwordx4 v[152:155], v5, s[8:11], s22 offen offset:768
  buffer_load_dwordx4 v[156:159], v5, s[8:11], s22 offen offset:1024
  buffer_load_dwordx4 a[0:3], v7, s[12:15], 0 offen offset:0
  buffer_load_dwordx4 a[4:7], v7, s[12:15], 0 offen offset:1024
  buffer_load_dwordx4 a[8:11], v7, s[12:15], 0 offen offset:2048
  buffer_load_dwordx4 a[12:15], v7, s[12:15], 0 offen offset:3072
  s_movk_i32 s30, 0x1000
  buffer_load_dwordx4 a[16:19], v7, s[12:15], s30 offen offset:0
  buffer_load_dwordx4 a[20:23], v7, s[12:15], s30 offen offset:1024
  s_mul_i32 s30, s20, 10240
  s_add_u32 s30, s30, 6144
  buffer_load_dwordx4 v[176:179], v7, s[12:15], s30 offen offset:0
  buffer_load_dwordx4 v[180:183], v7, s[12:15], s30 offen offset:1024
  buffer_load_dwordx4 v[184:187], v7, s[12:15], s30 offen offset:2048
  buffer_load_dwordx4 v[188:191], v7, s[12:15], s30 offen offset:3072
  s_add_u32 s30, s30, 4096
  buffer_load_dwordx4 v[192:195], v7, s[12:15], s30 offen offset:0
  buffer_load_dwordx4 v[196:199], v7, s[12:15], s30 offen offset:1024
  buffer_load_dwordx4 v[200:203], v7, s[12:15], s30 offen offset:2048
  buffer_load_dwordx4 v[204:207], v7, s[12:15], s30 offen offset:3072
  s_add_u32 s30, s30, 4096
  buffer_load_dwordx4 v[208:211], v7, s[12:15], s30 offen offset:0
  buffer_load_dwordx4 v[212:215], v7, s[12:15], s30 offen offset:1024
  s_getpc_b64 s[52:53]
  s_add_u32 s52, s52, k2_kernel@rel32@lo+4
  s_addc_u32 s53, s53, k2_kernel@rel32@hi+12
  s_mov_b32 s54, text_end-k2_kernel
  s_mov_b32 s55, 0x20000
  s_lshr_b32 s33, s2, 3
  s_lshl_b32 s33, s33, 11
  v_lshrrev_b32 v162, 5, v0
  v_lshlrev_b32 v162, 24, v162
  v_lshl_add_u32 v162, v0, 6, v162
  buffer_load_dword v162, v162, s[52:55], s33 offen
  s_add_u32 s33, s33, 47104
  v_lshrrev_b32 v167, 5, v0
  v_lshlrev_b32 v167, 24, v167
  v_lshl_add_u32 v167, v0, 6, v167
  buffer_load_dword v167, v167, s[12:15], s33 offen
  v_lshrrev_b32 v8, 4, v1
  v_mul_u32_u24 v9, 1296, v4
  s_lshl_b32 s23, s20, 3
  v_add_u32 v9, s23, v9
  v_lshl_add_u32 v10, v8, 7, v9
  v_lshl_add_u32 v11, v8, 6, v9
  v_add_u32 v11, 1024, v11
  v_mul_u32_u24 v12, 5120, v8
  v_lshl_add_u32 v12, v4, 4, v12
  s_lshl_b32 s23, s20, 8
  s_add_u32 s23, s23, 20736
  v_add_u32 v12, s23, v12
  s_mul_i32 s23, s20, 5120
  s_add_u32 s23, s23, 20736
  v_add_u32 v13, s23, v7
  v_lshlrev_b32 v14, 11, v8
  v_lshl_add_u32 v14, v4, 4, v14
  s_mul_i32 s24, s20, 40960
  s_lshr_b32 s23, s2, 3
  s_mul_i32 s23, s23, 165888
  s_add_u32 s24, s24, s23
  s_and_b32 s23, s2, 7
  s_lshl_b32 s23, s23, 8
  s_add_u32 s24, s24, s23
  s_add_u32 s24, s24, 0
  v_mov_b32 v57, 0
  v_mov_b32 v58, 0
  v_mov_b32 v59, 0
  v_mov_b32 v61, 0
  v_mov_b32 v62, 0
  v_mov_b32 v63, 0
  v_mov_b32 v65, 0
  v_mov_b32 v66, 0
  v_mov_b32 v67, 0
  v_mov_b32 v69, 0
  v_mov_b32 v70, 0
  v_mov_b32 v71, 0
  v_mov_b32 v36, 0
  v_mov_b32 v37, 0
  v_mov_b32 v38, 0x3f803f80
  s_waitcnt vmcnt(22)
  ds_write_b128 v6, v[140:143] offset:0
  s_waitcnt vmcnt(21)
  ds_write_b128 v6, v[144:147] offset:256
  s_waitcnt vmcnt(20)
  ds_write_b128 v6, v[148:151] offset:512
  s_waitcnt vmcnt(19)
  ds_write_b128 v6, v[152:155] offset:768
  s_waitcnt vmcnt(18)
  ds_write_b128 v6, v[156:159] offset:1024
  s_waitcnt lgkmcnt(0)
  s_barrier
  ds_read_b64 v[16:17], v10 offset:0
  ds_read_b64 v[18:19], v10 offset:32
  ds_read_b64 v[20:21], v10 offset:64
  ds_read_b64 v[22:23], v10 offset:96
  ds_read_b64 v[24:25], v10 offset:512
  ds_read_b64 v[26:27], v10 offset:544
  ds_read_b64 v[28:29], v10 offset:576
  ds_read_b64 v[30:31], v10 offset:608
  ds_read_b64 v[32:33], v11 offset:0
  ds_read_b64 v[34:35], v11 offset:32
  s_mov_b32 s31, 0x05040100
  s_mov_b32 s32, 0x07060302
  s_waitcnt lgkmcnt(8)
  v_perm_b32 v40, v18, v16, s31
  v_perm_b32 v44, v18, v16, s32
  v_perm_b32 v48, v19, v17, s31
  v_perm_b32 v52, v19, v17, s32
  s_waitcnt lgkmcnt(6)
  v_perm_b32 v41, v22, v20, s31
  v_perm_b32 v45, v22, v20, s32
  v_perm_b32 v49, v23, v21, s31
  v_perm_b32 v53, v23, v21, s32
  s_waitcnt lgkmcnt(4)
  v_perm_b32 v42, v26, v24, s31
  v_perm_b32 v46, v26, v24, s32
  v_perm_b32 v50, v27, v25, s31
  v_perm_b32 v54, v27, v25, s32
  s_waitcnt lgkmcnt(2)
  v_perm_b32 v43, v30, v28, s31
  v_perm_b32 v47, v30, v28, s32
  v_perm_b32 v51, v31, v29, s31
  v_perm_b32 v55, v31, v29, s32
  s_waitcnt lgkmcnt(0)
  v_perm_b32 v56, v34, v32, s31
  v_perm_b32 v60, v34, v32, s32
  v_perm_b32 v64, v35, v33, s31
  v_perm_b32 v68, v35, v33, s32
  s_waitcnt vmcnt(17)
  v_mfma_f32_16x16x32_bf16 v[72:75], a[0:3], v[40:43], 0
  s_waitcnt vmcnt(15)
  v_mfma_f32_16x16x32_bf16 v[76:79], a[8:11], v[40:43], 0
  s_waitcnt vmcnt(13)
  v_mfma_f32_16x16x32_bf16 v[80:83], a[16:19], v[40:43], 0
  v_mfma_f32_16x16x32_bf16 v[84:87], a[0:3], v[44:47], 0
  v_mfma_f32_16x16x32_bf16 v[88:91], a[8:11], v[44:47], 0
  v_mfma_f32_16x16x32_bf16 v[92:95], a[16:19], v[44:47], 0
  v_mfma_f32_16x16x32_bf16 v[96:99], a[0:3], v[48:51], 0
  v_mfma_f32_16x16x32_bf16 v[100:103], a[8:11], v[48:51], 0
  v_mfma_f32_16x16x32_bf16 v[104:107], a[16:19], v[48:51], 0
  v_mfma_f32_16x16x32_bf16 v[108:111], a[0:3], v[52:55], 0
  v_mfma_f32_16x16x32_bf16 v[112:115], a[8:11], v[52:55], 0
  v_mfma_f32_16x16x32_bf16 v[116:119], a[16:19], v[52:55], 0
  v_mfma_f32_16x16x32_bf16 v[72:75], a[4:7], v[56:59], v[72:75]
  v_mfma_f32_16x16x32_bf16 v[76:79], a[12:15], v[56:59], v[76:79]
  s_waitcnt vmcnt(12)
  v_mfma_f32_16x16x32_bf16 v[80:83], a[20:23], v[56:59], v[80:83]
  v_mfma_f32_16x16x32_bf16 v[84:87], a[4:7], v[60:63], v[84:87]
  v_mfma_f32_16x16x32_bf16 v[88:91], a[12:15], v[60:63], v[88:91]
  v_mfma_f32_16x16x32_bf16 v[92:95], a[20:23], v[60:63], v[92:95]
  v_mfma_f32_16x16x32_bf16 v[96:99], a[4:7], v[64:67], v[96:99]
  v_mfma_f32_16x16x32_bf16 v[100:103], a[12:15], v[64:67], v[100:103]
  v_mfma_f32_16x16x32_bf16 v[104:107], a[20:23], v[64:67], v[104:107]
  v_mfma_f32_16x16x32_bf16 v[108:111], a[4:7], v[68:71], v[108:111]
  v_mfma_f32_16x16x32_bf16 v[112:115], a[12:15], v[68:71], v[112:115]
  v_mfma_f32_16x16x32_bf16 v[116:119], a[20:23], v[68:71], v[116:119]
  v_cvt_pk_bf16_f32 v120, v72, v84
  s_nop 4
  v_cvt_pk_bf16_f32 v121, v96, v108
  v_cvt_pk_bf16_f32 v122, v73, v85
  v_cvt_pk_bf16_f32 v123, v97, v109
  ds_write_b128 v12, v[120:123] offset:0
  v_cvt_pk_bf16_f32 v124, v74, v86
  v_cvt_pk_bf16_f32 v125, v98, v110
  v_cvt_pk_bf16_f32 v126, v75, v87
  v_cvt_pk_bf16_f32 v127, v99, v111
  ds_write_b128 v12, v[124:127] offset:1024
  v_cvt_pk_bf16_f32 v128, v76, v88
  v_cvt_pk_bf16_f32 v129, v100, v112
  v_cvt_pk_bf16_f32 v130, v77, v89
  v_cvt_pk_bf16_f32 v131, v101, v113
  ds_write_b128 v12, v[128:131] offset:2048
  v_cvt_pk_bf16_f32 v132, v78, v90
  v_cvt_pk_bf16_f32 v133, v102, v114
  v_cvt_pk_bf16_f32 v134, v79, v91
  v_cvt_pk_bf16_f32 v135, v103, v115
  ds_write_b128 v12, v[132:135] offset:3072
  v_cvt_pk_bf16_f32 v136, v80, v92
  v_cvt_pk_bf16_f32 v137, v104, v116
  v_cvt_pk_bf16_f32 v138, v81, v93
  v_cvt_pk_bf16_f32 v139, v105, v117
  ds_write_b128 v12, v[136:139] offset:4096
  s_waitcnt lgkmcnt(0)
  s_barrier
  ds_read_b128 v[16:19], v13 offset:0
  ds_read_b128 v[20:23], v13 offset:1024
  ds_read_b128 v[24:27], v13 offset:2048
  ds_read_b128 v[28:31], v13 offset:3072
  ds_read_b128 v[32:35], v13 offset:4096
  s_waitcnt vmcnt(11) lgkmcnt(4)
  v_mfma_f32_16x16x32_bf16 v[72:75], v[176:179], v[16:19], 0
  s_waitcnt vmcnt(10)
  v_mfma_f32_16x16x32_bf16 v[76:79], v[180:183], v[16:19], 0
  s_waitcnt vmcnt(9) lgkmcnt(3)
  v_mfma_f32_16x16x32_bf16 v[80:83], v[184:187], v[20:23], 0
  s_waitcnt vmcnt(8)
  v_mfma_f32_16x16x32_bf16 v[84:87], v[188:191], v[20:23], 0
  s_waitcnt vmcnt(7) lgkmcnt(2)
  v_mfma_f32_16x16x32_bf16 v[88:91], v[192:195], v[24:27], 0
  s_waitcnt vmcnt(6)
  v_mfma_f32_16x16x32_bf16 v[92:95], v[196:199], v[24:27], 0
  s_waitcnt vmcnt(5) lgkmcnt(1)
  v_mfma_f32_16x16x32_bf16 v[96:99], v[200:203], v[28:31], 0
  s_waitcnt vmcnt(4)
  v_mfma_f32_16x16x32_bf16 v[100:103], v[204:207], v[28:31], 0
  s_waitcnt vmcnt(3) lgkmcnt(0)
  v_mfma_f32_16x16x32_bf16 v[104:107], v[208:211], v[32:35], 0
  s_waitcnt vmcnt(2)
  v_mfma_f32_16x16x32_bf16 v[108:111], v[212:215], v[32:35], 0
  v_cvt_pk_bf16_f32 v120, v72, v73
  v_cvt_pk_bf16_f32 v121, v74, v75
  v_cvt_pk_bf16_f32 v122, v76, v77
  v_cvt_pk_bf16_f32 v123, v78, v79
  buffer_store_dwordx4 v[120:123], v14, s[4:7], s24 offen
  s_add_u32 s24, s24, 8192
  v_cvt_pk_bf16_f32 v124, v80, v81
  v_cvt_pk_bf16_f32 v125, v82, v83
  v_cvt_pk_bf16_f32 v126, v84, v85
  v_cvt_pk_bf16_f32 v127, v86, v87
  buffer_store_dwordx4 v[124:127], v14, s[4:7], s24 offen
  s_add_u32 s24, s24, 8192
  v_cvt_pk_bf16_f32 v128, v88, v89
  v_cvt_pk_bf16_f32 v129, v90, v91
  v_cvt_pk_bf16_f32 v130, v92, v93
  v_cvt_pk_bf16_f32 v131, v94, v95
  buffer_store_dwordx4 v[128:131], v14, s[4:7], s24 offen
  s_add_u32 s24, s24, 8192
  v_cvt_pk_bf16_f32 v132, v96, v97
  v_cvt_pk_bf16_f32 v133, v98, v99
  v_cvt_pk_bf16_f32 v134, v100, v101
  v_cvt_pk_bf16_f32 v135, v102, v103
  buffer_store_dwordx4 v[132:135], v14, s[4:7], s24 offen
  s_add_u32 s24, s24, 8192
  v_cvt_pk_bf16_f32 v136, v104, v105
  v_cvt_pk_bf16_f32 v137, v106, v107
  v_cvt_pk_bf16_f32 v138, v108, v109
  v_cvt_pk_bf16_f32 v139, v110, v111
  buffer_store_dwordx4 v[136:139], v14, s[4:7], s24 offen
  v_dot2_f32_bf16 v36, v140, v140, v36
  v_dot2_f32_bf16 v37, v140, v38, v37
  v_dot2_f32_bf16 v36, v141, v141, v36
  v_dot2_f32_bf16 v37, v141, v38, v37
  v_dot2_f32_bf16 v36, v142, v142, v36
  v_dot2_f32_bf16 v37, v142, v38, v37
  v_dot2_f32_bf16 v36, v143, v143, v36
  v_dot2_f32_bf16 v37, v143, v38, v37
  v_dot2_f32_bf16 v36, v144, v144, v36
  v_dot2_f32_bf16 v37, v144, v38, v37
  v_dot2_f32_bf16 v36, v145, v145, v36
  v_dot2_f32_bf16 v37, v145, v38, v37
  v_dot2_f32_bf16 v36, v146, v146, v36
  v_dot2_f32_bf16 v37, v146, v38, v37
  v_dot2_f32_bf16 v36, v147, v147, v36
  v_dot2_f32_bf16 v37, v147, v38, v37
  v_dot2_f32_bf16 v36, v148, v148, v36
  v_dot2_f32_bf16 v37, v148, v38, v37
  v_dot2_f32_bf16 v36, v149, v149, v36
  v_dot2_f32_bf16 v37, v149, v38, v37
  v_dot2_f32_bf16 v36, v150, v150, v36
  v_dot2_f32_bf16 v37, v150, v38, v37
  v_dot2_f32_bf16 v36, v151, v151, v36
  v_dot2_f32_bf16 v37, v151, v38, v37
  v_dot2_f32_bf16 v36, v152, v152, v36
  v_dot2_f32_bf16 v37, v152, v38, v37
  v_dot2_f32_bf16 v36, v153, v153, v36
  v_dot2_f32_bf16 v37, v153, v38, v37
  v_dot2_f32_bf16 v36, v154, v154, v36
  v_dot2_f32_bf16 v37, v154, v38, v37
  v_dot2_f32_bf16 v36, v155, v155, v36
  v_dot2_f32_bf16 v37, v155, v38, v37
  v_dot2_f32_bf16 v36, v156, v156, v36
  v_dot2_f32_bf16 v37, v156, v38, v37
  v_dot2_f32_bf16 v36, v157, v157, v36
  v_dot2_f32_bf16 v37, v157, v38, v37
  v_dot2_f32_bf16 v36, v158, v158, v36
  v_dot2_f32_bf16 v37, v158, v38, v37
  v_dot2_f32_bf16 v36, v159, v159, v36
  v_dot2_f32_bf16 v37, v159, v38, v37
  s_nop 1
  v_add_f32_dpp v36, v36, v36 row_ror:8 row_mask:0xf bank_mask:0xf
  v_add_f32_dpp v37, v37, v37 row_ror:8 row_mask:0xf bank_mask:0xf
  s_nop 0
  v_add_f32_dpp v36, v36, v36 row_ror:4 row_mask:0xf bank_mask:0xf
  v_add_f32_dpp v37, v37, v37 row_ror:4 row_mask:0xf bank_mask:0xf
  s_nop 0
  v_add_f32_dpp v36, v36, v36 row_ror:2 row_mask:0xf bank_mask:0xf
  v_add_f32_dpp v37, v37, v37 row_ror:2 row_mask:0xf bank_mask:0xf
  s_nop 0
  v_add_f32_dpp v36, v36, v36 row_ror:1 row_mask:0xf bank_mask:0xf
  v_add_f32_dpp v37, v37, v37 row_ror:1 row_mask:0xf bank_mask:0xf
  v_mul_f32 v38, 0xbacccccd, v37
  v_fmac_f32 v36, v38, v37
  v_add_u32 v39, s21, v3
  v_lshlrev_b32 v39, 2, v39
  s_mov_b32 s25, 26116096
  buffer_store_dword v36, v39, s[4:7], s25 offen
  s_endpgm
k1_f:
  s_load_dwordx2 s[8:9], s[0:1], 8
  s_mov_b32 s10, 1314816
  s_mov_b32 s11, 0x20000
  s_load_dwordx2 s[16:17], s[0:1], 16
  s_mov_b32 s18, 1314816
  s_mov_b32 s19, 0x20000
  s_getpc_b64 s[12:13]
  s_add_u32 s12, s12, tabs@rel32@lo+4
  s_addc_u32 s13, s13, tabs@rel32@hi+12
  s_mov_b32 s14, 102160
  s_mov_b32 s15, 0x20000
  s_sub_u32 s20, s2, 128
  s_lshr_b32 s21, s20, 3
  s_and_b32 s22, s20, 7
  s_lshl_b32 s23, s22, 8
  s_lshl_b32 s24, s21, 2
  s_add_u32 s23, s23, s24
  s_mul_i32 s23, s23, 642
  v_lshlrev_b32 v1, 4, v0
  v_cmp_gt_u32 vcc, 161, v0
  v_mov_b32 v2, 0x40000000
  s_nop 0
  v_cndmask_b32 v2, v2, v1, vcc
  s_waitcnt lgkmcnt(0)
  buffer_load_dwordx4 v[16:19], v2, s[8:11], s23 offen
  buffer_load_dwordx4 v[32:35], v2, s[16:19], s23 offen
  s_add_u32 s23, s23, 41088
  buffer_load_dwordx4 v[20:23], v2, s[8:11], s23 offen
  buffer_load_dwordx4 v[36:39], v2, s[16:19], s23 offen
  s_add_u32 s23, s23, 41088
  buffer_load_dwordx4 v[24:27], v2, s[8:11], s23 offen
  buffer_load_dwordx4 v[40:43], v2, s[16:19], s23 offen
  s_add_u32 s23, s23, 41088
  buffer_load_dwordx4 v[28:31], v2, s[8:11], s23 offen
  buffer_load_dwordx4 v[44:47], v2, s[16:19], s23 offen
  v_lshrrev_b32 v3, 2, v0
  v_and_b32 v4, 3, v0
  v_lshlrev_b32 v5, 2, v3
  s_mov_b32 s25, 59908
  buffer_load_dword v48, v5, s[12:15], s25 offen offset:0
  buffer_load_dword v49, v5, s[12:15], s25 offen offset:256
  buffer_load_dword v50, v5, s[12:15], s25 offen offset:512
  buffer_load_dword v51, v5, s[12:15], s25 offen offset:768
  buffer_load_dword v52, v5, s[12:15], s25 offen offset:1024
  s_getpc_b64 s[52:53]
  s_add_u32 s52, s52, k2_kernel@rel32@lo+4
  s_addc_u32 s53, s53, k2_kernel@rel32@hi+12
  s_mov_b32 s54, text_end-k2_kernel
  s_mov_b32 s55, 0x20000
  s_lshr_b32 s33, s2, 3
  s_lshl_b32 s33, s33, 11
  v_lshrrev_b32 v13, 5, v0
  v_lshlrev_b32 v13, 24, v13
  v_lshl_add_u32 v13, v0, 6, v13
  buffer_load_dword v13, v13, s[52:55], s33 offen
  s_add_u32 s33, s33, 47104
  v_lshrrev_b32 v167, 5, v0
  v_lshlrev_b32 v167, 24, v167
  v_lshl_add_u32 v167, v0, 6, v167
  buffer_load_dword v167, v167, s[12:15], s33 offen
  v_mov_b32 v8, 0
  v_mov_b32 v9, 0
  v_mov_b32 v10, 0
  v_mov_b32 v11, 0
  v_cmp_gt_u32 vcc, 68, v0
  v_mov_b32 v6, 0x40000000
  s_nop 0
  v_cndmask_b32 v6, v6, v1, vcc
  s_mul_i32 s26, s20, 1088
  s_add_u32 s26, s26, 26124288
  buffer_store_dwordx4 v[8:11], v6, s[4:7], s26 offen
  v_cmp_gt_u32 vcc, 161, v0
  s_nop 0
  s_and_saveexec_b64 s[28:29], vcc
  s_waitcnt vmcnt(15)
  ds_write_b128 v1, v[16:19] offset:0
  s_waitcnt vmcnt(14)
  ds_write_b128 v1, v[32:35] offset:10304
  s_waitcnt vmcnt(13)
  ds_write_b128 v1, v[20:23] offset:2576
  s_waitcnt vmcnt(12)
  ds_write_b128 v1, v[36:39] offset:12880
  s_waitcnt vmcnt(11)
  ds_write_b128 v1, v[24:27] offset:5152
  s_waitcnt vmcnt(10)
  ds_write_b128 v1, v[40:43] offset:15456
  s_waitcnt vmcnt(9)
  ds_write_b128 v1, v[28:31] offset:7728
  s_waitcnt vmcnt(8)
  ds_write_b128 v1, v[44:47] offset:18032
  s_mov_b64 exec, s[28:29]
  v_mul_u32_u24 v12, 642, v4
  v_lshl_add_u32 v12, v3, 1, v12
  s_lshl_b32 s27, s22, 6
  s_add_u32 s27, s27, s24
  s_lshl_b32 s27, s27, 4
  s_add_u32 s27, s27, 18579456
  s_waitcnt lgkmcnt(0)
  s_barrier
  s_and_b32 s33, s2, 7
  s_lshr_b32 s34, s2, 3
  v_mul_u32_u24 v105, 171, v0
  v_lshrrev_b32 v105, 9, v105
  v_mul_u32_u24 v106, 3, v105
  v_sub_u32 v106, v0, v106
  v_lshlrev_b32 v106, 7, v106
  v_min_u32 v106, 156, v106
  v_mul_u32_u24 v105, 3840, v105
  v_add_u32 v105, v105, v106
  v_cmp_gt_u32 vcc, 120, v0
  v_mov_b32 v107, 0x40000000
  s_nop 0
  v_cndmask_b32 v105, v107, v105, vcc
  s_sub_u32 s35, s34, 16
  s_mul_i32 s35, s35, 153600
  s_and_b32 s36, s33, 1
  s_mul_i32 s36, s36, 640
  s_add_u32 s35, s35, s36
  s_and_b32 s36, s33, 6
  s_mul_i32 s36, s36, 80
  s_add_u32 s35, s35, s36
  buffer_load_dword v109, v105, s[44:47], s35 offen offset:1280
  buffer_load_dword v111, v105, s[44:47], s35 offen offset:2560
  buffer_load_dword v105, v105, s[44:47], s35 offen
  v_subrev_u32 v104, 192, v0
  v_mul_u32_u24 v106, 13, v104
  v_lshrrev_b32 v106, 8, v106
  v_cmp_gt_u32 vcc, 60, v104
  v_mul_u32_u24 v107, 20, v106
  v_sub_u32 v104, v104, v107
  v_lshl_add_u32 v106, v106, 3, s33
  v_mul_u32_u24 v107, 52, v106
  v_lshrrev_b32 v107, 8, v107
  v_mul_u32_u24 v108, 5, v107
  v_sub_u32 v106, v106, v108
  s_and_b32 s35, s34, 7
  v_lshl_add_u32 v106, v106, 3, s35
  v_mul_u32_u24 v108, 52, v106
  v_lshrrev_b32 v108, 8, v108
  v_mad_u32_u24 v106, v108, 15, v106
  v_mul_u32_u24 v107, 160, v107
  v_add_u32 v106, v106, v107
  v_mul_u32_u24 v106, 1280, v106
  v_lshl_add_u32 v106, v104, 6, v106
  v_mov_b32 v107, 0x40000000
  v_cndmask_b32 v106, v107, v106, vcc
  s_lshr_b32 s35, s34, 3
  s_mul_i32 s35, s35, 6400
  buffer_load_dword v110, v106, s[48:51], s35 offen
  s_sub_u32 s35, s35, 12800
  buffer_load_dword v106, v106, s[48:51], s35 offen
  ds_read_u16 v64, v12 offset:2
  ds_read_u16 v84, v12 offset:10306
  ds_read_u16 v65, v12 offset:2578
  ds_read_u16 v85, v12 offset:12882
  ds_read_u16 v66, v12 offset:5154
  ds_read_u16 v86, v12 offset:15458
  ds_read_u16 v67, v12 offset:7730
  ds_read_u16 v87, v12 offset:18034
  ds_read_u16 v68, v12 offset:130
  ds_read_u16 v88, v12 offset:10434
  ds_read_u16 v69, v12 offset:2706
  ds_read_u16 v89, v12 offset:13010
  ds_read_u16 v70, v12 offset:5282
  ds_read_u16 v90, v12 offset:15586
  ds_read_u16 v71, v12 offset:7858
  ds_read_u16 v91, v12 offset:18162
  ds_read_u16 v72, v12 offset:258
  ds_read_u16 v92, v12 offset:10562
  ds_read_u16 v73, v12 offset:2834
  ds_read_u16 v93, v12 offset:13138
  ds_read_u16 v74, v12 offset:5410
  ds_read_u16 v94, v12 offset:15714
  ds_read_u16 v75, v12 offset:7986
  ds_read_u16 v95, v12 offset:18290
  ds_read_u16 v76, v12 offset:386
  ds_read_u16 v96, v12 offset:10690
  ds_read_u16 v77, v12 offset:2962
  ds_read_u16 v97, v12 offset:13266
  ds_read_u16 v78, v12 offset:5538
  ds_read_u16 v98, v12 offset:15842
  ds_read_u16 v79, v12 offset:8114
  ds_read_u16 v99, v12 offset:18418
  ds_read_u16 v80, v12 offset:514
  ds_read_u16 v100, v12 offset:10818
  ds_read_u16 v81, v12 offset:3090
  ds_read_u16 v101, v12 offset:13394
  ds_read_u16 v82, v12 offset:5666
  ds_read_u16 v102, v12 offset:15970
  ds_read_u16 v83, v12 offset:8242
  ds_read_u16 v103, v12 offset:18546
  s_waitcnt lgkmcnt(15)
  v_lshl_or_b32 v64, v84, 16, v64
  v_lshl_or_b32 v65, v85, 16, v65
  v_lshl_or_b32 v66, v86, 16, v66
  v_lshl_or_b32 v67, v87, 16, v67
  s_waitcnt vmcnt(12)
  v_lshl_add_u32 v48, v4, 4, v48
  buffer_store_dwordx4 v[64:67], v48, s[4:7], s27 offen
  v_lshl_or_b32 v68, v88, 16, v68
  v_lshl_or_b32 v69, v89, 16, v69
  v_lshl_or_b32 v70, v90, 16, v70
  v_lshl_or_b32 v71, v91, 16, v71
  s_waitcnt vmcnt(12)
  v_lshl_add_u32 v49, v4, 4, v49
  buffer_store_dwordx4 v[68:71], v49, s[4:7], s27 offen
  v_lshl_or_b32 v72, v92, 16, v72
  v_lshl_or_b32 v73, v93, 16, v73
  v_lshl_or_b32 v74, v94, 16, v74
  v_lshl_or_b32 v75, v95, 16, v75
  s_waitcnt vmcnt(12)
  v_lshl_add_u32 v50, v4, 4, v50
  buffer_store_dwordx4 v[72:75], v50, s[4:7], s27 offen
  s_waitcnt lgkmcnt(14)
  v_lshl_or_b32 v76, v96, 16, v76
  s_waitcnt lgkmcnt(12)
  v_lshl_or_b32 v77, v97, 16, v77
  s_waitcnt lgkmcnt(10)
  v_lshl_or_b32 v78, v98, 16, v78
  s_waitcnt lgkmcnt(8)
  v_lshl_or_b32 v79, v99, 16, v79
  s_waitcnt vmcnt(12)
  v_lshl_add_u32 v51, v4, 4, v51
  buffer_store_dwordx4 v[76:79], v51, s[4:7], s27 offen
  s_waitcnt lgkmcnt(6)
  v_lshl_or_b32 v80, v100, 16, v80
  s_waitcnt lgkmcnt(4)
  v_lshl_or_b32 v81, v101, 16, v81
  s_waitcnt lgkmcnt(2)
  v_lshl_or_b32 v82, v102, 16, v82
  s_waitcnt lgkmcnt(0)
  v_lshl_or_b32 v83, v103, 16, v83
  s_waitcnt vmcnt(12)
  v_lshl_add_u32 v52, v4, 4, v52
  buffer_store_dwordx4 v[80:83], v52, s[4:7], s27 offen
  s_endpgm
k1_exit:
  s_endpgm
.globl k2_kernel
.p2align 8
.type k2_kernel,@function
k2_kernel:
  s_mov_b32 s40, 0
  s_mov_b32 s41, 2654208
  s_mov_b32 s42, 26116096
  s_load_dwordx2 s[4:5], s[0:1], 64
  s_mov_b32 s6, 28360704
  s_mov_b32 s7, 0x20000
  s_cmp_lt_u32 s2, 160
  s_cbranch_scc1 k2_col
  s_cmp_lt_u32 s2, 224
  s_cbranch_scc1 k2_b
  s_cmp_lt_u32 s2, 244
  s_cbranch_scc1 k2_c
  s_endpgm
.globl k5_kernel
.p2align 8
.type k5_kernel,@function
k5_kernel:
  s_mov_b32 s40, 5308416
  s_mov_b32 s41, 7962624
  s_mov_b32 s42, 26124288
  s_load_dwordx2 s[4:5], s[0:1], 64
  s_mov_b32 s6, 28360704
  s_mov_b32 s7, 0x20000
  s_cmp_lt_u32 s2, 160
  s_cbranch_scc1 k2_col
  s_cmp_lt_u32 s2, 176
  s_cbranch_scc1 k2_i
  s_endpgm
k2_col:
  v_and_b32 v1, 63, v0
  v_and_b32 v2, 15, v0
  v_bfe_u32 v3, v0, 4, 2
  v_lshrrev_b32 v4, 6, v0
  s_nop 0
  v_readfirstlane_b32 s20, v4
  s_nop 0
  s_and_b32 s21, s20, 3
  s_lshr_b32 s22, s20, 2
  s_and_b32 s23, s2, 7
  s_lshr_b32 s24, s2, 4
  s_lshl_b32 s24, s24, 3
  s_add_u32 s23, s23, s24
  s_bfe_u32 s24, s2, 0x10003
  v_lshlrev_b32 v7, 9, v3
  v_lshl_add_u32 v7, v2, 2, v7
  s_lshl_b32 s25, s21, 11
  s_lshl_b32 s26, s22, 6
  s_add_u32 s25, s25, s26
  s_add_u32 s42, s42, s25
  s_mov_b32 s25, 165888
  v_mul_lo_u32 v6, v3, s25
  v_lshl_add_u32 v6, v2, 4, v6
  s_lshl_b32 s26, s23, 11
  s_lshl_b32 s27, s24, 3
  s_add_u32 s26, s26, s27
  s_mul_i32 s27, s21, 663552
  s_add_u32 s26, s26, s27
  s_lshl_b32 s27, s22, 8
  s_add_u32 s26, s26, s27
  s_add_u32 s27, s26, s41
  s_add_u32 s26, s26, s40
  s_lshl_b32 s28, s23, 2
  s_lshl_b32 s29, s24, 1
  s_add_u32 s28, s28, s29
  s_add_u32 s28, s28, s22
  s_lshl_b32 s28, s28, 13
  s_add_u32 s28, s28, 18579456
  s_add_u32 s29, s28, 4096
  s_lshl_b32 s30, s21, 4
  v_add_u32 v28, s30, v2
  v_lshl_add_u32 v29, v3, 6, v28
  v_lshlrev_b32 v29, 4, v29
  s_getpc_b64 s[12:13]
  s_add_u32 s12, s12, tabs@rel32@lo+4
  s_addc_u32 s13, s13, tabs@rel32@hi+12
  s_mov_b32 s14, 102160
  s_mov_b32 s15, 0x20000
  v_lshlrev_b32 v4, 4, v1
  s_lshl_b32 s36, s21, 13
  s_add_u32 s36, s36, 69392
  s_add_u32 s37, s36, 4096
  s_waitcnt lgkmcnt(0)
  buffer_load_dwordx2 v[8:9], v6, s[4:7], s26 offen offset:0
  buffer_load_dwordx2 v[10:11], v6, s[4:7], s26 offen offset:512
  buffer_load_dwordx2 v[12:13], v6, s[4:7], s26 offen offset:1024
  buffer_load_dwordx2 v[14:15], v6, s[4:7], s26 offen offset:1536
  buffer_load_dword v16, v7, s[4:7], s42 offen offset:0
  buffer_load_dword v17, v7, s[4:7], s42 offen offset:128
  buffer_load_dword v18, v7, s[4:7], s42 offen offset:256
  buffer_load_dword v19, v7, s[4:7], s42 offen offset:384
  v_cvt_f32_u32 v30, v28
  v_mul_f32 v30, 0x3c800000, v30
  v_cvt_f32_u32 v31, v3
  v_mul_f32 v31, 4.0, v31
  v_mul_f32 v184, v31, v30
  v_fmamk_f32 v185, v30, 0x3f800000, v184
  v_fmamk_f32 v186, v30, 0x40000000, v184
  v_fmamk_f32 v187, v30, 0x40400000, v184
  v_cos_f32 v188, v184
  v_sin_f32 v184, v184
  v_cos_f32 v189, v185
  buffer_load_dwordx4 v[96:99], v4, s[12:15], s36 offen offset:0
  v_sin_f32 v185, v185
  v_cos_f32 v190, v186
  v_sin_f32 v186, v186
  v_cos_f32 v191, v187
  v_sin_f32 v187, v187
  s_mov_b32 s32, 0x80008000
  v_and_b32 v192, 1, v2
  v_cmp_ne_u32 s[38:39], 0, v192
  v_mul_lo_u32 v192, v192, s32
  v_bfe_u32 v194, v2, 1, 1
  v_mul_lo_u32 v194, v194, s32
  buffer_load_dwordx4 v[100:103], v4, s[12:15], s36 offen offset:1024
  v_xor_b32 v195, v194, v192
  v_xor_b32 v193, s32, v192
  v_cvt_pk_bf16_f32 v32, v188, v184
  v_cvt_pk_bf16_f32 v48, -v184, v188
  v_cvt_pk_bf16_f32 v33, v189, v185
  v_cvt_pk_bf16_f32 v49, -v185, v189
  v_cvt_pk_bf16_f32 v34, v190, v186
  v_cvt_pk_bf16_f32 v50, -v186, v190
  v_cvt_pk_bf16_f32 v35, v191, v187
  v_cvt_pk_bf16_f32 v51, -v187, v191
  v_cndmask_b32 v36, v32, v48, s[38:39]
  buffer_load_dwordx4 v[104:107], v4, s[12:15], s36 offen offset:2048
  v_cndmask_b32 v52, v48, v32, s[38:39]
  v_xor_b32 v40, v32, v192
  v_xor_b32 v56, v48, v192
  v_cndmask_b32 v37, v33, v49, s[38:39]
  v_cndmask_b32 v53, v49, v33, s[38:39]
  v_xor_b32 v41, v33, v192
  v_xor_b32 v57, v49, v192
  v_cndmask_b32 v38, v34, v50, s[38:39]
  v_cndmask_b32 v54, v50, v34, s[38:39]
  v_xor_b32 v42, v34, v192
  v_xor_b32 v58, v50, v192
  buffer_load_dwordx4 v[108:111], v4, s[12:15], s36 offen offset:3072
  v_cndmask_b32 v39, v35, v51, s[38:39]
  v_cndmask_b32 v55, v51, v35, s[38:39]
  v_xor_b32 v43, v35, v192
  v_xor_b32 v59, v51, v192
  v_xor_b32 v44, v36, v195
  v_xor_b32 v60, v52, v194
  v_xor_b32 v36, v36, v194
  v_xor_b32 v52, v52, v195
  v_xor_b32 v45, v37, v195
  v_xor_b32 v61, v53, v194
  v_xor_b32 v37, v37, v194
  buffer_load_dwordx4 v[20:23], v29, s[4:7], s28 offen
  v_xor_b32 v53, v53, v195
  v_xor_b32 v46, v38, v195
  v_xor_b32 v62, v54, v194
  v_xor_b32 v38, v38, v194
  v_xor_b32 v54, v54, v195
  v_xor_b32 v47, v39, v195
  v_xor_b32 v63, v55, v194
  v_xor_b32 v39, v39, v194
  v_xor_b32 v55, v55, v195
  v_cvt_f32_u32 v30, v2
  v_mul_f32 v30, 0x3d000000, v30
  buffer_load_dwordx4 v[24:27], v29, s[4:7], s29 offen
  v_mul_f32 v184, v31, v30
  v_fmamk_f32 v185, v30, 0x3f800000, v184
  v_fmamk_f32 v186, v30, 0x40000000, v184
  v_fmamk_f32 v187, v30, 0x40400000, v184
  v_cos_f32 v188, v184
  v_sin_f32 v184, v184
  v_cos_f32 v189, v185
  v_sin_f32 v185, v185
  v_cos_f32 v190, v186
  v_sin_f32 v186, v186
  v_cos_f32 v191, v187
  buffer_load_dwordx4 v[112:115], v4, s[12:15], s37 offen offset:0
  v_sin_f32 v187, v187
  s_lshl_b32 s33, s20, 10
  v_add_u32 v5, s33, v4
  s_lshl_b32 s33, s22, 13
  v_add_u32 v31, s33, v4
  s_lshl_b32 s34, s21, 10
  s_add_u32 s34, s34, s33
  v_add_u32 v28, s34, v4
  s_lshl_b32 s33, s22, 12
  v_add_u32 v1, s33, v4
  v_cvt_pk_bf16_f32 v64, v188, v184
  buffer_load_dwordx4 v[116:119], v4, s[12:15], s37 offen offset:1024
  v_cvt_pk_bf16_f32 v80, -v184, v188
  v_cvt_pk_bf16_f32 v65, v189, v185
  v_cvt_pk_bf16_f32 v81, -v185, v189
  v_cvt_pk_bf16_f32 v66, v190, v186
  v_cvt_pk_bf16_f32 v82, -v186, v190
  v_cvt_pk_bf16_f32 v67, v191, v187
  v_cvt_pk_bf16_f32 v83, -v187, v191
  v_xor_b32 v68, v64, v192
  v_mov_b32 v72, v64
  v_xor_b32 v76, v64, v192
  v_xor_b32 v84, v80, v192
  buffer_load_dwordx4 v[120:123], v4, s[12:15], s37 offen offset:2048
  v_mov_b32 v88, v80
  v_xor_b32 v92, v80, v192
  v_xor_b32 v69, v65, v192
  v_xor_b32 v73, s32, v65
  v_xor_b32 v77, v65, v193
  v_xor_b32 v85, v81, v192
  v_xor_b32 v89, s32, v81
  v_xor_b32 v93, v81, v193
  v_xor_b32 v70, v66, v192
  v_mov_b32 v74, v66
  v_xor_b32 v78, v66, v192
  buffer_load_dwordx4 v[124:127], v4, s[12:15], s37 offen offset:3072
  v_xor_b32 v86, v82, v192
  v_mov_b32 v90, v82
  v_xor_b32 v94, v82, v192
  v_xor_b32 v71, v67, v192
  v_xor_b32 v75, s32, v67
  v_xor_b32 v79, v67, v193
  v_xor_b32 v87, v83, v192
  v_xor_b32 v91, s32, v83
  v_xor_b32 v95, v83, v193
  s_cmp_eq_u32 s2, 0
  s_cselect_b32 s31, 0xffff, -1
  s_mov_b32 s35, 0x45cccccd
  v_mov_b32 v30, 0x4227c5ac
  s_waitcnt vmcnt(13)
  v_fma_f32 v16, v16, s35, v30
  s_waitcnt vmcnt(12)
  v_fma_f32 v17, v17, s35, v30
  s_waitcnt vmcnt(11)
  v_fma_f32 v18, v18, s35, v30
  s_waitcnt vmcnt(10)
  v_fma_f32 v19, v19, s35, v30
  v_rsq_f32 v16, v16
  v_rsq_f32 v17, v17
  v_rsq_f32 v18, v18
  v_rsq_f32 v19, v19
  v_lshlrev_b32 v128, 16, v8
  v_and_b32 v132, 0xffff0000, v8
  v_lshlrev_b32 v129, 16, v10
  v_and_b32 v133, 0xffff0000, v10
  v_lshlrev_b32 v130, 16, v12
  v_and_b32 v134, 0xffff0000, v12
  v_lshlrev_b32 v131, 16, v14
  v_and_b32 v135, 0xffff0000, v14
  v_pk_mul_f32 v[184:185], v[128:129], v[16:17]
  v_pk_mul_f32 v[188:189], v[132:133], v[16:17]
  v_pk_mul_f32 v[186:187], v[130:131], v[18:19]
  v_pk_mul_f32 v[190:191], v[134:135], v[18:19]
  v_cvt_pk_bf16_f32 v176, v184, v188
  v_and_b32 v176, s31, v176
  v_cvt_pk_bf16_f32 v177, v185, v189
  v_and_b32 v177, s31, v177
  v_cvt_pk_bf16_f32 v178, v186, v190
  v_and_b32 v178, s31, v178
  v_cvt_pk_bf16_f32 v179, v187, v191
  v_and_b32 v179, s31, v179
  ds_write_b128 v5, v[176:179] offset:0
  v_lshlrev_b32 v136, 16, v9
  v_and_b32 v140, 0xffff0000, v9
  v_lshlrev_b32 v137, 16, v11
  v_and_b32 v141, 0xffff0000, v11
  v_lshlrev_b32 v138, 16, v13
  v_and_b32 v142, 0xffff0000, v13
  v_lshlrev_b32 v139, 16, v15
  v_and_b32 v143, 0xffff0000, v15
  v_pk_mul_f32 v[184:185], v[136:137], v[16:17]
  v_pk_mul_f32 v[188:189], v[140:141], v[16:17]
  v_pk_mul_f32 v[186:187], v[138:139], v[18:19]
  v_pk_mul_f32 v[190:191], v[142:143], v[18:19]
  v_cvt_pk_bf16_f32 v180, v184, v188
  v_cvt_pk_bf16_f32 v181, v185, v189
  v_cvt_pk_bf16_f32 v182, v186, v190
  v_cvt_pk_bf16_f32 v183, v187, v191
  ds_write_b128 v5, v[180:183] offset:8192
  s_waitcnt lgkmcnt(0)
  s_barrier
  ds_read_b128 a[0:3], v31 offset:0
  ds_read_b128 a[4:7], v31 offset:1024
  ds_read_b128 a[8:11], v31 offset:2048
  ds_read_b128 a[12:15], v31 offset:3072
  ds_read_b128 a[16:19], v31 offset:4096
  ds_read_b128 a[20:23], v31 offset:5120
  ds_read_b128 a[24:27], v31 offset:6144
  ds_read_b128 a[28:31], v31 offset:7168
  s_waitcnt lgkmcnt(7)
  v_mfma_f32_16x16x32_bf16 v[144:147], a[0:3], v[32:35], 0
  v_mfma_f32_16x16x32_bf16 v[152:155], a[0:3], v[48:51], 0
  s_waitcnt lgkmcnt(6)
  v_mfma_f32_16x16x32_bf16 v[144:147], a[4:7], v[36:39], v[144:147]
  v_mfma_f32_16x16x32_bf16 v[152:155], a[4:7], v[52:55], v[152:155]
  s_waitcnt lgkmcnt(5)
  v_mfma_f32_16x16x32_bf16 v[144:147], a[8:11], v[40:43], v[144:147]
  v_mfma_f32_16x16x32_bf16 v[152:155], a[8:11], v[56:59], v[152:155]
  s_waitcnt lgkmcnt(4)
  v_mfma_f32_16x16x32_bf16 v[144:147], a[12:15], v[44:47], v[144:147]
  v_mfma_f32_16x16x32_bf16 v[152:155], a[12:15], v[60:63], v[152:155]
  s_waitcnt lgkmcnt(3)
  v_mfma_f32_16x16x32_bf16 v[148:151], a[16:19], v[32:35], 0
  s_waitcnt vmcnt(5)
  v_lshlrev_b32 v200, 16, v20
  v_and_b32 v208, 0xffff0000, v20
  v_lshlrev_b32 v201, 16, v21
  v_and_b32 v209, 0xffff0000, v21
  v_lshlrev_b32 v202, 16, v22
  v_mfma_f32_16x16x32_bf16 v[156:159], a[16:19], v[48:51], 0
  v_and_b32 v210, 0xffff0000, v22
  v_lshlrev_b32 v203, 16, v23
  v_and_b32 v211, 0xffff0000, v23
  s_waitcnt vmcnt(4)
  v_lshlrev_b32 v204, 16, v24
  v_and_b32 v212, 0xffff0000, v24
  s_waitcnt lgkmcnt(2)
  v_mfma_f32_16x16x32_bf16 v[148:151], a[20:23], v[36:39], v[148:151]
  v_lshlrev_b32 v205, 16, v25
  v_and_b32 v213, 0xffff0000, v25
  v_lshlrev_b32 v206, 16, v26
  v_and_b32 v214, 0xffff0000, v26
  v_lshlrev_b32 v207, 16, v27
  v_and_b32 v215, 0xffff0000, v27
  v_mfma_f32_16x16x32_bf16 v[156:159], a[20:23], v[52:55], v[156:159]
  v_mul_f32 v184, v144, v96
  v_mul_f32 v188, v152, v96
  v_mul_f32 v185, v145, v97
  v_mul_f32 v189, v153, v97
  s_waitcnt lgkmcnt(1)
  v_mfma_f32_16x16x32_bf16 v[148:151], a[24:27], v[40:43], v[148:151]
  v_mul_f32 v186, v146, v98
  v_mul_f32 v190, v154, v98
  v_mul_f32 v187, v147, v99
  v_mul_f32 v191, v155, v99
  v_mfma_f32_16x16x32_bf16 v[156:159], a[24:27], v[56:59], v[156:159]
  v_fma_f32 v184, v152, v100, v184
  v_fma_f32 v188, -v144, v100, v188
  v_fma_f32 v185, v153, v101, v185
  v_fma_f32 v189, -v145, v101, v189
  s_waitcnt lgkmcnt(0)
  v_mfma_f32_16x16x32_bf16 v[148:151], a[28:31], v[44:47], v[148:151]
  v_fma_f32 v186, v154, v102, v186
  v_fma_f32 v190, -v146, v102, v190
  v_fma_f32 v187, v155, v103, v187
  v_fma_f32 v191, -v147, v103, v191
  v_mfma_f32_16x16x32_bf16 v[156:159], a[28:31], v[60:63], v[156:159]
  v_cvt_pk_bf16_f32 v176, v184, v188
  v_cvt_pk_bf16_f32 v177, v185, v189
  v_cvt_pk_bf16_f32 v178, v186, v190
  v_cvt_pk_bf16_f32 v179, v187, v191
  s_nop 1
  v_mfma_f32_16x16x32_bf16 v[160:163], v[64:67], v[176:179], 0
  v_mul_f32 v20, v148, v104
  v_mul_f32 v24, v156, v104
  v_mul_f32 v21, v149, v105
  v_mul_f32 v25, v157, v105
  v_mul_f32 v22, v150, v106
  v_mfma_f32_16x16x32_bf16 v[168:171], v[80:83], v[176:179], 0
  v_mul_f32 v26, v158, v106
  v_mul_f32 v23, v151, v107
  v_mul_f32 v27, v159, v107
  v_fma_f32 v20, v156, v108, v20
  v_fma_f32 v24, -v148, v108, v24
  v_mfma_f32_16x16x32_bf16 v[164:167], v[72:75], v[176:179], 0
  v_fma_f32 v21, v157, v109, v21
  v_fma_f32 v25, -v149, v109, v25
  v_fma_f32 v22, v158, v110, v22
  v_fma_f32 v26, -v150, v110, v26
  v_fma_f32 v23, v159, v111, v23
  v_mfma_f32_16x16x32_bf16 v[172:175], v[88:91], v[176:179], 0
  v_fma_f32 v27, -v151, v111, v27
  v_cvt_pk_bf16_f32 v180, v20, v24
  v_cvt_pk_bf16_f32 v181, v21, v25
  v_cvt_pk_bf16_f32 v182, v22, v26
  v_cvt_pk_bf16_f32 v183, v23, v27
  s_nop 1
  v_mfma_f32_16x16x32_bf16 v[160:163], v[68:71], v[180:183], v[160:163]
  v_mfma_f32_16x16x32_bf16 v[168:171], v[84:87], v[180:183], v[168:171]
  v_mfma_f32_16x16x32_bf16 v[164:167], v[76:79], v[180:183], v[164:167]
  v_mfma_f32_16x16x32_bf16 v[172:175], v[92:95], v[180:183], v[172:175]
  s_nop 4
  v_mul_f32 v184, v160, v200
  v_mul_f32 v188, v168, v200
  v_mul_f32 v185, v161, v201
  v_mul_f32 v189, v169, v201
  v_mul_f32 v186, v162, v202
  v_mul_f32 v190, v170, v202
  v_mul_f32 v187, v163, v203
  v_mul_f32 v191, v171, v203
  v_fma_f32 v184, -v168, v208, v184
  v_fma_f32 v188, v160, v208, v188
  v_fma_f32 v185, -v169, v209, v185
  v_fma_f32 v189, v161, v209, v189
  v_fma_f32 v186, -v170, v210, v186
  v_fma_f32 v190, v162, v210, v190
  v_fma_f32 v187, -v171, v211, v187
  v_fma_f32 v191, v163, v211, v191
  v_cvt_pk_bf16_f32 v192, v188, v184
  v_cvt_pk_bf16_f32 v193, v189, v185
  v_cvt_pk_bf16_f32 v194, v190, v186
  v_cvt_pk_bf16_f32 v195, v191, v187
  s_nop 1
  v_mfma_f32_16x16x32_bf16 v[144:147], v[192:195], v[80:83], 0
  v_mul_f32 v20, v164, v204
  v_mul_f32 v24, v172, v204
  v_mul_f32 v21, v165, v205
  v_mul_f32 v25, v173, v205
  v_mul_f32 v22, v166, v206
  v_mfma_f32_16x16x32_bf16 v[152:155], v[192:195], v[64:67], 0
  v_mul_f32 v26, v174, v206
  v_mul_f32 v23, v167, v207
  v_mul_f32 v27, v175, v207
  v_fma_f32 v20, -v172, v212, v20
  v_fma_f32 v24, v164, v212, v24
  v_mfma_f32_16x16x32_bf16 v[148:151], v[192:195], v[88:91], 0
  v_fma_f32 v21, -v173, v213, v21
  v_fma_f32 v25, v165, v213, v25
  v_fma_f32 v22, -v174, v214, v22
  v_fma_f32 v26, v166, v214, v26
  v_fma_f32 v23, -v175, v215, v23
  v_mfma_f32_16x16x32_bf16 v[156:159], v[192:195], v[72:75], 0
  v_fma_f32 v27, v167, v215, v27
  v_cvt_pk_bf16_f32 v196, v24, v20
  v_cvt_pk_bf16_f32 v197, v25, v21
  v_cvt_pk_bf16_f32 v198, v26, v22
  v_cvt_pk_bf16_f32 v199, v27, v23
  s_nop 1
  v_mfma_f32_16x16x32_bf16 v[144:147], v[196:199], v[84:87], v[144:147]
  v_mfma_f32_16x16x32_bf16 v[152:155], v[196:199], v[68:71], v[152:155]
  v_mfma_f32_16x16x32_bf16 v[148:151], v[196:199], v[92:95], v[148:151]
  v_mfma_f32_16x16x32_bf16 v[156:159], v[196:199], v[76:79], v[156:159]
  s_waitcnt vmcnt(3)
  s_nop 3
  v_mul_f32 v184, v144, v112
  v_mul_f32 v188, v152, v112
  v_mul_f32 v185, v145, v113
  v_mul_f32 v189, v153, v113
  v_mul_f32 v186, v146, v114
  v_mul_f32 v190, v154, v114
  v_mul_f32 v187, v147, v115
  v_mul_f32 v191, v155, v115
  s_waitcnt vmcnt(2)
  v_fma_f32 v184, -v152, v116, v184
  v_fma_f32 v188, v144, v116, v188
  v_fma_f32 v185, -v153, v117, v185
  v_fma_f32 v189, v145, v117, v189
  v_fma_f32 v186, -v154, v118, v186
  v_fma_f32 v190, v146, v118, v190
  v_fma_f32 v187, -v155, v119, v187
  v_fma_f32 v191, v147, v119, v191
  v_cvt_pk_bf16_f32 v176, v188, v184
  v_cvt_pk_bf16_f32 v177, v189, v185
  v_cvt_pk_bf16_f32 v178, v190, v186
  v_cvt_pk_bf16_f32 v179, v191, v187
  ds_write_b128 v28, v[176:179] offset:16384
  s_waitcnt vmcnt(1)
  v_mul_f32 v20, v148, v120
  v_mul_f32 v24, v156, v120
  v_mul_f32 v21, v149, v121
  v_mul_f32 v25, v157, v121
  v_mul_f32 v22, v150, v122
  v_mul_f32 v26, v158, v122
  v_mul_f32 v23, v151, v123
  v_mul_f32 v27, v159, v123
  s_waitcnt vmcnt(0)
  v_fma_f32 v20, -v156, v124, v20
  v_fma_f32 v24, v148, v124, v24
  v_fma_f32 v21, -v157, v125, v21
  v_fma_f32 v25, v149, v125, v25
  v_fma_f32 v22, -v158, v126, v22
  v_fma_f32 v26, v150, v126, v26
  v_fma_f32 v23, -v159, v127, v23
  v_fma_f32 v27, v151, v127, v27
  v_cvt_pk_bf16_f32 v180, v24, v20
  v_cvt_pk_bf16_f32 v181, v25, v21
  v_cvt_pk_bf16_f32 v182, v26, v22
  v_cvt_pk_bf16_f32 v183, v27, v23
  ds_write_b128 v28, v[180:183] offset:20480
  s_waitcnt lgkmcnt(0)
  s_barrier
  ds_read_b128 a[0:3], v1 offset:16384
  ds_read_b128 a[16:19], v1 offset:24576
  ds_read_b128 a[4:7], v1 offset:17408
  ds_read_b128 a[20:23], v1 offset:25600
  ds_read_b128 a[8:11], v1 offset:18432
  ds_read_b128 a[24:27], v1 offset:26624
  ds_read_b128 a[12:15], v1 offset:19456
  ds_read_b128 a[28:31], v1 offset:27648
  s_waitcnt lgkmcnt(7)
  v_mfma_f32_16x16x32_bf16 v[128:131], v[48:51], a[0:3], v[128:131]
  v_mfma_f32_16x16x32_bf16 v[132:135], v[32:35], a[0:3], v[132:135]
  s_waitcnt lgkmcnt(6)
  v_mfma_f32_16x16x32_bf16 v[136:139], v[48:51], a[16:19], v[136:139]
  v_mfma_f32_16x16x32_bf16 v[140:143], v[32:35], a[16:19], v[140:143]
  s_waitcnt lgkmcnt(5)
  v_mfma_f32_16x16x32_bf16 v[128:131], v[52:55], a[4:7], v[128:131]
  v_mfma_f32_16x16x32_bf16 v[132:135], v[36:39], a[4:7], v[132:135]
  s_waitcnt lgkmcnt(4)
  v_mfma_f32_16x16x32_bf16 v[136:139], v[52:55], a[20:23], v[136:139]
  v_mfma_f32_16x16x32_bf16 v[140:143], v[36:39], a[20:23], v[140:143]
  s_waitcnt lgkmcnt(3)
  v_mfma_f32_16x16x32_bf16 v[128:131], v[56:59], a[8:11], v[128:131]
  v_mfma_f32_16x16x32_bf16 v[132:135], v[40:43], a[8:11], v[132:135]
  s_waitcnt lgkmcnt(2)
  v_mfma_f32_16x16x32_bf16 v[136:139], v[56:59], a[24:27], v[136:139]
  v_mfma_f32_16x16x32_bf16 v[140:143], v[40:43], a[24:27], v[140:143]
  s_waitcnt lgkmcnt(1)
  v_mfma_f32_16x16x32_bf16 v[128:131], v[60:63], a[12:15], v[128:131]
  v_mfma_f32_16x16x32_bf16 v[132:135], v[44:47], a[12:15], v[132:135]
  s_waitcnt lgkmcnt(0)
  v_mfma_f32_16x16x32_bf16 v[136:139], v[60:63], a[28:31], v[136:139]
  v_mfma_f32_16x16x32_bf16 v[140:143], v[44:47], a[28:31], v[140:143]
  s_nop 4
  v_cvt_pk_bf16_f32 v176, v128, v132
  s_nop 1
  v_cvt_pk_bf16_f32 v177, v136, v140
  v_bfi_b32 v176, s31, v176, v8
  buffer_store_dwordx2 v[176:177], v6, s[4:7], s27 offen offset:0
  v_cvt_pk_bf16_f32 v178, v129, v133
  v_cvt_pk_bf16_f32 v179, v137, v141
  v_bfi_b32 v178, s31, v178, v10
  buffer_store_dwordx2 v[178:179], v6, s[4:7], s27 offen offset:512
  v_cvt_pk_bf16_f32 v180, v130, v134
  v_cvt_pk_bf16_f32 v181, v138, v142
  v_bfi_b32 v180, s31, v180, v12
  buffer_store_dwordx2 v[180:181], v6, s[4:7], s27 offen offset:1024
  v_cvt_pk_bf16_f32 v182, v131, v135
  v_cvt_pk_bf16_f32 v183, v139, v143
  v_bfi_b32 v182, s31, v182, v14
  buffer_store_dwordx2 v[182:183], v6, s[4:7], s27 offen offset:1536
  s_endpgm
k2_i:
  s_load_dwordx2 s[8:9], s[0:1], 32
  s_mov_b32 s10, 2457600
  s_mov_b32 s11, 0x20000
  s_sub_u32 s23, s2, 160
  s_mov_b32 s24, 4
  s_mov_b32 s36, 825368624
  s_mov_b32 s37, 1966498868
  s_mov_b32 s44, 255
  s_branch k2_t
k2_b:
  s_load_dwordx2 s[8:9], s[0:1], 32
  s_mov_b32 s10, 2457600
  s_mov_b32 s11, 0x20000
  s_and_b32 s23, s2, 1
  s_lshl_b32 s23, s23, 3
  s_and_b32 s24, s2, 6
  s_add_u32 s23, s23, s24
  s_sub_u32 s25, s2, 160
  s_lshr_b32 s24, s25, 5
  s_add_u32 s23, s23, s24
  s_bfe_u32 s24, s25, 0x20003
  s_mov_b32 s36, 840044560
  s_mov_b32 s37, 1981174804
  s_cmp_eq_u32 s24, 1
  s_cselect_b32 s36, 270038532, s36
  s_cselect_b32 s37, 1411527200, s37
  s_cmp_eq_u32 s24, 2
  s_cselect_b32 s36, 807670328, s36
  s_cselect_b32 s37, 1982354470, s37
  s_cselect_b32 s44, 6, 0
  s_cmp_eq_u32 s24, 3
  s_cselect_b32 s36, 822222848, s36
  s_cselect_b32 s37, 1963484166, s37
k2_t:
  s_getpc_b64 s[12:13]
  s_add_u32 s12, s12, tabs@rel32@lo+4
  s_addc_u32 s13, s13, tabs@rel32@hi+12
  s_mov_b32 s14, 102160
  s_mov_b32 s15, 0x20000
  v_and_b32 v1, 63, v0
  v_lshrrev_b32 v2, 6, v0
  s_nop 0
  v_readfirstlane_b32 s21, v2
  v_lshlrev_b32 v7, 4, v1
  s_mul_i32 s30, s21, 6144
  s_add_u32 m0, s30, 83200
  s_nop 0
  buffer_load_dwordx4 v7, s[12:15], s30 offen offset:0 lds
  buffer_load_dwordx4 v7, s[12:15], s30 offen offset:1024 lds
  buffer_load_dwordx4 v7, s[12:15], s30 offen offset:2048 lds
  buffer_load_dwordx4 v7, s[12:15], s30 offen offset:3072 lds
  s_add_u32 s30, s30, 4096
  s_add_u32 m0, s30, 83200
  s_nop 0
  buffer_load_dwordx4 v7, s[12:15], s30 offen offset:0 lds
  buffer_load_dwordx4 v7, s[12:15], s30 offen offset:1024 lds
  v_lshrrev_b32 v3, 2, v0
  v_and_b32 v4, 3, v0
  v_lshlrev_b32 v5, 4, v4
  v_lshrrev_b64 v[16:17], v5, s[36:37]
  v_bfe_u32 v18, v16, 4, 2
  v_and_b32 v19, 15, v16
  v_mul_u32_u24 v20, 1280, v18
  v_lshl_add_u32 v20, v19, 3, v20
  v_mul_u32_u24 v21, 3840, v3
  v_add_u32 v20, v20, v21
  v_cmp_eq_u32 vcc, 3, v18
  v_mov_b32 v21, 0x40000000
  s_nop 0
  v_cndmask_b32 v20, v20, v21, vcc
  s_mov_b64 s[38:39], vcc
  s_mul_i32 s25, s23, 80
  s_waitcnt lgkmcnt(0)
  buffer_load_dwordx4 v[140:143], v20, s[8:11], s25 offen
  s_add_u32 s25, s25, 491520
  buffer_load_dwordx4 v[144:147], v20, s[8:11], s25 offen
  s_add_u32 s25, s25, 491520
  buffer_load_dwordx4 v[148:151], v20, s[8:11], s25 offen
  s_add_u32 s25, s25, 491520
  buffer_load_dwordx4 v[152:155], v20, s[8:11], s25 offen
  s_add_u32 s25, s25, 491520
  buffer_load_dwordx4 v[156:159], v20, s[8:11], s25 offen
  s_and_b32 s20, s21, 3
  s_lshr_b32 s22, s21, 2
  v_lshrrev_b32 v6, 4, v3
  v_lshlrev_b32 v6, 5, v6
  v_lshl_add_u32 v6, v3, 6, v6
  v_bfe_u32 v5, v16, 12, 3
  v_lshl_add_u32 v5, v5, 3, v6
  v_bfe_u32 v17, v16, 8, 3
  v_lshl_add_u32 v6, v17, 3, v6
  s_mul_i32 s25, s23, 40
  v_lshl_add_u32 v19, v19, 2, s25
  v_and_b32 v21, 127, v19
  v_sub_u32 v21, v3, v21
  v_cmp_gt_u32 vcc, 8, v21
  s_nop 0
  s_and_b64 s[38:39], s[38:39], vcc
  v_cmp_gt_u32 vcc, 4, v21
  s_nop 1
  v_cndmask_b32 v22, v5, v6, vcc
  v_and_b32 v21, 3, v21
  v_lshl_add_u32 v22, v21, 1, v22
  v_lshrrev_b32 v19, 7, v19
  v_mul_u32_u24 v19, 8448, v19
  v_add_u32 v19, v19, v22
  v_mov_b32 v22, 0x3f80
  v_and_b32 v15, 15, v0
  v_lshrrev_b32 v8, 4, v1
  v_and_b32 v4, 3, v0
  v_bfe_u32 v9, v0, 2, 2
  s_lshl_b32 s26, s22, 2
  s_lshr_b32 s26, s44, s26
  v_lshrrev_b32 v24, v9, s26
  v_and_b32 v24, 1, v24
  v_cmp_eq_u32 s[40:41], 0, v24
  s_cmp_eq_u32 s20, 0
  s_cselect_b64 s[42:43], 0xffff, 0
  s_and_b64 s[40:41], s[40:41], s[42:43]
  v_lshl_add_u32 v10, v8, 2, v9
  v_mul_u32_u24 v10, 1056, v10
  v_lshl_add_u32 v10, v4, 3, v10
  s_lshl_b32 s26, s20, 8
  s_lshl_b32 s27, s22, 5
  s_add_u32 s26, s26, s27
  v_add_u32 v10, s26, v10
  v_and_b32 v9, 1, v9
  v_lshl_add_u32 v11, v8, 1, v9
  v_mul_u32_u24 v11, 1056, v11
  v_lshl_add_u32 v11, v4, 3, v11
  s_add_u32 s26, s26, 33792
  v_add_u32 v11, s26, v11
  s_mul_i32 s27, s22, 20480
  s_add_u32 s27, s27, 42240
  v_mul_u32_u24 v12, 5120, v8
  v_lshl_add_u32 v12, v15, 4, v12
  s_lshl_b32 s26, s20, 8
  s_add_u32 s26, s26, s27
  v_add_u32 v12, s26, v12
  s_mul_i32 s26, s20, 5120
  s_add_u32 s26, s26, s27
  v_add_u32 v13, s26, v7
  v_lshrrev_b32 v9, 1, v8
  v_mul_u32_u24 v9, 5120, v9
  v_and_b32 v14, 1, v8
  v_lshl_add_u32 v9, v14, 9, v9
  v_lshl_add_u32 v14, v15, 4, v9
  s_mul_i32 s25, s23, 204800
  s_lshl_b32 s24, s24, 10
  s_add_u32 s24, s24, s25
  s_lshl_b32 s25, s22, 8
  s_add_u32 s24, s24, s25
  s_mul_i32 s25, s20, 51200
  s_add_u32 s24, s24, s25
  s_add_u32 s24, s24, 21200896
  v_mov_b32 v38, 0
  v_mov_b32 v58, 0
  v_mov_b32 v59, 0
  v_mov_b32 v62, 0
  v_mov_b32 v63, 0
  v_mov_b32 v66, 0
  v_mov_b32 v67, 0
  v_mov_b32 v70, 0
  v_mov_b32 v71, 0
  s_waitcnt vmcnt(4)
  ds_write_b64 v6, v[140:141] offset:0
  ds_write_b64 v5, v[142:143] offset:0
  s_waitcnt vmcnt(3)
  ds_write_b64 v6, v[144:145] offset:8448
  ds_write_b64 v5, v[146:147] offset:8448
  s_waitcnt vmcnt(2)
  ds_write_b64 v6, v[148:149] offset:16896
  ds_write_b64 v5, v[150:151] offset:16896
  s_waitcnt vmcnt(1)
  ds_write_b64 v6, v[152:153] offset:25344
  ds_write_b64 v5, v[154:155] offset:25344
  s_waitcnt vmcnt(0)
  ds_write_b64 v6, v[156:157] offset:33792
  ds_write_b64 v5, v[158:159] offset:33792
  s_mov_b64 exec, s[38:39]
  ds_write_b16 v19, v22
  s_mov_b64 exec, -1
  s_waitcnt vmcnt(0) lgkmcnt(0)
  s_barrier
  v_add_u32 v36, 83200, v7
  s_mul_i32 s30, s20, 10240
  s_add_u32 s30, s30, 6144
  v_add_u32 v37, s30, v36
  ds_read_b128 a[0:3], v36 offset:0
  ds_read_b128 a[4:7], v36 offset:1024
  ds_read_b128 a[8:11], v36 offset:2048
  ds_read_b128 a[12:15], v36 offset:3072
  ds_read_b128 a[16:19], v36 offset:4096
  ds_read_b128 a[20:23], v36 offset:5120
  ds_read_b64_tr_b16 v[40:41], v10 offset:0
  ds_read_b64_tr_b16 v[42:43], v10 offset:16896
  ds_read_b64_tr_b16 v[56:57], v11 offset:0
  ds_read_b64_tr_b16 v[44:45], v10 offset:64
  ds_read_b64_tr_b16 v[46:47], v10 offset:16960
  ds_read_b64_tr_b16 v[60:61], v11 offset:64
  ds_read_b64_tr_b16 v[48:49], v10 offset:128
  ds_read_b64_tr_b16 v[50:51], v10 offset:17024
  ds_read_b64_tr_b16 v[64:65], v11 offset:128
  ds_read_b64_tr_b16 v[52:53], v10 offset:192
  ds_read_b64_tr_b16 v[54:55], v10 offset:17088
  ds_read_b64_tr_b16 v[68:69], v11 offset:192
  s_waitcnt lgkmcnt(10)
  v_mfma_f32_16x16x32_bf16 v[72:75], a[0:3], v[40:43], 0
  v_mfma_f32_16x16x32_bf16 v[76:79], a[8:11], v[40:43], 0
  v_mfma_f32_16x16x32_bf16 v[80:83], a[16:19], v[40:43], 0
  s_waitcnt lgkmcnt(7)
  v_mfma_f32_16x16x32_bf16 v[84:87], a[0:3], v[44:47], 0
  v_mfma_f32_16x16x32_bf16 v[88:91], a[8:11], v[44:47], 0
  v_mfma_f32_16x16x32_bf16 v[92:95], a[16:19], v[44:47], 0
  s_waitcnt lgkmcnt(4)
  v_mfma_f32_16x16x32_bf16 v[96:99], a[0:3], v[48:51], 0
  v_mfma_f32_16x16x32_bf16 v[100:103], a[8:11], v[48:51], 0
  v_mfma_f32_16x16x32_bf16 v[104:107], a[16:19], v[48:51], 0
  s_waitcnt lgkmcnt(1)
  v_mfma_f32_16x16x32_bf16 v[108:111], a[0:3], v[52:55], 0
  v_mfma_f32_16x16x32_bf16 v[112:115], a[8:11], v[52:55], 0
  v_mfma_f32_16x16x32_bf16 v[116:119], a[16:19], v[52:55], 0
  v_mfma_f32_16x16x32_bf16 v[72:75], a[4:7], v[56:59], v[72:75]
  v_mfma_f32_16x16x32_bf16 v[76:79], a[12:15], v[56:59], v[76:79]
  v_mfma_f32_16x16x32_bf16 v[80:83], a[20:23], v[56:59], v[80:83]
  v_mfma_f32_16x16x32_bf16 v[84:87], a[4:7], v[60:63], v[84:87]
  v_mfma_f32_16x16x32_bf16 v[88:91], a[12:15], v[60:63], v[88:91]
  v_mfma_f32_16x16x32_bf16 v[92:95], a[20:23], v[60:63], v[92:95]
  v_mfma_f32_16x16x32_bf16 v[96:99], a[4:7], v[64:67], v[96:99]
  v_mfma_f32_16x16x32_bf16 v[100:103], a[12:15], v[64:67], v[100:103]
  v_mfma_f32_16x16x32_bf16 v[104:107], a[20:23], v[64:67], v[104:107]
  s_waitcnt lgkmcnt(0)
  v_mfma_f32_16x16x32_bf16 v[108:111], a[4:7], v[68:71], v[108:111]
  v_mfma_f32_16x16x32_bf16 v[112:115], a[12:15], v[68:71], v[112:115]
  v_mfma_f32_16x16x32_bf16 v[116:119], a[20:23], v[68:71], v[116:119]
  ds_read_b128 v[176:179], v37 offset:0
  ds_read_b128 v[180:183], v37 offset:1024
  ds_read_b128 v[184:187], v37 offset:2048
  ds_read_b128 v[188:191], v37 offset:3072
  ds_read_b128 v[192:195], v37 offset:4096
  ds_read_b128 v[196:199], v37 offset:5120
  ds_read_b128 v[200:203], v37 offset:6144
  ds_read_b128 v[204:207], v37 offset:7168
  ds_read_b128 v[208:211], v37 offset:8192
  ds_read_b128 v[212:215], v37 offset:9216
  v_cvt_pk_bf16_f32 v120, v72, v84
  v_cvt_pk_bf16_f32 v121, v96, v108
  v_cvt_pk_bf16_f32 v122, v73, v85
  v_cvt_pk_bf16_f32 v123, v97, v109
  ds_write_b128 v12, v[120:123] offset:0
  v_cvt_pk_bf16_f32 v124, v74, v86
  v_cvt_pk_bf16_f32 v125, v98, v110
  v_cvt_pk_bf16_f32 v126, v75, v87
  v_cvt_pk_bf16_f32 v127, v99, v111
  ds_write_b128 v12, v[124:127] offset:1024
  v_cvt_pk_bf16_f32 v128, v76, v88
  v_cvt_pk_bf16_f32 v129, v100, v112
  v_cvt_pk_bf16_f32 v130, v77, v89
  v_cvt_pk_bf16_f32 v131, v101, v113
  ds_write_b128 v12, v[128:131] offset:2048
  v_cvt_pk_bf16_f32 v132, v78, v90
  v_cvt_pk_bf16_f32 v133, v102, v114
  v_cvt_pk_bf16_f32 v134, v79, v91
  v_cvt_pk_bf16_f32 v135, v103, v115
  ds_write_b128 v12, v[132:135] offset:3072
  v_cvt_pk_bf16_f32 v136, v80, v92
  v_cvt_pk_bf16_f32 v137, v104, v116
  v_cvt_pk_bf16_f32 v138, v81, v93
  v_cvt_pk_bf16_f32 v139, v105, v117
  ds_write_b128 v12, v[136:139] offset:4096
  s_waitcnt lgkmcnt(0)
  s_barrier
  ds_read_b128 v[16:19], v13 offset:0
  ds_read_b128 v[20:23], v13 offset:1024
  ds_read_b128 v[24:27], v13 offset:2048
  ds_read_b128 v[28:31], v13 offset:3072
  ds_read_b128 v[32:35], v13 offset:4096
  s_waitcnt lgkmcnt(4)
  v_mfma_f32_16x16x32_bf16 v[72:75], v[176:179], v[16:19], 0
  v_mfma_f32_16x16x32_bf16 v[76:79], v[180:183], v[16:19], 0
  s_waitcnt lgkmcnt(3)
  v_mfma_f32_16x16x32_bf16 v[80:83], v[184:187], v[20:23], 0
  v_mfma_f32_16x16x32_bf16 v[84:87], v[188:191], v[20:23], 0
  s_waitcnt lgkmcnt(2)
  v_mfma_f32_16x16x32_bf16 v[88:91], v[192:195], v[24:27], 0
  v_mfma_f32_16x16x32_bf16 v[92:95], v[196:199], v[24:27], 0
  s_waitcnt lgkmcnt(1)
  v_mfma_f32_16x16x32_bf16 v[96:99], v[200:203], v[28:31], 0
  v_mfma_f32_16x16x32_bf16 v[100:103], v[204:207], v[28:31], 0
  s_waitcnt lgkmcnt(0)
  v_mfma_f32_16x16x32_bf16 v[104:107], v[208:211], v[32:35], 0
  v_mfma_f32_16x16x32_bf16 v[108:111], v[212:215], v[32:35], 0
  v_cndmask_b32 v73, v73, v38, s[40:41]
  v_cvt_pk_bf16_f32 v120, v72, v73
  v_cvt_pk_bf16_f32 v121, v74, v75
  v_cvt_pk_bf16_f32 v122, v76, v77
  v_cvt_pk_bf16_f32 v123, v78, v79
  buffer_store_dwordx4 v[120:123], v14, s[4:7], s24 offen sc1
  s_add_u32 s24, s24, 10240
  v_cvt_pk_bf16_f32 v124, v80, v81
  v_cvt_pk_bf16_f32 v125, v82, v83
  v_cvt_pk_bf16_f32 v126, v84, v85
  v_cvt_pk_bf16_f32 v127, v86, v87
  buffer_store_dwordx4 v[124:127], v14, s[4:7], s24 offen sc1
  s_add_u32 s24, s24, 10240
  v_cvt_pk_bf16_f32 v128, v88, v89
  v_cvt_pk_bf16_f32 v129, v90, v91
  v_cvt_pk_bf16_f32 v130, v92, v93
  v_cvt_pk_bf16_f32 v131, v94, v95
  buffer_store_dwordx4 v[128:131], v14, s[4:7], s24 offen sc1
  s_add_u32 s24, s24, 10240
  v_cvt_pk_bf16_f32 v132, v96, v97
  v_cvt_pk_bf16_f32 v133, v98, v99
  v_cvt_pk_bf16_f32 v134, v100, v101
  v_cvt_pk_bf16_f32 v135, v102, v103
  buffer_store_dwordx4 v[132:135], v14, s[4:7], s24 offen sc1
  s_add_u32 s24, s24, 10240
  v_cvt_pk_bf16_f32 v136, v104, v105
  v_cvt_pk_bf16_f32 v137, v106, v107
  v_cvt_pk_bf16_f32 v138, v108, v109
  v_cvt_pk_bf16_f32 v139, v110, v111
  buffer_store_dwordx4 v[136:139], v14, s[4:7], s24 offen sc1
  s_endpgm
k2_c:
  s_load_dwordx2 s[8:9], s[0:1], 40
  s_mov_b32 s10, 819200
  s_mov_b32 s11, 0x20000
  s_getpc_b64 s[12:13]
  s_add_u32 s12, s12, tabs@rel32@lo+4
  s_addc_u32 s13, s13, tabs@rel32@hi+12
  s_mov_b32 s14, 102160
  s_mov_b32 s15, 0x20000
  v_and_b32 v1, 63, v0
  v_lshrrev_b32 v2, 6, v0
  s_nop 0
  v_readfirstlane_b32 s21, v2
  v_lshlrev_b32 v7, 4, v1
  s_mul_i32 s30, s21, 6144
  s_add_u32 m0, s30, 83200
  s_nop 0
  buffer_load_dwordx4 v7, s[12:15], s30 offen offset:0 lds
  buffer_load_dwordx4 v7, s[12:15], s30 offen offset:1024 lds
  buffer_load_dwordx4 v7, s[12:15], s30 offen offset:2048 lds
  buffer_load_dwordx4 v7, s[12:15], s30 offen offset:3072 lds
  s_add_u32 s30, s30, 4096
  s_add_u32 m0, s30, 83200
  s_nop 0
  buffer_load_dwordx4 v7, s[12:15], s30 offen offset:0 lds
  buffer_load_dwordx4 v7, s[12:15], s30 offen offset:1024 lds
  s_and_b32 s20, s21, 3
  s_lshr_b32 s22, s21, 2
  s_sub_u32 s23, s2, 224
  s_mul_i32 s24, s23, 52
  s_lshr_b32 s24, s24, 8
  s_mul_i32 s25, s24, 5
  s_sub_u32 s25, s23, s25
  v_bfe_u32 v3, v0, 4, 4
  v_and_b32 v4, 15, v0
  v_and_b32 v5, 7, v3
  s_lshl_b32 s25, s25, 3
  v_add_u32 v5, s25, v5
  v_mul_u32_u24 v6, 52, v5
  v_lshrrev_b32 v6, 8, v6
  v_mul_u32_u24 v6, 15, v6
  v_add_u32 v5, v5, v6
  v_lshrrev_b32 v6, 3, v3
  v_mul_u32_u24 v6, 5, v6
  v_add_u32 v5, v5, v6
  s_mul_i32 s24, s24, 160
  s_mul_i32 s25, s22, 10
  s_add_u32 s24, s24, s25
  v_add_u32 v5, s24, v5
  v_mul_u32_u24 v5, 1280, v5
  v_lshl_add_u32 v5, v4, 4, v5
  s_waitcnt lgkmcnt(0)
  buffer_load_dwordx4 v[140:143], v5, s[8:11], 0 offen offset:0
  buffer_load_dwordx4 v[144:147], v5, s[8:11], 0 offen offset:256
  buffer_load_dwordx4 v[148:151], v5, s[8:11], 0 offen offset:512
  buffer_load_dwordx4 v[152:155], v5, s[8:11], 0 offen offset:768
  buffer_load_dwordx4 v[156:159], v5, s[8:11], 0 offen offset:1024
  s_mul_i32 s27, s22, 41216
  v_mul_u32_u24 v6, 1296, v3
  v_lshl_add_u32 v6, v4, 4, v6
  v_add_u32 v6, s27, v6
  v_lshrrev_b32 v8, 4, v1
  v_lshrrev_b32 v9, 1, v8
  v_lshl_add_u32 v9, v9, 4, v4
  v_lshlrev_b32 v9, 6, v9
  s_lshl_b32 s26, s20, 11
  s_add_u32 s26, s26, 61200
  buffer_load_dwordx4 v[160:163], v9, s[12:15], s26 offen offset:0
  buffer_load_dwordx4 v[164:167], v9, s[12:15], s26 offen offset:16
  buffer_load_dwordx4 v[168:171], v9, s[12:15], s26 offen offset:32
  buffer_load_dwordx4 v[172:175], v9, s[12:15], s26 offen offset:48
  v_mul_u32_u24 v9, 1296, v4
  s_lshl_b32 s26, s20, 3
  s_add_u32 s26, s26, s27
  v_add_u32 v9, s26, v9
  v_lshl_add_u32 v10, v8, 7, v9
  v_lshl_add_u32 v11, v8, 6, v9
  v_add_u32 v11, 1024, v11
  v_mul_u32_u24 v12, 5120, v8
  v_lshl_add_u32 v12, v4, 4, v12
  s_lshl_b32 s26, s20, 8
  s_add_u32 s26, s26, s27
  s_add_u32 s26, s26, 20736
  v_add_u32 v12, s26, v12
  s_mul_i32 s26, s20, 5120
  s_add_u32 s26, s26, s27
  s_add_u32 s26, s26, 20736
  v_add_u32 v13, s26, v7
  v_and_b32 v14, 1, v8
  v_bfe_u32 v15, v0, 2, 2
  v_lshl_add_u32 v15, v14, 3, v15
  v_mul_u32_u24 v15, 1296, v15
  v_and_b32 v36, 3, v0
  v_lshl_add_u32 v15, v36, 3, v15
  v_lshrrev_b32 v36, 1, v8
  v_lshl_add_u32 v15, v36, 5, v15
  s_mul_i32 s26, s20, 320
  s_add_u32 s26, s26, s27
  v_add_u32 v15, s26, v15
  s_mul_i32 s24, s23, 5120
  s_lshl_b32 s25, s22, 9
  s_add_u32 s24, s24, s25
  s_add_u32 s25, s24, 25296896
  s_add_u32 s24, s24, 24477696
  v_lshlrev_b32 v37, 8, v14
  v_lshlrev_b32 v38, 8, v36
  v_lshl_add_u32 v38, v14, 3, v38
  v_mov_b32 v57, 0
  v_mov_b32 v58, 0
  v_mov_b32 v59, 0
  v_mov_b32 v61, 0
  v_mov_b32 v62, 0
  v_mov_b32 v63, 0
  v_mov_b32 v65, 0
  v_mov_b32 v66, 0
  v_mov_b32 v67, 0
  v_mov_b32 v69, 0
  v_mov_b32 v70, 0
  v_mov_b32 v71, 0
  s_waitcnt vmcnt(8)
  ds_write_b128 v6, v[140:143] offset:0
  s_waitcnt vmcnt(7)
  ds_write_b128 v6, v[144:147] offset:256
  s_waitcnt vmcnt(6)
  ds_write_b128 v6, v[148:151] offset:512
  s_waitcnt vmcnt(5)
  ds_write_b128 v6, v[152:155] offset:768
  s_waitcnt vmcnt(4)
  ds_write_b128 v6, v[156:159] offset:1024
  s_waitcnt vmcnt(4) lgkmcnt(0)
  s_barrier
  v_add_u32 v36, 83200, v7
  s_mul_i32 s30, s20, 10240
  s_add_u32 s30, s30, 6144
  v_add_u32 v39, s30, v36
  ds_read_b128 a[0:3], v36 offset:0
  ds_read_b128 a[4:7], v36 offset:1024
  ds_read_b128 a[8:11], v36 offset:2048
  ds_read_b128 a[12:15], v36 offset:3072
  ds_read_b128 a[16:19], v36 offset:4096
  ds_read_b128 a[20:23], v36 offset:5120
  ds_read_b64 v[16:17], v10 offset:0
  ds_read_b64 v[18:19], v10 offset:32
  ds_read_b64 v[20:21], v10 offset:64
  ds_read_b64 v[22:23], v10 offset:96
  ds_read_b64 v[24:25], v10 offset:512
  ds_read_b64 v[26:27], v10 offset:544
  ds_read_b64 v[28:29], v10 offset:576
  ds_read_b64 v[30:31], v10 offset:608
  ds_read_b64 v[32:33], v11 offset:0
  ds_read_b64 v[34:35], v11 offset:32
  s_mov_b32 s31, 0x05040100
  s_mov_b32 s32, 0x07060302
  s_waitcnt lgkmcnt(8)
  v_perm_b32 v40, v18, v16, s31
  v_perm_b32 v44, v18, v16, s32
  v_perm_b32 v48, v19, v17, s31
  v_perm_b32 v52, v19, v17, s32
  s_waitcnt lgkmcnt(6)
  v_perm_b32 v41, v22, v20, s31
  v_perm_b32 v45, v22, v20, s32
  v_perm_b32 v49, v23, v21, s31
  v_perm_b32 v53, v23, v21, s32
  s_waitcnt lgkmcnt(4)
  v_perm_b32 v42, v26, v24, s31
  v_perm_b32 v46, v26, v24, s32
  v_perm_b32 v50, v27, v25, s31
  v_perm_b32 v54, v27, v25, s32
  s_waitcnt lgkmcnt(2)
  v_perm_b32 v43, v30, v28, s31
  v_perm_b32 v47, v30, v28, s32
  v_perm_b32 v51, v31, v29, s31
  v_perm_b32 v55, v31, v29, s32
  s_waitcnt lgkmcnt(0)
  v_perm_b32 v56, v34, v32, s31
  v_perm_b32 v60, v34, v32, s32
  v_perm_b32 v64, v35, v33, s31
  v_perm_b32 v68, v35, v33, s32
  ds_read_b64_tr_b16 v[140:141], v15 offset:0
  ds_read_b64_tr_b16 v[142:143], v15 offset:5184
  ds_read_b64_tr_b16 v[144:145], v15 offset:64
  ds_read_b64_tr_b16 v[146:147], v15 offset:5248
  ds_read_b64_tr_b16 v[148:149], v15 offset:128
  ds_read_b64_tr_b16 v[150:151], v15 offset:5312
  ds_read_b64_tr_b16 v[152:153], v15 offset:192
  ds_read_b64_tr_b16 v[154:155], v15 offset:5376
  ds_read_b64_tr_b16 v[156:157], v15 offset:256
  ds_read_b64_tr_b16 v[158:159], v15 offset:5440
  v_mfma_f32_16x16x32_bf16 v[72:75], a[0:3], v[40:43], 0
  v_mfma_f32_16x16x32_bf16 v[76:79], a[8:11], v[40:43], 0
  v_mfma_f32_16x16x32_bf16 v[80:83], a[16:19], v[40:43], 0
  v_mfma_f32_16x16x32_bf16 v[84:87], a[0:3], v[44:47], 0
  v_mfma_f32_16x16x32_bf16 v[88:91], a[8:11], v[44:47], 0
  v_mfma_f32_16x16x32_bf16 v[92:95], a[16:19], v[44:47], 0
  v_mfma_f32_16x16x32_bf16 v[96:99], a[0:3], v[48:51], 0
  v_mfma_f32_16x16x32_bf16 v[100:103], a[8:11], v[48:51], 0
  v_mfma_f32_16x16x32_bf16 v[104:107], a[16:19], v[48:51], 0
  v_mfma_f32_16x16x32_bf16 v[108:111], a[0:3], v[52:55], 0
  v_mfma_f32_16x16x32_bf16 v[112:115], a[8:11], v[52:55], 0
  v_mfma_f32_16x16x32_bf16 v[116:119], a[16:19], v[52:55], 0
  v_mfma_f32_16x16x32_bf16 v[72:75], a[4:7], v[56:59], v[72:75]
  v_mfma_f32_16x16x32_bf16 v[76:79], a[12:15], v[56:59], v[76:79]
  v_mfma_f32_16x16x32_bf16 v[80:83], a[20:23], v[56:59], v[80:83]
  v_mfma_f32_16x16x32_bf16 v[84:87], a[4:7], v[60:63], v[84:87]
  v_mfma_f32_16x16x32_bf16 v[88:91], a[12:15], v[60:63], v[88:91]
  v_mfma_f32_16x16x32_bf16 v[92:95], a[20:23], v[60:63], v[92:95]
  v_mfma_f32_16x16x32_bf16 v[96:99], a[4:7], v[64:67], v[96:99]
  v_mfma_f32_16x16x32_bf16 v[100:103], a[12:15], v[64:67], v[100:103]
  v_mfma_f32_16x16x32_bf16 v[104:107], a[20:23], v[64:67], v[104:107]
  v_mfma_f32_16x16x32_bf16 v[108:111], a[4:7], v[68:71], v[108:111]
  v_mfma_f32_16x16x32_bf16 v[112:115], a[12:15], v[68:71], v[112:115]
  v_mfma_f32_16x16x32_bf16 v[116:119], a[20:23], v[68:71], v[116:119]
  ds_read_b128 v[176:179], v39 offset:0
  ds_read_b128 v[180:183], v39 offset:1024
  ds_read_b128 v[184:187], v39 offset:2048
  ds_read_b128 v[188:191], v39 offset:3072
  ds_read_b128 v[192:195], v39 offset:4096
  ds_read_b128 v[196:199], v39 offset:5120
  ds_read_b128 v[200:203], v39 offset:6144
  ds_read_b128 v[204:207], v39 offset:7168
  ds_read_b128 v[208:211], v39 offset:8192
  ds_read_b128 v[212:215], v39 offset:9216
  s_waitcnt vmcnt(1)
  v_add_u32 v170, v170, v37
  s_waitcnt lgkmcnt(15)
  buffer_store_dwordx4 v[140:143], v170, s[4:7], s25 offen sc1
  v_add_u32 v171, v171, v37
  buffer_store_dwordx4 v[144:147], v171, s[4:7], s25 offen sc1
  s_waitcnt vmcnt(2)
  v_add_u32 v172, v172, v37
  s_waitcnt lgkmcnt(14)
  buffer_store_dwordx4 v[148:151], v172, s[4:7], s25 offen sc1
  v_add_u32 v173, v173, v37
  s_waitcnt lgkmcnt(12)
  buffer_store_dwordx4 v[152:155], v173, s[4:7], s25 offen sc1
  v_add_u32 v174, v174, v37
  s_waitcnt lgkmcnt(10)
  buffer_store_dwordx4 v[156:159], v174, s[4:7], s25 offen sc1
  v_cvt_pk_bf16_f32 v120, v72, v84
  v_cvt_pk_bf16_f32 v121, v96, v108
  v_cvt_pk_bf16_f32 v122, v73, v85
  v_cvt_pk_bf16_f32 v123, v97, v109
  ds_write_b128 v12, v[120:123] offset:0
  v_cvt_pk_bf16_f32 v124, v74, v86
  v_cvt_pk_bf16_f32 v125, v98, v110
  v_cvt_pk_bf16_f32 v126, v75, v87
  v_cvt_pk_bf16_f32 v127, v99, v111
  ds_write_b128 v12, v[124:127] offset:1024
  v_cvt_pk_bf16_f32 v128, v76, v88
  v_cvt_pk_bf16_f32 v129, v100, v112
  v_cvt_pk_bf16_f32 v130, v77, v89
  v_cvt_pk_bf16_f32 v131, v101, v113
  ds_write_b128 v12, v[128:131] offset:2048
  v_cvt_pk_bf16_f32 v132, v78, v90
  v_cvt_pk_bf16_f32 v133, v102, v114
  v_cvt_pk_bf16_f32 v134, v79, v91
  v_cvt_pk_bf16_f32 v135, v103, v115
  ds_write_b128 v12, v[132:135] offset:3072
  v_cvt_pk_bf16_f32 v136, v80, v92
  v_cvt_pk_bf16_f32 v137, v104, v116
  v_cvt_pk_bf16_f32 v138, v81, v93
  v_cvt_pk_bf16_f32 v139, v105, v117
  ds_write_b128 v12, v[136:139] offset:4096
  s_waitcnt lgkmcnt(0)
  s_barrier
  ds_read_b128 v[16:19], v13 offset:0
  ds_read_b128 v[20:23], v13 offset:1024
  ds_read_b128 v[24:27], v13 offset:2048
  ds_read_b128 v[28:31], v13 offset:3072
  ds_read_b128 v[32:35], v13 offset:4096
  s_waitcnt lgkmcnt(4)
  v_mfma_f32_16x16x32_bf16 v[72:75], v[16:19], v[176:179], 0
  v_mfma_f32_16x16x32_bf16 v[76:79], v[16:19], v[180:183], 0
  s_waitcnt lgkmcnt(3)
  v_mfma_f32_16x16x32_bf16 v[80:83], v[20:23], v[184:187], 0
  v_mfma_f32_16x16x32_bf16 v[84:87], v[20:23], v[188:191], 0
  s_waitcnt lgkmcnt(2)
  v_mfma_f32_16x16x32_bf16 v[88:91], v[24:27], v[192:195], 0
  v_mfma_f32_16x16x32_bf16 v[92:95], v[24:27], v[196:199], 0
  s_waitcnt lgkmcnt(1)
  v_mfma_f32_16x16x32_bf16 v[96:99], v[28:31], v[200:203], 0
  v_mfma_f32_16x16x32_bf16 v[100:103], v[28:31], v[204:207], 0
  s_waitcnt lgkmcnt(0)
  v_mfma_f32_16x16x32_bf16 v[104:107], v[32:35], v[208:211], 0
  v_mfma_f32_16x16x32_bf16 v[108:111], v[32:35], v[212:215], 0
  v_cvt_pk_bf16_f32 v120, v72, v73
  v_cvt_pk_bf16_f32 v121, v74, v75
  v_add_u32 v160, v160, v38
  buffer_store_dwordx2 v[120:121], v160, s[4:7], s24 offen
  v_cvt_pk_bf16_f32 v122, v76, v77
  v_cvt_pk_bf16_f32 v123, v78, v79
  v_add_u32 v161, v161, v38
  buffer_store_dwordx2 v[122:123], v161, s[4:7], s24 offen
  v_cvt_pk_bf16_f32 v124, v80, v81
  v_cvt_pk_bf16_f32 v125, v82, v83
  v_add_u32 v162, v162, v38
  buffer_store_dwordx2 v[124:125], v162, s[4:7], s24 offen
  v_cvt_pk_bf16_f32 v126, v84, v85
  v_cvt_pk_bf16_f32 v127, v86, v87
  v_add_u32 v163, v163, v38
  buffer_store_dwordx2 v[126:127], v163, s[4:7], s24 offen
  v_cvt_pk_bf16_f32 v128, v88, v89
  v_cvt_pk_bf16_f32 v129, v90, v91
  v_add_u32 v164, v164, v38
  buffer_store_dwordx2 v[128:129], v164, s[4:7], s24 offen
  v_cvt_pk_bf16_f32 v130, v92, v93
  v_cvt_pk_bf16_f32 v131, v94, v95
  v_add_u32 v165, v165, v38
  buffer_store_dwordx2 v[130:131], v165, s[4:7], s24 offen
  v_cvt_pk_bf16_f32 v132, v96, v97
  v_cvt_pk_bf16_f32 v133, v98, v99
  v_add_u32 v166, v166, v38
  buffer_store_dwordx2 v[132:133], v166, s[4:7], s24 offen
  v_cvt_pk_bf16_f32 v134, v100, v101
  v_cvt_pk_bf16_f32 v135, v102, v103
  v_add_u32 v167, v167, v38
  buffer_store_dwordx2 v[134:135], v167, s[4:7], s24 offen
  v_cvt_pk_bf16_f32 v136, v104, v105
  v_cvt_pk_bf16_f32 v137, v106, v107
  v_add_u32 v168, v168, v38
  buffer_store_dwordx2 v[136:137], v168, s[4:7], s24 offen
  v_cvt_pk_bf16_f32 v138, v108, v109
  v_cvt_pk_bf16_f32 v139, v110, v111
  v_add_u32 v169, v169, v38
  buffer_store_dwordx2 v[138:139], v169, s[4:7], s24 offen
  s_endpgm
.globl k3_kernel
.p2align 8
.type k3_kernel,@function
k3_kernel:
  s_cmp_ge_u32 s2, 256
  s_cbranch_scc1 k3_exit
  s_load_dwordx2 s[4:5], s[0:1], 64
  s_mov_b32 s6, 28360704
  s_mov_b32 s7, 0x20000
  v_lshrrev_b32 v1, 6, v0
  s_nop 0
  v_readfirstlane_b32 s19, v1
  v_and_b32 v1, 63, v0
  v_lshlrev_b32 v1, 4, v1
  s_bfe_u32 s21, s2, 0x20001
  s_lshl_b32 s21, s21, 2
  s_lshr_b32 s22, s2, 6
  s_add_u32 s21, s21, s22
  s_and_b32 s22, s2, 1
  s_lshl_b32 s22, s22, 3
  s_bfe_u32 s23, s2, 0x30003
  s_add_u32 s22, s22, s23
  s_and_b32 s20, s19, 3
  s_mul_i32 s23, s21, 165888
  s_mul_i32 s43, s22, 10240
  s_add_u32 s43, s43, s23
  s_mul_i32 s28, s22, 204800
  s_mul_i32 s27, s20, 5120
  s_add_u32 s28, s28, s27
  s_add_u32 s28, s28, 21200896
  s_lshl_b32 s29, s20, 10
  s_lshr_b32 s24, s19, 2
  s_mul_i32 s25, s24, 40960
  s_add_u32 s25, s25, s29
  s_lshl_b32 s24, s24, 10
  s_add_u32 s24, s24, s28
  s_add_u32 m0, s25, 0
  s_waitcnt lgkmcnt(0)
  buffer_load_dwordx4 v1, s[4:7], s24 offen lds
  s_add_u32 s24, s24, 20480
  s_add_u32 m0, s25, 4096
  s_nop 0
  buffer_load_dwordx4 v1, s[4:7], s24 offen lds
  s_add_u32 s24, s24, 20480
  s_add_u32 m0, s25, 8192
  s_nop 0
  buffer_load_dwordx4 v1, s[4:7], s24 offen lds
  s_cmp_ge_u32 s19, 4
  s_cbranch_scc1 k3_h
  v_and_b32 v2, 31, v0
  v_bfe_u32 v3, v0, 5, 1
  s_lshl_b32 s24, s20, 9
  v_lshl_add_u32 v7, v2, 4, s24
  v_lshl_add_u32 v7, v3, 11, v7
  v_add_u32 v5, 4096, v7
  s_add_u32 s25, s23, 2654208
  s_add_u32 s28, s28, 3072
  buffer_load_dwordx4 v[96:99], v7, s[4:7], s25 offen
  buffer_load_dwordx4 v[100:103], v5, s[4:7], s25 offen
  s_add_u32 s25, s25, 8192
  buffer_load_dwordx4 v[104:107], v7, s[4:7], s25 offen
  buffer_load_dwordx4 v[108:111], v5, s[4:7], s25 offen
  s_add_u32 s25, s25, 8192
  s_mul_i32 s27, s20, 384
  s_add_u32 s27, s27, 139264
  v_cmp_eq_u32 s[30:31], 0, v3
  v_mov_b32 v44, -1
  v_mov_b32 v45, 0xffff
  v_cndmask_b32 v44, v44, v45, s[30:31]
  v_and_b32 v45, 1, v2
  v_cmp_ne_u32 s[32:33], 0, v45
  v_and_b32 v45, 2, v2
  v_cmp_ne_u32 s[34:35], 0, v45
  v_and_b32 v45, 8, v2
  v_cmp_ne_u32 s[36:37], 0, v45
  v_and_b32 v45, 16, v2
  v_cmp_ne_u32 s[38:39], 0, v45
  v_bfe_u32 v45, v2, 2, 1
  v_cmp_eq_u32 s[40:41], v45, v3
  v_add_u32 v3, 0x10000, v1
  s_lshl_b32 s24, s20, 13
  s_add_u32 s24, s24, 40960
  v_add_u32 v6, s24, v1
  s_lshl_b32 s24, s20, 12
  s_add_u32 s24, s24, 122880
  v_add_u32 v4, s24, v1
  s_lshl_b32 s24, s20, 2
  s_add_u32 s24, s24, 140800
  v_mov_b32 v2, s24
  buffer_load_dwordx4 v[112:115], v7, s[4:7], s25 offen
  buffer_load_dwordx4 v[116:119], v5, s[4:7], s25 offen
  s_add_u32 s25, s25, 8192
  buffer_load_dwordx4 v[120:123], v7, s[4:7], s25 offen
  buffer_load_dwordx4 v[124:127], v5, s[4:7], s25 offen
  s_add_u32 s25, s25, 8192
  s_waitcnt vmcnt(8)
  s_barrier
  ds_read_b128 v[72:75], v1 offset:0
  ds_read_b128 v[76:79], v1 offset:40960
  ds_read_b128 v[80:83], v1 offset:1024
  ds_read_b128 v[84:87], v1 offset:41984
  ds_read_b128 v[88:91], v1 offset:2048
  s_waitcnt vmcnt(7) lgkmcnt(4)
  v_mfma_f32_32x32x16_bf16 v[8:23], v[96:99], v[72:75], 0
  buffer_load_dwordx4 v[128:131], v7, s[4:7], s25 offen
  v_and_b32 v40, v96, v44
  v_mov_b32 v41, v97
  s_nop 1
  v_mfma_f32_4x4x4_16b_bf16 v[56:59], v[40:41], v[40:41], 0
  ds_read_b128 v[92:95], v1 offset:43008
  s_waitcnt lgkmcnt(4)
  v_mfma_f32_32x32x16_bf16 v[24:39], v[96:99], v[76:79], 0
  buffer_load_dwordx4 v[132:135], v5, s[4:7], s25 offen
  s_add_u32 s25, s25, 8192
  v_mfma_f32_4x4x4_16b_bf16 v[60:63], v[98:99], v[98:99], 0
  ds_read_b128 v[72:75], v1 offset:3072
  s_waitcnt vmcnt(8) lgkmcnt(4)
  v_mfma_f32_32x32x16_bf16 v[8:23], v[100:103], v[80:83], v[8:23]
  buffer_load_dwordx4 v[136:139], v7, s[4:7], s25 offen
  v_mfma_f32_4x4x4_16b_bf16 v[56:59], v[100:101], v[100:101], v[56:59]
  ds_read_b128 v[76:79], v1 offset:44032
  s_waitcnt lgkmcnt(4)
  v_mfma_f32_32x32x16_bf16 v[24:39], v[100:103], v[84:87], v[24:39]
  buffer_load_dwordx4 v[140:143], v5, s[4:7], s25 offen
  s_add_u32 s25, s25, 8192
  v_mfma_f32_4x4x4_16b_bf16 v[60:63], v[102:103], v[102:103], v[60:63]
  ds_read_b128 v[80:83], v1 offset:4096
  s_waitcnt vmcnt(9) lgkmcnt(4)
  v_mfma_f32_32x32x16_bf16 v[8:23], v[104:107], v[88:91], v[8:23]
  buffer_load_dwordx4 v[144:147], v7, s[4:7], s25 offen
  v_mfma_f32_4x4x4_16b_bf16 v[56:59], v[104:105], v[104:105], v[56:59]
  ds_read_b128 v[84:87], v1 offset:45056
  s_waitcnt lgkmcnt(4)
  v_mfma_f32_32x32x16_bf16 v[24:39], v[104:107], v[92:95], v[24:39]
  buffer_load_dwordx4 v[148:151], v5, s[4:7], s25 offen
  s_add_u32 s25, s25, 8192
  v_mfma_f32_4x4x4_16b_bf16 v[60:63], v[106:107], v[106:107], v[60:63]
  ds_read_b128 v[88:91], v1 offset:5120
  s_waitcnt vmcnt(10) lgkmcnt(4)
  v_mfma_f32_32x32x16_bf16 v[8:23], v[108:111], v[72:75], v[8:23]
  buffer_load_dwordx4 v[152:155], v7, s[4:7], s25 offen
  v_mfma_f32_4x4x4_16b_bf16 v[56:59], v[108:109], v[108:109], v[56:59]
  ds_read_b128 v[92:95], v1 offset:46080
  s_waitcnt lgkmcnt(4)
  v_mfma_f32_32x32x16_bf16 v[24:39], v[108:111], v[76:79], v[24:39]
  buffer_load_dwordx4 v[156:159], v5, s[4:7], s25 offen
  s_add_u32 s25, s25, 8192
  v_mfma_f32_4x4x4_16b_bf16 v[60:63], v[110:111], v[110:111], v[60:63]
  ds_read_b128 v[72:75], v1 offset:6144
  s_waitcnt vmcnt(11) lgkmcnt(4)
  v_mfma_f32_32x32x16_bf16 v[8:23], v[112:115], v[80:83], v[8:23]
  buffer_load_dwordx4 v[160:163], v7, s[4:7], s25 offen
  v_mfma_f32_4x4x4_16b_bf16 v[56:59], v[112:113], v[112:113], v[56:59]
  ds_read_b128 v[76:79], v1 offset:47104
  s_waitcnt lgkmcnt(4)
  v_mfma_f32_32x32x16_bf16 v[24:39], v[112:115], v[84:87], v[24:39]
  v_mfma_f32_4x4x4_16b_bf16 v[60:63], v[114:115], v[114:115], v[60:63]
  ds_read_b128 v[80:83], v1 offset:7168
  s_waitcnt vmcnt(11) lgkmcnt(4)
  v_mfma_f32_32x32x16_bf16 v[8:23], v[116:119], v[88:91], v[8:23]
  buffer_load_dwordx4 v[164:167], v5, s[4:7], s25 offen
  s_add_u32 s25, s25, 8192
  v_mfma_f32_4x4x4_16b_bf16 v[56:59], v[116:117], v[116:117], v[56:59]
  ds_read_b128 v[84:87], v1 offset:48128
  s_waitcnt lgkmcnt(4)
  v_mfma_f32_32x32x16_bf16 v[24:39], v[116:119], v[92:95], v[24:39]
  v_mfma_f32_4x4x4_16b_bf16 v[60:63], v[118:119], v[118:119], v[60:63]
  ds_read_b128 v[88:91], v1 offset:8192
  s_waitcnt vmcnt(11) lgkmcnt(4)
  v_mfma_f32_32x32x16_bf16 v[8:23], v[120:123], v[72:75], v[8:23]
  buffer_load_dwordx4 v[168:171], v7, s[4:7], s25 offen
  v_mfma_f32_4x4x4_16b_bf16 v[56:59], v[120:121], v[120:121], v[56:59]
  ds_read_b128 v[92:95], v1 offset:49152
  s_waitcnt lgkmcnt(4)
  v_mfma_f32_32x32x16_bf16 v[24:39], v[120:123], v[76:79], v[24:39]
  v_mfma_f32_4x4x4_16b_bf16 v[60:63], v[122:123], v[122:123], v[60:63]
  ds_read_b128 v[72:75], v1 offset:9216
  s_waitcnt vmcnt(11) lgkmcnt(4)
  v_mfma_f32_32x32x16_bf16 v[8:23], v[124:127], v[80:83], v[8:23]
  buffer_load_dwordx4 v[172:175], v5, s[4:7], s25 offen
  s_add_u32 s25, s25, 8192
  v_mfma_f32_4x4x4_16b_bf16 v[56:59], v[124:125], v[124:125], v[56:59]
  ds_read_b128 v[76:79], v1 offset:50176
  s_waitcnt lgkmcnt(4)
  v_mfma_f32_32x32x16_bf16 v[24:39], v[124:127], v[84:87], v[24:39]
  v_mfma_f32_4x4x4_16b_bf16 v[60:63], v[126:127], v[126:127], v[60:63]
  ds_read_b128 v[80:83], v1 offset:10240
  s_waitcnt vmcnt(11) lgkmcnt(4)
  v_mfma_f32_32x32x16_bf16 v[8:23], v[128:131], v[88:91], v[8:23]
  buffer_load_dwordx4 v[176:179], v7, s[4:7], s25 offen
  v_mfma_f32_4x4x4_16b_bf16 v[56:59], v[128:129], v[128:129], v[56:59]
  ds_read_b128 v[84:87], v1 offset:51200
  s_waitcnt lgkmcnt(4)
  v_mfma_f32_32x32x16_bf16 v[24:39], v[128:131], v[92:95], v[24:39]
  v_mfma_f32_4x4x4_16b_bf16 v[60:63], v[130:131], v[130:131], v[60:63]
  ds_read_b128 v[88:91], v1 offset:11264
  s_waitcnt vmcnt(11) lgkmcnt(4)
  v_mfma_f32_32x32x16_bf16 v[8:23], v[132:135], v[72:75], v[8:23]
  buffer_load_dwordx4 v[180:183], v5, s[4:7], s25 offen
  s_add_u32 s25, s25, 8192
  v_mfma_f32_4x4x4_16b_bf16 v[56:59], v[132:133], v[132:133], v[56:59]
  ds_read_b128 v[92:95], v1 offset:52224
  s_waitcnt lgkmcnt(4)
  v_mfma_f32_32x32x16_bf16 v[24:39], v[132:135], v[76:79], v[24:39]
  v_mfma_f32_4x4x4_16b_bf16 v[60:63], v[134:135], v[134:135], v[60:63]
  s_barrier
  ds_read_b128 v[72:75], v1 offset:12288
  s_waitcnt vmcnt(11) lgkmcnt(4)
  v_mfma_f32_32x32x16_bf16 v[8:23], v[136:139], v[80:83], v[8:23]
  buffer_load_dwordx4 v[184:187], v7, s[4:7], s25 offen
  v_mfma_f32_4x4x4_16b_bf16 v[56:59], v[136:137], v[136:137], v[56:59]
  ds_read_b128 v[76:79], v1 offset:53248
  s_waitcnt lgkmcnt(4)
  v_mfma_f32_32x32x16_bf16 v[24:39], v[136:139], v[84:87], v[24:39]
  v_mfma_f32_4x4x4_16b_bf16 v[60:63], v[138:139], v[138:139], v[60:63]
  ds_read_b128 v[80:83], v1 offset:13312
  s_waitcnt vmcnt(11) lgkmcnt(4)
  v_mfma_f32_32x32x16_bf16 v[8:23], v[140:143], v[88:91], v[8:23]
  buffer_load_dwordx4 v[188:191], v5, s[4:7], s25 offen
  s_add_u32 s25, s25, 8192
  v_mfma_f32_4x4x4_16b_bf16 v[56:59], v[140:141], v[140:141], v[56:59]
  ds_read_b128 v[84:87], v1 offset:54272
  s_waitcnt lgkmcnt(4)
  v_mfma_f32_32x32x16_bf16 v[24:39], v[140:143], v[92:95], v[24:39]
  v_mfma_f32_4x4x4_16b_bf16 v[60:63], v[142:143], v[142:143], v[60:63]
  ds_read_b128 v[88:91], v1 offset:14336
  s_waitcnt vmcnt(11) lgkmcnt(4)
  v_mfma_f32_32x32x16_bf16 v[8:23], v[144:147], v[72:75], v[8:23]
  buffer_load_dwordx4 v[192:195], v7, s[4:7], s25 offen
  v_mfma_f32_4x4x4_16b_bf16 v[56:59], v[144:145], v[144:145], v[56:59]
  ds_read_b128 v[92:95], v1 offset:55296
  s_waitcnt lgkmcnt(4)
  v_mfma_f32_32x32x16_bf16 v[24:39], v[144:147], v[76:79], v[24:39]
  v_mfma_f32_4x4x4_16b_bf16 v[60:63], v[146:147], v[146:147], v[60:63]
  ds_read_b128 v[72:75], v1 offset:15360
  s_waitcnt vmcnt(11) lgkmcnt(4)
  v_mfma_f32_32x32x16_bf16 v[8:23], v[148:151], v[80:83], v[8:23]
  buffer_load_dwordx4 v[196:199], v5, s[4:7], s25 offen
  s_add_u32 s25, s25, 8192
  v_mfma_f32_4x4x4_16b_bf16 v[56:59], v[148:149], v[148:149], v[56:59]
  ds_read_b128 v[76:79], v1 offset:56320
  s_waitcnt lgkmcnt(4)
  v_mfma_f32_32x32x16_bf16 v[24:39], v[148:151], v[84:87], v[24:39]
  v_mfma_f32_4x4x4_16b_bf16 v[60:63], v[150:151], v[150:151], v[60:63]
  ds_read_b128 v[80:83], v1 offset:16384
  s_waitcnt vmcnt(11) lgkmcnt(4)
  v_mfma_f32_32x32x16_bf16 v[8:23], v[152:155], v[88:91], v[8:23]
  buffer_load_dwordx4 v[200:203], v7, s[4:7], s25 offen
  v_mfma_f32_4x4x4_16b_bf16 v[56:59], v[152:153], v[152:153], v[56:59]
  ds_read_b128 v[84:87], v1 offset:57344
  s_waitcnt lgkmcnt(4)
  v_mfma_f32_32x32x16_bf16 v[24:39], v[152:155], v[92:95], v[24:39]
  v_mfma_f32_4x4x4_16b_bf16 v[60:63], v[154:155], v[154:155], v[60:63]
  ds_read_b128 v[88:91], v1 offset:17408
  s_waitcnt vmcnt(11) lgkmcnt(4)
  v_mfma_f32_32x32x16_bf16 v[8:23], v[156:159], v[72:75], v[8:23]
  buffer_load_dwordx4 v[204:207], v5, s[4:7], s25 offen
  s_add_u32 s25, s25, 8192
  v_mfma_f32_4x4x4_16b_bf16 v[56:59], v[156:157], v[156:157], v[56:59]
  ds_read_b128 v[92:95], v1 offset:58368
  s_waitcnt lgkmcnt(4)
  v_mfma_f32_32x32x16_bf16 v[24:39], v[156:159], v[76:79], v[24:39]
  v_mfma_f32_4x4x4_16b_bf16 v[60:63], v[158:159], v[158:159], v[60:63]
  ds_read_b128 v[72:75], v1 offset:18432
  s_waitcnt vmcnt(11) lgkmcnt(4)
  v_mfma_f32_32x32x16_bf16 v[8:23], v[160:163], v[80:83], v[8:23]
  buffer_load_dwordx4 v[208:211], v7, s[4:7], s25 offen
  v_mfma_f32_4x4x4_16b_bf16 v[56:59], v[160:161], v[160:161], v[56:59]
  ds_read_b128 v[76:79], v1 offset:59392
  s_waitcnt lgkmcnt(4)
  v_mfma_f32_32x32x16_bf16 v[24:39], v[160:163], v[84:87], v[24:39]
  v_mfma_f32_4x4x4_16b_bf16 v[60:63], v[162:163], v[162:163], v[60:63]
  ds_read_b128 v[80:83], v1 offset:19456
  s_waitcnt vmcnt(11) lgkmcnt(4)
  v_mfma_f32_32x32x16_bf16 v[8:23], v[164:167], v[88:91], v[8:23]
  buffer_load_dwordx4 v[212:215], v5, s[4:7], s25 offen
  s_add_u32 s25, s25, 8192
  v_mfma_f32_4x4x4_16b_bf16 v[56:59], v[164:165], v[164:165], v[56:59]
  ds_read_b128 v[84:87], v1 offset:60416
  s_waitcnt lgkmcnt(4)
  v_mfma_f32_32x32x16_bf16 v[24:39], v[164:167], v[92:95], v[24:39]
  v_mfma_f32_4x4x4_16b_bf16 v[60:63], v[166:167], v[166:167], v[60:63]
  ds_read_b128 v[88:91], v1 offset:20480
  s_waitcnt vmcnt(11) lgkmcnt(4)
  v_mfma_f32_32x32x16_bf16 v[8:23], v[168:171], v[72:75], v[8:23]
  buffer_load_dwordx4 v[216:219], v7, s[4:7], s25 offen
  v_mfma_f32_4x4x4_16b_bf16 v[56:59], v[168:169], v[168:169], v[56:59]
  ds_read_b128 v[92:95], v1 offset:61440
  s_waitcnt lgkmcnt(4)
  v_mfma_f32_32x32x16_bf16 v[24:39], v[168:171], v[76:79], v[24:39]
  v_mfma_f32_4x4x4_16b_bf16 v[60:63], v[170:171], v[170:171], v[60:63]
  ds_read_b128 v[72:75], v1 offset:21504
  s_waitcnt vmcnt(11) lgkmcnt(4)
  v_mfma_f32_32x32x16_bf16 v[8:23], v[172:175], v[80:83], v[8:23]
  buffer_load_dwordx4 v[220:223], v5, s[4:7], s25 offen
  s_add_u32 s25, s25, 8192
  v_mfma_f32_4x4x4_16b_bf16 v[56:59], v[172:173], v[172:173], v[56:59]
  ds_read_b128 v[76:79], v1 offset:62464
  s_waitcnt lgkmcnt(4)
  v_mfma_f32_32x32x16_bf16 v[24:39], v[172:175], v[84:87], v[24:39]
  v_mfma_f32_4x4x4_16b_bf16 v[60:63], v[174:175], v[174:175], v[60:63]
  ds_read_b128 v[80:83], v1 offset:22528
  s_waitcnt vmcnt(11) lgkmcnt(4)
  v_mfma_f32_32x32x16_bf16 v[8:23], v[176:179], v[88:91], v[8:23]
  buffer_load_dwordx4 v[224:227], v7, s[4:7], s25 offen
  v_mfma_f32_4x4x4_16b_bf16 v[56:59], v[176:177], v[176:177], v[56:59]
  ds_read_b128 v[84:87], v1 offset:63488
  s_waitcnt lgkmcnt(4)
  v_mfma_f32_32x32x16_bf16 v[24:39], v[176:179], v[92:95], v[24:39]
  v_mfma_f32_4x4x4_16b_bf16 v[60:63], v[178:179], v[178:179], v[60:63]
  ds_read_b128 v[88:91], v1 offset:23552
  s_waitcnt vmcnt(11) lgkmcnt(4)
  v_mfma_f32_32x32x16_bf16 v[8:23], v[180:183], v[72:75], v[8:23]
  buffer_load_dwordx4 v[228:231], v5, s[4:7], s25 offen
  s_add_u32 s25, s25, 8192
  v_mfma_f32_4x4x4_16b_bf16 v[56:59], v[180:181], v[180:181], v[56:59]
  ds_read_b128 v[92:95], v1 offset:64512
  s_waitcnt lgkmcnt(4)
  v_mfma_f32_32x32x16_bf16 v[24:39], v[180:183], v[76:79], v[24:39]
  v_mfma_f32_4x4x4_16b_bf16 v[60:63], v[182:183], v[182:183], v[60:63]
  s_barrier
  ds_read_b128 v[72:75], v1 offset:24576
  s_waitcnt vmcnt(11) lgkmcnt(4)
  v_mfma_f32_32x32x16_bf16 v[8:23], v[184:187], v[80:83], v[8:23]
  buffer_load_dwordx4 v[232:235], v7, s[4:7], s25 offen
  v_mfma_f32_4x4x4_16b_bf16 v[56:59], v[184:185], v[184:185], v[56:59]
  ds_read_b128 v[76:79], v3 offset:0
  s_waitcnt lgkmcnt(4)
  v_mfma_f32_32x32x16_bf16 v[24:39], v[184:187], v[84:87], v[24:39]
  v_mfma_f32_4x4x4_16b_bf16 v[60:63], v[186:187], v[186:187], v[60:63]
  ds_read_b128 v[80:83], v1 offset:25600
  s_waitcnt vmcnt(11) lgkmcnt(4)
  v_mfma_f32_32x32x16_bf16 v[8:23], v[188:191], v[88:91], v[8:23]
  buffer_load_dwordx4 v[236:239], v5, s[4:7], s25 offen
  s_add_u32 s25, s25, 8192
  v_mfma_f32_4x4x4_16b_bf16 v[56:59], v[188:189], v[188:189], v[56:59]
  ds_read_b128 v[84:87], v3 offset:1024
  s_waitcnt lgkmcnt(4)
  v_mfma_f32_32x32x16_bf16 v[24:39], v[188:191], v[92:95], v[24:39]
  v_mfma_f32_4x4x4_16b_bf16 v[60:63], v[190:191], v[190:191], v[60:63]
  ds_read_b128 v[88:91], v1 offset:26624
  s_waitcnt vmcnt(11) lgkmcnt(4)
  v_mfma_f32_32x32x16_bf16 v[8:23], v[192:195], v[72:75], v[8:23]
  buffer_load_dwordx4 v[240:243], v7, s[4:7], s25 offen
  v_mfma_f32_4x4x4_16b_bf16 v[56:59], v[192:193], v[192:193], v[56:59]
  ds_read_b128 v[92:95], v3 offset:2048
  s_waitcnt lgkmcnt(4)
  v_mfma_f32_32x32x16_bf16 v[24:39], v[192:195], v[76:79], v[24:39]
  v_mfma_f32_4x4x4_16b_bf16 v[60:63], v[194:195], v[194:195], v[60:63]
  ds_read_b128 v[72:75], v1 offset:27648
  s_waitcnt vmcnt(11) lgkmcnt(4)
  v_mfma_f32_32x32x16_bf16 v[8:23], v[196:199], v[80:83], v[8:23]
  buffer_load_dwordx4 v[244:247], v5, s[4:7], s25 offen
  s_add_u32 s25, s25, 8192
  v_mfma_f32_4x4x4_16b_bf16 v[56:59], v[196:197], v[196:197], v[56:59]
  ds_read_b128 v[76:79], v3 offset:3072
  s_waitcnt lgkmcnt(4)
  v_mfma_f32_32x32x16_bf16 v[24:39], v[196:199], v[84:87], v[24:39]
  v_mfma_f32_4x4x4_16b_bf16 v[60:63], v[198:199], v[198:199], v[60:63]
  ds_read_b128 v[80:83], v1 offset:28672
  s_waitcnt vmcnt(11) lgkmcnt(4)
  v_mfma_f32_32x32x16_bf16 v[8:23], v[200:203], v[88:91], v[8:23]
  buffer_load_dwordx4 v[248:251], v7, s[4:7], s25 offen
  v_mfma_f32_4x4x4_16b_bf16 v[56:59], v[200:201], v[200:201], v[56:59]
  ds_read_b128 v[84:87], v3 offset:4096
  s_waitcnt lgkmcnt(4)
  v_mfma_f32_32x32x16_bf16 v[24:39], v[200:203], v[92:95], v[24:39]
  v_mfma_f32_4x4x4_16b_bf16 v[60:63], v[202:203], v[202:203], v[60:63]
  ds_read_b128 v[88:91], v1 offset:29696
  s_waitcnt vmcnt(11) lgkmcnt(4)
  v_mfma_f32_32x32x16_bf16 v[8:23], v[204:207], v[72:75], v[8:23]
  buffer_load_dwordx4 v[252:255], v5, s[4:7], s25 offen
  s_add_u32 s25, s25, 8192
  v_mfma_f32_4x4x4_16b_bf16 v[56:59], v[204:205], v[204:205], v[56:59]
  ds_read_b128 v[92:95], v3 offset:5120
  s_waitcnt lgkmcnt(4)
  v_mfma_f32_32x32x16_bf16 v[24:39], v[204:207], v[76:79], v[24:39]
  v_mfma_f32_4x4x4_16b_bf16 v[60:63], v[206:207], v[206:207], v[60:63]
  ds_read_b128 v[72:75], v1 offset:30720
  s_waitcnt vmcnt(11) lgkmcnt(4)
  v_mfma_f32_32x32x16_bf16 v[8:23], v[208:211], v[80:83], v[8:23]
  v_mfma_f32_4x4x4_16b_bf16 v[56:59], v[208:209], v[208:209], v[56:59]
  ds_read_b128 v[76:79], v3 offset:6144
  s_waitcnt lgkmcnt(4)
  v_mfma_f32_32x32x16_bf16 v[24:39], v[208:211], v[84:87], v[24:39]
  v_mfma_f32_4x4x4_16b_bf16 v[60:63], v[210:211], v[210:211], v[60:63]
  ds_read_b128 v[80:83], v1 offset:31744
  s_waitcnt vmcnt(10) lgkmcnt(4)
  v_mfma_f32_32x32x16_bf16 v[8:23], v[212:215], v[88:91], v[8:23]
  v_mfma_f32_4x4x4_16b_bf16 v[56:59], v[212:213], v[212:213], v[56:59]
  ds_read_b128 v[84:87], v3 offset:7168
  s_waitcnt lgkmcnt(4)
  v_mfma_f32_32x32x16_bf16 v[24:39], v[212:215], v[92:95], v[24:39]
  v_mfma_f32_4x4x4_16b_bf16 v[60:63], v[214:215], v[214:215], v[60:63]
  ds_read_b128 v[88:91], v1 offset:32768
  s_waitcnt vmcnt(9) lgkmcnt(4)
  v_mfma_f32_32x32x16_bf16 v[8:23], v[216:219], v[72:75], v[8:23]
  v_mfma_f32_4x4x4_16b_bf16 v[56:59], v[216:217], v[216:217], v[56:59]
  ds_read_b128 v[92:95], v3 offset:8192
  s_waitcnt lgkmcnt(4)
  v_mfma_f32_32x32x16_bf16 v[24:39], v[216:219], v[76:79], v[24:39]
  v_mfma_f32_4x4x4_16b_bf16 v[60:63], v[218:219], v[218:219], v[60:63]
  ds_read_b128 v[72:75], v1 offset:33792
  s_waitcnt vmcnt(8) lgkmcnt(4)
  v_mfma_f32_32x32x16_bf16 v[8:23], v[220:223], v[80:83], v[8:23]
  v_mfma_f32_4x4x4_16b_bf16 v[56:59], v[220:221], v[220:221], v[56:59]
  ds_read_b128 v[76:79], v3 offset:9216
  s_waitcnt lgkmcnt(4)
  v_mfma_f32_32x32x16_bf16 v[24:39], v[220:223], v[84:87], v[24:39]
  v_mfma_f32_4x4x4_16b_bf16 v[60:63], v[222:223], v[222:223], v[60:63]
  ds_read_b128 v[80:83], v1 offset:34816
  s_waitcnt vmcnt(7) lgkmcnt(4)
  v_mfma_f32_32x32x16_bf16 v[8:23], v[224:227], v[88:91], v[8:23]
  v_mfma_f32_4x4x4_16b_bf16 v[56:59], v[224:225], v[224:225], v[56:59]
  ds_read_b128 v[84:87], v3 offset:10240
  s_waitcnt lgkmcnt(4)
  v_mfma_f32_32x32x16_bf16 v[24:39], v[224:227], v[92:95], v[24:39]
  v_mfma_f32_4x4x4_16b_bf16 v[60:63], v[226:227], v[226:227], v[60:63]
  ds_read_b128 v[88:91], v1 offset:35840
  s_waitcnt vmcnt(6) lgkmcnt(4)
  v_mfma_f32_32x32x16_bf16 v[8:23], v[228:231], v[72:75], v[8:23]
  v_mfma_f32_4x4x4_16b_bf16 v[56:59], v[228:229], v[228:229], v[56:59]
  ds_read_b128 v[92:95], v3 offset:11264
  s_waitcnt lgkmcnt(4)
  v_mfma_f32_32x32x16_bf16 v[24:39], v[228:231], v[76:79], v[24:39]
  v_mfma_f32_4x4x4_16b_bf16 v[60:63], v[230:231], v[230:231], v[60:63]
  ds_read_b128 v[72:75], v1 offset:36864
  s_waitcnt vmcnt(5) lgkmcnt(4)
  v_mfma_f32_32x32x16_bf16 v[8:23], v[232:235], v[80:83], v[8:23]
  v_mfma_f32_4x4x4_16b_bf16 v[56:59], v[232:233], v[232:233], v[56:59]
  ds_read_b128 v[76:79], v3 offset:12288
  s_waitcnt lgkmcnt(4)
  v_mfma_f32_32x32x16_bf16 v[24:39], v[232:235], v[84:87], v[24:39]
  v_mfma_f32_4x4x4_16b_bf16 v[60:63], v[234:235], v[234:235], v[60:63]
  ds_read_b128 v[80:83], v1 offset:37888
  s_waitcnt vmcnt(4) lgkmcnt(4)
  v_mfma_f32_32x32x16_bf16 v[8:23], v[236:239], v[88:91], v[8:23]
  v_mfma_f32_4x4x4_16b_bf16 v[56:59], v[236:237], v[236:237], v[56:59]
  ds_read_b128 v[84:87], v3 offset:13312
  s_waitcnt lgkmcnt(4)
  v_mfma_f32_32x32x16_bf16 v[24:39], v[236:239], v[92:95], v[24:39]
  v_mfma_f32_4x4x4_16b_bf16 v[60:63], v[238:239], v[238:239], v[60:63]
  ds_read_b128 v[88:91], v1 offset:38912
  s_waitcnt vmcnt(3) lgkmcnt(4)
  v_mfma_f32_32x32x16_bf16 v[8:23], v[240:243], v[72:75], v[8:23]
  v_mfma_f32_4x4x4_16b_bf16 v[56:59], v[240:241], v[240:241], v[56:59]
  ds_read_b128 v[92:95], v3 offset:14336
  s_waitcnt lgkmcnt(4)
  v_mfma_f32_32x32x16_bf16 v[24:39], v[240:243], v[76:79], v[24:39]
  v_mfma_f32_4x4x4_16b_bf16 v[60:63], v[242:243], v[242:243], v[60:63]
  ds_read_b128 v[72:75], v1 offset:39936
  s_waitcnt vmcnt(2) lgkmcnt(4)
  v_mfma_f32_32x32x16_bf16 v[8:23], v[244:247], v[80:83], v[8:23]
  v_mfma_f32_4x4x4_16b_bf16 v[56:59], v[244:245], v[244:245], v[56:59]
  ds_read_b128 v[76:79], v3 offset:15360
  s_waitcnt lgkmcnt(4)
  v_mfma_f32_32x32x16_bf16 v[24:39], v[244:247], v[84:87], v[24:39]
  v_mfma_f32_4x4x4_16b_bf16 v[60:63], v[246:247], v[246:247], v[60:63]
  s_waitcnt lgkmcnt(0)
  s_barrier
  ds_read_b128 v[80:83], v3 offset:16384
  s_waitcnt vmcnt(1)
  v_mfma_f32_32x32x16_bf16 v[8:23], v[248:251], v[88:91], v[8:23]
  s_add_u32 m0, s29, 0
  s_nop 0
  buffer_load_dwordx4 v1, s[4:7], s28 offen lds
  s_add_u32 s28, s28, 20480
  v_mfma_f32_4x4x4_16b_bf16 v[56:59], v[248:249], v[248:249], v[56:59]
  ds_read_b128 v[84:87], v3 offset:17408
  v_mfma_f32_32x32x16_bf16 v[24:39], v[248:251], v[92:95], v[24:39]
  v_mfma_f32_4x4x4_16b_bf16 v[60:63], v[250:251], v[250:251], v[60:63]
  ds_read_b128 v[88:91], v3 offset:18432
  s_waitcnt vmcnt(1)
  v_mfma_f32_32x32x16_bf16 v[8:23], v[252:255], v[72:75], v[8:23]
  s_add_u32 m0, s29, 4096
  s_nop 0
  buffer_load_dwordx4 v1, s[4:7], s28 offen lds
  s_add_u32 s28, s28, 20480
  v_mfma_f32_4x4x4_16b_bf16 v[56:59], v[252:253], v[252:253], v[56:59]
  ds_read_b128 v[92:95], v3 offset:19456
  v_mfma_f32_32x32x16_bf16 v[24:39], v[252:255], v[76:79], v[24:39]
  v_mfma_f32_4x4x4_16b_bf16 v[60:63], v[254:255], v[254:255], v[60:63]
  ds_read_b128 v[72:75], v3 offset:20480
  s_waitcnt lgkmcnt(4)
  v_mfma_f32_32x32x16_bf16 v[40:55], v[96:99], v[80:83], 0
  s_add_u32 m0, s29, 8192
  s_nop 0
  buffer_load_dwordx4 v1, s[4:7], s28 offen lds
  s_add_u32 s28, s28, 20480
  ds_read_b128 v[76:79], v3 offset:21504
  s_waitcnt lgkmcnt(4)
  v_mfma_f32_32x32x16_bf16 v[40:55], v[100:103], v[84:87], v[40:55]
  ds_write_b128 v6, v[8:11] offset:0
  ds_write_b128 v6, v[12:15] offset:1024
  ds_write_b128 v6, v[16:19] offset:2048
  ds_write_b128 v6, v[20:23] offset:3072
  v_cndmask_b32 v56, v56, v57, s[32:33]
  v_cndmask_b32 v58, v58, v59, s[32:33]
  v_cndmask_b32 v60, v60, v61, s[32:33]
  v_cndmask_b32 v62, v62, v63, s[32:33]
  ds_read_b128 v[80:83], v3 offset:22528
  s_waitcnt lgkmcnt(8)
  v_mfma_f32_32x32x16_bf16 v[40:55], v[104:107], v[88:91], v[40:55]
  s_add_u32 m0, s29, 12288
  s_nop 0
  buffer_load_dwordx4 v1, s[4:7], s28 offen lds
  s_add_u32 s28, s28, 20480
  v_cndmask_b32 v56, v56, v58, s[34:35]
  v_cndmask_b32 v60, v60, v62, s[34:35]
  v_add_f32 v56, v56, v60
  v_lshrrev_b32 v64, 2, v1
  v_add_u32 v64, s27, v64
  v_mov_b32 v57, v56
  v_mov_b32 v58, 0x36a1369a
  ds_write_b128 v6, v[24:27] offset:4096
  ds_read_b128 v[84:87], v3 offset:23552
  s_waitcnt lgkmcnt(9)
  v_mfma_f32_32x32x16_bf16 v[40:55], v[108:111], v[92:95], v[40:55]
  v_permlane32_swap_b32 v56, v57
  v_add_f32 v56, v56, v57
  v_fmamk_f32 v56, v56, 0x3a44cb26, v58
  v_rsq_f32 v5, v56
  ds_write_b128 v6, v[28:31] offset:5120
  v_mul_f32 v57, 0x3f317218, v5
  v_cndmask_b32 v57, v57, v5, s[30:31]
  ds_write_b32 v64, v57
  ds_read_b128 v[88:91], v3 offset:24576
  s_waitcnt lgkmcnt(11)
  v_mfma_f32_32x32x16_bf16 v[40:55], v[112:115], v[72:75], v[40:55]
  s_add_u32 m0, s29, 16384
  s_nop 0
  buffer_load_dwordx4 v1, s[4:7], s28 offen lds
  s_add_u32 s28, s28, 20480
  v_mov_b32 v0, 1
  ds_write_b32 v2, v0 offset:16
  ds_write_b128 v6, v[32:35] offset:6144
  ds_write_b128 v6, v[36:39] offset:7168
  v_mov_b32 v59, 2
  ds_write_b32 v2, v59 offset:16
  v_mov_b32 v26, 140800
  v_mov_b32 v27, 1
  ds_read_b128 v[92:95], v3 offset:25600
  s_waitcnt lgkmcnt(15)
  v_mfma_f32_32x32x16_bf16 v[40:55], v[116:119], v[76:79], v[40:55]
  ds_read_b128 v[72:75], v3 offset:26624
  s_waitcnt lgkmcnt(11)
  v_mfma_f32_32x32x16_bf16 v[40:55], v[120:123], v[80:83], v[40:55]
  s_add_u32 m0, s29, 20480
  s_nop 0
  buffer_load_dwordx4 v1, s[4:7], s28 offen lds
  s_add_u32 s28, s28, 20480
  ds_read_b128 v[76:79], v3 offset:27648
  s_waitcnt lgkmcnt(10)
  v_mfma_f32_32x32x16_bf16 v[40:55], v[124:127], v[84:87], v[40:55]
  ds_read_b128 v[80:83], v3 offset:28672
  s_waitcnt lgkmcnt(8)
  v_mfma_f32_32x32x16_bf16 v[40:55], v[128:131], v[88:91], v[40:55]
  s_add_u32 m0, s29, 24576
  s_nop 0
  buffer_load_dwordx4 v1, s[4:7], s28 offen lds
  s_add_u32 s28, s28, 20480
  ds_read_b32 v25, v26 offset:76
  ds_read_b128 v[84:87], v3 offset:29696
  s_waitcnt lgkmcnt(5)
  v_mfma_f32_32x32x16_bf16 v[40:55], v[132:135], v[92:95], v[40:55]
  ds_read_b128 v[88:91], v3 offset:30720
  s_waitcnt lgkmcnt(5)
  v_mfma_f32_32x32x16_bf16 v[40:55], v[136:139], v[72:75], v[40:55]
  s_add_u32 m0, s29, 28672
  s_nop 0
  buffer_load_dwordx4 v1, s[4:7], s28 offen lds
  s_add_u32 s28, s28, 20480
  ds_read_b128 v[92:95], v3 offset:31744
  s_waitcnt lgkmcnt(5)
  v_mfma_f32_32x32x16_bf16 v[40:55], v[140:143], v[76:79], v[40:55]
  s_add_u32 m0, s29, 32768
  s_nop 0
  buffer_load_dwordx4 v1, s[4:7], s28 offen lds
  s_add_u32 s28, s28, 20480
  s_waitcnt lgkmcnt(3)
  v_readfirstlane_b32 s26, v25
  s_nop 0
  s_cmp_ge_u32 s26, 4
  s_cbranch_scc1 k3_g1_ok
k3_g1_sp:
  ds_read_b32 v25, v26 offset:76
  s_waitcnt lgkmcnt(0)
  v_readfirstlane_b32 s26, v25
  s_nop 0
  s_cmp_ge_u32 s26, 4
  s_cbranch_scc0 k3_g1_sp
k3_g1_ok:
  ds_read_b128 v[72:75], v3 offset:32768
  v_mfma_f32_32x32x16_bf16 v[40:55], v[144:147], v[80:83], v[40:55]
  s_add_u32 m0, s29, 36864
  s_nop 0
  buffer_load_dwordx4 v1, s[4:7], s28 offen lds
  s_add_u32 s28, s28, -183296
  ds_read_b128 v[76:79], v3 offset:33792
  s_waitcnt lgkmcnt(4)
  v_mfma_f32_32x32x16_bf16 v[40:55], v[148:151], v[84:87], v[40:55]
  ds_read_b128 v[80:83], v3 offset:34816
  s_waitcnt lgkmcnt(4)
  v_mfma_f32_32x32x16_bf16 v[40:55], v[152:155], v[88:91], v[40:55]
  ds_read_b128 v[84:87], v3 offset:35840
  s_waitcnt lgkmcnt(4)
  v_mfma_f32_32x32x16_bf16 v[40:55], v[156:159], v[92:95], v[40:55]
  ds_read_b128 v[88:91], v3 offset:36864
  s_waitcnt lgkmcnt(4)
  v_mfma_f32_32x32x16_bf16 v[40:55], v[160:163], v[72:75], v[40:55]
  ds_read_b128 v[92:95], v3 offset:37888
  s_waitcnt lgkmcnt(4)
  v_mfma_f32_32x32x16_bf16 v[40:55], v[164:167], v[76:79], v[40:55]
  ds_read_b128 v[72:75], v3 offset:38912
  s_waitcnt lgkmcnt(4)
  v_mfma_f32_32x32x16_bf16 v[40:55], v[168:171], v[80:83], v[40:55]
  ds_read_b128 v[76:79], v3 offset:39936
  s_waitcnt lgkmcnt(4)
  v_mfma_f32_32x32x16_bf16 v[40:55], v[172:175], v[84:87], v[40:55]
  ds_read_b32 v25, v26 offset:80
  ds_read_b128 v[80:83], v3 offset:40960
  s_waitcnt lgkmcnt(5)
  v_mfma_f32_32x32x16_bf16 v[40:55], v[176:179], v[88:91], v[40:55]
  ds_read_b128 v[84:87], v3 offset:41984
  s_waitcnt lgkmcnt(5)
  v_mfma_f32_32x32x16_bf16 v[40:55], v[180:183], v[92:95], v[40:55]
  ds_read_b128 v[88:91], v3 offset:43008
  s_waitcnt lgkmcnt(5)
  v_mfma_f32_32x32x16_bf16 v[40:55], v[184:187], v[72:75], v[40:55]
  ds_read_b128 v[92:95], v3 offset:44032
  s_waitcnt lgkmcnt(5)
  v_mfma_f32_32x32x16_bf16 v[40:55], v[188:191], v[76:79], v[40:55]
  s_waitcnt lgkmcnt(4)
  v_readfirstlane_b32 s26, v25
  s_nop 0
  s_cmp_ge_u32 s26, 4
  s_cbranch_scc1 k3_g2_ok
k3_g2_sp:
  ds_read_b32 v25, v26 offset:80
  s_waitcnt lgkmcnt(0)
  v_readfirstlane_b32 s26, v25
  s_nop 0
  s_cmp_ge_u32 s26, 4
  s_cbranch_scc0 k3_g2_sp
k3_g2_ok:
  ds_read_b128 v[72:75], v3 offset:45056
  s_waitcnt lgkmcnt(4)
  v_mfma_f32_32x32x16_bf16 v[40:55], v[192:195], v[80:83], v[40:55]
  ds_read_b128 v[76:79], v3 offset:46080
  s_waitcnt lgkmcnt(4)
  v_mfma_f32_32x32x16_bf16 v[40:55], v[196:199], v[84:87], v[40:55]
  ds_read_b128 v[80:83], v3 offset:47104
  s_waitcnt lgkmcnt(4)
  v_mfma_f32_32x32x16_bf16 v[40:55], v[200:203], v[88:91], v[40:55]
  ds_read_b128 v[84:87], v3 offset:48128
  s_waitcnt lgkmcnt(4)
  v_mfma_f32_32x32x16_bf16 v[40:55], v[204:207], v[92:95], v[40:55]
  ds_read_b128 v[88:91], v3 offset:49152
  s_waitcnt lgkmcnt(4)
  v_mfma_f32_32x32x16_bf16 v[40:55], v[208:211], v[72:75], v[40:55]
  ds_read_b128 v[92:95], v3 offset:50176
  s_waitcnt lgkmcnt(4)
  v_mfma_f32_32x32x16_bf16 v[40:55], v[212:215], v[76:79], v[40:55]
  s_waitcnt vmcnt(0)
  s_mov_b64 exec, 1
  ds_add_u32 v26, v27 offset:64
  s_mov_b64 exec, -1
  ds_read_b128 v[72:75], v3 offset:51200
  s_waitcnt lgkmcnt(5)
  v_mfma_f32_32x32x16_bf16 v[40:55], v[216:219], v[80:83], v[40:55]
  ds_read_b128 v[76:79], v3 offset:52224
  s_waitcnt lgkmcnt(5)
  v_mfma_f32_32x32x16_bf16 v[40:55], v[220:223], v[84:87], v[40:55]
  ds_read_b128 v[80:83], v3 offset:53248
  s_waitcnt lgkmcnt(5)
  v_mfma_f32_32x32x16_bf16 v[40:55], v[224:227], v[88:91], v[40:55]
  ds_read_b32 v25, v26 offset:64
  ds_read_b128 v[84:87], v3 offset:54272
  s_waitcnt lgkmcnt(6)
  v_mfma_f32_32x32x16_bf16 v[40:55], v[228:231], v[92:95], v[40:55]
  ds_read_b128 v[88:91], v3 offset:55296
  s_waitcnt lgkmcnt(5)
  v_mfma_f32_32x32x16_bf16 v[40:55], v[232:235], v[72:75], v[40:55]
  ds_read_b128 v[92:95], v3 offset:56320
  s_waitcnt lgkmcnt(5)
  v_mfma_f32_32x32x16_bf16 v[40:55], v[236:239], v[76:79], v[40:55]
  s_waitcnt lgkmcnt(3)
  v_readfirstlane_b32 s26, v25
  s_nop 0
  s_cmp_ge_u32 s26, 4
  s_cbranch_scc1 k3_g3_ok
k3_g3_sp:
  ds_read_b32 v25, v26 offset:64
  s_waitcnt lgkmcnt(0)
  v_readfirstlane_b32 s26, v25
  s_nop 0
  s_cmp_ge_u32 s26, 4
  s_cbranch_scc0 k3_g3_sp
k3_g3_ok:
  ds_read_b128 v[72:75], v1 offset:0
  v_mfma_f32_32x32x16_bf16 v[40:55], v[240:243], v[80:83], v[40:55]
  ds_read_b128 v[76:79], v1 offset:1024
  s_waitcnt lgkmcnt(4)
  v_mfma_f32_32x32x16_bf16 v[40:55], v[244:247], v[84:87], v[40:55]
  ds_read_b128 v[80:83], v1 offset:2048
  s_waitcnt lgkmcnt(4)
  v_mfma_f32_32x32x16_bf16 v[40:55], v[248:251], v[88:91], v[40:55]
  ds_read_b128 v[84:87], v1 offset:3072
  s_waitcnt lgkmcnt(4)
  v_mfma_f32_32x32x16_bf16 v[40:55], v[252:255], v[92:95], v[40:55]
  ds_read_b128 v[88:91], v1 offset:4096
  s_waitcnt lgkmcnt(4)
  v_mfma_f32_32x32x16_bf16 v[56:71], v[72:75], v[96:99], 0
  ds_read_b128 v[92:95], v1 offset:5120
  s_waitcnt lgkmcnt(4)
  v_mfma_f32_32x32x16_bf16 v[56:71], v[76:79], v[100:103], v[56:71]
  ds_read_b128 v[72:75], v1 offset:6144
  s_waitcnt lgkmcnt(4)
  v_mfma_f32_32x32x16_bf16 v[56:71], v[80:83], v[104:107], v[56:71]
  s_nop 2
  ds_write_b128 v4, v[40:43] offset:0
  ds_write_b128 v4, v[44:47] offset:1024
  ds_write_b128 v4, v[48:51] offset:2048
  ds_read_b128 v[76:79], v1 offset:7168
  s_waitcnt lgkmcnt(7)
  v_mfma_f32_32x32x16_bf16 v[56:71], v[84:87], v[108:111], v[56:71]
  ds_write_b128 v4, v[52:55] offset:3072
  v_mov_b32 v0, 3
  ds_write_b32 v2, v0 offset:16
  ds_read_b128 v[80:83], v1 offset:8192
  s_waitcnt lgkmcnt(9)
  v_mfma_f32_32x32x16_bf16 v[56:71], v[88:91], v[112:115], v[56:71]
  ds_read_b128 v[84:87], v1 offset:9216
  s_waitcnt lgkmcnt(9)
  v_mfma_f32_32x32x16_bf16 v[56:71], v[92:95], v[116:119], v[56:71]
  ds_read_b128 v[88:91], v1 offset:10240
  s_waitcnt lgkmcnt(9)
  v_mfma_f32_32x32x16_bf16 v[56:71], v[72:75], v[120:123], v[56:71]
  ds_read_b128 v[92:95], v1 offset:11264
  s_waitcnt lgkmcnt(6)
  v_mfma_f32_32x32x16_bf16 v[56:71], v[76:79], v[124:127], v[56:71]
  ds_read_b128 v[72:75], v1 offset:12288
  s_waitcnt lgkmcnt(4)
  v_mfma_f32_32x32x16_bf16 v[56:71], v[80:83], v[128:131], v[56:71]
  ds_read_b128 v[76:79], v1 offset:13312
  s_waitcnt lgkmcnt(4)
  v_mfma_f32_32x32x16_bf16 v[56:71], v[84:87], v[132:135], v[56:71]
  ds_read_b128 v[80:83], v1 offset:14336
  s_waitcnt lgkmcnt(4)
  v_mfma_f32_32x32x16_bf16 v[56:71], v[88:91], v[136:139], v[56:71]
  ds_read_b128 v[84:87], v1 offset:15360
  s_waitcnt lgkmcnt(4)
  v_mfma_f32_32x32x16_bf16 v[56:71], v[92:95], v[140:143], v[56:71]
  ds_read_b128 v[88:91], v1 offset:16384
  s_waitcnt lgkmcnt(4)
  v_mfma_f32_32x32x16_bf16 v[56:71], v[72:75], v[144:147], v[56:71]
  ds_read_b128 v[92:95], v1 offset:17408
  s_waitcnt lgkmcnt(4)
  v_mfma_f32_32x32x16_bf16 v[56:71], v[76:79], v[148:151], v[56:71]
  ds_read_b128 v[72:75], v1 offset:18432
  s_waitcnt lgkmcnt(4)
  v_mfma_f32_32x32x16_bf16 v[56:71], v[80:83], v[152:155], v[56:71]
  ds_read_b128 v[76:79], v1 offset:19456
  s_waitcnt lgkmcnt(4)
  v_mfma_f32_32x32x16_bf16 v[56:71], v[84:87], v[156:159], v[56:71]
  ds_read_b128 v[80:83], v1 offset:20480
  s_waitcnt lgkmcnt(4)
  v_mfma_f32_32x32x16_bf16 v[56:71], v[88:91], v[160:163], v[56:71]
  ds_read_b128 v[84:87], v1 offset:21504
  s_waitcnt lgkmcnt(4)
  v_mfma_f32_32x32x16_bf16 v[56:71], v[92:95], v[164:167], v[56:71]
  ds_read_b128 v[88:91], v1 offset:22528
  s_waitcnt lgkmcnt(4)
  v_mfma_f32_32x32x16_bf16 v[56:71], v[72:75], v[168:171], v[56:71]
  ds_read_b128 v[92:95], v1 offset:23552
  s_waitcnt lgkmcnt(4)
  v_mfma_f32_32x32x16_bf16 v[56:71], v[76:79], v[172:175], v[56:71]
  ds_read_b128 v[72:75], v1 offset:24576
  s_waitcnt lgkmcnt(4)
  v_mfma_f32_32x32x16_bf16 v[56:71], v[80:83], v[176:179], v[56:71]
  ds_read_b128 v[76:79], v1 offset:25600
  s_waitcnt lgkmcnt(4)
  v_mfma_f32_32x32x16_bf16 v[56:71], v[84:87], v[180:183], v[56:71]
  ds_read_b128 v[80:83], v1 offset:26624
  s_waitcnt lgkmcnt(4)
  v_mfma_f32_32x32x16_bf16 v[56:71], v[88:91], v[184:187], v[56:71]
  ds_read_b128 v[84:87], v1 offset:27648
  s_waitcnt lgkmcnt(4)
  v_mfma_f32_32x32x16_bf16 v[56:71], v[92:95], v[188:191], v[56:71]
  ds_read_b128 v[88:91], v1 offset:28672
  s_waitcnt lgkmcnt(4)
  v_mfma_f32_32x32x16_bf16 v[56:71], v[72:75], v[192:195], v[56:71]
  ds_read_b128 v[92:95], v1 offset:29696
  s_waitcnt lgkmcnt(4)
  v_mfma_f32_32x32x16_bf16 v[56:71], v[76:79], v[196:199], v[56:71]
  ds_read_b128 v[72:75], v1 offset:30720
  s_waitcnt lgkmcnt(4)
  v_mfma_f32_32x32x16_bf16 v[56:71], v[80:83], v[200:203], v[56:71]
  ds_read_b128 v[76:79], v1 offset:31744
  s_waitcnt lgkmcnt(4)
  v_mfma_f32_32x32x16_bf16 v[56:71], v[84:87], v[204:207], v[56:71]
  ds_read_b128 v[80:83], v1 offset:32768
  s_waitcnt lgkmcnt(4)
  v_mfma_f32_32x32x16_bf16 v[56:71], v[88:91], v[208:211], v[56:71]
  ds_read_b128 v[84:87], v1 offset:33792
  s_waitcnt lgkmcnt(4)
  v_mfma_f32_32x32x16_bf16 v[56:71], v[92:95], v[212:215], v[56:71]
  ds_read_b128 v[88:91], v1 offset:34816
  s_waitcnt lgkmcnt(4)
  v_mfma_f32_32x32x16_bf16 v[56:71], v[72:75], v[216:219], v[56:71]
  ds_read_b128 v[92:95], v1 offset:35840
  s_waitcnt lgkmcnt(4)
  v_mfma_f32_32x32x16_bf16 v[56:71], v[76:79], v[220:223], v[56:71]
  ds_read_b128 v[72:75], v1 offset:36864
  s_waitcnt lgkmcnt(4)
  v_mfma_f32_32x32x16_bf16 v[56:71], v[80:83], v[224:227], v[56:71]
  ds_read_b128 v[76:79], v1 offset:37888
  s_waitcnt lgkmcnt(4)
  v_mfma_f32_32x32x16_bf16 v[56:71], v[84:87], v[228:231], v[56:71]
  ds_read_b128 v[80:83], v1 offset:38912
  s_waitcnt lgkmcnt(4)
  v_mfma_f32_32x32x16_bf16 v[56:71], v[88:91], v[232:235], v[56:71]
  ds_read_b128 v[84:87], v1 offset:39936
  s_waitcnt lgkmcnt(4)
  v_mfma_f32_32x32x16_bf16 v[56:71], v[92:95], v[236:239], v[56:71]
  s_waitcnt lgkmcnt(3)
  v_mfma_f32_32x32x16_bf16 v[56:71], v[72:75], v[240:243], v[56:71]
  s_waitcnt lgkmcnt(2)
  v_mfma_f32_32x32x16_bf16 v[56:71], v[76:79], v[244:247], v[56:71]
  s_waitcnt lgkmcnt(1)
  v_mfma_f32_32x32x16_bf16 v[56:71], v[80:83], v[248:251], v[56:71]
  s_waitcnt lgkmcnt(0)
  v_mfma_f32_32x32x16_bf16 v[56:71], v[84:87], v[252:255], v[56:71]
  v_mov_b32 v6, 0x35c1a2a0
  s_mov_b32 s39, 0x3f317218
  s_add_u32 s44, s43, 13271040
  s_nop 8
  v_mul_f32 v56, v56, v5
  v_min_f32 v40, 0, v56
  v_exp_f32 v40, v40
  v_max_f32 v56, v6, v56
  v_mul_f32 v57, v57, v5
  v_min_f32 v41, 0, v57
  v_exp_f32 v41, v41
  v_max_f32 v57, v6, v57
  v_fma_f32 v56, v56, s39, v40
  v_mul_f32 v58, v58, v5
  v_min_f32 v42, 0, v58
  v_exp_f32 v42, v42
  v_max_f32 v58, v6, v58
  v_fma_f32 v57, v57, s39, v41
  v_cvt_pk_bf16_f32 v40, v56, v57
  v_mul_f32 v59, v59, v5
  v_min_f32 v43, 0, v59
  v_exp_f32 v43, v43
  v_max_f32 v59, v6, v59
  v_fma_f32 v58, v58, s39, v42
  v_mul_f32 v60, v60, v5
  v_min_f32 v44, 0, v60
  v_exp_f32 v44, v44
  v_max_f32 v60, v6, v60
  v_fma_f32 v59, v59, s39, v43
  v_cvt_pk_bf16_f32 v41, v58, v59
  v_mul_f32 v61, v61, v5
  v_min_f32 v45, 0, v61
  v_exp_f32 v45, v45
  v_max_f32 v61, v6, v61
  v_fma_f32 v60, v60, s39, v44
  v_mul_f32 v62, v62, v5
  v_min_f32 v46, 0, v62
  v_exp_f32 v46, v46
  v_max_f32 v62, v6, v62
  v_fma_f32 v61, v61, s39, v45
  v_cvt_pk_bf16_f32 v42, v60, v61
  v_mul_f32 v63, v63, v5
  v_min_f32 v47, 0, v63
  v_exp_f32 v47, v47
  v_max_f32 v63, v6, v63
  v_fma_f32 v62, v62, s39, v46
  v_mul_f32 v64, v64, v5
  v_min_f32 v48, 0, v64
  v_exp_f32 v48, v48
  v_max_f32 v64, v6, v64
  v_fma_f32 v63, v63, s39, v47
  v_cvt_pk_bf16_f32 v43, v62, v63
  buffer_store_dwordx4 v[40:43], v7, s[4:7], s44 offen sc1
  s_add_u32 s44, s44, 4096
  v_mul_f32 v65, v65, v5
  v_min_f32 v49, 0, v65
  v_exp_f32 v49, v49
  v_max_f32 v65, v6, v65
  v_fma_f32 v64, v64, s39, v48
  v_mul_f32 v66, v66, v5
  v_min_f32 v50, 0, v66
  v_exp_f32 v50, v50
  v_max_f32 v66, v6, v66
  v_fma_f32 v65, v65, s39, v49
  v_cvt_pk_bf16_f32 v44, v64, v65
  v_mul_f32 v67, v67, v5
  v_min_f32 v51, 0, v67
  v_exp_f32 v51, v51
  v_max_f32 v67, v6, v67
  v_fma_f32 v66, v66, s39, v50
  v_mul_f32 v68, v68, v5
  v_min_f32 v52, 0, v68
  v_exp_f32 v52, v52
  v_max_f32 v68, v6, v68
  v_fma_f32 v67, v67, s39, v51
  v_cvt_pk_bf16_f32 v45, v66, v67
  v_mul_f32 v69, v69, v5
  v_min_f32 v53, 0, v69
  v_exp_f32 v53, v53
  v_max_f32 v69, v6, v69
  v_fma_f32 v68, v68, s39, v52
  v_mul_f32 v70, v70, v5
  v_min_f32 v54, 0, v70
  v_exp_f32 v54, v54
  v_max_f32 v70, v6, v70
  v_fma_f32 v69, v69, s39, v53
  v_cvt_pk_bf16_f32 v46, v68, v69
  v_mul_f32 v71, v71, v5
  v_min_f32 v55, 0, v71
  v_exp_f32 v55, v55
  v_max_f32 v71, v6, v71
  v_fma_f32 v70, v70, s39, v54
  v_fma_f32 v71, v71, s39, v55
  v_cvt_pk_bf16_f32 v47, v70, v71
  buffer_store_dwordx4 v[44:47], v7, s[4:7], s44 offen sc1
  s_endpgm
k3_h:
  s_add_u32 s26, s28, 2048
  s_add_u32 s28, s28, 61440
  v_and_b32 v9, 31, v0
  v_lshlrev_b32 v9, 2, v9
  v_add_u32 v9, 140800, v9
  v_mov_b32 v8, 0
  ds_write_b32 v9, v8
  v_mov_b32 v20, 140800
  v_mov_b32 v21, 1
  s_add_u32 m0, s29, 12288
  s_nop 0
  buffer_load_dwordx4 v1, s[4:7], s28 offen offset:0 lds
  s_add_u32 m0, s29, 52224
  s_nop 0
  buffer_load_dwordx4 v1, s[4:7], s28 offen offset:1024 lds
  s_add_u32 s28, s28, 20480
  s_waitcnt vmcnt(2) lgkmcnt(0)
  s_barrier
  s_add_u32 m0, s29, 16384
  s_nop 0
  buffer_load_dwordx4 v1, s[4:7], s28 offen offset:0 lds
  s_add_u32 m0, s29, 56320
  s_nop 0
  buffer_load_dwordx4 v1, s[4:7], s28 offen offset:1024 lds
  s_add_u32 s28, s28, 20480
  s_add_u32 m0, s29, 20480
  s_nop 0
  buffer_load_dwordx4 v1, s[4:7], s28 offen offset:0 lds
  s_add_u32 m0, s29, 60416
  s_nop 0
  buffer_load_dwordx4 v1, s[4:7], s28 offen offset:1024 lds
  s_add_u32 s28, s28, 20480
  s_add_u32 m0, s29, 24576
  s_nop 0
  buffer_load_dwordx4 v1, s[4:7], s28 offen offset:0 lds
  s_add_u32 m0, s29, 64512
  s_nop 0
  buffer_load_dwordx4 v1, s[4:7], s28 offen offset:1024 lds
  s_add_u32 s28, s28, 20480
  v_and_b32 v2, 31, v0
  v_bfe_u32 v3, v0, 5, 1
  s_lshl_b32 s30, s20, 9
  v_lshl_add_u32 v4, v2, 4, s30
  v_lshlrev_b32 v11, 2, v3
  v_sub_u32 v11, v2, v11
  v_and_b32 v12, 1, v11
  v_lshlrev_b32 v12, 4, v12
  v_mov_b32 v13, 0x3f80
  v_lshlrev_b32 v12, v12, v13
  v_or_b32 v11, 1, v11
  v_cmp_eq_u32 vcc, 1, v11
  s_nop 1
  v_cndmask_b32 v32, 0, v12, vcc
  v_cmp_eq_u32 vcc, 3, v11
  s_nop 1
  v_cndmask_b32 v33, 0, v12, vcc
  v_cmp_eq_u32 vcc, 9, v11
  s_nop 1
  v_cndmask_b32 v34, 0, v12, vcc
  v_cmp_eq_u32 vcc, 11, v11
  s_nop 1
  v_cndmask_b32 v35, 0, v12, vcc
  v_cmp_eq_u32 vcc, 17, v11
  s_nop 1
  v_cndmask_b32 v36, 0, v12, vcc
  v_cmp_eq_u32 vcc, 19, v11
  s_nop 1
  v_cndmask_b32 v37, 0, v12, vcc
  v_cmp_eq_u32 vcc, 25, v11
  s_nop 1
  v_cndmask_b32 v38, 0, v12, vcc
  v_cmp_eq_u32 vcc, 27, v11
  s_nop 1
  v_cndmask_b32 v39, 0, v12, vcc
  v_cmp_gt_u32 s[30:31], 8, v2
  v_cmp_gt_u32 s[32:33], 16, v2
  v_cmp_eq_u32 s[34:35], 4, v2
  v_cmp_eq_u32 s[36:37], 11, v2
  s_nop 0
  s_or_b64 s[34:35], s[34:35], s[36:37]
  v_subrev_u32 v12, 8, v2
  v_cmp_gt_u32 s[36:37], 16, v12
  v_mov_b32 v13, 0xff800000
  v_mov_b32 v14, 0x35c1a2a0
  v_cndmask_b32 v15, v14, v13, s[36:37]
  v_cndmask_b32 v13, 0, v13, s[36:37]
  s_mov_b32 s39, 0x3f317218
  v_mov_b32 v11, 0x3f803f80
  s_mul_i32 s38, s20, 384
  s_add_u32 s38, s38, 139264
  v_mov_b32 v9, 1.0
  v_lshl_add_u32 v17, v2, 2, s38
  ds_write_b32 v17, v9 offset:256
  v_lshl_add_u32 v17, v3, 4, s38
  v_subrev_u32 v9, 4, v2
  v_cmp_gt_u32 vcc, 8, v9
  v_add_u32 v9, 128, v17
  s_nop 0
  v_cndmask_b32 v18, v17, v9, vcc
  s_lshl_b32 s38, s20, 12
  s_add_u32 s38, s38, 122880
  v_add_u32 v16, s38, v1
  s_lshl_b32 s38, s20, 13
  s_add_u32 s38, s38, 40960
  v_add_u32 v6, s38, v1
  v_lshrrev_b32 v9, 1, v1
  v_add_u32 v7, s38, v9
  s_mul_i32 s38, s20, 1536
  s_add_u32 m0, s29, 28672
  s_nop 0
  buffer_load_dwordx4 v1, s[4:7], s28 offen offset:0 lds
  s_add_u32 m0, s29, 68608
  s_nop 0
  buffer_load_dwordx4 v1, s[4:7], s28 offen offset:1024 lds
  s_add_u32 s28, s28, 20480
  s_waitcnt vmcnt(4) lgkmcnt(0)
  s_barrier
  s_add_u32 m0, s29, 32768
  s_nop 0
  buffer_load_dwordx4 v1, s[4:7], s28 offen offset:0 lds
  s_add_u32 m0, s29, 72704
  s_nop 0
  buffer_load_dwordx4 v1, s[4:7], s28 offen offset:1024 lds
  s_add_u32 s28, s28, 20480
  s_add_u32 m0, s29, 36864
  s_nop 0
  buffer_load_dwordx4 v1, s[4:7], s28 offen offset:0 lds
  s_add_u32 m0, s29, 76800
  s_nop 0
  buffer_load_dwordx4 v1, s[4:7], s28 offen offset:1024 lds
  s_add_u32 s28, s28, 20480
  s_add_u32 s38, s38, 40960
  v_add_u32 v12, s38, v9
  s_lshl_b32 s38, s20, 2
  s_add_u32 s38, s38, 140800
  v_mov_b32 v19, s38
  s_lshr_b32 s40, s20, 1
  s_and_b32 s41, s20, 1
  s_mul_i32 s42, s40, 12
  v_add_u32 v10, s42, v2
  v_and_b32 v10, 31, v10
  v_cmp_gt_u32 s[50:51], 20, v10
  s_lshl_b32 s42, s40, 2
  v_subrev_u32 v10, s42, v10
  v_cmp_gt_i32 vcc, 0, v10
  v_add_u32 v9, 24, v10
  s_nop 0
  v_cndmask_b32 v10, v10, v9, vcc
  v_lshlrev_b32 v10, 2, v10
  v_mul_u32_u24 v9, 384, v3
  v_add_u32 v10, v10, v9
  v_lshl_add_u32 v5, v3, 3, v4
  v_cmp_eq_u32 s[52:53], s40, v3
  s_nop 0
  s_and_b64 s[52:53], s[52:53], s[50:51]
  s_cmp_eq_u32 s41, 0
  s_cselect_b64 s[52:53], s[52:53], s[50:51]
  s_cmp_eq_u32 s40, 0
  s_cselect_b64 s[54:55], s[50:51], s[52:53]
  s_cselect_b64 s[56:57], s[52:53], s[50:51]
  s_mul_i32 s45, s22, 4032
  s_add_u32 s45, s45, 26132480
  s_lshl_b32 s46, s20, 3
  s_lshr_b32 s60, 470943488, s46
  s_and_b32 s60, s60, 0xff
  s_mul_i32 s60, s60, 96
  s_add_u32 s60, s60, s45
  s_lshr_b32 s61, 487786497, s46
  s_and_b32 s61, s61, 0xff
  s_mul_i32 s61, s61, 96
  s_add_u32 s61, s61, s45
  s_lshr_b32 s62, 571739394, s46
  s_and_b32 s62, s62, 0xff
  s_mul_i32 s62, s62, 96
  s_add_u32 s62, s62, s45
  s_lshr_b32 s63, 588582403, s46
  s_and_b32 s63, s63, 0xff
  s_mul_i32 s63, s63, 96
  s_add_u32 s63, s63, s45
  s_lshr_b32 s64, 605687557, s46
  s_and_b32 s64, s64, 0xff
  s_mul_i32 s64, s64, 96
  s_add_u32 s64, s64, s45
  s_lshr_b32 s65, 622530566, s46
  s_and_b32 s65, s65, 0xff
  s_mul_i32 s65, s65, 96
  s_add_u32 s65, s65, s45
  s_add_u32 m0, s29, 81920
  s_nop 0
  buffer_load_dwordx4 v1, s[4:7], s26 offen lds
  s_add_u32 s26, s26, 20480
  s_add_u32 m0, s29, 86016
  s_nop 0
  buffer_load_dwordx4 v1, s[4:7], s26 offen lds
  s_add_u32 s26, s26, 20480
  s_add_u32 m0, s29, 90112
  s_nop 0
  buffer_load_dwordx4 v1, s[4:7], s26 offen lds
  s_add_u32 s26, s26, 20480
  s_add_u32 m0, s29, 94208
  s_nop 0
  buffer_load_dwordx4 v1, s[4:7], s26 offen lds
  s_add_u32 s26, s26, 20480
  s_waitcnt vmcnt(4) lgkmcnt(0)
  s_barrier
  s_add_u32 m0, s29, 98304
  s_nop 0
  buffer_load_dwordx4 v1, s[4:7], s26 offen lds
  s_add_u32 s26, s26, 20480
  s_add_u32 m0, s29, 102400
  s_nop 0
  buffer_load_dwordx4 v1, s[4:7], s26 offen lds
  s_add_u32 s26, s26, 20480
  s_add_u32 m0, s29, 106496
  s_nop 0
  buffer_load_dwordx4 v1, s[4:7], s26 offen lds
  s_add_u32 s26, s26, 20480
  s_add_u32 m0, s29, 110592
  s_nop 0
  buffer_load_dwordx4 v1, s[4:7], s26 offen lds
  s_add_u32 s26, s26, 20480
  s_add_u32 m0, s29, 114688
  s_nop 0
  buffer_load_dwordx4 v1, s[4:7], s26 offen lds
  s_add_u32 s26, s26, 20480
  s_add_u32 m0, s29, 118784
  s_nop 0
  buffer_load_dwordx4 v1, s[4:7], s26 offen lds
  s_add_u32 s26, s26, 20480
  s_waitcnt vmcnt(6) lgkmcnt(0)
  s_barrier
  s_waitcnt vmcnt(3)
  s_mov_b64 exec, 1
  ds_add_u32 v20, v21 offset:76
  s_mov_b64 exec, -1
k3_h4:
  ds_read_b32 v22, v19 offset:16
  s_waitcnt lgkmcnt(0)
  v_readfirstlane_b32 s68, v22
  s_nop 0
  s_cmp_ge_u32 s68, 1
  s_cbranch_scc0 k3_h4
  ds_read_b128 v[88:91], v17 offset:0
  ds_read_b128 v[40:43], v6 offset:0
  ds_read_b128 v[92:95], v17 offset:32
  ds_read_b128 v[44:47], v6 offset:1024
  ds_read_b128 v[96:99], v17 offset:64
  ds_read_b128 v[48:51], v6 offset:2048
  ds_read_b128 v[100:103], v17 offset:96
  ds_read_b128 v[52:55], v6 offset:3072
  s_waitcnt lgkmcnt(6)
  v_mul_f32 v120, v40, v88
  v_min_f32 v136, 0, v120
  v_exp_f32 v136, v136
  v_max_f32 v120, v14, v120
  v_mul_f32 v121, v41, v89
  v_min_f32 v137, 0, v121
  v_exp_f32 v137, v137
  v_max_f32 v121, v14, v121
  v_fma_f32 v120, v120, s39, v136
  v_mul_f32 v122, v42, v90
  v_min_f32 v138, 0, v122
  v_exp_f32 v138, v138
  v_max_f32 v122, v14, v122
  v_fma_f32 v121, v121, s39, v137
  v_cvt_pk_bf16_f32 v152, v120, v121
  v_mul_f32 v123, v43, v91
  v_min_f32 v139, 0, v123
  v_exp_f32 v139, v139
  v_max_f32 v123, v14, v123
  v_fma_f32 v122, v122, s39, v138
  s_waitcnt vmcnt(0)
  s_mov_b64 exec, 1
  ds_add_u32 v20, v21 offset:80
  s_mov_b64 exec, -1
  s_waitcnt lgkmcnt(5)
  v_mul_f32 v124, v44, v92
  v_min_f32 v140, 0, v124
  v_exp_f32 v140, v140
  v_max_f32 v124, v14, v124
  v_fma_f32 v123, v123, s39, v139
  v_cvt_pk_bf16_f32 v153, v122, v123
  v_mul_f32 v125, v45, v93
  v_min_f32 v141, 0, v125
  v_exp_f32 v141, v141
  v_max_f32 v125, v14, v125
  v_fma_f32 v124, v124, s39, v140
  v_mul_f32 v126, v46, v94
  v_min_f32 v142, 0, v126
  v_exp_f32 v142, v142
  v_max_f32 v126, v14, v126
  v_fma_f32 v125, v125, s39, v141
  v_cvt_pk_bf16_f32 v154, v124, v125
  v_mul_f32 v127, v47, v95
  v_min_f32 v143, 0, v127
  v_exp_f32 v143, v143
  v_max_f32 v127, v14, v127
  v_fma_f32 v126, v126, s39, v142
k3_h5:
  ds_read_b32 v22, v19 offset:16
  s_waitcnt lgkmcnt(0)
  v_readfirstlane_b32 s68, v22
  s_nop 0
  s_cmp_ge_u32 s68, 2
  s_cbranch_scc0 k3_h5
  ds_read_b128 v[56:59], v6 offset:4096
  ds_read_b128 v[60:63], v6 offset:5120
  ds_read_b128 v[64:67], v6 offset:6144
  ds_read_b128 v[68:71], v6 offset:7168
  ds_read_b128 v[104:107], v18 offset:128
  ds_read_b128 v[108:111], v18 offset:160
  ds_read_b128 v[112:115], v18 offset:192
  ds_read_b128 v[116:119], v18 offset:224
  v_mul_f32 v128, v48, v96
  v_min_f32 v144, 0, v128
  v_exp_f32 v144, v144
  v_max_f32 v128, v14, v128
  v_fma_f32 v127, v127, s39, v143
  v_cvt_pk_bf16_f32 v155, v126, v127
  v_mul_f32 v129, v49, v97
  v_min_f32 v145, 0, v129
  v_exp_f32 v145, v145
  v_max_f32 v129, v14, v129
  v_fma_f32 v128, v128, s39, v144
  v_mul_f32 v130, v50, v98
  v_min_f32 v146, 0, v130
  v_exp_f32 v146, v146
  v_max_f32 v130, v14, v130
  v_fma_f32 v129, v129, s39, v145
  v_cvt_pk_bf16_f32 v156, v128, v129
  v_mul_f32 v131, v51, v99
  v_min_f32 v147, 0, v131
  v_exp_f32 v147, v147
  v_max_f32 v131, v14, v131
  v_fma_f32 v130, v130, s39, v146
  v_mul_f32 v132, v52, v100
  v_min_f32 v148, 0, v132
  v_exp_f32 v148, v148
  v_max_f32 v132, v14, v132
  v_fma_f32 v131, v131, s39, v147
  v_cvt_pk_bf16_f32 v157, v130, v131
  v_mul_f32 v133, v53, v101
  v_min_f32 v149, 0, v133
  v_exp_f32 v149, v149
  v_max_f32 v133, v14, v133
  v_fma_f32 v132, v132, s39, v148
  v_mul_f32 v134, v54, v102
  v_min_f32 v150, 0, v134
  v_exp_f32 v150, v150
  v_max_f32 v134, v14, v134
  v_fma_f32 v133, v133, s39, v149
  v_cvt_pk_bf16_f32 v158, v132, v133
  v_mul_f32 v135, v55, v103
  v_min_f32 v151, 0, v135
  v_exp_f32 v151, v151
  v_max_f32 v135, v14, v135
  v_fma_f32 v134, v134, s39, v150
  v_fma_f32 v135, v135, s39, v151
  v_cvt_pk_bf16_f32 v159, v134, v135
  s_waitcnt lgkmcnt(7)
  v_mul_f32 v120, v56, v88
  v_min_f32 v136, v13, v120
  v_exp_f32 v136, v136
  v_max_f32 v120, v15, v120
  v_mul_f32 v121, v57, v89
  v_min_f32 v137, v13, v121
  v_exp_f32 v137, v137
  v_max_f32 v121, v15, v121
  v_fma_f32 v120, v120, s39, v136
  v_mul_f32 v122, v58, v90
  v_min_f32 v138, v13, v122
  v_exp_f32 v138, v138
  v_max_f32 v122, v15, v122
  v_fma_f32 v121, v121, s39, v137
  v_cvt_pk_bf16_f32 v160, v120, v121
  v_mul_f32 v123, v59, v91
  v_min_f32 v139, v13, v123
  v_exp_f32 v139, v139
  v_max_f32 v123, v15, v123
  v_fma_f32 v122, v122, s39, v138
  s_waitcnt lgkmcnt(6)
  v_mul_f32 v124, v60, v92
  v_min_f32 v140, v13, v124
  v_exp_f32 v140, v140
  v_max_f32 v124, v15, v124
  v_fma_f32 v123, v123, s39, v139
  v_cvt_pk_bf16_f32 v161, v122, v123
  v_mul_f32 v125, v61, v93
  v_min_f32 v141, v13, v125
  v_exp_f32 v141, v141
  v_max_f32 v125, v15, v125
  v_fma_f32 v124, v124, s39, v140
  v_mul_f32 v126, v62, v94
  v_min_f32 v142, v13, v126
  v_exp_f32 v142, v142
  v_max_f32 v126, v15, v126
  v_fma_f32 v125, v125, s39, v141
  v_cvt_pk_bf16_f32 v162, v124, v125
  v_mul_f32 v127, v63, v95
  v_min_f32 v143, v13, v127
  v_exp_f32 v143, v143
  v_max_f32 v127, v15, v127
  v_fma_f32 v126, v126, s39, v142
  s_waitcnt lgkmcnt(5)
  v_mul_f32 v128, v64, v96
  v_min_f32 v144, v13, v128
  v_exp_f32 v144, v144
  v_max_f32 v128, v15, v128
  v_fma_f32 v127, v127, s39, v143
  v_cvt_pk_bf16_f32 v163, v126, v127
  v_mul_f32 v129, v65, v97
  v_min_f32 v145, v13, v129
  v_exp_f32 v145, v145
  v_max_f32 v129, v15, v129
  v_fma_f32 v128, v128, s39, v144
  v_mul_f32 v130, v66, v98
  v_min_f32 v146, v13, v130
  v_exp_f32 v146, v146
  v_max_f32 v130, v15, v130
  v_fma_f32 v129, v129, s39, v145
  v_cvt_pk_bf16_f32 v164, v128, v129
  v_mul_f32 v131, v67, v99
  v_min_f32 v147, v13, v131
  v_exp_f32 v147, v147
  v_max_f32 v131, v15, v131
  v_fma_f32 v130, v130, s39, v146
  s_waitcnt lgkmcnt(4)
  v_mul_f32 v132, v68, v100
  v_min_f32 v148, v13, v132
  v_exp_f32 v148, v148
  v_max_f32 v132, v15, v132
  v_fma_f32 v131, v131, s39, v147
  v_cvt_pk_bf16_f32 v165, v130, v131
  v_mul_f32 v133, v69, v101
  v_min_f32 v149, v13, v133
  v_exp_f32 v149, v149
  v_max_f32 v133, v15, v133
  v_fma_f32 v132, v132, s39, v148
  v_mul_f32 v134, v70, v102
  v_min_f32 v150, v13, v134
  v_exp_f32 v150, v150
  v_max_f32 v134, v15, v134
  v_fma_f32 v133, v133, s39, v149
  v_cvt_pk_bf16_f32 v166, v132, v133
  v_mul_f32 v135, v71, v103
  v_min_f32 v151, v13, v135
  v_exp_f32 v151, v151
  v_max_f32 v135, v15, v135
  v_fma_f32 v134, v134, s39, v150
  v_fma_f32 v135, v135, s39, v151
  v_cvt_pk_bf16_f32 v167, v134, v135
  v_cndmask_b32 v136, v152, v160, s[30:31]
  v_cndmask_b32 v137, v153, v161, s[30:31]
  v_cndmask_b32 v138, v154, v162, s[30:31]
  v_cndmask_b32 v139, v155, v163, s[30:31]
  v_cndmask_b32 v140, v156, v164, s[30:31]
  v_cndmask_b32 v141, v157, v165, s[30:31]
  v_cndmask_b32 v142, v158, v166, s[30:31]
  v_cndmask_b32 v143, v159, v167, s[30:31]
k3_h6:
  ds_read_b32 v22, v19 offset:16
  s_waitcnt lgkmcnt(0)
  v_readfirstlane_b32 s68, v22
  s_nop 0
  s_cmp_ge_u32 s68, 3
  s_cbranch_scc0 k3_h6
  s_setprio 1
  ds_read_b128 v[72:75], v16 offset:0
  ds_read_b128 v[76:79], v16 offset:1024
  ds_read_b128 v[80:83], v16 offset:2048
  ds_read_b128 v[84:87], v16 offset:3072
  s_waitcnt lgkmcnt(3)
  v_mul_f32 v120, v72, v104
  v_mul_f32 v121, v73, v105
  v_cvt_pk_bf16_f32 v176, v120, v121
  v_cndmask_b32 v168, v176, v11, s[34:35]
  v_cndmask_b32 v184, v160, v168, s[30:31]
  v_mul_f32 v122, v74, v106
  v_mul_f32 v123, v75, v107
  v_cvt_pk_bf16_f32 v177, v122, v123
  v_cndmask_b32 v169, v177, v11, s[34:35]
  v_cndmask_b32 v185, v161, v169, s[30:31]
  s_waitcnt lgkmcnt(2)
  v_mul_f32 v124, v76, v108
  v_mul_f32 v125, v77, v109
  v_cvt_pk_bf16_f32 v178, v124, v125
  v_cndmask_b32 v170, v178, v11, s[34:35]
  v_cndmask_b32 v186, v162, v170, s[30:31]
  v_mul_f32 v126, v78, v110
  v_mul_f32 v127, v79, v111
  v_cvt_pk_bf16_f32 v179, v126, v127
  v_cndmask_b32 v171, v179, v11, s[34:35]
  v_cndmask_b32 v187, v163, v171, s[30:31]
  s_nop 0
  v_mfma_f32_32x32x16_bf16 v[208:223], v[168:171], v[136:139], 0
  v_mfma_f32_32x32x16_bf16 v[192:207], v[184:187], v[152:155], 0
  s_waitcnt lgkmcnt(1)
  v_mul_f32 v128, v80, v112
  v_mul_f32 v129, v81, v113
  v_cvt_pk_bf16_f32 v180, v128, v129
  v_cndmask_b32 v172, v180, v11, s[34:35]
  v_cndmask_b32 v188, v164, v172, s[30:31]
  v_mul_f32 v130, v82, v114
  v_mul_f32 v131, v83, v115
  v_cvt_pk_bf16_f32 v181, v130, v131
  v_cndmask_b32 v173, v181, v11, s[34:35]
  v_cndmask_b32 v189, v165, v173, s[30:31]
  s_waitcnt lgkmcnt(0)
  v_mul_f32 v132, v84, v116
  v_mul_f32 v133, v85, v117
  v_cvt_pk_bf16_f32 v182, v132, v133
  v_cndmask_b32 v174, v182, v11, s[34:35]
  v_cndmask_b32 v190, v166, v174, s[30:31]
  v_mul_f32 v134, v86, v118
  v_mul_f32 v135, v87, v119
  v_cvt_pk_bf16_f32 v183, v134, v135
  v_cndmask_b32 v175, v183, v11, s[34:35]
  v_cndmask_b32 v191, v167, v175, s[30:31]
  s_nop 0
  v_mfma_f32_32x32x16_bf16 v[208:223], v[172:175], v[140:143], v[208:223]
  v_mfma_f32_32x32x16_bf16 v[192:207], v[188:191], v[156:159], v[192:207]
  v_cndmask_b32 v176, v160, v176, s[32:33]
  v_cndmask_b32 v177, v161, v177, s[32:33]
  v_cndmask_b32 v178, v162, v178, s[32:33]
  v_cndmask_b32 v179, v163, v179, s[32:33]
  v_cndmask_b32 v180, v164, v180, s[32:33]
  v_cndmask_b32 v181, v165, v181, s[32:33]
  v_cndmask_b32 v182, v166, v182, s[32:33]
  v_cndmask_b32 v183, v167, v183, s[32:33]
  s_nop 2
  ds_write_b64 v7, v[212:213] offset:3072
  ds_write_b64 v7, v[214:215] offset:3584
  ds_write_b64 v7, v[216:217] offset:4096
  ds_write_b64 v7, v[218:219] offset:4608
  ds_write_b64 v7, v[220:221] offset:5120
  ds_write_b64 v7, v[222:223] offset:5632
  ds_write_b64 v7, v[192:193] offset:0
  ds_write_b64 v7, v[194:195] offset:512
  ds_write_b64 v7, v[196:197] offset:1024
  ds_write_b64 v7, v[198:199] offset:1536
  ds_write_b64 v7, v[200:201] offset:2048
  ds_write_b64 v7, v[202:203] offset:2560
  s_mov_b64 exec, 1
  ds_add_u32 v20, v21 offset:36
  s_mov_b64 exec, -1
  v_mfma_f32_32x32x16_bf16 v[224:239], v[176:179], v[32:35], 0
  v_mfma_f32_32x32x16_bf16 v[224:239], v[180:183], v[36:39], v[224:239]
k3_h7:
  ds_read_b32 v22, v20 offset:36
  s_waitcnt lgkmcnt(0)
  v_readfirstlane_b32 s68, v22
  s_nop 0
  s_cmp_ge_u32 s68, 4
  s_cbranch_scc0 k3_h7
  ds_read_b64 v[40:41], v12 offset:0
  ds_read_b64 v[42:43], v12 offset:512
  ds_read_b64 v[44:45], v12 offset:1024
  ds_read_b64 v[46:47], v12 offset:8192
  ds_read_b64 v[48:49], v12 offset:8704
  ds_read_b64 v[50:51], v12 offset:9216
  ds_read_b64 v[52:53], v12 offset:16384
  ds_read_b64 v[54:55], v12 offset:16896
  ds_read_b64 v[56:57], v12 offset:17408
  ds_read_b64 v[58:59], v12 offset:24576
  ds_read_b64 v[60:61], v12 offset:25088
  ds_read_b64 v[62:63], v12 offset:25600
  s_waitcnt lgkmcnt(8)
  v_add_f32 v40, v40, v46
  s_waitcnt lgkmcnt(2)
  v_add_f32 v52, v52, v58
  v_add_f32 v41, v41, v47
  v_add_f32 v53, v53, v59
  v_add_f32 v42, v42, v48
  s_waitcnt lgkmcnt(1)
  v_add_f32 v54, v54, v60
  v_add_f32 v43, v43, v49
  v_add_f32 v55, v55, v61
  v_add_f32 v44, v44, v50
  s_waitcnt lgkmcnt(0)
  v_add_f32 v56, v56, v62
  v_add_f32 v45, v45, v51
  v_add_f32 v57, v57, v63
  v_add_f32 v40, v40, v52
  v_add_f32 v41, v41, v53
  v_add_f32 v42, v42, v54
  v_add_f32 v43, v43, v55
  v_add_f32 v44, v44, v56
  v_add_f32 v45, v45, v57
  s_mov_b64 exec, s[54:55]
  buffer_atomic_add_f32 v40, v10, s[4:7], s60 offen
  s_mov_b64 exec, s[52:53]
  buffer_atomic_add_f32 v41, v10, s[4:7], s61 offen
  s_mov_b64 exec, s[52:53]
  buffer_atomic_add_f32 v42, v10, s[4:7], s62 offen
  s_mov_b64 exec, s[56:57]
  buffer_atomic_add_f32 v43, v10, s[4:7], s63 offen
  s_mov_b64 exec, s[50:51]
  buffer_atomic_add_f32 v44, v10, s[4:7], s64 offen
  s_mov_b64 exec, s[50:51]
  buffer_atomic_add_f32 v45, v10, s[4:7], s65 offen
  s_mov_b64 exec, -1
  s_add_u32 s44, s43, 13279232
  v_cvt_pk_bf16_f32 v120, v236, v237
  v_cvt_pk_bf16_f32 v121, v238, v239
  buffer_store_dwordx2 v[120:121], v5, s[4:7], s44 offen
  s_endpgm
k3_exit:
  s_endpgm
.globl k6_kernel
.p2align 8
.type k6_kernel,@function
k6_kernel:
  s_cmp_ge_u32 s2, 256
  s_cbranch_scc1 k6_exit
  s_load_dwordx2 s[4:5], s[0:1], 64
  s_mov_b32 s6, 28360704
  s_mov_b32 s7, 0x20000
  v_lshrrev_b32 v1, 6, v0
  s_nop 0
  v_readfirstlane_b32 s19, v1
  v_and_b32 v1, 63, v0
  v_lshlrev_b32 v1, 4, v1
  s_bfe_u32 s21, s2, 0x20001
  s_lshl_b32 s21, s21, 2
  s_lshr_b32 s22, s2, 6
  s_add_u32 s21, s21, s22
  s_and_b32 s22, s2, 1
  s_lshl_b32 s22, s22, 3
  s_bfe_u32 s23, s2, 0x30003
  s_add_u32 s22, s22, s23
  s_and_b32 s20, s19, 3
  s_mul_i32 s23, s21, 165888
  s_mul_i32 s43, s22, 10240
  s_add_u32 s43, s43, s23
  s_mul_i32 s28, s22, 204800
  s_mul_i32 s27, s20, 5120
  s_add_u32 s28, s28, s27
  s_add_u32 s28, s28, 21200896
  s_lshl_b32 s29, s20, 10
  s_lshr_b32 s24, s19, 2
  s_mul_i32 s25, s24, 40960
  s_add_u32 s25, s25, s29
  s_lshl_b32 s24, s24, 10
  s_add_u32 s24, s24, s28
  s_add_u32 m0, s25, 0
  s_waitcnt lgkmcnt(0)
  buffer_load_dwordx4 v1, s[4:7], s24 offen lds
  s_add_u32 s24, s24, 20480
  s_add_u32 m0, s25, 4096
  s_nop 0
  buffer_load_dwordx4 v1, s[4:7], s24 offen lds
  s_add_u32 s24, s24, 20480
  s_add_u32 m0, s25, 8192
  s_nop 0
  buffer_load_dwordx4 v1, s[4:7], s24 offen lds
  s_cmp_ge_u32 s19, 4
  s_cbranch_scc1 k6_h
  v_and_b32 v2, 31, v0
  v_bfe_u32 v3, v0, 5, 1
  s_lshl_b32 s24, s20, 9
  v_lshl_add_u32 v7, v2, 4, s24
  v_lshl_add_u32 v7, v3, 11, v7
  v_add_u32 v5, 4096, v7
  s_add_u32 s25, s23, 7962624
  s_add_u32 s28, s28, 3072
  buffer_load_dwordx4 v[96:99], v7, s[4:7], s25 offen
  buffer_load_dwordx4 v[100:103], v5, s[4:7], s25 offen
  s_add_u32 s25, s25, 8192
  buffer_load_dwordx4 v[104:107], v7, s[4:7], s25 offen
  buffer_load_dwordx4 v[108:111], v5, s[4:7], s25 offen
  s_add_u32 s25, s25, 8192
  s_mul_i32 s27, s20, 384
  s_add_u32 s27, s27, 139264
  v_cmp_eq_u32 s[30:31], 0, v3
  v_mov_b32 v44, -1
  v_mov_b32 v45, 0xffff
  v_cndmask_b32 v44, v44, v45, s[30:31]
  v_and_b32 v45, 1, v2
  v_cmp_ne_u32 s[32:33], 0, v45
  v_and_b32 v45, 2, v2
  v_cmp_ne_u32 s[34:35], 0, v45
  v_and_b32 v45, 8, v2
  v_cmp_ne_u32 s[36:37], 0, v45
  v_and_b32 v45, 16, v2
  v_cmp_ne_u32 s[38:39], 0, v45
  v_bfe_u32 v45, v2, 2, 1
  v_cmp_eq_u32 s[40:41], v45, v3
  v_add_u32 v3, 0x10000, v1
  s_lshl_b32 s24, s20, 13
  s_add_u32 s24, s24, 40960
  v_add_u32 v6, s24, v1
  s_lshl_b32 s24, s20, 12
  s_add_u32 s24, s24, 122880
  v_add_u32 v4, s24, v1
  s_lshl_b32 s24, s20, 2
  s_add_u32 s24, s24, 140800
  v_mov_b32 v2, s24
  buffer_load_dwordx4 v[112:115], v7, s[4:7], s25 offen
  buffer_load_dwordx4 v[116:119], v5, s[4:7], s25 offen
  s_add_u32 s25, s25, 8192
  buffer_load_dwordx4 v[120:123], v7, s[4:7], s25 offen
  buffer_load_dwordx4 v[124:127], v5, s[4:7], s25 offen
  s_add_u32 s25, s25, 8192
  s_waitcnt vmcnt(8)
  s_barrier
  ds_read_b128 v[72:75], v1 offset:0
  ds_read_b128 v[76:79], v1 offset:40960
  ds_read_b128 v[80:83], v1 offset:1024
  ds_read_b128 v[84:87], v1 offset:41984
  ds_read_b128 v[88:91], v1 offset:2048
  s_waitcnt vmcnt(7) lgkmcnt(4)
  v_mfma_f32_32x32x16_bf16 v[8:23], v[96:99], v[72:75], 0
  buffer_load_dwordx4 v[128:131], v7, s[4:7], s25 offen
  v_and_b32 v40, v96, v44
  v_mov_b32 v41, v97
  s_nop 1
  v_mfma_f32_4x4x4_16b_bf16 v[56:59], v[40:41], v[40:41], 0
  ds_read_b128 v[92:95], v1 offset:43008
  s_waitcnt lgkmcnt(4)
  v_mfma_f32_32x32x16_bf16 v[24:39], v[96:99], v[76:79], 0
  buffer_load_dwordx4 v[132:135], v5, s[4:7], s25 offen
  s_add_u32 s25, s25, 8192
  v_mfma_f32_4x4x4_16b_bf16 v[60:63], v[98:99], v[98:99], 0
  ds_read_b128 v[72:75], v1 offset:3072
  s_waitcnt vmcnt(8) lgkmcnt(4)
  v_mfma_f32_32x32x16_bf16 v[8:23], v[100:103], v[80:83], v[8:23]
  buffer_load_dwordx4 v[136:139], v7, s[4:7], s25 offen
  v_mfma_f32_4x4x4_16b_bf16 v[56:59], v[100:101], v[100:101], v[56:59]
  ds_read_b128 v[76:79], v1 offset:44032
  s_waitcnt lgkmcnt(4)
  v_mfma_f32_32x32x16_bf16 v[24:39], v[100:103], v[84:87], v[24:39]
  buffer_load_dwordx4 v[140:143], v5, s[4:7], s25 offen
  s_add_u32 s25, s25, 8192
  v_mfma_f32_4x4x4_16b_bf16 v[60:63], v[102:103], v[102:103], v[60:63]
  ds_read_b128 v[80:83], v1 offset:4096
  s_waitcnt vmcnt(9) lgkmcnt(4)
  v_mfma_f32_32x32x16_bf16 v[8:23], v[104:107], v[88:91], v[8:23]
  buffer_load_dwordx4 v[144:147], v7, s[4:7], s25 offen
  v_mfma_f32_4x4x4_16b_bf16 v[56:59], v[104:105], v[104:105], v[56:59]
  ds_read_b128 v[84:87], v1 offset:45056
  s_waitcnt lgkmcnt(4)
  v_mfma_f32_32x32x16_bf16 v[24:39], v[104:107], v[92:95], v[24:39]
  buffer_load_dwordx4 v[148:151], v5, s[4:7], s25 offen
  s_add_u32 s25, s25, 8192
  v_mfma_f32_4x4x4_16b_bf16 v[60:63], v[106:107], v[106:107], v[60:63]
  ds_read_b128 v[88:91], v1 offset:5120
  s_waitcnt vmcnt(10) lgkmcnt(4)
  v_mfma_f32_32x32x16_bf16 v[8:23], v[108:111], v[72:75], v[8:23]
  buffer_load_dwordx4 v[152:155], v7, s[4:7], s25 offen
  v_mfma_f32_4x4x4_16b_bf16 v[56:59], v[108:109], v[108:109], v[56:59]
  ds_read_b128 v[92:95], v1 offset:46080
  s_waitcnt lgkmcnt(4)
  v_mfma_f32_32x32x16_bf16 v[24:39], v[108:111], v[76:79], v[24:39]
  buffer_load_dwordx4 v[156:159], v5, s[4:7], s25 offen
  s_add_u32 s25, s25, 8192
  v_mfma_f32_4x4x4_16b_bf16 v[60:63], v[110:111], v[110:111], v[60:63]
  ds_read_b128 v[72:75], v1 offset:6144
  s_waitcnt vmcnt(11) lgkmcnt(4)
  v_mfma_f32_32x32x16_bf16 v[8:23], v[112:115], v[80:83], v[8:23]
  buffer_load_dwordx4 v[160:163], v7, s[4:7], s25 offen
  v_mfma_f32_4x4x4_16b_bf16 v[56:59], v[112:113], v[112:113], v[56:59]
  ds_read_b128 v[76:79], v1 offset:47104
  s_waitcnt lgkmcnt(4)
  v_mfma_f32_32x32x16_bf16 v[24:39], v[112:115], v[84:87], v[24:39]
  v_mfma_f32_4x4x4_16b_bf16 v[60:63], v[114:115], v[114:115], v[60:63]
  ds_read_b128 v[80:83], v1 offset:7168
  s_waitcnt vmcnt(11) lgkmcnt(4)
  v_mfma_f32_32x32x16_bf16 v[8:23], v[116:119], v[88:91], v[8:23]
  buffer_load_dwordx4 v[164:167], v5, s[4:7], s25 offen
  s_add_u32 s25, s25, 8192
  v_mfma_f32_4x4x4_16b_bf16 v[56:59], v[116:117], v[116:117], v[56:59]
  ds_read_b128 v[84:87], v1 offset:48128
  s_waitcnt lgkmcnt(4)
  v_mfma_f32_32x32x16_bf16 v[24:39], v[116:119], v[92:95], v[24:39]
  v_mfma_f32_4x4x4_16b_bf16 v[60:63], v[118:119], v[118:119], v[60:63]
  ds_read_b128 v[88:91], v1 offset:8192
  s_waitcnt vmcnt(11) lgkmcnt(4)
  v_mfma_f32_32x32x16_bf16 v[8:23], v[120:123], v[72:75], v[8:23]
  buffer_load_dwordx4 v[168:171], v7, s[4:7], s25 offen
  v_mfma_f32_4x4x4_16b_bf16 v[56:59], v[120:121], v[120:121], v[56:59]
  ds_read_b128 v[92:95], v1 offset:49152
  s_waitcnt lgkmcnt(4)
  v_mfma_f32_32x32x16_bf16 v[24:39], v[120:123], v[76:79], v[24:39]
  v_mfma_f32_4x4x4_16b_bf16 v[60:63], v[122:123], v[122:123], v[60:63]
  ds_read_b128 v[72:75], v1 offset:9216
  s_waitcnt vmcnt(11) lgkmcnt(4)
  v_mfma_f32_32x32x16_bf16 v[8:23], v[124:127], v[80:83], v[8:23]
  buffer_load_dwordx4 v[172:175], v5, s[4:7], s25 offen
  s_add_u32 s25, s25, 8192
  v_mfma_f32_4x4x4_16b_bf16 v[56:59], v[124:125], v[124:125], v[56:59]
  ds_read_b128 v[76:79], v1 offset:50176
  s_waitcnt lgkmcnt(4)
  v_mfma_f32_32x32x16_bf16 v[24:39], v[124:127], v[84:87], v[24:39]
  v_mfma_f32_4x4x4_16b_bf16 v[60:63], v[126:127], v[126:127], v[60:63]
  ds_read_b128 v[80:83], v1 offset:10240
  s_waitcnt vmcnt(11) lgkmcnt(4)
  v_mfma_f32_32x32x16_bf16 v[8:23], v[128:131], v[88:91], v[8:23]
  buffer_load_dwordx4 v[176:179], v7, s[4:7], s25 offen
  v_mfma_f32_4x4x4_16b_bf16 v[56:59], v[128:129], v[128:129], v[56:59]
  ds_read_b128 v[84:87], v1 offset:51200
  s_waitcnt lgkmcnt(4)
  v_mfma_f32_32x32x16_bf16 v[24:39], v[128:131], v[92:95], v[24:39]
  v_mfma_f32_4x4x4_16b_bf16 v[60:63], v[130:131], v[130:131], v[60:63]
  ds_read_b128 v[88:91], v1 offset:11264
  s_waitcnt vmcnt(11) lgkmcnt(4)
  v_mfma_f32_32x32x16_bf16 v[8:23], v[132:135], v[72:75], v[8:23]
  buffer_load_dwordx4 v[180:183], v5, s[4:7], s25 offen
  s_add_u32 s25, s25, 8192
  v_mfma_f32_4x4x4_16b_bf16 v[56:59], v[132:133], v[132:133], v[56:59]
  ds_read_b128 v[92:95], v1 offset:52224
  s_waitcnt lgkmcnt(4)
  v_mfma_f32_32x32x16_bf16 v[24:39], v[132:135], v[76:79], v[24:39]
  v_mfma_f32_4x4x4_16b_bf16 v[60:63], v[134:135], v[134:135], v[60:63]
  s_barrier
  ds_read_b128 v[72:75], v1 offset:12288
  s_waitcnt vmcnt(11) lgkmcnt(4)
  v_mfma_f32_32x32x16_bf16 v[8:23], v[136:139], v[80:83], v[8:23]
  buffer_load_dwordx4 v[184:187], v7, s[4:7], s25 offen
  v_mfma_f32_4x4x4_16b_bf16 v[56:59], v[136:137], v[136:137], v[56:59]
  ds_read_b128 v[76:79], v1 offset:53248
  s_waitcnt lgkmcnt(4)
  v_mfma_f32_32x32x16_bf16 v[24:39], v[136:139], v[84:87], v[24:39]
  v_mfma_f32_4x4x4_16b_bf16 v[60:63], v[138:139], v[138:139], v[60:63]
  ds_read_b128 v[80:83], v1 offset:13312
  s_waitcnt vmcnt(11) lgkmcnt(4)
  v_mfma_f32_32x32x16_bf16 v[8:23], v[140:143], v[88:91], v[8:23]
  buffer_load_dwordx4 v[188:191], v5, s[4:7], s25 offen
  s_add_u32 s25, s25, 8192
  v_mfma_f32_4x4x4_16b_bf16 v[56:59], v[140:141], v[140:141], v[56:59]
  ds_read_b128 v[84:87], v1 offset:54272
  s_waitcnt lgkmcnt(4)
  v_mfma_f32_32x32x16_bf16 v[24:39], v[140:143], v[92:95], v[24:39]
  v_mfma_f32_4x4x4_16b_bf16 v[60:63], v[142:143], v[142:143], v[60:63]
  ds_read_b128 v[88:91], v1 offset:14336
  s_waitcnt vmcnt(11) lgkmcnt(4)
  v_mfma_f32_32x32x16_bf16 v[8:23], v[144:147], v[72:75], v[8:23]
  buffer_load_dwordx4 v[192:195], v7, s[4:7], s25 offen
  v_mfma_f32_4x4x4_16b_bf16 v[56:59], v[144:145], v[144:145], v[56:59]
  ds_read_b128 v[92:95], v1 offset:55296
  s_waitcnt lgkmcnt(4)
  v_mfma_f32_32x32x16_bf16 v[24:39], v[144:147], v[76:79], v[24:39]
  v_mfma_f32_4x4x4_16b_bf16 v[60:63], v[146:147], v[146:147], v[60:63]
  ds_read_b128 v[72:75], v1 offset:15360
  s_waitcnt vmcnt(11) lgkmcnt(4)
  v_mfma_f32_32x32x16_bf16 v[8:23], v[148:151], v[80:83], v[8:23]
  buffer_load_dwordx4 v[196:199], v5, s[4:7], s25 offen
  s_add_u32 s25, s25, 8192
  v_mfma_f32_4x4x4_16b_bf16 v[56:59], v[148:149], v[148:149], v[56:59]
  ds_read_b128 v[76:79], v1 offset:56320
  s_waitcnt lgkmcnt(4)
  v_mfma_f32_32x32x16_bf16 v[24:39], v[148:151], v[84:87], v[24:39]
  v_mfma_f32_4x4x4_16b_bf16 v[60:63], v[150:151], v[150:151], v[60:63]
  ds_read_b128 v[80:83], v1 offset:16384
  s_waitcnt vmcnt(11) lgkmcnt(4)
  v_mfma_f32_32x32x16_bf16 v[8:23], v[152:155], v[88:91], v[8:23]
  buffer_load_dwordx4 v[200:203], v7, s[4:7], s25 offen
  v_mfma_f32_4x4x4_16b_bf16 v[56:59], v[152:153], v[152:153], v[56:59]
  ds_read_b128 v[84:87], v1 offset:57344
  s_waitcnt lgkmcnt(4)
  v_mfma_f32_32x32x16_bf16 v[24:39], v[152:155], v[92:95], v[24:39]
  v_mfma_f32_4x4x4_16b_bf16 v[60:63], v[154:155], v[154:155], v[60:63]
  ds_read_b128 v[88:91], v1 offset:17408
  s_waitcnt vmcnt(11) lgkmcnt(4)
  v_mfma_f32_32x32x16_bf16 v[8:23], v[156:159], v[72:75], v[8:23]
  buffer_load_dwordx4 v[204:207], v5, s[4:7], s25 offen
  s_add_u32 s25, s25, 8192
  v_mfma_f32_4x4x4_16b_bf16 v[56:59], v[156:157], v[156:157], v[56:59]
  ds_read_b128 v[92:95], v1 offset:58368
  s_waitcnt lgkmcnt(4)
  v_mfma_f32_32x32x16_bf16 v[24:39], v[156:159], v[76:79], v[24:39]
  v_mfma_f32_4x4x4_16b_bf16 v[60:63], v[158:159], v[158:159], v[60:63]
  ds_read_b128 v[72:75], v1 offset:18432
  s_waitcnt vmcnt(11) lgkmcnt(4)
  v_mfma_f32_32x32x16_bf16 v[8:23], v[160:163], v[80:83], v[8:23]
  buffer_load_dwordx4 v[208:211], v7, s[4:7], s25 offen
  v_mfma_f32_4x4x4_16b_bf16 v[56:59], v[160:161], v[160:161], v[56:59]
  ds_read_b128 v[76:79], v1 offset:59392
  s_waitcnt lgkmcnt(4)
  v_mfma_f32_32x32x16_bf16 v[24:39], v[160:163], v[84:87], v[24:39]
  v_mfma_f32_4x4x4_16b_bf16 v[60:63], v[162:163], v[162:163], v[60:63]
  ds_read_b128 v[80:83], v1 offset:19456
  s_waitcnt vmcnt(11) lgkmcnt(4)
  v_mfma_f32_32x32x16_bf16 v[8:23], v[164:167], v[88:91], v[8:23]
  buffer_load_dwordx4 v[212:215], v5, s[4:7], s25 offen
  s_add_u32 s25, s25, 8192
  v_mfma_f32_4x4x4_16b_bf16 v[56:59], v[164:165], v[164:165], v[56:59]
  ds_read_b128 v[84:87], v1 offset:60416
  s_waitcnt lgkmcnt(4)
  v_mfma_f32_32x32x16_bf16 v[24:39], v[164:167], v[92:95], v[24:39]
  v_mfma_f32_4x4x4_16b_bf16 v[60:63], v[166:167], v[166:167], v[60:63]
  ds_read_b128 v[88:91], v1 offset:20480
  s_waitcnt vmcnt(11) lgkmcnt(4)
  v_mfma_f32_32x32x16_bf16 v[8:23], v[168:171], v[72:75], v[8:23]
  buffer_load_dwordx4 v[216:219], v7, s[4:7], s25 offen
  v_mfma_f32_4x4x4_16b_bf16 v[56:59], v[168:169], v[168:169], v[56:59]
  ds_read_b128 v[92:95], v1 offset:61440
  s_waitcnt lgkmcnt(4)
  v_mfma_f32_32x32x16_bf16 v[24:39], v[168:171], v[76:79], v[24:39]
  v_mfma_f32_4x4x4_16b_bf16 v[60:63], v[170:171], v[170:171], v[60:63]
  ds_read_b128 v[72:75], v1 offset:21504
  s_waitcnt vmcnt(11) lgkmcnt(4)
  v_mfma_f32_32x32x16_bf16 v[8:23], v[172:175], v[80:83], v[8:23]
  buffer_load_dwordx4 v[220:223], v5, s[4:7], s25 offen
  s_add_u32 s25, s25, 8192
  v_mfma_f32_4x4x4_16b_bf16 v[56:59], v[172:173], v[172:173], v[56:59]
  ds_read_b128 v[76:79], v1 offset:62464
  s_waitcnt lgkmcnt(4)
  v_mfma_f32_32x32x16_bf16 v[24:39], v[172:175], v[84:87], v[24:39]
  v_mfma_f32_4x4x4_16b_bf16 v[60:63], v[174:175], v[174:175], v[60:63]
  ds_read_b128 v[80:83], v1 offset:22528
  s_waitcnt vmcnt(11) lgkmcnt(4)
  v_mfma_f32_32x32x16_bf16 v[8:23], v[176:179], v[88:91], v[8:23]
  buffer_load_dwordx4 v[224:227], v7, s[4:7], s25 offen
  v_mfma_f32_4x4x4_16b_bf16 v[56:59], v[176:177], v[176:177], v[56:59]
  ds_read_b128 v[84:87], v1 offset:63488
  s_waitcnt lgkmcnt(4)
  v_mfma_f32_32x32x16_bf16 v[24:39], v[176:179], v[92:95], v[24:39]
  v_mfma_f32_4x4x4_16b_bf16 v[60:63], v[178:179], v[178:179], v[60:63]
  ds_read_b128 v[88:91], v1 offset:23552
  s_waitcnt vmcnt(11) lgkmcnt(4)
  v_mfma_f32_32x32x16_bf16 v[8:23], v[180:183], v[72:75], v[8:23]
  buffer_load_dwordx4 v[228:231], v5, s[4:7], s25 offen
  s_add_u32 s25, s25, 8192
  v_mfma_f32_4x4x4_16b_bf16 v[56:59], v[180:181], v[180:181], v[56:59]
  ds_read_b128 v[92:95], v1 offset:64512
  s_waitcnt lgkmcnt(4)
  v_mfma_f32_32x32x16_bf16 v[24:39], v[180:183], v[76:79], v[24:39]
  v_mfma_f32_4x4x4_16b_bf16 v[60:63], v[182:183], v[182:183], v[60:63]
  s_barrier
  ds_read_b128 v[72:75], v1 offset:24576
  s_waitcnt vmcnt(11) lgkmcnt(4)
  v_mfma_f32_32x32x16_bf16 v[8:23], v[184:187], v[80:83], v[8:23]
  buffer_load_dwordx4 v[232:235], v7, s[4:7], s25 offen
  v_mfma_f32_4x4x4_16b_bf16 v[56:59], v[184:185], v[184:185], v[56:59]
  ds_read_b128 v[76:79], v3 offset:0
  s_waitcnt lgkmcnt(4)
  v_mfma_f32_32x32x16_bf16 v[24:39], v[184:187], v[84:87], v[24:39]
  v_mfma_f32_4x4x4_16b_bf16 v[60:63], v[186:187], v[186:187], v[60:63]
  ds_read_b128 v[80:83], v1 offset:25600
  s_waitcnt vmcnt(11) lgkmcnt(4)
  v_mfma_f32_32x32x16_bf16 v[8:23], v[188:191], v[88:91], v[8:23]
  buffer_load_dwordx4 v[236:239], v5, s[4:7], s25 offen
  s_add_u32 s25, s25, 8192
  v_mfma_f32_4x4x4_16b_bf16 v[56:59], v[188:189], v[188:189], v[56:59]
  ds_read_b128 v[84:87], v3 offset:1024
  s_waitcnt lgkmcnt(4)
  v_mfma_f32_32x32x16_bf16 v[24:39], v[188:191], v[92:95], v[24:39]
  v_mfma_f32_4x4x4_16b_bf16 v[60:63], v[190:191], v[190:191], v[60:63]
  ds_read_b128 v[88:91], v1 offset:26624
  s_waitcnt vmcnt(11) lgkmcnt(4)
  v_mfma_f32_32x32x16_bf16 v[8:23], v[192:195], v[72:75], v[8:23]
  buffer_load_dwordx4 v[240:243], v7, s[4:7], s25 offen
  v_mfma_f32_4x4x4_16b_bf16 v[56:59], v[192:193], v[192:193], v[56:59]
  ds_read_b128 v[92:95], v3 offset:2048
  s_waitcnt lgkmcnt(4)
  v_mfma_f32_32x32x16_bf16 v[24:39], v[192:195], v[76:79], v[24:39]
  v_mfma_f32_4x4x4_16b_bf16 v[60:63], v[194:195], v[194:195], v[60:63]
  ds_read_b128 v[72:75], v1 offset:27648
  s_waitcnt vmcnt(11) lgkmcnt(4)
  v_mfma_f32_32x32x16_bf16 v[8:23], v[196:199], v[80:83], v[8:23]
  buffer_load_dwordx4 v[244:247], v5, s[4:7], s25 offen
  s_add_u32 s25, s25, 8192
  v_mfma_f32_4x4x4_16b_bf16 v[56:59], v[196:197], v[196:197], v[56:59]
  ds_read_b128 v[76:79], v3 offset:3072
  s_waitcnt lgkmcnt(4)
  v_mfma_f32_32x32x16_bf16 v[24:39], v[196:199], v[84:87], v[24:39]
  v_mfma_f32_4x4x4_16b_bf16 v[60:63], v[198:199], v[198:199], v[60:63]
  ds_read_b128 v[80:83], v1 offset:28672
  s_waitcnt vmcnt(11) lgkmcnt(4)
  v_mfma_f32_32x32x16_bf16 v[8:23], v[200:203], v[88:91], v[8:23]
  buffer_load_dwordx4 v[248:251], v7, s[4:7], s25 offen
  v_mfma_f32_4x4x4_16b_bf16 v[56:59], v[200:201], v[200:201], v[56:59]
  ds_read_b128 v[84:87], v3 offset:4096
  s_waitcnt lgkmcnt(4)
  v_mfma_f32_32x32x16_bf16 v[24:39], v[200:203], v[92:95], v[24:39]
  v_mfma_f32_4x4x4_16b_bf16 v[60:63], v[202:203], v[202:203], v[60:63]
  ds_read_b128 v[88:91], v1 offset:29696
  s_waitcnt vmcnt(11) lgkmcnt(4)
  v_mfma_f32_32x32x16_bf16 v[8:23], v[204:207], v[72:75], v[8:23]
  buffer_load_dwordx4 v[252:255], v5, s[4:7], s25 offen
  s_add_u32 s25, s25, 8192
  v_mfma_f32_4x4x4_16b_bf16 v[56:59], v[204:205], v[204:205], v[56:59]
  ds_read_b128 v[92:95], v3 offset:5120
  s_waitcnt lgkmcnt(4)
  v_mfma_f32_32x32x16_bf16 v[24:39], v[204:207], v[76:79], v[24:39]
  v_mfma_f32_4x4x4_16b_bf16 v[60:63], v[206:207], v[206:207], v[60:63]
  ds_read_b128 v[72:75], v1 offset:30720
  s_waitcnt vmcnt(11) lgkmcnt(4)
  v_mfma_f32_32x32x16_bf16 v[8:23], v[208:211], v[80:83], v[8:23]
  v_mfma_f32_4x4x4_16b_bf16 v[56:59], v[208:209], v[208:209], v[56:59]
  ds_read_b128 v[76:79], v3 offset:6144
  s_waitcnt lgkmcnt(4)
  v_mfma_f32_32x32x16_bf16 v[24:39], v[208:211], v[84:87], v[24:39]
  v_mfma_f32_4x4x4_16b_bf16 v[60:63], v[210:211], v[210:211], v[60:63]
  ds_read_b128 v[80:83], v1 offset:31744
  s_waitcnt vmcnt(10) lgkmcnt(4)
  v_mfma_f32_32x32x16_bf16 v[8:23], v[212:215], v[88:91], v[8:23]
  v_mfma_f32_4x4x4_16b_bf16 v[56:59], v[212:213], v[212:213], v[56:59]
  ds_read_b128 v[84:87], v3 offset:7168
  s_waitcnt lgkmcnt(4)
  v_mfma_f32_32x32x16_bf16 v[24:39], v[212:215], v[92:95], v[24:39]
  v_mfma_f32_4x4x4_16b_bf16 v[60:63], v[214:215], v[214:215], v[60:63]
  ds_read_b128 v[88:91], v1 offset:32768
  s_waitcnt vmcnt(9) lgkmcnt(4)
  v_mfma_f32_32x32x16_bf16 v[8:23], v[216:219], v[72:75], v[8:23]
  v_mfma_f32_4x4x4_16b_bf16 v[56:59], v[216:217], v[216:217], v[56:59]
  ds_read_b128 v[92:95], v3 offset:8192
  s_waitcnt lgkmcnt(4)
  v_mfma_f32_32x32x16_bf16 v[24:39], v[216:219], v[76:79], v[24:39]
  v_mfma_f32_4x4x4_16b_bf16 v[60:63], v[218:219], v[218:219], v[60:63]
  ds_read_b128 v[72:75], v1 offset:33792
  s_waitcnt vmcnt(8) lgkmcnt(4)
  v_mfma_f32_32x32x16_bf16 v[8:23], v[220:223], v[80:83], v[8:23]
  v_mfma_f32_4x4x4_16b_bf16 v[56:59], v[220:221], v[220:221], v[56:59]
  ds_read_b128 v[76:79], v3 offset:9216
  s_waitcnt lgkmcnt(4)
  v_mfma_f32_32x32x16_bf16 v[24:39], v[220:223], v[84:87], v[24:39]
  v_mfma_f32_4x4x4_16b_bf16 v[60:63], v[222:223], v[222:223], v[60:63]
  ds_read_b128 v[80:83], v1 offset:34816
  s_waitcnt vmcnt(7) lgkmcnt(4)
  v_mfma_f32_32x32x16_bf16 v[8:23], v[224:227], v[88:91], v[8:23]
  v_mfma_f32_4x4x4_16b_bf16 v[56:59], v[224:225], v[224:225], v[56:59]
  ds_read_b128 v[84:87], v3 offset:10240
  s_waitcnt lgkmcnt(4)
  v_mfma_f32_32x32x16_bf16 v[24:39], v[224:227], v[92:95], v[24:39]
  v_mfma_f32_4x4x4_16b_bf16 v[60:63], v[226:227], v[226:227], v[60:63]
  ds_read_b128 v[88:91], v1 offset:35840
  s_waitcnt vmcnt(6) lgkmcnt(4)
  v_mfma_f32_32x32x16_bf16 v[8:23], v[228:231], v[72:75], v[8:23]
  v_mfma_f32_4x4x4_16b_bf16 v[56:59], v[228:229], v[228:229], v[56:59]
  ds_read_b128 v[92:95], v3 offset:11264
  s_waitcnt lgkmcnt(4)
  v_mfma_f32_32x32x16_bf16 v[24:39], v[228:231], v[76:79], v[24:39]
  v_mfma_f32_4x4x4_16b_bf16 v[60:63], v[230:231], v[230:231], v[60:63]
  ds_read_b128 v[72:75], v1 offset:36864
  s_waitcnt vmcnt(5) lgkmcnt(4)
  v_mfma_f32_32x32x16_bf16 v[8:23], v[232:235], v[80:83], v[8:23]
  v_mfma_f32_4x4x4_16b_bf16 v[56:59], v[232:233], v[232:233], v[56:59]
  ds_read_b128 v[76:79], v3 offset:12288
  s_waitcnt lgkmcnt(4)
  v_mfma_f32_32x32x16_bf16 v[24:39], v[232:235], v[84:87], v[24:39]
  v_mfma_f32_4x4x4_16b_bf16 v[60:63], v[234:235], v[234:235], v[60:63]
  ds_read_b128 v[80:83], v1 offset:37888
  s_waitcnt vmcnt(4) lgkmcnt(4)
  v_mfma_f32_32x32x16_bf16 v[8:23], v[236:239], v[88:91], v[8:23]
  v_mfma_f32_4x4x4_16b_bf16 v[56:59], v[236:237], v[236:237], v[56:59]
  ds_read_b128 v[84:87], v3 offset:13312
  s_waitcnt lgkmcnt(4)
  v_mfma_f32_32x32x16_bf16 v[24:39], v[236:239], v[92:95], v[24:39]
  v_mfma_f32_4x4x4_16b_bf16 v[60:63], v[238:239], v[238:239], v[60:63]
  ds_read_b128 v[88:91], v1 offset:38912
  s_waitcnt vmcnt(3) lgkmcnt(4)
  v_mfma_f32_32x32x16_bf16 v[8:23], v[240:243], v[72:75], v[8:23]
  v_mfma_f32_4x4x4_16b_bf16 v[56:59], v[240:241], v[240:241], v[56:59]
  ds_read_b128 v[92:95], v3 offset:14336
  s_waitcnt lgkmcnt(4)
  v_mfma_f32_32x32x16_bf16 v[24:39], v[240:243], v[76:79], v[24:39]
  v_mfma_f32_4x4x4_16b_bf16 v[60:63], v[242:243], v[242:243], v[60:63]
  ds_read_b128 v[72:75], v1 offset:39936
  s_waitcnt vmcnt(2) lgkmcnt(4)
  v_mfma_f32_32x32x16_bf16 v[8:23], v[244:247], v[80:83], v[8:23]
  v_mfma_f32_4x4x4_16b_bf16 v[56:59], v[244:245], v[244:245], v[56:59]
  ds_read_b128 v[76:79], v3 offset:15360
  s_waitcnt lgkmcnt(4)
  v_mfma_f32_32x32x16_bf16 v[24:39], v[244:247], v[84:87], v[24:39]
  v_mfma_f32_4x4x4_16b_bf16 v[60:63], v[246:247], v[246:247], v[60:63]
  s_waitcnt lgkmcnt(0)
  s_barrier
  ds_read_b128 v[80:83], v3 offset:16384
  s_waitcnt vmcnt(1)
  v_mfma_f32_32x32x16_bf16 v[8:23], v[248:251], v[88:91], v[8:23]
  s_add_u32 m0, s29, 0
  s_nop 0
  buffer_load_dwordx4 v1, s[4:7], s28 offen lds
  s_add_u32 s28, s28, 20480
  v_mfma_f32_4x4x4_16b_bf16 v[56:59], v[248:249], v[248:249], v[56:59]
  ds_read_b128 v[84:87], v3 offset:17408
  v_mfma_f32_32x32x16_bf16 v[24:39], v[248:251], v[92:95], v[24:39]
  v_mfma_f32_4x4x4_16b_bf16 v[60:63], v[250:251], v[250:251], v[60:63]
  ds_read_b128 v[88:91], v3 offset:18432
  s_waitcnt vmcnt(1)
  v_mfma_f32_32x32x16_bf16 v[8:23], v[252:255], v[72:75], v[8:23]
  s_add_u32 m0, s29, 4096
  s_nop 0
  buffer_load_dwordx4 v1, s[4:7], s28 offen lds
  s_add_u32 s28, s28, 20480
  v_mfma_f32_4x4x4_16b_bf16 v[56:59], v[252:253], v[252:253], v[56:59]
  ds_read_b128 v[92:95], v3 offset:19456
  v_mfma_f32_32x32x16_bf16 v[24:39], v[252:255], v[76:79], v[24:39]
  v_mfma_f32_4x4x4_16b_bf16 v[60:63], v[254:255], v[254:255], v[60:63]
  ds_read_b128 v[72:75], v3 offset:20480
  s_waitcnt lgkmcnt(4)
  v_mfma_f32_32x32x16_bf16 v[40:55], v[96:99], v[80:83], 0
  s_add_u32 m0, s29, 8192
  s_nop 0
  buffer_load_dwordx4 v1, s[4:7], s28 offen lds
  s_add_u32 s28, s28, 20480
  ds_read_b128 v[76:79], v3 offset:21504
  s_waitcnt lgkmcnt(4)
  v_mfma_f32_32x32x16_bf16 v[40:55], v[100:103], v[84:87], v[40:55]
  ds_write_b128 v6, v[8:11] offset:0
  ds_write_b128 v6, v[12:15] offset:1024
  ds_write_b128 v6, v[16:19] offset:2048
  ds_write_b128 v6, v[20:23] offset:3072
  v_cndmask_b32 v56, v56, v57, s[32:33]
  v_cndmask_b32 v58, v58, v59, s[32:33]
  v_cndmask_b32 v60, v60, v61, s[32:33]
  v_cndmask_b32 v62, v62, v63, s[32:33]
  ds_read_b128 v[80:83], v3 offset:22528
  s_waitcnt lgkmcnt(8)
  v_mfma_f32_32x32x16_bf16 v[40:55], v[104:107], v[88:91], v[40:55]
  s_add_u32 m0, s29, 12288
  s_nop 0
  buffer_load_dwordx4 v1, s[4:7], s28 offen lds
  s_add_u32 s28, s28, 20480
  v_cndmask_b32 v56, v56, v58, s[34:35]
  v_cndmask_b32 v60, v60, v62, s[34:35]
  v_add_f32 v56, v56, v60
  v_lshrrev_b32 v64, 2, v1
  v_add_u32 v64, s27, v64
  v_mov_b32 v57, v56
  v_mov_b32 v58, 0x36a1369a
  ds_write_b128 v6, v[24:27] offset:4096
  ds_read_b128 v[84:87], v3 offset:23552
  s_waitcnt lgkmcnt(9)
  v_mfma_f32_32x32x16_bf16 v[40:55], v[108:111], v[92:95], v[40:55]
  v_permlane32_swap_b32 v56, v57
  v_add_f32 v56, v56, v57
  v_fmamk_f32 v56, v56, 0x3a44cb26, v58
  v_rsq_f32 v5, v56
  ds_write_b128 v6, v[28:31] offset:5120
  v_mul_f32 v57, 0x3f317218, v5
  v_cndmask_b32 v57, v57, v5, s[30:31]
  ds_write_b32 v64, v57
  ds_read_b128 v[88:91], v3 offset:24576
  s_waitcnt lgkmcnt(11)
  v_mfma_f32_32x32x16_bf16 v[40:55], v[112:115], v[72:75], v[40:55]
  s_add_u32 m0, s29, 16384
  s_nop 0
  buffer_load_dwordx4 v1, s[4:7], s28 offen lds
  s_add_u32 s28, s28, 20480
  v_mov_b32 v0, 1
  ds_write_b32 v2, v0 offset:16
  ds_write_b128 v6, v[32:35] offset:6144
  ds_write_b128 v6, v[36:39] offset:7168
  v_mov_b32 v59, 2
  ds_write_b32 v2, v59 offset:16
  v_mov_b32 v26, 140800
  v_mov_b32 v27, 1
  ds_read_b128 v[92:95], v3 offset:25600
  s_waitcnt lgkmcnt(15)
  v_mfma_f32_32x32x16_bf16 v[40:55], v[116:119], v[76:79], v[40:55]
  ds_read_b128 v[72:75], v3 offset:26624
  s_waitcnt lgkmcnt(11)
  v_mfma_f32_32x32x16_bf16 v[40:55], v[120:123], v[80:83], v[40:55]
  s_add_u32 m0, s29, 20480
  s_nop 0
  buffer_load_dwordx4 v1, s[4:7], s28 offen lds
  s_add_u32 s28, s28, 20480
  ds_read_b128 v[76:79], v3 offset:27648
  s_waitcnt lgkmcnt(10)
  v_mfma_f32_32x32x16_bf16 v[40:55], v[124:127], v[84:87], v[40:55]
  ds_read_b128 v[80:83], v3 offset:28672
  s_waitcnt lgkmcnt(8)
  v_mfma_f32_32x32x16_bf16 v[40:55], v[128:131], v[88:91], v[40:55]
  s_add_u32 m0, s29, 24576
  s_nop 0
  buffer_load_dwordx4 v1, s[4:7], s28 offen lds
  s_add_u32 s28, s28, 20480
  ds_read_b32 v25, v26 offset:76
  ds_read_b128 v[84:87], v3 offset:29696
  s_waitcnt lgkmcnt(5)
  v_mfma_f32_32x32x16_bf16 v[40:55], v[132:135], v[92:95], v[40:55]
  ds_read_b128 v[88:91], v3 offset:30720
  s_waitcnt lgkmcnt(5)
  v_mfma_f32_32x32x16_bf16 v[40:55], v[136:139], v[72:75], v[40:55]
  s_add_u32 m0, s29, 28672
  s_nop 0
  buffer_load_dwordx4 v1, s[4:7], s28 offen lds
  s_add_u32 s28, s28, 20480
  ds_read_b128 v[92:95], v3 offset:31744
  s_waitcnt lgkmcnt(5)
  v_mfma_f32_32x32x16_bf16 v[40:55], v[140:143], v[76:79], v[40:55]
  s_add_u32 m0, s29, 32768
  s_nop 0
  buffer_load_dwordx4 v1, s[4:7], s28 offen lds
  s_add_u32 s28, s28, 20480
  s_waitcnt lgkmcnt(3)
  v_readfirstlane_b32 s26, v25
  s_nop 0
  s_cmp_ge_u32 s26, 4
  s_cbranch_scc1 k6_g1_ok
k6_g1_sp:
  ds_read_b32 v25, v26 offset:76
  s_waitcnt lgkmcnt(0)
  v_readfirstlane_b32 s26, v25
  s_nop 0
  s_cmp_ge_u32 s26, 4
  s_cbranch_scc0 k6_g1_sp
k6_g1_ok:
  ds_read_b128 v[72:75], v3 offset:32768
  v_mfma_f32_32x32x16_bf16 v[40:55], v[144:147], v[80:83], v[40:55]
  s_add_u32 m0, s29, 36864
  s_nop 0
  buffer_load_dwordx4 v1, s[4:7], s28 offen lds
  s_add_u32 s28, s28, -183296
  ds_read_b128 v[76:79], v3 offset:33792
  s_waitcnt lgkmcnt(4)
  v_mfma_f32_32x32x16_bf16 v[40:55], v[148:151], v[84:87], v[40:55]
  ds_read_b128 v[80:83], v3 offset:34816
  s_waitcnt lgkmcnt(4)
  v_mfma_f32_32x32x16_bf16 v[40:55], v[152:155], v[88:91], v[40:55]
  ds_read_b128 v[84:87], v3 offset:35840
  s_waitcnt lgkmcnt(4)
  v_mfma_f32_32x32x16_bf16 v[40:55], v[156:159], v[92:95], v[40:55]
  ds_read_b128 v[88:91], v3 offset:36864
  s_waitcnt lgkmcnt(4)
  v_mfma_f32_32x32x16_bf16 v[40:55], v[160:163], v[72:75], v[40:55]
  ds_read_b128 v[92:95], v3 offset:37888
  s_waitcnt lgkmcnt(4)
  v_mfma_f32_32x32x16_bf16 v[40:55], v[164:167], v[76:79], v[40:55]
  ds_read_b128 v[72:75], v3 offset:38912
  s_waitcnt lgkmcnt(4)
  v_mfma_f32_32x32x16_bf16 v[40:55], v[168:171], v[80:83], v[40:55]
  ds_read_b128 v[76:79], v3 offset:39936
  s_waitcnt lgkmcnt(4)
  v_mfma_f32_32x32x16_bf16 v[40:55], v[172:175], v[84:87], v[40:55]
  ds_read_b32 v25, v26 offset:80
  ds_read_b128 v[80:83], v3 offset:40960
  s_waitcnt lgkmcnt(5)
  v_mfma_f32_32x32x16_bf16 v[40:55], v[176:179], v[88:91], v[40:55]
  ds_read_b128 v[84:87], v3 offset:41984
  s_waitcnt lgkmcnt(5)
  v_mfma_f32_32x32x16_bf16 v[40:55], v[180:183], v[92:95], v[40:55]
  ds_read_b128 v[88:91], v3 offset:43008
  s_waitcnt lgkmcnt(5)
  v_mfma_f32_32x32x16_bf16 v[40:55], v[184:187], v[72:75], v[40:55]
  ds_read_b128 v[92:95], v3 offset:44032
  s_waitcnt lgkmcnt(5)
  v_mfma_f32_32x32x16_bf16 v[40:55], v[188:191], v[76:79], v[40:55]
  s_waitcnt lgkmcnt(4)
  v_readfirstlane_b32 s26, v25
  s_nop 0
  s_cmp_ge_u32 s26, 4
  s_cbranch_scc1 k6_g2_ok
k6_g2_sp:
  ds_read_b32 v25, v26 offset:80
  s_waitcnt lgkmcnt(0)
  v_readfirstlane_b32 s26, v25
  s_nop 0
  s_cmp_ge_u32 s26, 4
  s_cbranch_scc0 k6_g2_sp
k6_g2_ok:
  ds_read_b128 v[72:75], v3 offset:45056
  s_waitcnt lgkmcnt(4)
  v_mfma_f32_32x32x16_bf16 v[40:55], v[192:195], v[80:83], v[40:55]
  ds_read_b128 v[76:79], v3 offset:46080
  s_waitcnt lgkmcnt(4)
  v_mfma_f32_32x32x16_bf16 v[40:55], v[196:199], v[84:87], v[40:55]
  ds_read_b128 v[80:83], v3 offset:47104
  s_waitcnt lgkmcnt(4)
  v_mfma_f32_32x32x16_bf16 v[40:55], v[200:203], v[88:91], v[40:55]
  ds_read_b128 v[84:87], v3 offset:48128
  s_waitcnt lgkmcnt(4)
  v_mfma_f32_32x32x16_bf16 v[40:55], v[204:207], v[92:95], v[40:55]
  ds_read_b128 v[88:91], v3 offset:49152
  s_waitcnt lgkmcnt(4)
  v_mfma_f32_32x32x16_bf16 v[40:55], v[208:211], v[72:75], v[40:55]
  ds_read_b128 v[92:95], v3 offset:50176
  s_waitcnt lgkmcnt(4)
  v_mfma_f32_32x32x16_bf16 v[40:55], v[212:215], v[76:79], v[40:55]
  s_waitcnt vmcnt(0)
  s_mov_b64 exec, 1
  ds_add_u32 v26, v27 offset:64
  s_mov_b64 exec, -1
  ds_read_b128 v[72:75], v3 offset:51200
  s_waitcnt lgkmcnt(5)
  v_mfma_f32_32x32x16_bf16 v[40:55], v[216:219], v[80:83], v[40:55]
  ds_read_b128 v[76:79], v3 offset:52224
  s_waitcnt lgkmcnt(5)
  v_mfma_f32_32x32x16_bf16 v[40:55], v[220:223], v[84:87], v[40:55]
  ds_read_b128 v[80:83], v3 offset:53248
  s_waitcnt lgkmcnt(5)
  v_mfma_f32_32x32x16_bf16 v[40:55], v[224:227], v[88:91], v[40:55]
  ds_read_b32 v25, v26 offset:64
  ds_read_b128 v[84:87], v3 offset:54272
  s_waitcnt lgkmcnt(6)
  v_mfma_f32_32x32x16_bf16 v[40:55], v[228:231], v[92:95], v[40:55]
  ds_read_b128 v[88:91], v3 offset:55296
  s_waitcnt lgkmcnt(5)
  v_mfma_f32_32x32x16_bf16 v[40:55], v[232:235], v[72:75], v[40:55]
  ds_read_b128 v[92:95], v3 offset:56320
  s_waitcnt lgkmcnt(5)
  v_mfma_f32_32x32x16_bf16 v[40:55], v[236:239], v[76:79], v[40:55]
  s_waitcnt lgkmcnt(3)
  v_readfirstlane_b32 s26, v25
  s_nop 0
  s_cmp_ge_u32 s26, 4
  s_cbranch_scc1 k6_g3_ok
k6_g3_sp:
  ds_read_b32 v25, v26 offset:64
  s_waitcnt lgkmcnt(0)
  v_readfirstlane_b32 s26, v25
  s_nop 0
  s_cmp_ge_u32 s26, 4
  s_cbranch_scc0 k6_g3_sp
k6_g3_ok:
  ds_read_b128 v[72:75], v1 offset:0
  v_mfma_f32_32x32x16_bf16 v[40:55], v[240:243], v[80:83], v[40:55]
  ds_read_b128 v[76:79], v1 offset:1024
  s_waitcnt lgkmcnt(4)
  v_mfma_f32_32x32x16_bf16 v[40:55], v[244:247], v[84:87], v[40:55]
  s_waitcnt lgkmcnt(2)
  s_mov_b64 exec, 1
  ds_add_u32 v26, v27 offset:68
  s_mov_b64 exec, -1
  ds_read_b128 v[80:83], v1 offset:2048
  v_mfma_f32_32x32x16_bf16 v[40:55], v[248:251], v[88:91], v[40:55]
  ds_read_b128 v[84:87], v1 offset:3072
  v_mfma_f32_32x32x16_bf16 v[40:55], v[252:255], v[92:95], v[40:55]
  ds_read_b128 v[88:91], v1 offset:4096
  s_waitcnt lgkmcnt(5)
  v_mfma_f32_32x32x16_bf16 v[56:71], v[72:75], v[96:99], 0
  ds_read_b128 v[92:95], v1 offset:5120
  s_waitcnt lgkmcnt(5)
  v_mfma_f32_32x32x16_bf16 v[56:71], v[76:79], v[100:103], v[56:71]
  ds_read_b32 v25, v26 offset:68
  ds_read_b128 v[72:75], v1 offset:6144
  s_waitcnt lgkmcnt(5)
  v_mfma_f32_32x32x16_bf16 v[56:71], v[80:83], v[104:107], v[56:71]
  s_nop 1
  ds_write_b128 v4, v[40:43] offset:0
  ds_write_b128 v4, v[44:47] offset:1024
  ds_write_b128 v4, v[48:51] offset:2048
  ds_read_b128 v[76:79], v1 offset:7168
  s_waitcnt lgkmcnt(8)
  v_mfma_f32_32x32x16_bf16 v[56:71], v[84:87], v[108:111], v[56:71]
  ds_write_b128 v4, v[52:55] offset:3072
  v_mov_b32 v0, 3
  ds_write_b32 v2, v0 offset:16
  ds_read_b128 v[80:83], v1 offset:8192
  s_waitcnt lgkmcnt(10)
  v_mfma_f32_32x32x16_bf16 v[56:71], v[88:91], v[112:115], v[56:71]
  ds_read_b128 v[84:87], v1 offset:9216
  s_waitcnt lgkmcnt(10)
  v_mfma_f32_32x32x16_bf16 v[56:71], v[92:95], v[116:119], v[56:71]
  s_waitcnt lgkmcnt(9)
  v_readfirstlane_b32 s26, v25
  s_nop 0
  s_cmp_ge_u32 s26, 4
  s_cbranch_scc1 k6_g4_ok
k6_g4_sp:
  ds_read_b32 v25, v26 offset:68
  s_waitcnt lgkmcnt(0)
  v_readfirstlane_b32 s26, v25
  s_nop 0
  s_cmp_ge_u32 s26, 4
  s_cbranch_scc0 k6_g4_sp
k6_g4_ok:
  ds_read_b128 v[88:91], v1 offset:10240
  s_waitcnt lgkmcnt(9)
  v_mfma_f32_32x32x16_bf16 v[56:71], v[72:75], v[120:123], v[56:71]
  s_add_u32 m0, s29, 81920
  s_nop 0
  buffer_load_dwordx4 v1, s[4:7], s28 offen lds
  s_add_u32 s28, s28, 20480
  ds_read_b128 v[92:95], v1 offset:11264
  s_waitcnt lgkmcnt(6)
  v_mfma_f32_32x32x16_bf16 v[56:71], v[76:79], v[124:127], v[56:71]
  s_add_u32 m0, s29, 86016
  s_nop 0
  buffer_load_dwordx4 v1, s[4:7], s28 offen lds
  s_add_u32 s28, s28, 20480
  ds_read_b128 v[72:75], v1 offset:12288
  s_waitcnt lgkmcnt(4)
  v_mfma_f32_32x32x16_bf16 v[56:71], v[80:83], v[128:131], v[56:71]
  s_add_u32 m0, s29, 90112
  s_nop 0
  buffer_load_dwordx4 v1, s[4:7], s28 offen lds
  s_add_u32 s28, s28, 20480
  ds_read_b128 v[76:79], v1 offset:13312
  s_waitcnt lgkmcnt(4)
  v_mfma_f32_32x32x16_bf16 v[56:71], v[84:87], v[132:135], v[56:71]
  s_add_u32 m0, s29, 94208
  s_nop 0
  buffer_load_dwordx4 v1, s[4:7], s28 offen lds
  s_add_u32 s28, s28, 20480
  ds_read_b128 v[80:83], v1 offset:14336
  s_waitcnt lgkmcnt(4)
  v_mfma_f32_32x32x16_bf16 v[56:71], v[88:91], v[136:139], v[56:71]
  s_add_u32 m0, s29, 98304
  s_nop 0
  buffer_load_dwordx4 v1, s[4:7], s28 offen lds
  s_add_u32 s28, s28, 20480
  ds_read_b128 v[84:87], v1 offset:15360
  s_waitcnt lgkmcnt(4)
  v_mfma_f32_32x32x16_bf16 v[56:71], v[92:95], v[140:143], v[56:71]
  s_add_u32 m0, s29, 102400
  s_nop 0
  buffer_load_dwordx4 v1, s[4:7], s28 offen lds
  s_add_u32 s28, s28, 20480
  ds_read_b128 v[88:91], v1 offset:16384
  s_waitcnt lgkmcnt(4)
  v_mfma_f32_32x32x16_bf16 v[56:71], v[72:75], v[144:147], v[56:71]
  s_add_u32 m0, s29, 106496
  s_nop 0
  buffer_load_dwordx4 v1, s[4:7], s28 offen lds
  s_add_u32 s28, s28, 20480
  ds_read_b128 v[92:95], v1 offset:17408
  s_waitcnt lgkmcnt(4)
  v_mfma_f32_32x32x16_bf16 v[56:71], v[76:79], v[148:151], v[56:71]
  s_add_u32 m0, s29, 110592
  s_nop 0
  buffer_load_dwordx4 v1, s[4:7], s28 offen lds
  s_add_u32 s28, s28, 20480
  ds_read_b128 v[72:75], v1 offset:18432
  s_waitcnt lgkmcnt(4)
  v_mfma_f32_32x32x16_bf16 v[56:71], v[80:83], v[152:155], v[56:71]
  s_add_u32 m0, s29, 114688
  s_nop 0
  buffer_load_dwordx4 v1, s[4:7], s28 offen lds
  s_add_u32 s28, s28, 20480
  ds_read_b128 v[76:79], v1 offset:19456
  s_waitcnt lgkmcnt(4)
  v_mfma_f32_32x32x16_bf16 v[56:71], v[84:87], v[156:159], v[56:71]
  s_add_u32 m0, s29, 118784
  s_nop 0
  buffer_load_dwordx4 v1, s[4:7], s28 offen lds
  s_add_u32 s28, s28, -183296
  ds_read_b128 v[80:83], v1 offset:20480
  s_waitcnt lgkmcnt(4)
  v_mfma_f32_32x32x16_bf16 v[56:71], v[88:91], v[160:163], v[56:71]
  ds_read_b128 v[84:87], v1 offset:21504
  s_waitcnt lgkmcnt(4)
  v_mfma_f32_32x32x16_bf16 v[56:71], v[92:95], v[164:167], v[56:71]
  ds_read_b128 v[88:91], v1 offset:22528
  s_waitcnt lgkmcnt(4)
  v_mfma_f32_32x32x16_bf16 v[56:71], v[72:75], v[168:171], v[56:71]
  ds_read_b128 v[92:95], v1 offset:23552
  s_waitcnt lgkmcnt(4)
  v_mfma_f32_32x32x16_bf16 v[56:71], v[76:79], v[172:175], v[56:71]
  ds_read_b128 v[72:75], v1 offset:24576
  s_waitcnt lgkmcnt(4)
  v_mfma_f32_32x32x16_bf16 v[56:71], v[80:83], v[176:179], v[56:71]
  ds_read_b128 v[76:79], v1 offset:25600
  s_waitcnt lgkmcnt(4)
  v_mfma_f32_32x32x16_bf16 v[56:71], v[84:87], v[180:183], v[56:71]
  ds_read_b128 v[80:83], v1 offset:26624
  s_waitcnt lgkmcnt(4)
  v_mfma_f32_32x32x16_bf16 v[56:71], v[88:91], v[184:187], v[56:71]
  ds_read_b128 v[84:87], v1 offset:27648
  s_waitcnt lgkmcnt(4)
  v_mfma_f32_32x32x16_bf16 v[56:71], v[92:95], v[188:191], v[56:71]
  ds_read_b128 v[88:91], v1 offset:28672
  s_waitcnt lgkmcnt(4)
  v_mfma_f32_32x32x16_bf16 v[56:71], v[72:75], v[192:195], v[56:71]
  ds_read_b128 v[92:95], v1 offset:29696
  s_waitcnt lgkmcnt(4)
  v_mfma_f32_32x32x16_bf16 v[56:71], v[76:79], v[196:199], v[56:71]
  ds_read_b128 v[72:75], v1 offset:30720
  s_waitcnt lgkmcnt(4)
  v_mfma_f32_32x32x16_bf16 v[56:71], v[80:83], v[200:203], v[56:71]
  ds_read_b128 v[76:79], v1 offset:31744
  s_waitcnt lgkmcnt(4)
  v_mfma_f32_32x32x16_bf16 v[56:71], v[84:87], v[204:207], v[56:71]
  ds_read_b128 v[80:83], v1 offset:32768
  s_waitcnt lgkmcnt(4)
  v_mfma_f32_32x32x16_bf16 v[56:71], v[88:91], v[208:211], v[56:71]
  ds_read_b128 v[84:87], v1 offset:33792
  s_waitcnt lgkmcnt(4)
  v_mfma_f32_32x32x16_bf16 v[56:71], v[92:95], v[212:215], v[56:71]
  s_waitcnt vmcnt(0)
  s_mov_b64 exec, 1
  ds_add_u32 v26, v27 offset:72
  s_mov_b64 exec, -1
  ds_read_b128 v[88:91], v1 offset:34816
  s_waitcnt lgkmcnt(5)
  v_mfma_f32_32x32x16_bf16 v[56:71], v[72:75], v[216:219], v[56:71]
  ds_read_b128 v[92:95], v1 offset:35840
  s_waitcnt lgkmcnt(5)
  v_mfma_f32_32x32x16_bf16 v[56:71], v[76:79], v[220:223], v[56:71]
  ds_read_b128 v[72:75], v1 offset:36864
  s_waitcnt lgkmcnt(5)
  v_mfma_f32_32x32x16_bf16 v[56:71], v[80:83], v[224:227], v[56:71]
  ds_read_b32 v25, v26 offset:72
  ds_read_b128 v[76:79], v1 offset:37888
  s_waitcnt lgkmcnt(6)
  v_mfma_f32_32x32x16_bf16 v[56:71], v[84:87], v[228:231], v[56:71]
  ds_read_b128 v[80:83], v1 offset:38912
  s_waitcnt lgkmcnt(5)
  v_mfma_f32_32x32x16_bf16 v[56:71], v[88:91], v[232:235], v[56:71]
  ds_read_b128 v[84:87], v1 offset:39936
  s_waitcnt lgkmcnt(5)
  v_mfma_f32_32x32x16_bf16 v[56:71], v[92:95], v[236:239], v[56:71]
  s_waitcnt lgkmcnt(3)
  v_readfirstlane_b32 s26, v25
  s_nop 0
  s_cmp_ge_u32 s26, 4
  s_cbranch_scc1 k6_g5_ok
k6_g5_sp:
  ds_read_b32 v25, v26 offset:72
  s_waitcnt lgkmcnt(0)
  v_readfirstlane_b32 s26, v25
  s_nop 0
  s_cmp_ge_u32 s26, 4
  s_cbranch_scc0 k6_g5_sp
k6_g5_ok:
  ds_read_b128 v[88:91], v3 offset:16384
  v_mfma_f32_32x32x16_bf16 v[56:71], v[72:75], v[240:243], v[56:71]
  ds_read_b128 v[92:95], v3 offset:17408
  s_waitcnt lgkmcnt(4)
  v_mfma_f32_32x32x16_bf16 v[56:71], v[76:79], v[244:247], v[56:71]
  ds_read_b128 v[72:75], v3 offset:18432
  s_waitcnt lgkmcnt(4)
  v_mfma_f32_32x32x16_bf16 v[56:71], v[80:83], v[248:251], v[56:71]
  ds_read_b128 v[76:79], v3 offset:19456
  s_waitcnt lgkmcnt(4)
  v_mfma_f32_32x32x16_bf16 v[56:71], v[84:87], v[252:255], v[56:71]
  ds_read_b128 v[80:83], v3 offset:20480
  s_waitcnt lgkmcnt(4)
  v_mfma_f32_32x32x16_bf16 v[8:23], v[88:91], v[96:99], 0
  ds_read_b128 v[84:87], v3 offset:21504
  s_waitcnt lgkmcnt(4)
  v_mfma_f32_32x32x16_bf16 v[8:23], v[92:95], v[100:103], v[8:23]
  ds_read_b128 v[88:91], v3 offset:22528
  s_waitcnt lgkmcnt(4)
  v_mfma_f32_32x32x16_bf16 v[8:23], v[72:75], v[104:107], v[8:23]
  v_mov_b32 v6, 0x35c1a2a0
  s_mov_b32 s39, 0x3f317218
  s_add_u32 s44, s43, 15925248
  ds_read_b128 v[92:95], v3 offset:23552
  s_waitcnt lgkmcnt(4)
  v_mfma_f32_32x32x16_bf16 v[8:23], v[76:79], v[108:111], v[8:23]
  v_mul_f32 v56, v56, v5
  v_min_f32 v40, 0, v56
  v_exp_f32 v40, v40
  ds_read_b128 v[72:75], v3 offset:24576
  s_waitcnt lgkmcnt(4)
  v_mfma_f32_32x32x16_bf16 v[8:23], v[80:83], v[112:115], v[8:23]
  v_max_f32 v56, v6, v56
  v_mul_f32 v57, v57, v5
  v_min_f32 v41, 0, v57
  ds_read_b128 v[76:79], v3 offset:25600
  s_waitcnt lgkmcnt(4)
  v_mfma_f32_32x32x16_bf16 v[8:23], v[84:87], v[116:119], v[8:23]
  v_exp_f32 v41, v41
  v_max_f32 v57, v6, v57
  v_fma_f32 v56, v56, s39, v40
  ds_read_b128 v[80:83], v3 offset:26624
  s_waitcnt lgkmcnt(4)
  v_mfma_f32_32x32x16_bf16 v[8:23], v[88:91], v[120:123], v[8:23]
  v_mul_f32 v58, v58, v5
  v_min_f32 v42, 0, v58
  v_exp_f32 v42, v42
  ds_read_b128 v[84:87], v3 offset:27648
  s_waitcnt lgkmcnt(4)
  v_mfma_f32_32x32x16_bf16 v[8:23], v[92:95], v[124:127], v[8:23]
  v_max_f32 v58, v6, v58
  v_fma_f32 v57, v57, s39, v41
  v_cvt_pk_bf16_f32 v40, v56, v57
  ds_read_b128 v[88:91], v3 offset:28672
  s_waitcnt lgkmcnt(4)
  v_mfma_f32_32x32x16_bf16 v[8:23], v[72:75], v[128:131], v[8:23]
  v_mul_f32 v59, v59, v5
  v_min_f32 v43, 0, v59
  v_exp_f32 v43, v43
  ds_read_b128 v[92:95], v3 offset:29696
  s_waitcnt lgkmcnt(4)
  v_mfma_f32_32x32x16_bf16 v[8:23], v[76:79], v[132:135], v[8:23]
  v_max_f32 v59, v6, v59
  v_fma_f32 v58, v58, s39, v42
  v_mul_f32 v60, v60, v5
  ds_read_b128 v[72:75], v3 offset:30720
  s_waitcnt lgkmcnt(4)
  v_mfma_f32_32x32x16_bf16 v[8:23], v[80:83], v[136:139], v[8:23]
  v_min_f32 v44, 0, v60
  v_exp_f32 v44, v44
  v_max_f32 v60, v6, v60
  ds_read_b128 v[76:79], v3 offset:31744
  s_waitcnt lgkmcnt(4)
  v_mfma_f32_32x32x16_bf16 v[8:23], v[84:87], v[140:143], v[8:23]
  v_fma_f32 v59, v59, s39, v43
  v_cvt_pk_bf16_f32 v41, v58, v59
  v_mul_f32 v61, v61, v5
  ds_read_b128 v[80:83], v3 offset:32768
  s_waitcnt lgkmcnt(4)
  v_mfma_f32_32x32x16_bf16 v[8:23], v[88:91], v[144:147], v[8:23]
  v_min_f32 v45, 0, v61
  v_exp_f32 v45, v45
  v_max_f32 v61, v6, v61
  ds_read_b128 v[84:87], v3 offset:33792
  s_waitcnt lgkmcnt(4)
  v_mfma_f32_32x32x16_bf16 v[8:23], v[92:95], v[148:151], v[8:23]
  v_fma_f32 v60, v60, s39, v44
  v_mul_f32 v62, v62, v5
  v_min_f32 v46, 0, v62
  ds_read_b128 v[88:91], v3 offset:34816
  s_waitcnt lgkmcnt(4)
  v_mfma_f32_32x32x16_bf16 v[8:23], v[72:75], v[152:155], v[8:23]
  v_exp_f32 v46, v46
  v_max_f32 v62, v6, v62
  v_fma_f32 v61, v61, s39, v45
  ds_read_b128 v[92:95], v3 offset:35840
  s_waitcnt lgkmcnt(4)
  v_mfma_f32_32x32x16_bf16 v[8:23], v[76:79], v[156:159], v[8:23]
  v_cvt_pk_bf16_f32 v42, v60, v61
  v_mul_f32 v63, v63, v5
  v_min_f32 v47, 0, v63
  ds_read_b128 v[72:75], v3 offset:36864
  s_waitcnt lgkmcnt(4)
  v_mfma_f32_32x32x16_bf16 v[8:23], v[80:83], v[160:163], v[8:23]
  v_exp_f32 v47, v47
  v_max_f32 v63, v6, v63
  v_fma_f32 v62, v62, s39, v46
  ds_read_b128 v[76:79], v3 offset:37888
  s_waitcnt lgkmcnt(4)
  v_mfma_f32_32x32x16_bf16 v[8:23], v[84:87], v[164:167], v[8:23]
  v_mul_f32 v64, v64, v5
  v_min_f32 v48, 0, v64
  v_exp_f32 v48, v48
  ds_read_b128 v[80:83], v3 offset:38912
  s_waitcnt lgkmcnt(4)
  v_mfma_f32_32x32x16_bf16 v[8:23], v[88:91], v[168:171], v[8:23]
  v_max_f32 v64, v6, v64
  v_fma_f32 v63, v63, s39, v47
  v_cvt_pk_bf16_f32 v43, v62, v63
  ds_read_b128 v[84:87], v3 offset:39936
  s_waitcnt lgkmcnt(4)
  v_mfma_f32_32x32x16_bf16 v[8:23], v[92:95], v[172:175], v[8:23]
  buffer_store_dwordx4 v[40:43], v7, s[4:7], s44 offen sc1
  s_add_u32 s44, s44, 4096
  v_mul_f32 v65, v65, v5
  ds_read_b128 v[88:91], v3 offset:40960
  s_waitcnt lgkmcnt(4)
  v_mfma_f32_32x32x16_bf16 v[8:23], v[72:75], v[176:179], v[8:23]
  v_min_f32 v49, 0, v65
  v_exp_f32 v49, v49
  v_max_f32 v65, v6, v65
  ds_read_b128 v[92:95], v3 offset:41984
  s_waitcnt lgkmcnt(4)
  v_mfma_f32_32x32x16_bf16 v[8:23], v[76:79], v[180:183], v[8:23]
  v_fma_f32 v64, v64, s39, v48
  v_mul_f32 v66, v66, v5
  v_min_f32 v50, 0, v66
  ds_read_b128 v[72:75], v3 offset:43008
  s_waitcnt lgkmcnt(4)
  v_mfma_f32_32x32x16_bf16 v[8:23], v[80:83], v[184:187], v[8:23]
  v_exp_f32 v50, v50
  v_max_f32 v66, v6, v66
  v_fma_f32 v65, v65, s39, v49
  ds_read_b128 v[76:79], v3 offset:44032
  s_waitcnt lgkmcnt(4)
  v_mfma_f32_32x32x16_bf16 v[8:23], v[84:87], v[188:191], v[8:23]
  v_cvt_pk_bf16_f32 v44, v64, v65
  v_mul_f32 v67, v67, v5
  v_min_f32 v51, 0, v67
  ds_read_b128 v[80:83], v3 offset:45056
  s_waitcnt lgkmcnt(4)
  v_mfma_f32_32x32x16_bf16 v[8:23], v[88:91], v[192:195], v[8:23]
  v_exp_f32 v51, v51
  v_max_f32 v67, v6, v67
  v_fma_f32 v66, v66, s39, v50
  ds_read_b128 v[84:87], v3 offset:46080
  s_waitcnt lgkmcnt(4)
  v_mfma_f32_32x32x16_bf16 v[8:23], v[92:95], v[196:199], v[8:23]
  v_mul_f32 v68, v68, v5
  v_min_f32 v52, 0, v68
  v_exp_f32 v52, v52
  ds_read_b128 v[88:91], v3 offset:47104
  s_waitcnt lgkmcnt(4)
  v_mfma_f32_32x32x16_bf16 v[8:23], v[72:75], v[200:203], v[8:23]
  v_max_f32 v68, v6, v68
  v_fma_f32 v67, v67, s39, v51
  v_cvt_pk_bf16_f32 v45, v66, v67
  ds_read_b128 v[92:95], v3 offset:48128
  s_waitcnt lgkmcnt(4)
  v_mfma_f32_32x32x16_bf16 v[8:23], v[76:79], v[204:207], v[8:23]
  v_mul_f32 v69, v69, v5
  v_min_f32 v53, 0, v69
  v_exp_f32 v53, v53
  ds_read_b128 v[72:75], v3 offset:49152
  s_waitcnt lgkmcnt(4)
  v_mfma_f32_32x32x16_bf16 v[8:23], v[80:83], v[208:211], v[8:23]
  v_max_f32 v69, v6, v69
  v_fma_f32 v68, v68, s39, v52
  v_mul_f32 v70, v70, v5
  ds_read_b128 v[76:79], v3 offset:50176
  s_waitcnt lgkmcnt(4)
  v_mfma_f32_32x32x16_bf16 v[8:23], v[84:87], v[212:215], v[8:23]
  v_min_f32 v54, 0, v70
  v_exp_f32 v54, v54
  v_max_f32 v70, v6, v70
  ds_read_b128 v[80:83], v3 offset:51200
  s_waitcnt lgkmcnt(4)
  v_mfma_f32_32x32x16_bf16 v[8:23], v[88:91], v[216:219], v[8:23]
  v_fma_f32 v69, v69, s39, v53
  v_cvt_pk_bf16_f32 v46, v68, v69
  v_mul_f32 v71, v71, v5
  ds_read_b128 v[84:87], v3 offset:52224
  s_waitcnt lgkmcnt(4)
  v_mfma_f32_32x32x16_bf16 v[8:23], v[92:95], v[220:223], v[8:23]
  v_min_f32 v55, 0, v71
  v_exp_f32 v55, v55
  v_max_f32 v71, v6, v71
  ds_read_b128 v[88:91], v3 offset:53248
  s_waitcnt lgkmcnt(4)
  v_mfma_f32_32x32x16_bf16 v[8:23], v[72:75], v[224:227], v[8:23]
  v_fma_f32 v70, v70, s39, v54
  v_fma_f32 v71, v71, s39, v55
  v_cvt_pk_bf16_f32 v47, v70, v71
  ds_read_b128 v[92:95], v3 offset:54272
  s_waitcnt lgkmcnt(4)
  v_mfma_f32_32x32x16_bf16 v[8:23], v[76:79], v[228:231], v[8:23]
  buffer_store_dwordx4 v[44:47], v7, s[4:7], s44 offen sc1
  ds_read_b128 v[72:75], v3 offset:55296
  s_waitcnt lgkmcnt(4)
  v_mfma_f32_32x32x16_bf16 v[8:23], v[80:83], v[232:235], v[8:23]
  ds_read_b128 v[76:79], v3 offset:56320
  s_waitcnt lgkmcnt(4)
  v_mfma_f32_32x32x16_bf16 v[8:23], v[84:87], v[236:239], v[8:23]
  s_waitcnt lgkmcnt(3)
  v_mfma_f32_32x32x16_bf16 v[8:23], v[88:91], v[240:243], v[8:23]
  s_waitcnt lgkmcnt(2)
  v_mfma_f32_32x32x16_bf16 v[8:23], v[92:95], v[244:247], v[8:23]
  s_waitcnt lgkmcnt(1)
  v_mfma_f32_32x32x16_bf16 v[8:23], v[72:75], v[248:251], v[8:23]
  s_waitcnt lgkmcnt(0)
  v_mfma_f32_32x32x16_bf16 v[8:23], v[76:79], v[252:255], v[8:23]
  s_add_u32 s47, s43, 10616832
  s_nop 10
  v_cvt_pk_bf16_f32 v72, v8, v9
  v_cvt_pk_bf16_f32 v73, v10, v11
  v_cvt_pk_bf16_f32 v74, v12, v13
  v_cvt_pk_bf16_f32 v75, v14, v15
  buffer_store_dwordx4 v[72:75], v7, s[4:7], s47 offen sc1
  s_add_u32 s47, s47, 4096
  v_cvt_pk_bf16_f32 v76, v16, v17
  v_cvt_pk_bf16_f32 v77, v18, v19
  v_cvt_pk_bf16_f32 v78, v20, v21
  v_cvt_pk_bf16_f32 v79, v22, v23
  buffer_store_dwordx4 v[76:79], v7, s[4:7], s47 offen sc1
  s_add_u32 s47, s47, 4096
  s_endpgm
k6_h:
  s_add_u32 s26, s28, 2048
  s_add_u32 s28, s28, 61440
  v_and_b32 v9, 31, v0
  v_lshlrev_b32 v9, 2, v9
  v_add_u32 v9, 140800, v9
  v_mov_b32 v8, 0
  ds_write_b32 v9, v8
  v_mov_b32 v20, 140800
  v_mov_b32 v21, 1
  s_add_u32 m0, s29, 12288
  s_nop 0
  buffer_load_dwordx4 v1, s[4:7], s28 offen offset:0 lds
  s_add_u32 m0, s29, 52224
  s_nop 0
  buffer_load_dwordx4 v1, s[4:7], s28 offen offset:1024 lds
  s_add_u32 s28, s28, 20480
  s_waitcnt vmcnt(2) lgkmcnt(0)
  s_barrier
  s_add_u32 m0, s29, 16384
  s_nop 0
  buffer_load_dwordx4 v1, s[4:7], s28 offen offset:0 lds
  s_add_u32 m0, s29, 56320
  s_nop 0
  buffer_load_dwordx4 v1, s[4:7], s28 offen offset:1024 lds
  s_add_u32 s28, s28, 20480
  s_add_u32 m0, s29, 20480
  s_nop 0
  buffer_load_dwordx4 v1, s[4:7], s28 offen offset:0 lds
  s_add_u32 m0, s29, 60416
  s_nop 0
  buffer_load_dwordx4 v1, s[4:7], s28 offen offset:1024 lds
  s_add_u32 s28, s28, 20480
  s_add_u32 m0, s29, 24576
  s_nop 0
  buffer_load_dwordx4 v1, s[4:7], s28 offen offset:0 lds
  s_add_u32 m0, s29, 64512
  s_nop 0
  buffer_load_dwordx4 v1, s[4:7], s28 offen offset:1024 lds
  s_add_u32 s28, s28, 20480
  v_and_b32 v2, 31, v0
  v_bfe_u32 v3, v0, 5, 1
  s_lshl_b32 s30, s20, 9
  v_lshl_add_u32 v4, v2, 4, s30
  v_lshlrev_b32 v11, 2, v3
  v_sub_u32 v11, v2, v11
  v_and_b32 v12, 1, v11
  v_lshlrev_b32 v12, 4, v12
  v_mov_b32 v13, 0x3f80
  v_lshlrev_b32 v12, v12, v13
  v_or_b32 v11, 1, v11
  v_cmp_eq_u32 vcc, 1, v11
  s_nop 1
  v_cndmask_b32 v32, 0, v12, vcc
  v_cmp_eq_u32 vcc, 3, v11
  s_nop 1
  v_cndmask_b32 v33, 0, v12, vcc
  v_cmp_eq_u32 vcc, 9, v11
  s_nop 1
  v_cndmask_b32 v34, 0, v12, vcc
  v_cmp_eq_u32 vcc, 11, v11
  s_nop 1
  v_cndmask_b32 v35, 0, v12, vcc
  v_cmp_eq_u32 vcc, 17, v11
  s_nop 1
  v_cndmask_b32 v36, 0, v12, vcc
  v_cmp_eq_u32 vcc, 19, v11
  s_nop 1
  v_cndmask_b32 v37, 0, v12, vcc
  v_cmp_eq_u32 vcc, 25, v11
  s_nop 1
  v_cndmask_b32 v38, 0, v12, vcc
  v_cmp_eq_u32 vcc, 27, v11
  s_nop 1
  v_cndmask_b32 v39, 0, v12, vcc
  v_cmp_gt_u32 s[30:31], 8, v2
  v_cmp_gt_u32 s[32:33], 16, v2
  v_cmp_eq_u32 s[34:35], 4, v2
  v_cmp_eq_u32 s[36:37], 11, v2
  s_nop 0
  s_or_b64 s[34:35], s[34:35], s[36:37]
  v_subrev_u32 v12, 8, v2
  v_cmp_gt_u32 s[36:37], 16, v12
  v_mov_b32 v13, 0xff800000
  v_mov_b32 v14, 0x35c1a2a0
  v_cndmask_b32 v15, v14, v13, s[36:37]
  v_cndmask_b32 v13, 0, v13, s[36:37]
  s_mov_b32 s39, 0x3f317218
  v_mov_b32 v11, 0x3f803f80
  s_mul_i32 s38, s20, 384
  s_add_u32 s38, s38, 139264
  v_mov_b32 v9, 1.0
  v_lshl_add_u32 v17, v2, 2, s38
  ds_write_b32 v17, v9 offset:256
  v_lshl_add_u32 v17, v3, 4, s38
  v_subrev_u32 v9, 4, v2
  v_cmp_gt_u32 vcc, 8, v9
  v_add_u32 v9, 128, v17
  s_nop 0
  v_cndmask_b32 v18, v17, v9, vcc
  s_lshl_b32 s38, s20, 12
  s_add_u32 s38, s38, 122880
  v_add_u32 v16, s38, v1
  s_lshl_b32 s38, s20, 13
  s_add_u32 s38, s38, 40960
  v_add_u32 v6, s38, v1
  v_lshrrev_b32 v9, 1, v1
  v_add_u32 v7, s38, v9
  s_mul_i32 s38, s20, 1536
  s_add_u32 m0, s29, 28672
  s_nop 0
  buffer_load_dwordx4 v1, s[4:7], s28 offen offset:0 lds
  s_add_u32 m0, s29, 68608
  s_nop 0
  buffer_load_dwordx4 v1, s[4:7], s28 offen offset:1024 lds
  s_add_u32 s28, s28, 20480
  s_waitcnt vmcnt(4) lgkmcnt(0)
  s_barrier
  s_add_u32 m0, s29, 32768
  s_nop 0
  buffer_load_dwordx4 v1, s[4:7], s28 offen offset:0 lds
  s_add_u32 m0, s29, 72704
  s_nop 0
  buffer_load_dwordx4 v1, s[4:7], s28 offen offset:1024 lds
  s_add_u32 s28, s28, 20480
  s_add_u32 m0, s29, 36864
  s_nop 0
  buffer_load_dwordx4 v1, s[4:7], s28 offen offset:0 lds
  s_add_u32 m0, s29, 76800
  s_nop 0
  buffer_load_dwordx4 v1, s[4:7], s28 offen offset:1024 lds
  s_add_u32 s28, s28, 20480
  s_add_u32 s38, s38, 40960
  v_add_u32 v12, s38, v9
  s_lshl_b32 s38, s20, 2
  s_add_u32 s38, s38, 140800
  v_mov_b32 v19, s38
  s_lshr_b32 s40, s20, 1
  s_and_b32 s41, s20, 1
  s_mul_i32 s42, s40, 12
  v_add_u32 v10, s42, v2
  v_and_b32 v10, 31, v10
  v_cmp_gt_u32 s[50:51], 20, v10
  s_lshl_b32 s42, s40, 2
  v_subrev_u32 v10, s42, v10
  v_cmp_gt_i32 vcc, 0, v10
  v_add_u32 v9, 24, v10
  s_nop 0
  v_cndmask_b32 v10, v10, v9, vcc
  v_lshlrev_b32 v10, 2, v10
  v_mul_u32_u24 v9, 384, v3
  v_add_u32 v10, v10, v9
  v_lshl_add_u32 v5, v3, 3, v4
  v_cmp_eq_u32 s[52:53], s40, v3
  s_nop 0
  s_and_b64 s[52:53], s[52:53], s[50:51]
  s_cmp_eq_u32 s41, 0
  s_cselect_b64 s[52:53], s[52:53], s[50:51]
  s_cmp_eq_u32 s40, 0
  s_cselect_b64 s[54:55], s[50:51], s[52:53]
  s_cselect_b64 s[56:57], s[52:53], s[50:51]
  s_mul_i32 s45, s22, 4032
  s_add_u32 s45, s45, 26198016
  s_lshl_b32 s46, s20, 3
  s_lshr_b32 s60, 470943488, s46
  s_and_b32 s60, s60, 0xff
  s_mul_i32 s60, s60, 96
  s_add_u32 s60, s60, s45
  s_lshr_b32 s61, 487786497, s46
  s_and_b32 s61, s61, 0xff
  s_mul_i32 s61, s61, 96
  s_add_u32 s61, s61, s45
  s_lshr_b32 s62, 571739394, s46
  s_and_b32 s62, s62, 0xff
  s_mul_i32 s62, s62, 96
  s_add_u32 s62, s62, s45
  s_lshr_b32 s63, 588582403, s46
  s_and_b32 s63, s63, 0xff
  s_mul_i32 s63, s63, 96
  s_add_u32 s63, s63, s45
  s_lshr_b32 s64, 605687557, s46
  s_and_b32 s64, s64, 0xff
  s_mul_i32 s64, s64, 96
  s_add_u32 s64, s64, s45
  s_lshr_b32 s65, 622530566, s46
  s_and_b32 s65, s65, 0xff
  s_mul_i32 s65, s65, 96
  s_add_u32 s65, s65, s45
  s_add_u32 m0, s29, 81920
  s_nop 0
  buffer_load_dwordx4 v1, s[4:7], s26 offen lds
  s_add_u32 s26, s26, 20480
  s_add_u32 m0, s29, 86016
  s_nop 0
  buffer_load_dwordx4 v1, s[4:7], s26 offen lds
  s_add_u32 s26, s26, 20480
  s_add_u32 m0, s29, 90112
  s_nop 0
  buffer_load_dwordx4 v1, s[4:7], s26 offen lds
  s_add_u32 s26, s26, 20480
  s_add_u32 m0, s29, 94208
  s_nop 0
  buffer_load_dwordx4 v1, s[4:7], s26 offen lds
  s_add_u32 s26, s26, 20480
  s_waitcnt vmcnt(4) lgkmcnt(0)
  s_barrier
  s_add_u32 m0, s29, 98304
  s_nop 0
  buffer_load_dwordx4 v1, s[4:7], s26 offen lds
  s_add_u32 s26, s26, 20480
  s_add_u32 m0, s29, 102400
  s_nop 0
  buffer_load_dwordx4 v1, s[4:7], s26 offen lds
  s_add_u32 s26, s26, 20480
  s_add_u32 m0, s29, 106496
  s_nop 0
  buffer_load_dwordx4 v1, s[4:7], s26 offen lds
  s_add_u32 s26, s26, 20480
  s_add_u32 m0, s29, 110592
  s_nop 0
  buffer_load_dwordx4 v1, s[4:7], s26 offen lds
  s_add_u32 s26, s26, 20480
  s_add_u32 m0, s29, 114688
  s_nop 0
  buffer_load_dwordx4 v1, s[4:7], s26 offen lds
  s_add_u32 s26, s26, 20480
  s_add_u32 m0, s29, 118784
  s_nop 0
  buffer_load_dwordx4 v1, s[4:7], s26 offen lds
  s_add_u32 s26, s26, 20480
  s_waitcnt vmcnt(6) lgkmcnt(0)
  s_barrier
  s_waitcnt vmcnt(3)
  s_mov_b64 exec, 1
  ds_add_u32 v20, v21 offset:76
  s_mov_b64 exec, -1
k6_h6:
  ds_read_b32 v22, v19 offset:16
  s_waitcnt lgkmcnt(0)
  v_readfirstlane_b32 s68, v22
  s_nop 0
  s_cmp_ge_u32 s68, 1
  s_cbranch_scc0 k6_h6
  ds_read_b128 v[88:91], v17 offset:0
  ds_read_b128 v[40:43], v6 offset:0
  ds_read_b128 v[92:95], v17 offset:32
  ds_read_b128 v[44:47], v6 offset:1024
  ds_read_b128 v[96:99], v17 offset:64
  ds_read_b128 v[48:51], v6 offset:2048
  ds_read_b128 v[100:103], v17 offset:96
  ds_read_b128 v[52:55], v6 offset:3072
  s_waitcnt lgkmcnt(6)
  v_mul_f32 v120, v40, v88
  v_min_f32 v136, 0, v120
  v_exp_f32 v136, v136
  v_max_f32 v120, v14, v120
  v_mul_f32 v121, v41, v89
  v_min_f32 v137, 0, v121
  v_exp_f32 v137, v137
  v_max_f32 v121, v14, v121
  v_fma_f32 v120, v120, s39, v136
  v_mul_f32 v122, v42, v90
  v_min_f32 v138, 0, v122
  v_exp_f32 v138, v138
  v_max_f32 v122, v14, v122
  v_fma_f32 v121, v121, s39, v137
  v_cvt_pk_bf16_f32 v152, v120, v121
  v_mul_f32 v123, v43, v91
  v_min_f32 v139, 0, v123
  v_exp_f32 v139, v139
  v_max_f32 v123, v14, v123
  v_fma_f32 v122, v122, s39, v138
  s_waitcnt vmcnt(0)
  s_mov_b64 exec, 1
  ds_add_u32 v20, v21 offset:80
  s_mov_b64 exec, -1
  s_waitcnt lgkmcnt(5)
  v_mul_f32 v124, v44, v92
  v_min_f32 v140, 0, v124
  v_exp_f32 v140, v140
  v_max_f32 v124, v14, v124
  v_fma_f32 v123, v123, s39, v139
  v_cvt_pk_bf16_f32 v153, v122, v123
  v_mul_f32 v125, v45, v93
  v_min_f32 v141, 0, v125
  v_exp_f32 v141, v141
  v_max_f32 v125, v14, v125
  v_fma_f32 v124, v124, s39, v140
  v_mul_f32 v126, v46, v94
  v_min_f32 v142, 0, v126
  v_exp_f32 v142, v142
  v_max_f32 v126, v14, v126
  v_fma_f32 v125, v125, s39, v141
  v_cvt_pk_bf16_f32 v154, v124, v125
  v_mul_f32 v127, v47, v95
  v_min_f32 v143, 0, v127
  v_exp_f32 v143, v143
  v_max_f32 v127, v14, v127
  v_fma_f32 v126, v126, s39, v142
k6_h7:
  ds_read_b32 v22, v19 offset:16
  s_waitcnt lgkmcnt(0)
  v_readfirstlane_b32 s68, v22
  s_nop 0
  s_cmp_ge_u32 s68, 2
  s_cbranch_scc0 k6_h7
  ds_read_b128 v[56:59], v6 offset:4096
  ds_read_b128 v[60:63], v6 offset:5120
  ds_read_b128 v[64:67], v6 offset:6144
  ds_read_b128 v[68:71], v6 offset:7168
  ds_read_b128 v[104:107], v18 offset:128
  ds_read_b128 v[108:111], v18 offset:160
  ds_read_b128 v[112:115], v18 offset:192
  ds_read_b128 v[116:119], v18 offset:224
  v_mul_f32 v128, v48, v96
  v_min_f32 v144, 0, v128
  v_exp_f32 v144, v144
  v_max_f32 v128, v14, v128
  v_fma_f32 v127, v127, s39, v143
  v_cvt_pk_bf16_f32 v155, v126, v127
  v_mul_f32 v129, v49, v97
  v_min_f32 v145, 0, v129
  v_exp_f32 v145, v145
  v_max_f32 v129, v14, v129
  v_fma_f32 v128, v128, s39, v144
  v_mul_f32 v130, v50, v98
  v_min_f32 v146, 0, v130
  v_exp_f32 v146, v146
  v_max_f32 v130, v14, v130
  v_fma_f32 v129, v129, s39, v145
  v_cvt_pk_bf16_f32 v156, v128, v129
  v_mul_f32 v131, v51, v99
  v_min_f32 v147, 0, v131
  v_exp_f32 v147, v147
  v_max_f32 v131, v14, v131
  v_fma_f32 v130, v130, s39, v146
  v_mul_f32 v132, v52, v100
  v_min_f32 v148, 0, v132
  v_exp_f32 v148, v148
  v_max_f32 v132, v14, v132
  v_fma_f32 v131, v131, s39, v147
  v_cvt_pk_bf16_f32 v157, v130, v131
  v_mul_f32 v133, v53, v101
  v_min_f32 v149, 0, v133
  v_exp_f32 v149, v149
  v_max_f32 v133, v14, v133
  v_fma_f32 v132, v132, s39, v148
  v_mul_f32 v134, v54, v102
  v_min_f32 v150, 0, v134
  v_exp_f32 v150, v150
  v_max_f32 v134, v14, v134
  v_fma_f32 v133, v133, s39, v149
  v_cvt_pk_bf16_f32 v158, v132, v133
  v_mul_f32 v135, v55, v103
  v_min_f32 v151, 0, v135
  v_exp_f32 v151, v151
  v_max_f32 v135, v14, v135
  v_fma_f32 v134, v134, s39, v150
  v_fma_f32 v135, v135, s39, v151
  v_cvt_pk_bf16_f32 v159, v134, v135
  s_waitcnt lgkmcnt(7)
  v_mul_f32 v120, v56, v88
  v_min_f32 v136, v13, v120
  v_exp_f32 v136, v136
  v_max_f32 v120, v15, v120
  v_mul_f32 v121, v57, v89
  v_min_f32 v137, v13, v121
  v_exp_f32 v137, v137
  v_max_f32 v121, v15, v121
  v_fma_f32 v120, v120, s39, v136
  v_mul_f32 v122, v58, v90
  v_min_f32 v138, v13, v122
  v_exp_f32 v138, v138
  v_max_f32 v122, v15, v122
  v_fma_f32 v121, v121, s39, v137
  v_cvt_pk_bf16_f32 v160, v120, v121
  v_mul_f32 v123, v59, v91
  v_min_f32 v139, v13, v123
  v_exp_f32 v139, v139
  v_max_f32 v123, v15, v123
  v_fma_f32 v122, v122, s39, v138
  s_waitcnt lgkmcnt(6)
  v_mul_f32 v124, v60, v92
  v_min_f32 v140, v13, v124
  v_exp_f32 v140, v140
  v_max_f32 v124, v15, v124
  v_fma_f32 v123, v123, s39, v139
  v_cvt_pk_bf16_f32 v161, v122, v123
  v_mul_f32 v125, v61, v93
  v_min_f32 v141, v13, v125
  v_exp_f32 v141, v141
  v_max_f32 v125, v15, v125
  v_fma_f32 v124, v124, s39, v140
  v_mul_f32 v126, v62, v94
  v_min_f32 v142, v13, v126
  v_exp_f32 v142, v142
  v_max_f32 v126, v15, v126
  v_fma_f32 v125, v125, s39, v141
  v_cvt_pk_bf16_f32 v162, v124, v125
  v_mul_f32 v127, v63, v95
  v_min_f32 v143, v13, v127
  v_exp_f32 v143, v143
  v_max_f32 v127, v15, v127
  v_fma_f32 v126, v126, s39, v142
  s_waitcnt lgkmcnt(5)
  v_mul_f32 v128, v64, v96
  v_min_f32 v144, v13, v128
  v_exp_f32 v144, v144
  v_max_f32 v128, v15, v128
  v_fma_f32 v127, v127, s39, v143
  v_cvt_pk_bf16_f32 v163, v126, v127
  v_mul_f32 v129, v65, v97
  v_min_f32 v145, v13, v129
  v_exp_f32 v145, v145
  v_max_f32 v129, v15, v129
  v_fma_f32 v128, v128, s39, v144
  v_mul_f32 v130, v66, v98
  v_min_f32 v146, v13, v130
  v_exp_f32 v146, v146
  v_max_f32 v130, v15, v130
  v_fma_f32 v129, v129, s39, v145
  v_cvt_pk_bf16_f32 v164, v128, v129
  v_mul_f32 v131, v67, v99
  v_min_f32 v147, v13, v131
  v_exp_f32 v147, v147
  v_max_f32 v131, v15, v131
  v_fma_f32 v130, v130, s39, v146
  s_waitcnt lgkmcnt(4)
  v_mul_f32 v132, v68, v100
  v_min_f32 v148, v13, v132
  v_exp_f32 v148, v148
  v_max_f32 v132, v15, v132
  v_fma_f32 v131, v131, s39, v147
  v_cvt_pk_bf16_f32 v165, v130, v131
  v_mul_f32 v133, v69, v101
  v_min_f32 v149, v13, v133
  v_exp_f32 v149, v149
  v_max_f32 v133, v15, v133
  v_fma_f32 v132, v132, s39, v148
  v_mul_f32 v134, v70, v102
  v_min_f32 v150, v13, v134
  v_exp_f32 v150, v150
  v_max_f32 v134, v15, v134
  v_fma_f32 v133, v133, s39, v149
  v_cvt_pk_bf16_f32 v166, v132, v133
  v_mul_f32 v135, v71, v103
  v_min_f32 v151, v13, v135
  v_exp_f32 v151, v151
  v_max_f32 v135, v15, v135
  v_fma_f32 v134, v134, s39, v150
  v_fma_f32 v135, v135, s39, v151
  v_cvt_pk_bf16_f32 v167, v134, v135
  v_cndmask_b32 v136, v152, v160, s[30:31]
  v_cndmask_b32 v137, v153, v161, s[30:31]
  v_cndmask_b32 v138, v154, v162, s[30:31]
  v_cndmask_b32 v139, v155, v163, s[30:31]
  v_cndmask_b32 v140, v156, v164, s[30:31]
  v_cndmask_b32 v141, v157, v165, s[30:31]
  v_cndmask_b32 v142, v158, v166, s[30:31]
  v_cndmask_b32 v143, v159, v167, s[30:31]
k6_h8:
  ds_read_b32 v22, v19 offset:16
  s_waitcnt lgkmcnt(0)
  v_readfirstlane_b32 s68, v22
  s_nop 0
  s_cmp_ge_u32 s68, 3
  s_cbranch_scc0 k6_h8
  s_setprio 1
  ds_read_b128 v[72:75], v16 offset:0
  ds_read_b128 v[76:79], v16 offset:1024
  ds_read_b128 v[80:83], v16 offset:2048
  ds_read_b128 v[84:87], v16 offset:3072
  s_waitcnt lgkmcnt(3)
  v_mul_f32 v120, v72, v104
  v_mul_f32 v121, v73, v105
  v_cvt_pk_bf16_f32 v176, v120, v121
  v_cndmask_b32 v168, v176, v11, s[34:35]
  v_cndmask_b32 v184, v160, v168, s[30:31]
  v_mul_f32 v122, v74, v106
  v_mul_f32 v123, v75, v107
  v_cvt_pk_bf16_f32 v177, v122, v123
  v_cndmask_b32 v169, v177, v11, s[34:35]
  v_cndmask_b32 v185, v161, v169, s[30:31]
  s_waitcnt lgkmcnt(2)
  v_mul_f32 v124, v76, v108
  v_mul_f32 v125, v77, v109
  v_cvt_pk_bf16_f32 v178, v124, v125
  v_cndmask_b32 v170, v178, v11, s[34:35]
  v_cndmask_b32 v186, v162, v170, s[30:31]
  v_mul_f32 v126, v78, v110
  v_mul_f32 v127, v79, v111
  v_cvt_pk_bf16_f32 v179, v126, v127
  v_cndmask_b32 v171, v179, v11, s[34:35]
  v_cndmask_b32 v187, v163, v171, s[30:31]
  s_nop 0
  v_mfma_f32_32x32x16_bf16 v[208:223], v[168:171], v[136:139], 0
  v_mfma_f32_32x32x16_bf16 v[192:207], v[184:187], v[152:155], 0
  s_waitcnt lgkmcnt(1)
  v_mul_f32 v128, v80, v112
  v_mul_f32 v129, v81, v113
  v_cvt_pk_bf16_f32 v180, v128, v129
  v_cndmask_b32 v172, v180, v11, s[34:35]
  v_cndmask_b32 v188, v164, v172, s[30:31]
  v_mul_f32 v130, v82, v114
  v_mul_f32 v131, v83, v115
  v_cvt_pk_bf16_f32 v181, v130, v131
  v_cndmask_b32 v173, v181, v11, s[34:35]
  v_cndmask_b32 v189, v165, v173, s[30:31]
  s_waitcnt lgkmcnt(0)
  v_mul_f32 v132, v84, v116
  v_mul_f32 v133, v85, v117
  v_cvt_pk_bf16_f32 v182, v132, v133
  v_cndmask_b32 v174, v182, v11, s[34:35]
  v_cndmask_b32 v190, v166, v174, s[30:31]
  v_mul_f32 v134, v86, v118
  v_mul_f32 v135, v87, v119
  v_cvt_pk_bf16_f32 v183, v134, v135
  v_cndmask_b32 v175, v183, v11, s[34:35]
  v_cndmask_b32 v191, v167, v175, s[30:31]
  s_nop 0
  v_mfma_f32_32x32x16_bf16 v[208:223], v[172:175], v[140:143], v[208:223]
  v_mfma_f32_32x32x16_bf16 v[192:207], v[188:191], v[156:159], v[192:207]
  v_cndmask_b32 v176, v160, v176, s[32:33]
  v_cndmask_b32 v177, v161, v177, s[32:33]
  v_cndmask_b32 v178, v162, v178, s[32:33]
  v_cndmask_b32 v179, v163, v179, s[32:33]
  v_cndmask_b32 v180, v164, v180, s[32:33]
  v_cndmask_b32 v181, v165, v181, s[32:33]
  v_cndmask_b32 v182, v166, v182, s[32:33]
  v_cndmask_b32 v183, v167, v183, s[32:33]
  s_nop 2
  ds_write_b64 v7, v[212:213] offset:3072
  ds_write_b64 v7, v[214:215] offset:3584
  ds_write_b64 v7, v[216:217] offset:4096
  ds_write_b64 v7, v[218:219] offset:4608
  ds_write_b64 v7, v[220:221] offset:5120
  ds_write_b64 v7, v[222:223] offset:5632
  ds_write_b64 v7, v[192:193] offset:0
  ds_write_b64 v7, v[194:195] offset:512
  ds_write_b64 v7, v[196:197] offset:1024
  ds_write_b64 v7, v[198:199] offset:1536
  ds_write_b64 v7, v[200:201] offset:2048
  ds_write_b64 v7, v[202:203] offset:2560
  s_mov_b64 exec, 1
  ds_add_u32 v20, v21 offset:36
  s_mov_b64 exec, -1
  v_mfma_f32_32x32x16_bf16 v[224:239], v[176:179], v[32:35], 0
  v_mfma_f32_32x32x16_bf16 v[224:239], v[180:183], v[36:39], v[224:239]
k6_h9:
  ds_read_b32 v22, v20 offset:36
  s_waitcnt lgkmcnt(0)
  v_readfirstlane_b32 s68, v22
  s_nop 0
  s_cmp_ge_u32 s68, 4
  s_cbranch_scc0 k6_h9
  ds_read_b64 v[40:41], v12 offset:0
  ds_read_b64 v[42:43], v12 offset:512
  ds_read_b64 v[44:45], v12 offset:1024
  ds_read_b64 v[46:47], v12 offset:8192
  ds_read_b64 v[48:49], v12 offset:8704
  ds_read_b64 v[50:51], v12 offset:9216
  ds_read_b64 v[52:53], v12 offset:16384
  ds_read_b64 v[54:55], v12 offset:16896
  ds_read_b64 v[56:57], v12 offset:17408
  ds_read_b64 v[58:59], v12 offset:24576
  ds_read_b64 v[60:61], v12 offset:25088
  ds_read_b64 v[62:63], v12 offset:25600
  s_waitcnt lgkmcnt(8)
  v_add_f32 v40, v40, v46
  s_waitcnt lgkmcnt(2)
  v_add_f32 v52, v52, v58
  v_add_f32 v41, v41, v47
  v_add_f32 v53, v53, v59
  v_add_f32 v42, v42, v48
  s_waitcnt lgkmcnt(1)
  v_add_f32 v54, v54, v60
  v_add_f32 v43, v43, v49
  v_add_f32 v55, v55, v61
  v_add_f32 v44, v44, v50
  s_waitcnt lgkmcnt(0)
  v_add_f32 v56, v56, v62
  v_add_f32 v45, v45, v51
  v_add_f32 v57, v57, v63
  v_add_f32 v40, v40, v52
  v_add_f32 v41, v41, v53
  v_add_f32 v42, v42, v54
  v_add_f32 v43, v43, v55
  v_add_f32 v44, v44, v56
  v_add_f32 v45, v45, v57
  s_mov_b64 exec, s[54:55]
  buffer_atomic_add_f32 v40, v10, s[4:7], s60 offen
  s_mov_b64 exec, s[52:53]
  buffer_atomic_add_f32 v41, v10, s[4:7], s61 offen
  s_mov_b64 exec, s[52:53]
  buffer_atomic_add_f32 v42, v10, s[4:7], s62 offen
  s_mov_b64 exec, s[56:57]
  buffer_atomic_add_f32 v43, v10, s[4:7], s63 offen
  s_mov_b64 exec, s[50:51]
  buffer_atomic_add_f32 v44, v10, s[4:7], s64 offen
  s_mov_b64 exec, s[50:51]
  buffer_atomic_add_f32 v45, v10, s[4:7], s65 offen
  s_mov_b64 exec, -1
  s_add_u32 s44, s43, 15933440
  v_cvt_pk_bf16_f32 v120, v236, v237
  v_cvt_pk_bf16_f32 v121, v238, v239
  buffer_store_dwordx2 v[120:121], v5, s[4:7], s44 offen
  v_cmp_eq_u32 vcc, 0, v3
  v_cvt_pk_bf16_f32 v122, v224, v225
  v_cvt_pk_bf16_f32 v124, v228, v229
  v_cndmask_b32 v122, v122, v124, vcc
  v_cvt_pk_bf16_f32 v123, v226, v227
  v_cvt_pk_bf16_f32 v125, v230, v231
  v_cndmask_b32 v123, v123, v125, vcc
  s_add_u32 s44, s43, 10625024
  buffer_store_dwordx2 v[122:123], v5, s[4:7], s44 offen
  s_endpgm
k6_exit:
  s_endpgm
.globl k4_kernel
.p2align 8
.type k4_kernel,@function
k4_kernel:
  s_cmp_ge_u32 s2, 256
  s_cbranch_scc1 k4_exit
  s_load_dwordx2 s[4:5], s[0:1], 64
  s_mov_b32 s6, 28360704
  s_mov_b32 s7, 0x20000
  s_load_dwordx2 s[8:9], s[0:1], 64
  s_mov_b32 s10, 28360704
  s_mov_b32 s11, 0x20000
  s_mov_b32 s40, 13271040
  s_mov_b32 s41, 26132480
  s_mov_b32 s42, 24477696
  s_mov_b32 s43, 2654208
  s_mov_b32 s44, 5308416
  s_mov_b32 s45, 2048
  s_mov_b32 s46, 16
  s_mov_b32 s47, 165888
  s_branch k4_main
.globl k7_kernel
.p2align 8
.type k7_kernel,@function
k7_kernel:
  s_cmp_ge_u32 s2, 256
  s_cbranch_scc1 k4_exit
  s_load_dwordx2 s[4:5], s[0:1], 64
  s_mov_b32 s6, 28360704
  s_mov_b32 s7, 0x20000
  s_load_dwordx2 s[8:9], s[0:1], 48
  s_mov_b32 s10, 2621440
  s_mov_b32 s11, 0x20000
  s_mov_b32 s40, 15925248
  s_mov_b32 s41, 26198016
  s_mov_b32 s42, 25296896
  s_mov_b32 s43, 10616832
  s_mov_b32 s44, 0
  s_mov_b32 s45, 16
  s_mov_b32 s46, 1280
  s_mov_b32 s47, 163840
k4_main:
  v_lshlrev_b32 v5, 4, v0
  v_and_b32 v1, 63, v0
  v_lshrrev_b32 v2, 6, v0
  s_nop 0
  v_readfirstlane_b32 s19, v2
  v_and_b32 v2, 15, v0
  v_bfe_u32 v3, v0, 4, 2
  s_and_b32 s20, s19, 3
  s_lshr_b32 s19, s19, 2
  s_bfe_u32 s21, s2, 0x20001
  s_lshl_b32 s21, s21, 2
  s_lshr_b32 s22, s2, 6
  s_add_u32 s21, s21, s22
  s_bfe_u32 s24, s2, 0x10005
  s_and_b32 s22, s2, 1
  s_lshl_b32 s22, s22, 2
  s_bfe_u32 s23, s2, 0x20003
  s_add_u32 s22, s22, s23
  v_lshlrev_b32 v6, 4, v1
  s_cmp_eq_u32 s19, 2
  s_cbranch_scc1 k4_ld
  s_lshl_b32 s24, s24, 6
  s_lshl_b32 s23, s20, 4
  s_add_u32 s24, s24, s23
  v_add_u32 v4, s24, v2
  s_mul_i32 s23, s21, 165888
  s_add_u32 s40, s40, s23
  s_mul_i32 s26, s19, 81920
  s_add_u32 s40, s40, s26
  v_lshlrev_b32 v7, 11, v3
  v_lshl_add_u32 v8, v4, 4, v7
  v_add_u32 v10, 4096, v8
  v_cmp_eq_u32 vcc, 2, v3
  s_nop 1
  v_cndmask_b32 v9, v8, v10, vcc
  v_cmp_eq_u32 vcc, 3, v3
  v_mov_b32 v11, 0x40000000
  s_nop 0
  v_cndmask_b32 v9, v9, v11, vcc
  v_cndmask_b32 v10, v10, v11, vcc
  s_mul_i32 s26, s19, 51200
  s_waitcnt lgkmcnt(0)
  buffer_load_dwordx4 v[24:27], v5, s[4:7], s41 offen
  s_add_u32 s41, s41, 8064
  buffer_load_dwordx4 v[28:31], v5, s[4:7], s41 offen
  s_add_u32 s41, s41, 8064
  buffer_load_dwordx4 v[32:35], v5, s[4:7], s41 offen
  s_add_u32 s41, s41, 8064
  buffer_load_dwordx4 v[36:39], v5, s[4:7], s41 offen
  s_add_u32 s41, s41, 8064
  buffer_load_dwordx4 v[40:43], v5, s[4:7], s41 offen
  s_add_u32 s41, s41, 8064
  buffer_load_dwordx4 v[44:47], v5, s[4:7], s41 offen
  s_add_u32 s41, s41, 8064
  buffer_load_dwordx4 v[48:51], v5, s[4:7], s41 offen
  s_add_u32 s41, s41, 8064
  buffer_load_dwordx4 v[52:55], v5, s[4:7], s41 offen
  s_add_u32 s41, s41, 8064
  buffer_load_dwordx4 a[0:3], v9, s[4:7], s40 offen
  buffer_load_dwordx4 a[4:7], v10, s[4:7], s40 offen
  s_add_u32 s40, s40, 10240
  v_mul_u32_u24 v11, 521, v0
  v_lshrrev_b32 v11, 16, v11
  v_mul_u32_u24 v12, 126, v11
  v_sub_u32 v12, v0, v12
  v_mul_u32_u24 v13, 43, v12
  v_lshrrev_b32 v13, 8, v13
  v_mul_u32_u24 v14, 6, v13
  v_sub_u32 v12, v12, v14
  v_and_b32 v14, 1, v11
  v_lshl_add_u32 v13, v14, 2, v13
  v_subrev_u32 v13, 4, v13
  v_add_u32 v16, 21, v13
  v_cmp_gt_i32 vcc, 0, v13
  s_nop 1
  v_cndmask_b32 v13, v13, v16, vcc
  v_mul_u32_u24 v14, 52, v13
  v_lshrrev_b32 v14, 8, v14
  v_mul_u32_u24 v16, 5, v14
  v_cmp_eq_u32 vcc, v16, v13
  v_sub_u32 v13, v13, v14
  v_subrev_u32 v13, 1, v13
  v_lshrrev_b32 v16, 1, v12
  v_lshl_add_u32 v13, v16, 4, v13
  v_mad_u32_u24 v14, v16, 5, v14
  v_add_u32 v14, 48, v14
  v_cndmask_b32 v13, v13, v14, vcc
  v_and_b32 v12, 1, v12
  v_lshlrev_b32 v12, 3, v12
  v_lshl_add_u32 v12, v13, 4, v12
  v_lshl_add_u32 v11, v11, 10, v12
  v_add_u32 v11, 102400, v11
  v_cmp_gt_u32 vcc, 504, v0
  s_nop 0
  s_mov_b64 s[38:39], vcc
  s_mov_b64 exec, s[38:39]
  s_waitcnt vmcnt(9)
  v_cvt_pk_bf16_f32 v24, v24, v25
  v_cvt_pk_bf16_f32 v25, v26, v27
  ds_write_b64 v11, v[24:25] offset:0
  s_waitcnt vmcnt(8)
  v_cvt_pk_bf16_f32 v28, v28, v29
  v_cvt_pk_bf16_f32 v29, v30, v31
  ds_write_b64 v11, v[28:29] offset:4096
  s_waitcnt vmcnt(7)
  v_cvt_pk_bf16_f32 v32, v32, v33
  v_cvt_pk_bf16_f32 v33, v34, v35
  ds_write_b64 v11, v[32:33] offset:8192
  s_waitcnt vmcnt(6)
  v_cvt_pk_bf16_f32 v36, v36, v37
  v_cvt_pk_bf16_f32 v37, v38, v39
  ds_write_b64 v11, v[36:37] offset:12288
  s_waitcnt vmcnt(5)
  v_cvt_pk_bf16_f32 v40, v40, v41
  v_cvt_pk_bf16_f32 v41, v42, v43
  ds_write_b64 v11, v[40:41] offset:16384
  s_waitcnt vmcnt(4)
  v_cvt_pk_bf16_f32 v44, v44, v45
  v_cvt_pk_bf16_f32 v45, v46, v47
  ds_write_b64 v11, v[44:45] offset:20480
  s_waitcnt vmcnt(3)
  v_cvt_pk_bf16_f32 v48, v48, v49
  v_cvt_pk_bf16_f32 v49, v50, v51
  ds_write_b64 v11, v[48:49] offset:24576
  s_waitcnt vmcnt(2)
  v_cvt_pk_bf16_f32 v52, v52, v53
  v_cvt_pk_bf16_f32 v53, v54, v55
  ds_write_b64 v11, v[52:53] offset:28672
  s_mov_b64 exec, -1
  buffer_load_dwordx4 a[8:11], v9, s[4:7], s40 offen
  buffer_load_dwordx4 a[12:15], v10, s[4:7], s40 offen
  s_add_u32 s40, s40, 10240
  v_min_u32 v13, 2, v3
  s_lshl_b32 s28, s19, 14
  s_add_u32 s28, s28, 102400
  v_lshl_add_u32 v12, v13, 4, v2
  v_lshl_add_u32 v16, v12, 4, s28
  v_lshrrev_b32 v12, 2, v2
  v_add_u32 v12, 1, v12
  v_and_b32 v14, 3, v2
  v_cmp_eq_u32 vcc, 0, v14
  s_nop 1
  v_cndmask_b32 v12, 0, v12, vcc
  v_mad_u32_u24 v12, v13, 5, v12
  v_lshl_add_u32 v17, v12, 4, s28
  v_mov_b32 v108, 0
  v_mov_b32 v109, 0x358637bd
  v_mov_b32 v110, 0
  v_mov_b32 v111, 0
  s_waitcnt lgkmcnt(0)
  s_barrier
  ds_read_b128 a[32:35], v16 offset:0
  ds_read_b128 a[36:39], v17 offset:768
  ds_read_b128 a[40:43], v16 offset:1024
  ds_read_b128 a[44:47], v17 offset:1792
  buffer_load_dwordx4 a[16:19], v9, s[4:7], s40 offen
  buffer_load_dwordx4 a[20:23], v10, s[4:7], s40 offen
  s_add_u32 s40, s40, 10240
  buffer_load_dwordx4 a[24:27], v9, s[4:7], s40 offen
  ds_read_b128 a[48:51], v16 offset:2048
  ds_read_b128 a[52:55], v17 offset:2816
  s_waitcnt vmcnt(6) lgkmcnt(5)
  v_mfma_f32_16x16x32_bf16 v[24:27], a[32:35], a[0:3], 0
  s_waitcnt lgkmcnt(4)
  v_mfma_f32_16x16x32_bf16 v[28:31], a[36:39], a[0:3], v[108:111]
  buffer_load_dwordx4 a[28:31], v10, s[4:7], s40 offen
  s_add_u32 s40, s40, 10240
  v_add_u32 v21, s26, v6
  s_lshl_b32 s28, s19, 11
  v_add_u32 v14, s28, v21
  ds_read_b128 a[32:35], v16 offset:3072
  ds_read_b128 a[36:39], v17 offset:3840
  s_waitcnt vmcnt(6) lgkmcnt(5)
  v_mfma_f32_16x16x32_bf16 v[32:35], a[40:43], a[4:7], 0
  s_waitcnt lgkmcnt(4)
  v_mfma_f32_16x16x32_bf16 v[36:39], a[44:47], a[4:7], v[108:111]
  buffer_load_dwordx4 a[0:3], v9, s[4:7], s40 offen
  v_subrev_u32 v22, s28, v21
  v_lshrrev_b32 v18, 1, v3
  v_lshlrev_b32 v15, 11, v18
  ds_read_b128 a[40:43], v16 offset:4096
  ds_read_b128 a[44:47], v17 offset:4864
  s_waitcnt vmcnt(6) lgkmcnt(5)
  v_mfma_f32_16x16x32_bf16 v[40:43], a[48:51], a[8:11], 0
  s_waitcnt lgkmcnt(4)
  v_mfma_f32_16x16x32_bf16 v[44:47], a[52:55], a[8:11], v[108:111]
  buffer_load_dwordx4 a[4:7], v10, s[4:7], s40 offen
  s_add_u32 s40, s40, 10240
  v_and_b32 v7, 1, v3
  v_lshl_add_u32 v15, v7, 3, v15
  v_lshl_add_u32 v15, v4, 4, v15
  v_rcp_f32 v30, v29
  ds_read_b128 a[48:51], v16 offset:5120
  ds_read_b128 a[52:55], v17 offset:5888
  s_waitcnt vmcnt(6) lgkmcnt(5)
  v_mfma_f32_16x16x32_bf16 v[48:51], a[32:35], a[12:15], 0
  s_waitcnt lgkmcnt(4)
  v_mfma_f32_16x16x32_bf16 v[52:55], a[36:39], a[12:15], v[108:111]
  buffer_load_dwordx4 a[8:11], v9, s[4:7], s40 offen
  s_mul_i32 s28, s22, 20480
  s_add_u32 s43, s43, s28
  s_add_u32 s43, s43, s23
  v_rcp_f32 v38, v37
  v_mul_f32 v24, v24, v30
  v_mul_f32 v25, v25, v30
  v_mul_f32 v26, v26, v30
  v_mul_f32 v27, v27, v30
  v_mul_f32 v28, v28, v30
  v_cvt_pk_bf16_f32 v72, v24, v25
  v_cvt_pk_bf16_f32 v73, v26, v27
  ds_read_b128 a[32:35], v16 offset:6144
  ds_read_b128 a[36:39], v17 offset:6912
  s_waitcnt vmcnt(6) lgkmcnt(5)
  v_mfma_f32_16x16x32_bf16 v[56:59], a[40:43], a[16:19], 0
  s_waitcnt lgkmcnt(4)
  v_mfma_f32_16x16x32_bf16 v[60:63], a[44:47], a[16:19], v[108:111]
  buffer_load_dwordx4 a[12:15], v10, s[4:7], s40 offen
  s_add_u32 s40, s40, 10240
  s_lshl_b32 s28, s19, 13
  s_add_u32 s35, s43, s28
  s_add_u32 s43, s43, 16384
  v_rcp_f32 v46, v45
  v_mul_f32 v32, v32, v38
  v_mul_f32 v33, v33, v38
  v_mul_f32 v34, v34, v38
  v_mul_f32 v35, v35, v38
  v_mul_f32 v36, v36, v38
  v_cvt_pk_bf16_f32 v74, v28, v32
  v_cvt_pk_bf16_f32 v75, v33, v34
  v_cvt_pk_bf16_f32 v76, v35, v36
  ds_read_b128 a[40:43], v16 offset:7168
  ds_read_b128 a[44:47], v17 offset:7936
  s_waitcnt vmcnt(6) lgkmcnt(5)
  v_mfma_f32_16x16x32_bf16 v[64:67], a[48:51], a[20:23], 0
  s_waitcnt lgkmcnt(4)
  v_mfma_f32_16x16x32_bf16 v[68:71], a[52:55], a[20:23], v[108:111]
  buffer_load_dwordx4 a[16:19], v9, s[4:7], s40 offen
  s_mov_b32 s29, 0x358637bd
  v_mul_lo_u32 v19, v3, s45
  v_mul_lo_u32 v20, v4, s46
  v_rcp_f32 v54, v53
  v_mul_f32 v40, v40, v46
  v_mul_f32 v41, v41, v46
  v_mul_f32 v42, v42, v46
  v_mul_f32 v43, v43, v46
  v_mul_f32 v44, v44, v46
  v_cvt_pk_bf16_f32 v77, v40, v41
  v_cvt_pk_bf16_f32 v78, v42, v43
  ds_read_b128 a[48:51], v16 offset:8192
  ds_read_b128 a[52:55], v17 offset:8960
  s_waitcnt vmcnt(6) lgkmcnt(5)
  v_mfma_f32_16x16x32_bf16 v[24:27], a[32:35], a[24:27], 0
  s_waitcnt lgkmcnt(4)
  v_mfma_f32_16x16x32_bf16 v[28:31], a[36:39], a[24:27], v[108:111]
  buffer_load_dwordx4 a[20:23], v10, s[4:7], s40 offen
  s_add_u32 s40, s40, 10240
  v_add_u32 v19, v19, v20
  v_mul_lo_u32 v18, v18, s45
  v_lshl_add_u32 v18, v7, 3, v18
  v_rcp_f32 v62, v61
  v_mul_f32 v48, v48, v54
  v_mul_f32 v49, v49, v54
  v_mul_f32 v50, v50, v54
  v_mul_f32 v51, v51, v54
  v_mul_f32 v52, v52, v54
  v_cvt_pk_bf16_f32 v79, v44, v48
  v_cvt_pk_bf16_f32 v80, v49, v50
  v_cvt_pk_bf16_f32 v81, v51, v52
  ds_read_b128 a[32:35], v16 offset:9216
  ds_read_b128 a[36:39], v17 offset:9984
  s_waitcnt vmcnt(6) lgkmcnt(5)
  v_mfma_f32_16x16x32_bf16 v[32:35], a[40:43], a[28:31], 0
  s_waitcnt lgkmcnt(4)
  v_mfma_f32_16x16x32_bf16 v[36:39], a[44:47], a[28:31], v[108:111]
  buffer_load_dwordx4 a[24:27], v9, s[4:7], s40 offen
  v_add_u32 v20, v18, v20
  s_mul_i32 s30, s22, 10
  s_mul_i32 s30, s30, s45
  v_rcp_f32 v70, v69
  v_mul_f32 v56, v56, v62
  v_mul_f32 v57, v57, v62
  v_mul_f32 v58, v58, v62
  v_mul_f32 v59, v59, v62
  v_mul_f32 v60, v60, v62
  v_cvt_pk_bf16_f32 v82, v56, v57
  v_cvt_pk_bf16_f32 v83, v58, v59
  ds_read_b128 a[40:43], v16 offset:10240
  ds_read_b128 a[44:47], v17 offset:11008
  s_waitcnt vmcnt(6) lgkmcnt(5)
  v_mfma_f32_16x16x32_bf16 v[40:43], a[48:51], a[0:3], 0
  s_waitcnt lgkmcnt(4)
  v_mfma_f32_16x16x32_bf16 v[44:47], a[52:55], a[0:3], v[108:111]
  buffer_load_dwordx4 a[28:31], v10, s[4:7], s40 offen
  s_add_u32 s40, s40, 10240
  s_add_u32 s30, s30, s44
  s_mul_i32 s31, s21, s47
  s_add_u32 s30, s30, s31
  v_rcp_f32 v30, v29
  v_mul_f32 v64, v64, v70
  v_mul_f32 v65, v65, v70
  v_mul_f32 v66, v66, v70
  v_mul_f32 v67, v67, v70
  v_mul_f32 v68, v68, v70
  v_cvt_pk_bf16_f32 v84, v60, v64
  v_cvt_pk_bf16_f32 v85, v65, v66
  v_cvt_pk_bf16_f32 v86, v67, v68
  ds_read_b128 a[48:51], v16 offset:11264
  ds_read_b128 a[52:55], v17 offset:12032
  s_waitcnt vmcnt(6) lgkmcnt(5)
  v_mfma_f32_16x16x32_bf16 v[48:51], a[32:35], a[4:7], 0
  s_waitcnt lgkmcnt(4)
  v_mfma_f32_16x16x32_bf16 v[52:55], a[36:39], a[4:7], v[108:111]
  s_lshl_b32 s31, s45, 3
  s_add_u32 s33, s30, s31
  s_lshl_b32 s31, s45, 2
  v_rcp_f32 v38, v37
  v_mul_f32 v24, v24, v30
  v_mul_f32 v25, v25, v30
  v_mul_f32 v26, v26, v30
  v_mul_f32 v27, v27, v30
  v_mul_f32 v28, v28, v30
  v_cvt_pk_bf16_f32 v87, v24, v25
  v_cvt_pk_bf16_f32 v88, v26, v27
  ds_read_b128 a[32:35], v16 offset:12288
  ds_read_b128 a[36:39], v17 offset:13056
  s_waitcnt vmcnt(5) lgkmcnt(5)
  v_mfma_f32_16x16x32_bf16 v[56:59], a[40:43], a[8:11], 0
  s_waitcnt lgkmcnt(4)
  v_mfma_f32_16x16x32_bf16 v[60:63], a[44:47], a[8:11], v[108:111]
  s_mul_i32 s31, s31, s19
  s_add_u32 s30, s30, s31
  s_lshl_b32 s28, s19, 2
  v_rcp_f32 v46, v45
  v_mul_f32 v32, v32, v38
  v_mul_f32 v33, v33, v38
  v_mul_f32 v34, v34, v38
  v_mul_f32 v35, v35, v38
  v_mul_f32 v36, v36, v38
  v_cvt_pk_bf16_f32 v89, v28, v32
  v_cvt_pk_bf16_f32 v90, v33, v34
  v_cvt_pk_bf16_f32 v91, v35, v36
  ds_read_b128 a[40:43], v16 offset:13312
  ds_read_b128 a[44:47], v17 offset:14080
  s_waitcnt vmcnt(4) lgkmcnt(5)
  v_mfma_f32_16x16x32_bf16 v[64:67], a[48:51], a[12:15], 0
  s_waitcnt lgkmcnt(4)
  v_mfma_f32_16x16x32_bf16 v[68:71], a[52:55], a[12:15], v[108:111]
  s_add_u32 s28, s28, s20
  s_mul_i32 s34, s28, 3072
  s_add_u32 s34, s34, 102400
  v_rcp_f32 v54, v53
  v_mul_f32 v40, v40, v46
  v_mul_f32 v41, v41, v46
  v_mul_f32 v42, v42, v46
  v_mul_f32 v43, v43, v46
  v_mul_f32 v44, v44, v46
  v_cvt_pk_bf16_f32 v92, v40, v41
  v_cvt_pk_bf16_f32 v93, v42, v43
  ds_read_b128 a[48:51], v16 offset:14336
  ds_read_b128 a[52:55], v17 offset:15104
  s_waitcnt vmcnt(3) lgkmcnt(5)
  v_mfma_f32_16x16x32_bf16 v[24:27], a[32:35], a[16:19], 0
  s_waitcnt lgkmcnt(4)
  v_mfma_f32_16x16x32_bf16 v[28:31], a[36:39], a[16:19], v[108:111]
  v_add_u32 v18, s34, v6
  s_xor_b32 s28, s28, 4
  s_mul_i32 s34, s28, 3072
  v_rcp_f32 v62, v61
  v_mul_f32 v48, v48, v54
  v_mul_f32 v49, v49, v54
  v_mul_f32 v50, v50, v54
  v_mul_f32 v51, v51, v54
  v_mul_f32 v52, v52, v54
  v_cvt_pk_bf16_f32 v94, v44, v48
  v_cvt_pk_bf16_f32 v95, v49, v50
  v_cvt_pk_bf16_f32 v96, v51, v52
  ds_read_b128 a[32:35], v16 offset:15360
  ds_read_b128 a[36:39], v17 offset:16128
  s_waitcnt vmcnt(2) lgkmcnt(5)
  v_mfma_f32_16x16x32_bf16 v[32:35], a[40:43], a[20:23], 0
  s_waitcnt lgkmcnt(4)
  v_mfma_f32_16x16x32_bf16 v[36:39], a[44:47], a[20:23], v[108:111]
  s_add_u32 s34, s34, 102400
  v_add_u32 v23, s34, v6
  v_rcp_f32 v70, v69
  v_mul_f32 v56, v56, v62
  v_mul_f32 v57, v57, v62
  v_mul_f32 v58, v58, v62
  v_mul_f32 v59, v59, v62
  v_mul_f32 v60, v60, v62
  v_cvt_pk_bf16_f32 v97, v56, v57
  v_cvt_pk_bf16_f32 v98, v58, v59
  s_waitcnt vmcnt(1) lgkmcnt(3)
  v_mfma_f32_16x16x32_bf16 v[40:43], a[48:51], a[24:27], 0
  s_waitcnt lgkmcnt(2)
  v_mfma_f32_16x16x32_bf16 v[44:47], a[52:55], a[24:27], v[108:111]
  v_rcp_f32 v30, v29
  v_mul_f32 v64, v64, v70
  v_mul_f32 v65, v65, v70
  v_mul_f32 v66, v66, v70
  v_mul_f32 v67, v67, v70
  v_mul_f32 v68, v68, v70
  v_cvt_pk_bf16_f32 v99, v60, v64
  v_cvt_pk_bf16_f32 v100, v65, v66
  v_cvt_pk_bf16_f32 v101, v67, v68
  s_waitcnt vmcnt(0) lgkmcnt(1)
  v_mfma_f32_16x16x32_bf16 v[48:51], a[32:35], a[28:31], 0
  s_waitcnt lgkmcnt(0)
  v_mfma_f32_16x16x32_bf16 v[52:55], a[36:39], a[28:31], v[108:111]
  v_rcp_f32 v38, v37
  v_mul_f32 v24, v24, v30
  v_mul_f32 v25, v25, v30
  v_mul_f32 v26, v26, v30
  v_mul_f32 v27, v27, v30
  v_mul_f32 v28, v28, v30
  v_cvt_pk_bf16_f32 v102, v24, v25
  v_cvt_pk_bf16_f32 v103, v26, v27
  v_rcp_f32 v46, v45
  v_mul_f32 v32, v32, v38
  v_mul_f32 v33, v33, v38
  v_mul_f32 v34, v34, v38
  v_mul_f32 v35, v35, v38
  v_mul_f32 v36, v36, v38
  v_cvt_pk_bf16_f32 v104, v28, v32
  v_cvt_pk_bf16_f32 v105, v33, v34
  v_cvt_pk_bf16_f32 v106, v35, v36
  v_rcp_f32 v54, v53
  v_mul_f32 v40, v40, v46
  v_mul_f32 v41, v41, v46
  v_mul_f32 v42, v42, v46
  v_mul_f32 v43, v43, v46
  v_mul_f32 v44, v44, v46
  v_cvt_pk_bf16_f32 v107, v40, v41
  v_cvt_pk_bf16_f32 v108, v42, v43
  v_mul_f32 v48, v48, v54
  v_mul_f32 v49, v49, v54
  v_mul_f32 v50, v50, v54
  v_mul_f32 v51, v51, v54
  v_mul_f32 v52, v52, v54
  v_cvt_pk_bf16_f32 v109, v44, v48
  v_cvt_pk_bf16_f32 v110, v49, v50
  v_cvt_pk_bf16_f32 v111, v51, v52
  buffer_load_dwordx4 v[44:47], v8, s[4:7], s35 offen
  buffer_load_dwordx2 v[48:49], v15, s[4:7], s43 offen
  s_barrier
  ds_read_b128 a[0:3], v14 offset:0
  ds_read_b128 a[4:7], v14 offset:1024
  ds_read_b128 a[8:11], v22 offset:2048
  ds_read_b128 a[12:15], v22 offset:3072
  ds_read_b128 a[16:19], v21 offset:4096
  ds_read_b128 a[20:23], v14 offset:5120
  ds_read_b128 a[24:27], v14 offset:6144
  ds_read_b128 a[28:31], v22 offset:7168
  ds_read_b128 a[32:35], v22 offset:8192
  s_waitcnt lgkmcnt(8)
  v_mfma_f32_16x16x32_bf16 v[24:27], a[0:3], v[72:75], 0
  ds_read_b128 a[36:39], v21 offset:9216
  s_waitcnt lgkmcnt(8)
  v_mfma_f32_16x16x32_bf16 v[28:31], a[4:7], v[72:75], 0
  ds_read_b128 a[40:43], v14 offset:10240
  s_waitcnt lgkmcnt(8)
  v_mfma_f32_16x16x32_bf16 v[32:35], a[8:11], v[72:75], 0
  ds_read_b128 a[44:47], v14 offset:11264
  s_waitcnt lgkmcnt(8)
  v_mfma_f32_16x16x32_bf16 v[36:39], a[12:15], v[72:75], 0
  ds_read_b128 a[0:3], v22 offset:12288
  s_waitcnt lgkmcnt(8)
  v_mfma_f32_16x16x32_bf16 v[40:43], a[16:19], v[72:75], 0
  ds_read_b128 a[4:7], v22 offset:13312
  s_waitcnt lgkmcnt(8)
  v_mfma_f32_16x16x32_bf16 v[24:27], a[20:23], v[76:79], v[24:27]
  ds_read_b128 a[8:11], v21 offset:14336
  s_waitcnt lgkmcnt(8)
  v_mfma_f32_16x16x32_bf16 v[28:31], a[24:27], v[76:79], v[28:31]
  s_barrier
  ds_read_b128 a[12:15], v14 offset:15360
  s_waitcnt lgkmcnt(8)
  v_mfma_f32_16x16x32_bf16 v[32:35], a[28:31], v[76:79], v[32:35]
  ds_read_b128 a[16:19], v14 offset:16384
  s_waitcnt lgkmcnt(8)
  v_mfma_f32_16x16x32_bf16 v[36:39], a[32:35], v[76:79], v[36:39]
  ds_read_b128 a[20:23], v22 offset:17408
  s_waitcnt lgkmcnt(8)
  v_mfma_f32_16x16x32_bf16 v[40:43], a[36:39], v[76:79], v[40:43]
  ds_read_b128 a[24:27], v22 offset:18432
  s_waitcnt lgkmcnt(8)
  v_mfma_f32_16x16x32_bf16 v[24:27], a[40:43], v[80:83], v[24:27]
  ds_read_b128 a[28:31], v21 offset:19456
  s_waitcnt lgkmcnt(8)
  v_mfma_f32_16x16x32_bf16 v[28:31], a[44:47], v[80:83], v[28:31]
  ds_read_b128 a[32:35], v14 offset:20480
  s_waitcnt lgkmcnt(8)
  v_mfma_f32_16x16x32_bf16 v[32:35], a[0:3], v[80:83], v[32:35]
  ds_read_b128 a[36:39], v14 offset:21504
  s_waitcnt lgkmcnt(8)
  v_mfma_f32_16x16x32_bf16 v[36:39], a[4:7], v[80:83], v[36:39]
  ds_read_b128 a[40:43], v22 offset:22528
  s_waitcnt lgkmcnt(8)
  v_mfma_f32_16x16x32_bf16 v[40:43], a[8:11], v[80:83], v[40:43]
  ds_read_b128 a[44:47], v22 offset:23552
  s_waitcnt lgkmcnt(8)
  v_mfma_f32_16x16x32_bf16 v[24:27], a[12:15], v[84:87], v[24:27]
  ds_read_b128 a[0:3], v21 offset:24576
  s_waitcnt lgkmcnt(8)
  v_mfma_f32_16x16x32_bf16 v[28:31], a[16:19], v[84:87], v[28:31]
  ds_read_b128 a[4:7], v14 offset:25600
  s_waitcnt lgkmcnt(8)
  v_mfma_f32_16x16x32_bf16 v[32:35], a[20:23], v[84:87], v[32:35]
  ds_read_b128 a[8:11], v14 offset:26624
  s_waitcnt lgkmcnt(8)
  v_mfma_f32_16x16x32_bf16 v[36:39], a[24:27], v[84:87], v[36:39]
  ds_read_b128 a[12:15], v22 offset:27648
  s_waitcnt lgkmcnt(8)
  v_mfma_f32_16x16x32_bf16 v[40:43], a[28:31], v[84:87], v[40:43]
  ds_read_b128 a[16:19], v22 offset:28672
  s_waitcnt lgkmcnt(8)
  v_mfma_f32_16x16x32_bf16 v[24:27], a[32:35], v[88:91], v[24:27]
  ds_read_b128 a[20:23], v21 offset:29696
  s_waitcnt lgkmcnt(8)
  v_mfma_f32_16x16x32_bf16 v[28:31], a[36:39], v[88:91], v[28:31]
  s_barrier
  ds_read_b128 a[24:27], v14 offset:30720
  s_waitcnt lgkmcnt(8)
  v_mfma_f32_16x16x32_bf16 v[32:35], a[40:43], v[88:91], v[32:35]
  ds_read_b128 a[28:31], v14 offset:31744
  s_waitcnt lgkmcnt(8)
  v_mfma_f32_16x16x32_bf16 v[36:39], a[44:47], v[88:91], v[36:39]
  ds_read_b128 a[32:35], v22 offset:32768
  s_waitcnt lgkmcnt(8)
  v_mfma_f32_16x16x32_bf16 v[40:43], a[0:3], v[88:91], v[40:43]
  ds_read_b128 a[36:39], v22 offset:33792
  s_waitcnt lgkmcnt(8)
  v_mfma_f32_16x16x32_bf16 v[24:27], a[4:7], v[92:95], v[24:27]
  ds_read_b128 a[40:43], v21 offset:34816
  s_waitcnt lgkmcnt(8)
  v_mfma_f32_16x16x32_bf16 v[28:31], a[8:11], v[92:95], v[28:31]
  ds_read_b128 a[44:47], v14 offset:35840
  s_waitcnt lgkmcnt(8)
  v_mfma_f32_16x16x32_bf16 v[32:35], a[12:15], v[92:95], v[32:35]
  ds_read_b128 a[0:3], v14 offset:36864
  s_waitcnt lgkmcnt(8)
  v_mfma_f32_16x16x32_bf16 v[36:39], a[16:19], v[92:95], v[36:39]
  ds_read_b128 a[4:7], v22 offset:37888
  s_waitcnt lgkmcnt(8)
  v_mfma_f32_16x16x32_bf16 v[40:43], a[20:23], v[92:95], v[40:43]
  ds_read_b128 a[8:11], v22 offset:38912
  s_waitcnt lgkmcnt(8)
  v_mfma_f32_16x16x32_bf16 v[24:27], a[24:27], v[96:99], v[24:27]
  ds_read_b128 a[12:15], v21 offset:39936
  s_waitcnt lgkmcnt(8)
  v_mfma_f32_16x16x32_bf16 v[28:31], a[28:31], v[96:99], v[28:31]
  s_barrier
  ds_read_b128 a[16:19], v14 offset:40960
  s_waitcnt lgkmcnt(8)
  v_mfma_f32_16x16x32_bf16 v[32:35], a[32:35], v[96:99], v[32:35]
  ds_read_b128 a[20:23], v14 offset:41984
  s_waitcnt lgkmcnt(8)
  v_mfma_f32_16x16x32_bf16 v[36:39], a[36:39], v[96:99], v[36:39]
  ds_read_b128 a[24:27], v22 offset:43008
  s_waitcnt lgkmcnt(8)
  v_mfma_f32_16x16x32_bf16 v[40:43], a[40:43], v[96:99], v[40:43]
  ds_read_b128 a[28:31], v22 offset:44032
  s_waitcnt lgkmcnt(8)
  v_mfma_f32_16x16x32_bf16 v[24:27], a[44:47], v[100:103], v[24:27]
  ds_read_b128 a[32:35], v21 offset:45056
  s_waitcnt lgkmcnt(8)
  v_mfma_f32_16x16x32_bf16 v[28:31], a[0:3], v[100:103], v[28:31]
  ds_read_b128 a[36:39], v14 offset:46080
  s_waitcnt lgkmcnt(8)
  v_mfma_f32_16x16x32_bf16 v[32:35], a[4:7], v[100:103], v[32:35]
  ds_read_b128 a[40:43], v14 offset:47104
  s_waitcnt lgkmcnt(8)
  v_mfma_f32_16x16x32_bf16 v[36:39], a[8:11], v[100:103], v[36:39]
  ds_read_b128 a[44:47], v22 offset:48128
  s_waitcnt lgkmcnt(8)
  v_mfma_f32_16x16x32_bf16 v[40:43], a[12:15], v[100:103], v[40:43]
  ds_read_b128 a[0:3], v22 offset:49152
  s_waitcnt lgkmcnt(8)
  v_mfma_f32_16x16x32_bf16 v[24:27], a[16:19], v[104:107], v[24:27]
  ds_read_b128 a[4:7], v21 offset:50176
  s_waitcnt lgkmcnt(8)
  v_mfma_f32_16x16x32_bf16 v[28:31], a[20:23], v[104:107], v[28:31]
  s_waitcnt lgkmcnt(7)
  v_mfma_f32_16x16x32_bf16 v[32:35], a[24:27], v[104:107], v[32:35]
  s_waitcnt vmcnt(1)
  v_lshlrev_b32 v52, 16, v44
  v_and_b32 v53, 0xffff0000, v44
  s_waitcnt lgkmcnt(6)
  v_mfma_f32_16x16x32_bf16 v[36:39], a[28:31], v[104:107], v[36:39]
  v_lshlrev_b32 v54, 16, v45
  v_and_b32 v55, 0xffff0000, v45
  s_waitcnt lgkmcnt(5)
  v_mfma_f32_16x16x32_bf16 v[40:43], a[32:35], v[104:107], v[40:43]
  v_lshlrev_b32 v56, 16, v46
  v_and_b32 v57, 0xffff0000, v46
  s_waitcnt lgkmcnt(4)
  v_mfma_f32_16x16x32_bf16 v[24:27], a[36:39], v[108:111], v[24:27]
  v_lshlrev_b32 v58, 16, v47
  v_and_b32 v59, 0xffff0000, v47
  s_waitcnt lgkmcnt(3)
  v_mfma_f32_16x16x32_bf16 v[28:31], a[40:43], v[108:111], v[28:31]
  s_waitcnt vmcnt(0)
  v_lshlrev_b32 v60, 16, v48
  v_and_b32 v61, 0xffff0000, v48
  s_waitcnt lgkmcnt(2)
  v_mfma_f32_16x16x32_bf16 v[32:35], a[44:47], v[108:111], v[32:35]
  v_lshlrev_b32 v62, 16, v49
  v_and_b32 v63, 0xffff0000, v49
  s_waitcnt lgkmcnt(1)
  v_mfma_f32_16x16x32_bf16 v[36:39], a[0:3], v[108:111], v[36:39]
  s_waitcnt lgkmcnt(0)
  v_mfma_f32_16x16x32_bf16 v[40:43], a[4:7], v[108:111], v[40:43]
  s_nop 1
  ds_write_b128 v18, v[32:35] offset:0
  s_nop 2
  ds_write_b128 v18, v[36:39] offset:1024
  s_nop 0
  ds_write_b128 v18, v[40:43] offset:2048
  v_add_f32 v24, v24, v52
  v_add_f32 v25, v25, v53
  v_add_f32 v26, v26, v54
  v_add_f32 v27, v27, v55
  v_add_f32 v28, v28, v56
  v_add_f32 v29, v29, v57
  v_add_f32 v30, v30, v58
  v_add_f32 v31, v31, v59
  v_add_f32 v32, v40, v60
  v_add_f32 v33, v41, v61
  v_add_f32 v34, v42, v62
  v_add_f32 v35, v43, v63
  s_waitcnt lgkmcnt(0)
  s_barrier
  ds_read_b128 v[52:55], v23 offset:0
  ds_read_b128 v[56:59], v23 offset:1024
  ds_read_b128 v[60:63], v23 offset:2048
  s_waitcnt lgkmcnt(2)
  v_pk_add_f32 v[24:25], v[24:25], v[52:53]
  v_cvt_pk_bf16_f32 v72, v24, v25
  v_pk_add_f32 v[26:27], v[26:27], v[54:55]
  v_cvt_pk_bf16_f32 v73, v26, v27
  s_waitcnt lgkmcnt(1)
  v_pk_add_f32 v[28:29], v[28:29], v[56:57]
  v_cvt_pk_bf16_f32 v74, v28, v29
  v_pk_add_f32 v[30:31], v[30:31], v[58:59]
  v_cvt_pk_bf16_f32 v75, v30, v31
  buffer_store_dwordx4 v[72:75], v19, s[8:11], s30 offen
  s_waitcnt lgkmcnt(0)
  v_pk_add_f32 v[32:33], v[32:33], v[60:61]
  v_cvt_pk_bf16_f32 v76, v32, v33
  v_pk_add_f32 v[34:35], v[34:35], v[62:63]
  v_cvt_pk_bf16_f32 v77, v34, v35
  s_cmp_eq_u32 s19, 0
  s_cbranch_scc1 k4_st3
  v_mov_b32 v32, 0
  v_mov_b32 v33, 0
  v_mov_b32 v34, 0
  v_mov_b32 v35, 0
  s_branch k4_ssq
k4_st3:
  buffer_store_dwordx2 v[76:77], v20, s[8:11], s33 offen
k4_ssq:
  s_cmp_eq_u32 s46, 16
  s_cbranch_scc0 k4_done
  s_add_u32 s34, s22, s19
  s_cmp_eq_u32 s34, 0
  s_cselect_b32 s34, 16, 0
  v_cmp_gt_u32 vcc, s34, v1
  v_mov_b32 v12, 0
  s_nop 0
  v_cndmask_b32 v25, v25, v12, vcc
  v_pk_mul_f32 v[12:13], v[24:25], v[24:25]
  v_pk_mul_f32 v[14:15], v[26:27], v[26:27]
  v_pk_fma_f32 v[12:13], v[28:29], v[28:29], v[12:13]
  v_pk_fma_f32 v[14:15], v[30:31], v[30:31], v[14:15]
  v_pk_fma_f32 v[12:13], v[32:33], v[32:33], v[12:13]
  v_pk_fma_f32 v[14:15], v[34:35], v[34:35], v[14:15]
  v_pk_add_f32 v[12:13], v[12:13], v[14:15]
  v_add_f32 v12, v12, v13
  v_mov_b32 v13, v12
  s_nop 1
  v_permlane16_swap_b32 v12, v13
  v_add_f32 v12, v12, v13
  v_mov_b32 v13, v12
  s_nop 1
  v_permlane32_swap_b32 v12, v13
  v_add_f32 v12, v12, v13
  v_lshlrev_b32 v13, 2, v4
  s_lshl_b32 s34, s21, 9
  s_add_u32 s34, s34, 26124288
  s_mov_b64 exec, 0xffff
  buffer_atomic_add_f32 v12, v13, s[4:7], s34 offen
  s_mov_b64 exec, -1
  s_endpgm
k4_done:
  s_endpgm
k4_ld:
  s_mul_i32 s25, s22, 102400
  s_add_u32 s25, s25, s42
  s_mul_i32 s27, s20, 51200
  s_add_u32 s25, s25, s27
  s_sleep 4
  s_add_u32 m0, s27, 0
  s_waitcnt lgkmcnt(0)
  buffer_load_dwordx4 v6, s[4:7], s25 offen offset:0 lds
  buffer_load_dwordx4 v6, s[4:7], s25 offen offset:1024 lds
  buffer_load_dwordx4 v6, s[4:7], s25 offen offset:2048 lds
  buffer_load_dwordx4 v6, s[4:7], s25 offen offset:3072 lds
  s_add_u32 s25, s25, 4096
  s_add_u32 m0, s27, 4096
  s_nop 0
  buffer_load_dwordx4 v6, s[4:7], s25 offen offset:0 lds
  buffer_load_dwordx4 v6, s[4:7], s25 offen offset:1024 lds
  s_barrier
  buffer_load_dwordx4 v6, s[4:7], s25 offen offset:2048 lds
  buffer_load_dwordx4 v6, s[4:7], s25 offen offset:3072 lds
  s_add_u32 s25, s25, 4096
  s_add_u32 m0, s27, 8192
  s_waitcnt vmcnt(7)
  buffer_load_dwordx4 v6, s[4:7], s25 offen offset:0 lds
  s_waitcnt vmcnt(7)
  buffer_load_dwordx4 v6, s[4:7], s25 offen offset:1024 lds
  s_waitcnt vmcnt(7)
  buffer_load_dwordx4 v6, s[4:7], s25 offen offset:2048 lds
  s_waitcnt vmcnt(7)
  buffer_load_dwordx4 v6, s[4:7], s25 offen offset:3072 lds
  s_add_u32 s25, s25, 4096
  s_add_u32 m0, s27, 12288
  s_waitcnt vmcnt(7)
  buffer_load_dwordx4 v6, s[4:7], s25 offen offset:0 lds
  s_waitcnt vmcnt(7)
  buffer_load_dwordx4 v6, s[4:7], s25 offen offset:1024 lds
  s_waitcnt vmcnt(7)
  buffer_load_dwordx4 v6, s[4:7], s25 offen offset:2048 lds
  s_waitcnt vmcnt(7)
  buffer_load_dwordx4 v6, s[4:7], s25 offen offset:3072 lds
  s_add_u32 s25, s25, 4096
  s_add_u32 m0, s27, 16384
  s_waitcnt vmcnt(7)
  buffer_load_dwordx4 v6, s[4:7], s25 offen offset:0 lds
  s_waitcnt vmcnt(7)
  buffer_load_dwordx4 v6, s[4:7], s25 offen offset:1024 lds
  s_waitcnt vmcnt(7)
  buffer_load_dwordx4 v6, s[4:7], s25 offen offset:2048 lds
  s_waitcnt vmcnt(7)
  buffer_load_dwordx4 v6, s[4:7], s25 offen offset:3072 lds
  s_add_u32 s25, s25, 4096
  s_add_u32 m0, s27, 20480
  s_waitcnt vmcnt(7)
  buffer_load_dwordx4 v6, s[4:7], s25 offen offset:0 lds
  s_waitcnt vmcnt(7)
  buffer_load_dwordx4 v6, s[4:7], s25 offen offset:1024 lds
  s_waitcnt vmcnt(7)
  buffer_load_dwordx4 v6, s[4:7], s25 offen offset:2048 lds
  s_waitcnt vmcnt(7)
  buffer_load_dwordx4 v6, s[4:7], s25 offen offset:3072 lds
  s_add_u32 s25, s25, 4096
  s_add_u32 m0, s27, 24576
  s_waitcnt vmcnt(7)
  buffer_load_dwordx4 v6, s[4:7], s25 offen offset:0 lds
  s_waitcnt vmcnt(7)
  buffer_load_dwordx4 v6, s[4:7], s25 offen offset:1024 lds
  s_waitcnt vmcnt(7)
  buffer_load_dwordx4 v6, s[4:7], s25 offen offset:2048 lds
  s_waitcnt vmcnt(7)
  buffer_load_dwordx4 v6, s[4:7], s25 offen offset:3072 lds
  s_add_u32 s25, s25, 4096
  s_add_u32 m0, s27, 28672
  s_waitcnt vmcnt(7)
  buffer_load_dwordx4 v6, s[4:7], s25 offen offset:0 lds
  s_waitcnt vmcnt(7)
  buffer_load_dwordx4 v6, s[4:7], s25 offen offset:1024 lds
  s_waitcnt vmcnt(7)
  buffer_load_dwordx4 v6, s[4:7], s25 offen offset:2048 lds
  s_waitcnt vmcnt(7)
  buffer_load_dwordx4 v6, s[4:7], s25 offen offset:3072 lds
  s_add_u32 s25, s25, 4096
  s_add_u32 m0, s27, 32768
  s_waitcnt vmcnt(7)
  buffer_load_dwordx4 v6, s[4:7], s25 offen offset:0 lds
  s_waitcnt vmcnt(7)
  buffer_load_dwordx4 v6, s[4:7], s25 offen offset:1024 lds
  s_waitcnt vmcnt(19)
  s_barrier
  buffer_load_dwordx4 v6, s[4:7], s25 offen offset:2048 lds
  buffer_load_dwordx4 v6, s[4:7], s25 offen offset:3072 lds
  s_add_u32 s25, s25, 4096
  s_add_u32 m0, s27, 36864
  s_nop 0
  buffer_load_dwordx4 v6, s[4:7], s25 offen offset:0 lds
  buffer_load_dwordx4 v6, s[4:7], s25 offen offset:1024 lds
  buffer_load_dwordx4 v6, s[4:7], s25 offen offset:2048 lds
  buffer_load_dwordx4 v6, s[4:7], s25 offen offset:3072 lds
  s_add_u32 s25, s25, 4096
  s_add_u32 m0, s27, 40960
  s_nop 0
  buffer_load_dwordx4 v6, s[4:7], s25 offen offset:0 lds
  buffer_load_dwordx4 v6, s[4:7], s25 offen offset:1024 lds
  s_waitcnt vmcnt(12)
  s_barrier
  buffer_load_dwordx4 v6, s[4:7], s25 offen offset:2048 lds
  buffer_load_dwordx4 v6, s[4:7], s25 offen offset:3072 lds
  s_add_u32 s25, s25, 4096
  s_add_u32 m0, s27, 45056
  s_nop 0
  buffer_load_dwordx4 v6, s[4:7], s25 offen offset:0 lds
  buffer_load_dwordx4 v6, s[4:7], s25 offen offset:1024 lds
  buffer_load_dwordx4 v6, s[4:7], s25 offen offset:2048 lds
  buffer_load_dwordx4 v6, s[4:7], s25 offen offset:3072 lds
  s_add_u32 s25, s25, 4096
  s_add_u32 m0, s27, 49152
  s_nop 0
  buffer_load_dwordx4 v6, s[4:7], s25 offen offset:0 lds
  buffer_load_dwordx4 v6, s[4:7], s25 offen offset:1024 lds
  s_waitcnt vmcnt(10)
  s_barrier
  s_waitcnt vmcnt(0)
  s_barrier
k4_exit:
  s_endpgm
text_end:
.section .rodata,"a"
.p2align 6
desc_start:
.p2align 6
.amdhsa_kernel k1_kernel
  .amdhsa_next_free_vgpr 240
  .amdhsa_next_free_sgpr 58
  .amdhsa_accum_offset 216
  .amdhsa_group_segment_fixed_size 0
  .amdhsa_kernarg_size 72
  .amdhsa_user_sgpr_count 2
  .amdhsa_user_sgpr_kernarg_segment_ptr 1
  .amdhsa_system_sgpr_workgroup_id_x 1
.end_amdhsa_kernel
.p2align 6
.amdhsa_kernel k2_kernel
  .amdhsa_next_free_vgpr 248
  .amdhsa_next_free_sgpr 47
  .amdhsa_accum_offset 216
  .amdhsa_group_segment_fixed_size 0
  .amdhsa_kernarg_size 72
  .amdhsa_user_sgpr_count 2
  .amdhsa_user_sgpr_kernarg_segment_ptr 1
  .amdhsa_system_sgpr_workgroup_id_x 1
.end_amdhsa_kernel
.p2align 6
.amdhsa_kernel k5_kernel
  .amdhsa_next_free_vgpr 248
  .amdhsa_next_free_sgpr 47
  .amdhsa_accum_offset 216
  .amdhsa_group_segment_fixed_size 0
  .amdhsa_kernarg_size 72
  .amdhsa_user_sgpr_count 2
  .amdhsa_user_sgpr_kernarg_segment_ptr 1
  .amdhsa_system_sgpr_workgroup_id_x 1
.end_amdhsa_kernel
.p2align 6
.amdhsa_kernel k3_kernel
  .amdhsa_next_free_vgpr 256
  .amdhsa_next_free_sgpr 71
  .amdhsa_accum_offset 256
  .amdhsa_group_segment_fixed_size 0
  .amdhsa_kernarg_size 72
  .amdhsa_user_sgpr_count 2
  .amdhsa_user_sgpr_kernarg_segment_ptr 1
  .amdhsa_system_sgpr_workgroup_id_x 1
.end_amdhsa_kernel
.p2align 6
.amdhsa_kernel k6_kernel
  .amdhsa_next_free_vgpr 256
  .amdhsa_next_free_sgpr 71
  .amdhsa_accum_offset 256
  .amdhsa_group_segment_fixed_size 0
  .amdhsa_kernarg_size 72
  .amdhsa_user_sgpr_count 2
  .amdhsa_user_sgpr_kernarg_segment_ptr 1
  .amdhsa_system_sgpr_workgroup_id_x 1
.end_amdhsa_kernel
.p2align 6
.amdhsa_kernel k4_kernel
  .amdhsa_next_free_vgpr 168
  .amdhsa_next_free_sgpr 50
  .amdhsa_accum_offset 112
  .amdhsa_group_segment_fixed_size 0
  .amdhsa_kernarg_size 72
  .amdhsa_user_sgpr_count 2
  .amdhsa_user_sgpr_kernarg_segment_ptr 1
  .amdhsa_system_sgpr_workgroup_id_x 1
.end_amdhsa_kernel
.p2align 6
.amdhsa_kernel k7_kernel
  .amdhsa_next_free_vgpr 168
  .amdhsa_next_free_sgpr 50
  .amdhsa_accum_offset 112
  .amdhsa_group_segment_fixed_size 0
  .amdhsa_kernarg_size 72
  .amdhsa_user_sgpr_count 2
  .amdhsa_user_sgpr_kernarg_segment_ptr 1
  .amdhsa_system_sgpr_workgroup_id_x 1
.end_amdhsa_kernel
.p2align 8
tabs:
.long 0x3e223e22,0x3e223e22,0x3e223e22,0x3e223e22,0xbe223e22,0xbe223e22,0xbe223e22,0xbe223e22
.long 0x3e623e65,0x3e4c3e5a,0xbe4cbe39,0xbe62be5a,0xbd0f8000,0xbdd0bd8e,0xbdd0be07,0xbd0fbd8e
.long 0x3e223e65,0xbe22237d,0x3e223e65,0xbe22250e,0xbe228000,0xbe22be65,0xbe2224fd,0xbe22be65
.long 0x3e073e65,0xbe5abd8e,0xbe5abe39,0x3e07bd8e,0xbe398000,0xbd8ebe5a,0x3d8ebe07,0x3e393e5a
.long 0x237d3e65,0xa43dbe65,0xa53e3e65,0x251ebe65,0xbe658000,0x3e65a3fd,0xbe65257d,0x3e65a58e
.long 0xbd0f3e65,0x3dd0be5a,0xbdd0be39,0x3d0f3e5a,0xbe628000,0x3e4c3d8e,0x3e4cbe07,0xbe623d8e
.long 0xbe223e65,0x3e22a43d,0xbe223e65,0x3e22a65d,0xbe228000,0xbe223e65,0xbe2225bd,0xbe223e65
.long 0xbe393e65,0x3d8e3d8e,0x3d8ebe39,0xbe393d8e,0xbe078000,0xbe5a3e5a,0x3e5abe07,0x3e07be5a
.long 0x3e223e22,0x3e223e22,0x3e223e22,0x3e223e22,0xbe223e22,0xbe223e22,0xbe223e22,0xbe223e22
.long 0x3e223e39,0x3dd03e07,0xbe62be65,0xbe4cbe5a,0xbe22be07,0xbe4cbe39,0x3d0fa3fd,0x3dd03d8e
.long 0xbe22be65,0x3e22a43d,0xbe22be65,0x3e22258e,0x3e22a3fd,0x3e223e65,0x3e22a51e,0x3e223e65
.long 0xa43dbe39,0x3e5a3e39,0x3e073e65,0xbe5abd8e,0x3e653e07,0xbd8e3e07,0xbe39253d,0xbd8ebe5a
.long 0x249e3e65,0xa4ddbe65,0xa4fd3e65,0x267dbe65,0xbe65247d,0x3e65a4bd,0xbe65259e,0x3e65260e
.long 0xbe223e39,0x3e4cbe07,0x3d0fbe65,0xbdd03e5a,0xbe22be07,0x3dd03e39,0x3e62a69e,0xbe4cbd8e
.long 0x3e22be65,0xbe222616,0x3e22be65,0xbe2226ed,0x3e22a4bd,0x3e22be65,0x3e22a6ae,0x3e22be65
.long 0x3e65be39,0x3d8ebe39,0xbe393e65,0x3d8e3d8e,0x24fd3e07,0x3e5abe07,0xbe0725fd,0xbe5a3e5a
.long 0x3e223e22,0x3e223e22,0x3e223e22,0x3e223e22,0xbe223e22,0xbe223e22,0xbe223e22,0xbe223e22
.long 0x3d0f3d8e,0xbd0f237d,0xbe22be39,0xbdd0be07,0xbe62be5a,0xbe62be65,0x3e223e07,0x3e4c3e39
.long 0x3e223e65,0xbe22249e,0x3e223e65,0xbe222626,0xbe22247d,0xbe22be65,0xbe22253d,0xbe22be65
.long 0xbe073d8e,0xbe07be65,0xa62ebe39,0x3e5a3e39,0xbe39be5a,0x3e39a4bd,0x3e653e07,0xbd8e3e07
.long 0x250e3e65,0x258ebe65,0x26dd3e65,0xa65dbe65,0xbe6524fd,0x3e65a51e,0xbe6525bd,0x3e65a6a6
.long 0xbe623d8e,0x3e62a61e,0x3e22be39,0xbe4c3e07,0xbd0fbe5a,0xbd0f3e65,0x3e223e07,0xbdd0be39
.long 0xbe223e65,0x3e22a62e,0xbe223e65,0x3e22a686,0xbe22253d,0xbe223e65,0xbe222716,0xbe223e65
.long 0xbe393d8e,0xbe393e65,0x3e65be39,0x3d8ebe39,0x3e07be5a,0xbe07257d,0x261e3e07,0x3e5abe07
.long 0x3e223e22,0x3e223e22,0x3e223e22,0x3e223e22,0xbe223e22,0xbe223e22,0xbe223e22,0xbe223e22
.long 0xbdd0bd8e,0xbe22be07,0xbd0fbd8e,0x3d0fa43d,0xbe4cbe5a,0xbe22be39,0x3e623e5a,0x3e623e65
.long 0xbe22be65,0x3e22a4dd,0xbe22be65,0x3e22a62e,0x3e22a4bd,0x3e223e65,0x3e22a55d,0x3e223e65
.long 0x3e5a3d8e,0x250e3e39,0xbe073d8e,0xbe07be65,0x3d8e3e5a,0xbe65be07,0xbe39be5a,0x3e39a58e
.long 0x26263e65,0xa62ebe65,0xa0233e65,0xa66dbe65,0xbe65253d,0x3e65a55d,0xbe6525dd,0x3e65a6ae
.long 0xbe4cbd8e,0x3e223e07,0x3e62bd8e,0xbe6226ed,0x3dd0be5a,0xbe223e39,0x3d0f3e5a,0x3d0fbe65
.long 0x3e22be65,0xbe2226d5,0x3e22be65,0xbe22257c,0x3e22a696,0x3e22be65,0x3e22a755,0x3e22be65
.long 0x3d8e3d8e,0x3e65be39,0xbe393d8e,0xbe393e65,0xbe5a3e5a,0x25bd3e07,0x3e07be5a,0xbe07263d
.long 0x3e223e22,0x0,0x0,0x0,0xbe223e22,0x0,0x0,0x0
.long 0x3dd03d8e,0x0,0x0,0x0,0x3e4c3e5a,0x0,0x0,0x0
.long 0x3e223e65,0x0,0x0,0x0,0xbe22257d,0x0,0x0,0x0
.long 0x3e5a3d8e,0x0,0x0,0x0,0x3d8e3e5a,0x0,0x0,0x0
.long 0x26ed3e65,0x0,0x0,0x0,0xbe6525fd,0x0,0x0,0x0
.long 0x3e4c3d8e,0x0,0x0,0x0,0xbdd03e5a,0x0,0x0,0x0
.long 0xbe223e65,0x0,0x0,0x0,0xbe22263d,0x0,0x0,0x0
.long 0x3d8e3d8e,0x0,0x0,0x0,0xbe5a3e5a,0x0,0x0,0x0
.long 0x3e223e22,0x0,0x0,0x0,0xbe223e22,0x0,0x0,0x0
.long 0x3e223e07,0x0,0x0,0x0,0x3e223e39,0x0,0x0,0x0
.long 0xbe22a53e,0x0,0x0,0x0,0xbe22be65,0x0,0x0,0x0
.long 0xa4fd3e39,0x0,0x0,0x0,0xbe65be07,0x0,0x0,0x0
.long 0xa67dbe65,0x0,0x0,0x0,0x3e6525be,0x0,0x0,0x0
.long 0xbe22be07,0x0,0x0,0x0,0x3e22be39,0x0,0x0,0x0
.long 0x3e22a79a,0x0,0x0,0x0,0xbe223e65,0x0,0x0,0x0
.long 0x3e65be39,0x0,0x0,0x0,0x265d3e07,0x0,0x0,0x0
.long 0x3e223e22,0x0,0x0,0x0,0xbe223e22,0x0,0x0,0x0
.long 0x3e4c3e39,0x0,0x0,0x0,0x3dd03e07,0x0,0x0,0x0
.long 0xbe22be65,0x0,0x0,0x0,0x3e22a58e,0x0,0x0,0x0
.long 0xbe5abe39,0x0,0x0,0x0,0x3d8ebe07,0x0,0x0,0x0
.long 0x26f53e65,0x0,0x0,0x0,0xbe65260e,0x0,0x0,0x0
.long 0x3dd03e39,0x0,0x0,0x0,0xbe4c3e07,0x0,0x0,0x0
.long 0x3e22be65,0x0,0x0,0x0,0x3e22a6dd,0x0,0x0,0x0
.long 0x3d8ebe39,0x0,0x0,0x0,0x3e5abe07,0x0,0x0,0x0
.long 0x3e223e22,0x0,0x0,0x0,0xbe223e22,0x0,0x0,0x0
.long 0x3e623e5a,0x0,0x0,0x0,0x3d0f3d8e,0x0,0x0,0x0
.long 0x3e22251e,0x0,0x0,0x0,0x3e223e65,0x0,0x0,0x0
.long 0x3e07bd8e,0x0,0x0,0x0,0x3e393e5a,0x0,0x0,0x0
.long 0xa686be65,0x0,0x0,0x0,0x3e65259e,0x0,0x0,0x0
.long 0xbd0fbe5a,0x0,0x0,0x0,0x3e62bd8e,0x0,0x0,0x0
.long 0xbe22270e,0x0,0x0,0x0,0x3e22be65,0x0,0x0,0x0
.long 0xbe393d8e,0x0,0x0,0x0,0x3e07be5a,0x0,0x0,0x0
.long 0x3e5a3e65,0x3e073e39,0x3e073d8e,0x3e5a3e39,0xbd8e8000,0xbe39be07,0x3e393e5a,0x3d8e3e07
.long 0x3e4c3e65,0x3d0f3e07,0xbd0f3d8e,0xbe4cbe07,0xbdd08000,0xbe62be39,0xbe62be5a,0xbdd0be39
.long 0x3dd03e65,0xbe62be07,0x3e623d8e,0xbdd03e07,0xbe4c8000,0x3d0fbe39,0x3d0f3e5a,0xbe4cbe39
.long 0x3d8e3e65,0xbe39be39,0xbe393d8e,0x3d8ebe39,0xbe5a8000,0x3e07be07,0xbe07be5a,0x3e5a3e07
.long 0xbd8e3e65,0x3e39be39,0x3e393d8e,0xbd8ebe39,0xbe5a8000,0x3e073e07,0xbe073e5a,0x3e5abe07
.long 0xbdd03e65,0x3e62be07,0xbe623d8e,0x3dd03e07,0xbe4c8000,0x3d0f3e39,0x3d0fbe5a,0xbe4c3e39
.long 0xbe4c3e65,0xbd0f3e07,0x3d0f3d8e,0x3e4cbe07,0xbdd08000,0xbe623e39,0xbe623e5a,0xbdd03e39
.long 0xbe5a3e65,0xbe073e39,0xbe073d8e,0xbe5a3e39,0xbd8e8000,0xbe393e07,0x3e39be5a,0x3d8ebe07
.long 0x237d3d8e,0xbe07bd8e,0x3e5a3e65,0x3e073e39,0xbe65be5a,0xbe39be5a,0xbd8e247d,0xbe39be07
.long 0xbe22bd8e,0xbe62be5a,0xbe4cbe65,0xbd0fbe07,0xbe22be5a,0x3d0fbd8e,0x3dd0a4bd,0x3e623e39
.long 0x3e22bd8e,0x3d0f3e5a,0xbdd0be65,0x3e623e07,0x3e223e5a,0xbe62bd8e,0x3e4ca55d,0xbd0f3e39
.long 0x3e653d8e,0xbe393d8e,0x3d8e3e65,0xbe39be39,0x247d3e5a,0xbe07be5a,0xbe5a257d,0x3e07be07
.long 0xbe653d8e,0x3e393d8e,0xbd8e3e65,0x3e39be39,0xa4bdbe5a,0xbe073e5a,0xbe5a25bd,0x3e073e07
.long 0xbe22bd8e,0xbd0f3e5a,0x3dd0be65,0xbe623e07,0x3e22be5a,0xbe623d8e,0x3e4c25fd,0xbd0fbe39
.long 0x3e22bd8e,0x3e62be5a,0x3e4cbe65,0x3d0fbe07,0xbe223e5a,0x3d0f3d8e,0x3dd025be,0x3e62be39
.long 0x250e3d8e,0x3e07bd8e,0xbe5a3e65,0xbe073e39,0xbe653e5a,0xbe393e5a,0xbd8e260e,0xbe393e07
.long 0xbe5abe39,0xbe5abe65,0x249e3d8e,0xbe07bd8e,0xbd8ebe07,0x3d8ea3fd,0xbe65be5a,0xbe39be5a
.long 0xbdd0be39,0x3dd0a43d,0x3e223d8e,0x3e623e5a,0x3e4c3e07,0x3e4c3e65,0x3e223e5a,0xbd0f3d8e
.long 0xbe4cbe39,0x3e4ca4dd,0xbe223d8e,0xbd0fbe5a,0x3dd0be07,0x3dd03e65,0xbe22be5a,0x3e623d8e
.long 0x3d8ebe39,0x3d8e3e65,0x3e653d8e,0xbe393d8e,0x3e5a3e07,0xbe5a24fd,0x259e3e5a,0xbe07be5a
.long 0xbd8ebe39,0xbd8e3e65,0xbe653d8e,0x3e393d8e,0x3e5abe07,0xbe5a253d,0xa6aebe5a,0xbe073e5a
.long 0x3e4cbe39,0xbe4ca57d,0x3e223d8e,0x3d0fbe5a,0x3dd03e07,0x3dd0be65,0xbe223e5a,0x3e62bd8e
.long 0x3dd0be39,0xbdd0a53e,0xbe223d8e,0xbe623e5a,0x3e4cbe07,0x3e4cbe65,0x3e22be5a,0xbd0fbd8e
.long 0x3e5abe39,0x3e5abe65,0x257c3d8e,0x3e07bd8e,0xbd8e3e07,0x3d8ea58e,0xbe653e5a,0xbe393e5a
.long 0xbe07be39,0xa43dbd8e,0xbe5abe39,0xbe5abe65,0x3e393e07,0x3e653e5a,0xbd8ebe07,0x3d8ea4bd
.long 0x3e623e39,0x3e223e5a,0x3dd03e39,0xbdd0250e,0x3d0f3e07,0xbe22bd8e,0xbe4cbe07,0xbe4cbe65
.long 0xbd0f3e39,0xbe22be5a,0x3e4c3e39,0xbe4ca4fd,0xbe62be07,0x3e22bd8e,0xbdd03e07,0xbdd0be65
.long 0xbe39be39,0x3e653d8e,0x3d8ebe39,0x3d8e3e65,0x3e07be07,0x253d3e5a,0x3e5a3e07,0xbe5a25bd
.long 0x3e39be39,0xbe653d8e,0xbd8ebe39,0xbd8e3e65,0x3e073e07,0xa58ebe5a,0x3e5abe07,0xbe5a260e
.long 0x3d0f3e39,0x3e22be5a,0xbe4c3e39,0x3e4c263e,0xbe623e07,0x3e223d8e,0xbdd0be07,0xbdd03e65
.long 0xbe623e39,0xbe223e5a,0xbdd03e39,0x3dd0a69e,0x3d0fbe07,0xbe223d8e,0xbe4c3e07,0xbe4c3e65
.long 0x3e07be39,0xa65dbd8e,0x3e5abe39,0x3e5abe65,0x3e39be07,0x3e65be5a,0xbd8e3e07,0x3d8ea6dd
.long 0xbe07be39,0x0,0x0,0x0,0x3e393e07,0x0,0x0,0x0
.long 0xbe62be39,0x0,0x0,0x0,0xbd0fbe07,0x0,0x0,0x0
.long 0x3d0fbe39,0x0,0x0,0x0,0x3e623e07,0x0,0x0,0x0
.long 0xbe39be39,0x0,0x0,0x0,0x3e07be07,0x0,0x0,0x0
.long 0x3e39be39,0x0,0x0,0x0,0x3e073e07,0x0,0x0,0x0
.long 0xbd0fbe39,0x0,0x0,0x0,0x3e62be07,0x0,0x0,0x0
.long 0x3e62be39,0x0,0x0,0x0,0xbd0f3e07,0x0,0x0,0x0
.long 0x3e07be39,0x0,0x0,0x0,0x3e39be07,0x0,0x0,0x0
.long 0xa4ddbd8e,0x0,0x0,0x0,0x3e653e5a,0x0,0x0,0x0
.long 0xbe22be5a,0x0,0x0,0x0,0x3e223d8e,0x0,0x0,0x0
.long 0x3e223e5a,0x0,0x0,0x0,0xbe223d8e,0x0,0x0,0x0
.long 0x3e653d8e,0x0,0x0,0x0,0x25dd3e5a,0x0,0x0,0x0
.long 0xbe653d8e,0x0,0x0,0x0,0x257dbe5a,0x0,0x0,0x0
.long 0xbe223e5a,0x0,0x0,0x0,0xbe22bd8e,0x0,0x0,0x0
.long 0x3e22be5a,0x0,0x0,0x0,0x3e22bd8e,0x0,0x0,0x0
.long 0x25bebd8e,0x0,0x0,0x0,0x3e65be5a,0x0,0x0,0x0
.long 0x3e073d8e,0x0,0x0,0x0,0x3e393e5a,0x0,0x0,0x0
.long 0x3d0fbd8e,0x0,0x0,0x0,0x3e623e5a,0x0,0x0,0x0
.long 0xbe62bd8e,0x0,0x0,0x0,0xbd0fbe5a,0x0,0x0,0x0
.long 0xbe393d8e,0x0,0x0,0x0,0xbe07be5a,0x0,0x0,0x0
.long 0x3e393d8e,0x0,0x0,0x0,0xbe073e5a,0x0,0x0,0x0
.long 0x3e62bd8e,0x0,0x0,0x0,0xbd0f3e5a,0x0,0x0,0x0
.long 0xbd0fbd8e,0x0,0x0,0x0,0x3e62be5a,0x0,0x0,0x0
.long 0xbe073d8e,0x0,0x0,0x0,0x3e39be5a,0x0,0x0,0x0
.long 0x3e5a3e39,0x0,0x0,0x0,0x3d8e3e07,0x0,0x0,0x0
.long 0x3e4c3e07,0x0,0x0,0x0,0x3dd03e39,0x0,0x0,0x0
.long 0x3dd0be07,0x0,0x0,0x0,0x3e4c3e39,0x0,0x0,0x0
.long 0x3d8ebe39,0x0,0x0,0x0,0x3e5a3e07,0x0,0x0,0x0
.long 0xbd8ebe39,0x0,0x0,0x0,0x3e5abe07,0x0,0x0,0x0
.long 0xbdd0be07,0x0,0x0,0x0,0x3e4cbe39,0x0,0x0,0x0
.long 0xbe4c3e07,0x0,0x0,0x0,0x3dd0be39,0x0,0x0,0x0
.long 0xbe5a3e39,0x0,0x0,0x0,0x3d8ebe07,0x0,0x0,0x0
.long 0x3e393e65,0xbd8e3d8e,0xbd8ebe39,0x3e393d8e,0xbe078000,0xbe5abe5a,0x3e5a3e07,0x3e073e5a
.long 0x0,0x0,0x0,0x0,0x0,0x0,0x0,0x0
.long 0x3d0f3e65,0xbdd0be5a,0x3dd0be39,0xbd0f3e5a,0xbe628000,0x3e4cbd8e,0x3e4c3e07,0xbe62bd8e
.long 0x0,0x0,0x0,0x0,0x0,0x0,0x0,0x0
.long 0xbe073e65,0x3e5abd8e,0x3e5abe39,0xbe07bd8e,0xbe398000,0xbd8e3e5a,0x3d8e3e07,0x3e39be5a
.long 0x0,0x0,0x0,0x0,0x0,0x0,0x0,0x0
.long 0xbe623e65,0xbe4c3e5a,0x3e4cbe39,0x3e62be5a,0xbd0f8000,0xbdd03d8e,0xbdd03e07,0xbd0f3d8e
.long 0x0,0x0,0x0,0x0,0x0,0x0,0x0,0x0
.long 0xbe65be39,0xbd8ebe39,0x3e393e65,0xbd8e3d8e,0xa3fdbe07,0x3e5a3e07,0xbe0724fd,0xbe5abe5a
.long 0x0,0x0,0x0,0x0,0x0,0x0,0x0,0x0
.long 0x3e223e39,0xbe4cbe07,0xbd0fbe65,0x3dd03e5a,0xbe223e07,0x3dd0be39,0x3e62a58e,0xbe4c3d8e
.long 0x0,0x0,0x0,0x0,0x0,0x0,0x0,0x0
.long 0xa4ddbe39,0xbe5a3e39,0xbe073e65,0x3e5abd8e,0x3e65be07,0xbd8ebe07,0xbe3925dd,0xbd8e3e5a
.long 0x0,0x0,0x0,0x0,0x0,0x0,0x0,0x0
.long 0xbe223e39,0xbdd03e07,0x3e62be65,0x3e4cbe5a,0xbe223e07,0xbe4c3e39,0x3d0f259e,0x3dd0bd8e
.long 0x0,0x0,0x0,0x0,0x0,0x0,0x0,0x0
.long 0x3e393d8e,0x3e393e65,0xbe65be39,0xbd8ebe39,0x3e073e5a,0xbe07247d,0xa51ebe07,0x3e5a3e07
.long 0x0,0x0,0x0,0x0,0x0,0x0,0x0,0x0
.long 0x3e623d8e,0xbe62250e,0xbe22be39,0x3e4c3e07,0xbd0f3e5a,0xbd0fbe65,0x3e22be07,0xbdd03e39
.long 0x0,0x0,0x0,0x0,0x0,0x0,0x0,0x0
.long 0x3e073d8e,0x3e07be65,0xa67dbe39,0xbe5a3e39,0xbe393e5a,0x3e39a55d,0x3e65be07,0xbd8ebe07
.long 0x0,0x0,0x0,0x0,0x0,0x0,0x0,0x0
.long 0xbd0f3d8e,0x3d0f251e,0x3e22be39,0x3dd0be07,0xbe623e5a,0xbe623e65,0x3e22be07,0x3e4cbe39
.long 0x0,0x0,0x0,0x0,0x0,0x0,0x0,0x0
.long 0xbd8e3d8e,0xbe65be39,0x3e393d8e,0x3e393e65,0xbe5abe5a,0xa4bdbe07,0x3e073e5a,0xbe07253d
.long 0x0,0x0,0x0,0x0,0x0,0x0,0x0,0x0
.long 0x3e4cbd8e,0xbe223e07,0xbe62bd8e,0x3e62a65d,0x3dd03e5a,0xbe22be39,0x3d0fbe5a,0x3d0f3e65
.long 0x0,0x0,0x0,0x0,0x0,0x0,0x0,0x0
.long 0xbe5a3d8e,0xa4fd3e39,0x3e073d8e,0x3e07be65,0x3d8ebe5a,0xbe653e07,0xbe393e5a,0x3e39257d
.long 0x0,0x0,0x0,0x0,0x0,0x0,0x0,0x0
.long 0x3dd0bd8e,0x3e22be07,0x3d0fbd8e,0xbd0f270e,0xbe4c3e5a,0xbe223e39,0x3e62be5a,0x3e62be65
.long 0x0,0x0,0x0,0x0,0x0,0x0,0x0,0x0
.long 0xbd8e3d8e,0x0,0x0,0x0,0xbe5abe5a,0x0,0x0,0x0
.long 0x0,0x0,0x0,0x0,0x0,0x0,0x0,0x0
.long 0xbe4c3d8e,0x0,0x0,0x0,0xbdd0be5a,0x0,0x0,0x0
.long 0x0,0x0,0x0,0x0,0x0,0x0,0x0,0x0
.long 0xbe5a3d8e,0x0,0x0,0x0,0x3d8ebe5a,0x0,0x0,0x0
.long 0x0,0x0,0x0,0x0,0x0,0x0,0x0,0x0
.long 0xbdd03d8e,0x0,0x0,0x0,0x3e4cbe5a,0x0,0x0,0x0
.long 0x0,0x0,0x0,0x0,0x0,0x0,0x0,0x0
.long 0xbe65be39,0x0,0x0,0x0,0xa55dbe07,0x0,0x0,0x0
.long 0x0,0x0,0x0,0x0,0x0,0x0,0x0,0x0
.long 0x3e22be07,0x0,0x0,0x0,0x3e223e39,0x0,0x0,0x0
.long 0x0,0x0,0x0,0x0,0x0,0x0,0x0,0x0
.long 0x27063e39,0x0,0x0,0x0,0xbe653e07,0x0,0x0,0x0
.long 0x0,0x0,0x0,0x0,0x0,0x0,0x0,0x0
.long 0xbe223e07,0x0,0x0,0x0,0x3e22be39,0x0,0x0,0x0
.long 0x0,0x0,0x0,0x0,0x0,0x0,0x0,0x0
.long 0xbd8ebe39,0x0,0x0,0x0,0x3e5a3e07,0x0,0x0,0x0
.long 0x0,0x0,0x0,0x0,0x0,0x0,0x0,0x0
.long 0xbdd03e39,0x0,0x0,0x0,0xbe4cbe07,0x0,0x0,0x0
.long 0x0,0x0,0x0,0x0,0x0,0x0,0x0,0x0
.long 0x3e5abe39,0x0,0x0,0x0,0x3d8e3e07,0x0,0x0,0x0
.long 0x0,0x0,0x0,0x0,0x0,0x0,0x0,0x0
.long 0xbe4c3e39,0x0,0x0,0x0,0x3dd0be07,0x0,0x0,0x0
.long 0x0,0x0,0x0,0x0,0x0,0x0,0x0,0x0
.long 0x3e393d8e,0x0,0x0,0x0,0x3e073e5a,0x0,0x0,0x0
.long 0x0,0x0,0x0,0x0,0x0,0x0,0x0,0x0
.long 0x3d0fbe5a,0x0,0x0,0x0,0x3e623d8e,0x0,0x0,0x0
.long 0x0,0x0,0x0,0x0,0x0,0x0,0x0,0x0
.long 0xbe07bd8e,0x0,0x0,0x0,0x3e39be5a,0x0,0x0,0x0
.long 0x0,0x0,0x0,0x0,0x0,0x0,0x0,0x0
.long 0xbe623e5a,0x0,0x0,0x0,0x3d0fbd8e,0x0,0x0,0x0
.long 0x0,0x0,0x0,0x0,0x0,0x0,0x0,0x0
.long 0xbe803e80,0xbe803e80,0x0,0x0,0x3e803e80,0x3e803e80,0x0,0x0
.long 0x3ea73eb5,0x3e0b3e80,0x0,0x0,0xbe0b0000,0xbea7be80,0x0,0x0
.long 0x3eb5,0xbeb5,0x0,0x0,0xbeb50000,0x3eb50000,0x0,0x0
.long 0xbe0b3eb5,0x3ea7be80,0x0,0x0,0xbea70000,0x3e0b3e80,0x0,0x0
.long 0x0,0x0,0x3eb23eb5,0x3e973ea7,0x0,0x0,0xbd8d0000,0xbe49be0b
.long 0x0,0x0,0x3e973eb5,0xbd8d3e0b,0x0,0x0,0xbe490000,0xbeb2bea7
.long 0x0,0x0,0xbd8d3eb5,0x3e49bea7,0x0,0x0,0xbeb20000,0x3e973e0b
.long 0x0,0x0,0xbe493eb5,0x3eb2be0b,0x0,0x0,0xbe970000,0xbd8d3ea7
.long 0xbe803e80,0xbe803e80,0x0,0x0,0x3e803e80,0x3e803e80,0x0,0x0
.long 0xbe0b0000,0xbea7be80,0x0,0x0,0xbea7beb5,0xbe0bbe80,0x0,0x0
.long 0x3eb5,0xbeb5,0x0,0x0,0xbeb50000,0x3eb50000,0x0,0x0
.long 0xbea70000,0x3e0b3e80,0x0,0x0,0x3e0bbeb5,0xbea73e80,0x0,0x0
.long 0x0,0x0,0x3e493e80,0x3d8d3e0b,0x0,0x0,0xbe97be80,0xbeb2bea7
.long 0x0,0x0,0xbeb2be80,0xbe49bea7,0x0,0x0,0xbd8dbe80,0x3e973e0b
.long 0x0,0x0,0xbe973e80,0x3eb2be0b,0x0,0x0,0xbe49be80,0x3d8d3ea7
.long 0x0,0x0,0xbd8dbe80,0xbe973ea7,0x0,0x0,0x3eb2be80,0xbe49be0b
.long 0xbe803e80,0xbe803e80,0x0,0x0,0x3e803e80,0x3e803e80,0x0,0x0
.long 0xbea7beb5,0xbe0bbe80,0x0,0x0,0x3e0b0000,0x3ea73e80,0x0,0x0
.long 0x3eb5,0xbeb5,0x0,0x0,0xbeb50000,0x3eb50000,0x0,0x0
.long 0x3e0bbeb5,0xbea73e80,0x0,0x0,0x3ea70000,0xbe0bbe80,0x0,0x0
.long 0x0,0x0,0xbd8d0000,0xbe49be0b,0x0,0x0,0xbeb2beb5,0xbe97bea7
.long 0x0,0x0,0x3e490000,0x3eb23ea7,0x0,0x0,0x3e973eb5,0xbd8d3e0b
.long 0x0,0x0,0xbeb20000,0x3e973e0b,0x0,0x0,0x3d8dbeb5,0xbe493ea7
.long 0x0,0x0,0x3e970000,0x3d8dbea7,0x0,0x0,0xbe493eb5,0x3eb2be0b
.long 0xbe803e80,0xbe803e80,0x0,0x0,0x3e803e80,0x3e803e80,0x0,0x0
.long 0x3e0b0000,0x3ea73e80,0x0,0x0,0x3ea73eb5,0x3e0b3e80,0x0,0x0
.long 0x3eb5,0xbeb5,0x0,0x0,0xbeb50000,0x3eb50000,0x0,0x0
.long 0x3ea70000,0xbe0bbe80,0x0,0x0,0xbe0b3eb5,0x3ea7be80,0x0,0x0
.long 0x0,0x0,0xbe97be80,0xbeb2bea7,0x0,0x0,0xbe49be80,0xbd8dbe0b
.long 0x0,0x0,0x3d8d3e80,0xbe97be0b,0x0,0x0,0xbeb2be80,0xbe49bea7
.long 0x0,0x0,0xbe49be80,0x3d8d3ea7,0x0,0x0,0x3e97be80,0xbeb23e0b
.long 0x0,0x0,0xbeb23e80,0x3e493e0b,0x0,0x0,0xbd8dbe80,0xbe973ea7
.long 0x3e803eb5,0xbe800000,0x0,0x0,0xbe800000,0xbe80beb5,0x0,0x0
.long 0x3e0b3eb5,0xbea7be80,0x0,0x0,0xbea70000,0x3e0bbe80,0x0,0x0
.long 0xbe803eb5,0x3e800000,0x0,0x0,0xbe800000,0xbe803eb5,0x0,0x0
.long 0xbea73eb5,0xbe0b3e80,0x0,0x0,0xbe0b0000,0xbea73e80,0x0,0x0
.long 0x0,0x0,0x3e493eb5,0xbeb2be0b,0x0,0x0,0xbe970000,0xbd8dbea7
.long 0x0,0x0,0x3d8d3eb5,0xbe49bea7,0x0,0x0,0xbeb20000,0x3e97be0b
.long 0x0,0x0,0xbe973eb5,0x3d8d3e0b,0x0,0x0,0xbe490000,0xbeb23ea7
.long 0x0,0x0,0xbeb23eb5,0xbe973ea7,0x0,0x0,0xbd8d0000,0xbe493e0b
.long 0xbe80beb5,0x3e800000,0x0,0x0,0x3e800000,0x3e803eb5,0x0,0x0
.long 0x3ea70000,0xbe0b3e80,0x0,0x0,0x3e0b3eb5,0xbea7be80,0x0,0x0
.long 0x3e80beb5,0xbe800000,0x0,0x0,0x3e800000,0x3e80beb5,0x0,0x0
.long 0x3e0b0000,0x3ea7be80,0x0,0x0,0xbea73eb5,0xbe0b3e80,0x0,0x0
.long 0x0,0x0,0x3d8dbe80,0x3e973ea7,0x0,0x0,0x3eb23e80,0xbe493e0b
.long 0x0,0x0,0x3e973e80,0xbeb2be0b,0x0,0x0,0xbe493e80,0x3d8dbea7
.long 0x0,0x0,0x3eb2be80,0x3e49bea7,0x0,0x0,0xbd8d3e80,0x3e97be0b
.long 0x0,0x0,0xbe493e80,0xbd8d3e0b,0x0,0x0,0xbe973e80,0xbeb23ea7
.long 0x3e803eb5,0xbe800000,0x0,0x0,0xbe800000,0xbe80beb5,0x0,0x0
.long 0xbe0bbeb5,0x3ea73e80,0x0,0x0,0x3ea70000,0xbe0b3e80,0x0,0x0
.long 0xbe803eb5,0x3e800000,0x0,0x0,0xbe800000,0xbe803eb5,0x0,0x0
.long 0x3ea7beb5,0x3e0bbe80,0x0,0x0,0x3e0b0000,0x3ea7be80,0x0,0x0
.long 0x0,0x0,0xbe970000,0xbd8dbea7,0x0,0x0,0xbe49beb5,0x3eb23e0b
.long 0x0,0x0,0x3eb20000,0xbe973e0b,0x0,0x0,0x3d8d3eb5,0xbe49bea7
.long 0x0,0x0,0xbe490000,0xbeb23ea7,0x0,0x0,0x3e97beb5,0xbd8dbe0b
.long 0x0,0x0,0x3d8d0000,0x3e49be0b,0x0,0x0,0xbeb23eb5,0xbe973ea7
.long 0xbe80beb5,0x3e800000,0x0,0x0,0x3e800000,0x3e803eb5,0x0,0x0
.long 0xbea70000,0x3e0bbe80,0x0,0x0,0xbe0bbeb5,0x3ea73e80,0x0,0x0
.long 0x3e80beb5,0xbe800000,0x0,0x0,0x3e800000,0x3e80beb5,0x0,0x0
.long 0xbe0b0000,0xbea73e80,0x0,0x0,0x3ea7beb5,0x3e0bbe80,0x0,0x0
.long 0x0,0x0,0x3eb23e80,0xbe493e0b,0x0,0x0,0xbd8d3e80,0xbe97bea7
.long 0x0,0x0,0x3e49be80,0xbd8d3ea7,0x0,0x0,0x3e973e80,0xbeb2be0b
.long 0x0,0x0,0xbd8d3e80,0x3e97be0b,0x0,0x0,0xbeb23e80,0xbe493ea7
.long 0x0,0x0,0x3e97be80,0x3eb2bea7,0x0,0x0,0xbe493e80,0xbd8d3e0b
.long 0x3e803e80,0x3e803e80,0x3b210000,0x3bf13ba1,0xbb210000,0xbbf1bba1,0x3e803e80,0x3e803e80
.long 0x3e6c3e80,0x3db63e31,0x3dc90000,0x3e6f3e39,0xbdc90000,0xbe6fbe39,0x3e6c3e80,0x3db63e31
.long 0xbb213e80,0x3bf1be80,0x3e800000,0xbe80bba1,0xbe800000,0x3e803ba1,0xbb213e80,0x3bf1be80
.long 0xbdc93e80,0x3e6fbe31,0x3e6c0000,0xbdb6be39,0xbe6c0000,0x3db63e39,0xbdc93e80,0x3e6fbe31
.long 0x3e6d3e80,0x3dd23e39,0xbdbf0000,0xbe6abe31,0xbdbf0000,0xbe6abe31,0xbe6dbe80,0xbdd2be39
.long 0x3e373e80,0xbe303ba1,0xbe330000,0xbe3abe80,0xbe330000,0xbe3abe80,0xbe37be80,0x3e30bba1
.long 0xbdbf3e80,0x3e6abe39,0xbe6d0000,0x3dd23e31,0xbe6d0000,0x3dd23e31,0x3dbfbe80,0xbe6a3e39
.long 0xbe333e80,0x3e3abba1,0xbe370000,0xbe303e80,0xbe370000,0xbe303e80,0x3e33be80,0xbe3a3ba1
.long 0x3e803e80,0x3e7f3e80,0x3c493c21,0x3c8d3c71,0xbc49bc21,0xbc8dbc71,0x3e803e80,0x3e7f3e80
.long 0xbddbbc21,0xbe73be3f,0x3e673e80,0x3da33e2a,0xbe67be80,0xbda3be2a,0xbddbbc21,0xbe73be3f
.long 0xbc493e80,0x3c8dbe80,0x3e803c21,0xbe7fbc71,0xbe80bc21,0x3e7f3c71,0xbc493e80,0x3c8dbe80
.long 0xbe67bc21,0x3da33e3f,0xbddb3e80,0x3e73be2a,0x3ddbbe80,0xbe733e2a,0xbe67bc21,0x3da33e3f
.long 0xbdac3c21,0xbe65be2a,0xbe71be80,0xbde4be3f,0xbe71be80,0xbde4be3f,0x3dacbc21,0x3e653e2a
.long 0xbe3ebe80,0x3e28bc71,0x3e2cbc21,0x3e413e80,0x3e2cbc21,0x3e413e80,0x3e3e3e80,0xbe283c71
.long 0xbe713c21,0x3de43e2a,0x3dacbe80,0xbe653e3f,0x3dacbe80,0xbe653e3f,0x3e71bc21,0xbde4be2a
.long 0x3e2cbe80,0xbe413c71,0x3e3ebc21,0x3e28be80,0x3e3ebc21,0x3e28be80,0xbe2c3e80,0x3e41bc71
.long 0x3e7f3e7f,0x3e7f3e7f,0x3cb53ca1,0x3cdd3cc9,0xbcb5bca1,0xbcddbcc9,0x3e7f3e7f,0x3e7f3e7f
.long 0xbe63be7f,0xbd90be22,0xbdedbca1,0xbe76be46,0x3ded3ca1,0x3e763e46,0xbe63be7f,0xbd90be22
.long 0xbcb53e7f,0x3cddbe7f,0x3e7f3ca1,0xbe7fbcc9,0xbe7fbca1,0x3e7f3cc9,0xbcb53e7f,0x3cddbe7f
.long 0x3dedbe7f,0xbe763e22,0xbe63bca1,0x3d903e46,0x3e633ca1,0xbd90be46,0x3dedbe7f,0xbe763e22
.long 0xbe74be7f,0xbdf6be46,0x3d99bca1,0x3e613e22,0x3d99bca1,0x3e613e22,0x3e743e7f,0x3df63e46
.long 0x3e443e7f,0xbe203cc9,0xbe243ca1,0xbe47be7f,0xbe243ca1,0xbe47be7f,0xbe44be7f,0x3e20bcc9
.long 0x3d99be7f,0xbe613e46,0x3e74bca1,0xbdf6be22,0x3e74bca1,0xbdf6be22,0xbd993e7f,0x3e61be46
.long 0xbe243e7f,0x3e47bcc9,0xbe443ca1,0xbe203e7f,0xbe443ca1,0xbe203e7f,0x3e24be7f,0xbe473cc9
.long 0x3e7e3e7e,0x3e7d3e7e,0x3d023cf1,0x3d163d0c,0xbd02bcf1,0xbd16bd0c,0x3e7e3e7e,0x3e7d3e7e
.long 0x3dff3cf1,0x3e783e4c,0xbe5ebe7e,0xbd79be1b,0x3e5e3e7e,0x3d793e1b,0x3dff3cf1,0x3e783e4c
.long 0xbd023e7e,0x3d16be7e,0x3e7e3cf1,0xbe7dbd0c,0xbe7ebcf1,0x3e7d3d0c,0xbd023e7e,0x3d16be7e
.long 0x3e5e3cf1,0xbd79be4c,0x3dffbe7e,0xbe783e1b,0xbdff3e7e,0x3e78be1b,0x3e5e3cf1,0xbd79be4c
.long 0x3d86bcf1,0x3e5c3e1b,0x3e773e7e,0x3e043e4c,0x3e773e7e,0x3e043e4c,0xbd863cf1,0xbe5cbe1b
.long 0xbe4bbe7e,0x3e18bd0c,0x3e1dbcf1,0x3e4e3e7e,0x3e1dbcf1,0x3e4e3e7e,0x3e4b3e7e,0xbe183d0c
.long 0x3e77bcf1,0xbe04be1b,0xbd863e7e,0x3e5cbe4c,0xbd863e7e,0x3e5cbe4c,0xbe773cf1,0x3e043e1b
.long 0x3e1dbe7e,0xbe4e3d0c,0x3e4bbcf1,0x3e18be7e,0x3e4bbcf1,0x3e18be7e,0xbe1d3e7e,0x3e4ebd0c
.long 0x3e333e80,0xbe3abba1,0x3e370000,0x3e303e80,0xbe370000,0xbe30be80,0x3e333e80,0xbe3abba1
.long 0x3dbf3e80,0xbe6abe39,0x3e6d0000,0xbdd23e31,0xbe6d0000,0x3dd2be31,0x3dbf3e80,0xbe6abe39
.long 0xbe373e80,0x3e303ba1,0x3e330000,0x3e3abe80,0xbe330000,0xbe3a3e80,0xbe373e80,0x3e303ba1
.long 0xbe6d3e80,0xbdd23e39,0x3dbf0000,0x3e6abe31,0xbdbf0000,0xbe6a3e31,0xbe6d3e80,0xbdd23e39
.long 0x3dc93e80,0xbe6fbe31,0xbe6c0000,0x3db6be39,0xbe6c0000,0x3db6be39,0xbdc9be80,0x3e6f3e31
.long 0x3b213e80,0xbbf1be80,0xbe800000,0x3e80bba1,0xbe800000,0x3e80bba1,0xbb21be80,0x3bf13e80
.long 0xbe6c3e80,0xbdb63e31,0xbdc90000,0xbe6f3e39,0xbdc90000,0xbe6f3e39,0x3e6cbe80,0x3db6be31
.long 0xbe803e80,0xbe803e80,0xbb210000,0xbbf13ba1,0xbb210000,0xbbf13ba1,0x3e80be80,0x3e80be80
.long 0xbe2cbe80,0x3e413c71,0xbe3ebc21,0xbe28be80,0x3e3e3c21,0x3e283e80,0xbe2cbe80,0x3e413c71
.long 0x3e713c21,0xbde43e2a,0xbdacbe80,0x3e653e3f,0x3dac3e80,0xbe65be3f,0x3e713c21,0xbde43e2a
.long 0x3e3ebe80,0xbe28bc71,0xbe2cbc21,0xbe413e80,0x3e2c3c21,0x3e41be80,0x3e3ebe80,0xbe28bc71
.long 0x3dac3c21,0x3e65be2a,0x3e71be80,0x3de4be3f,0xbe713e80,0xbde43e3f,0x3dac3c21,0x3e65be2a
.long 0x3e67bc21,0xbda33e3f,0x3ddb3e80,0xbe73be2a,0x3ddb3e80,0xbe73be2a,0xbe673c21,0x3da3be3f
.long 0x3c493e80,0xbc8dbe80,0xbe803c21,0x3e7fbc71,0xbe803c21,0x3e7fbc71,0xbc49be80,0x3c8d3e80
.long 0x3ddbbc21,0x3e73be3f,0xbe673e80,0xbda33e2a,0xbe673e80,0xbda33e2a,0xbddb3c21,0xbe733e3f
.long 0xbe803e80,0xbe7f3e80,0xbc493c21,0xbc8d3c71,0xbc493c21,0xbc8d3c71,0x3e80be80,0x3e7fbe80
.long 0x3e243e7f,0xbe47bcc9,0x3e443ca1,0x3e203e7f,0xbe44bca1,0xbe20be7f,0x3e243e7f,0xbe47bcc9
.long 0xbd99be7f,0x3e613e46,0xbe74bca1,0x3df6be22,0x3e743ca1,0xbdf63e22,0xbd99be7f,0x3e613e46
.long 0xbe443e7f,0x3e203cc9,0x3e243ca1,0x3e47be7f,0xbe24bca1,0xbe473e7f,0xbe443e7f,0x3e203cc9
.long 0x3e74be7f,0x3df6be46,0xbd99bca1,0xbe613e22,0x3d993ca1,0x3e61be22,0x3e74be7f,0x3df6be46
.long 0xbdedbe7f,0x3e763e22,0x3e63bca1,0xbd903e46,0x3e63bca1,0xbd903e46,0x3ded3e7f,0xbe76be22
.long 0x3cb53e7f,0xbcddbe7f,0xbe7f3ca1,0x3e7fbcc9,0xbe7f3ca1,0x3e7fbcc9,0xbcb5be7f,0x3cdd3e7f
.long 0x3e63be7f,0x3d90be22,0x3dedbca1,0x3e76be46,0x3dedbca1,0x3e76be46,0xbe633e7f,0xbd903e22
.long 0xbe7f3e7f,0xbe7f3e7f,0xbcb53ca1,0xbcdd3cc9,0xbcb53ca1,0xbcdd3cc9,0x3e7fbe7f,0x3e7fbe7f
.long 0xbe1dbe7e,0x3e4e3d0c,0xbe4bbcf1,0xbe18be7e,0x3e4b3cf1,0x3e183e7e,0xbe1dbe7e,0x3e4e3d0c
.long 0xbe77bcf1,0x3e04be1b,0x3d863e7e,0xbe5cbe4c,0xbd86be7e,0x3e5c3e4c,0xbe77bcf1,0x3e04be1b
.long 0x3e4bbe7e,0xbe18bd0c,0xbe1dbcf1,0xbe4e3e7e,0x3e1d3cf1,0x3e4ebe7e,0x3e4bbe7e,0xbe18bd0c
.long 0xbd86bcf1,0xbe5c3e1b,0xbe773e7e,0xbe043e4c,0x3e77be7e,0x3e04be4c,0xbd86bcf1,0xbe5c3e1b
.long 0xbe5e3cf1,0x3d79be4c,0xbdffbe7e,0x3e783e1b,0xbdffbe7e,0x3e783e1b,0x3e5ebcf1,0xbd793e4c
.long 0x3d023e7e,0xbd16be7e,0xbe7e3cf1,0x3e7dbd0c,0xbe7e3cf1,0x3e7dbd0c,0xbd02be7e,0x3d163e7e
.long 0xbdff3cf1,0xbe783e4c,0x3e5ebe7e,0x3d79be1b,0x3e5ebe7e,0x3d79be1b,0x3dffbcf1,0x3e78be4c
.long 0xbe7e3e7e,0xbe7d3e7e,0xbd023cf1,0xbd163d0c,0xbd023cf1,0xbd163d0c,0x3e7ebe7e,0x3e7dbe7e
.long 0x3e803e80,0x3e803e80,0x3ba10000,0x3c713c21,0xbba10000,0xbc71bc21,0x3e803e80,0x3e803e80
.long 0x3e6b3e80,0x3da83e2e,0x3dcd0000,0x3e723e3c,0xbdcd0000,0xbe72be3c,0x3e6b3e80,0x3da83e2e
.long 0xbba13e80,0x3c71be80,0x3e800000,0xbe80bc21,0xbe800000,0x3e803c21,0xbba13e80,0x3c71be80
.long 0xbdcd3e80,0x3e72be2e,0x3e6b0000,0xbda8be3c,0xbe6b0000,0x3da83e3c,0xbdcd3e80,0x3e72be2e
.long 0x3e6e3e80,0x3ddf3e3c,0xbdbb0000,0xbe66be2e,0xbdbb0000,0xbe66be2e,0xbe6ebe80,0xbddfbe3c
.long 0x3e393e80,0xbe2a3c21,0xbe310000,0xbe3fbe80,0xbe310000,0xbe3fbe80,0xbe39be80,0x3e2abc21
.long 0xbdbb3e80,0x3e66be3c,0xbe6e0000,0x3ddf3e2e,0xbe6e0000,0x3ddf3e2e,0x3dbbbe80,0xbe663e3c
.long 0xbe313e80,0x3e3fbc21,0xbe390000,0xbe2a3e80,0xbe390000,0xbe2a3e80,0x3e31be80,0xbe3f3c21
.long 0x3e7f3e7f,0x3e7e3e7e,0x3cc93ca1,0x3d0c3cf1,0xbcc9bca1,0xbd0cbcf1,0x3e7f3e7f,0x3e7e3e7e
.long 0xbdf1bca1,0xbe78be49,0x3e623e7f,0x3d813e1e,0xbe62be7f,0xbd81be1e,0xbdf1bca1,0xbe78be49
.long 0xbcc93e7f,0x3d0cbe7e,0x3e7f3ca1,0xbe7ebcf1,0xbe7fbca1,0x3e7e3cf1,0xbcc93e7f,0x3d0cbe7e
.long 0xbe62bca1,0x3d813e49,0xbdf13e7f,0x3e78be1e,0x3df1be7f,0xbe783e1e,0xbe62bca1,0x3d813e49
.long 0xbd953ca1,0xbe5dbe1e,0xbe75be7f,0xbe01be49,0xbe75be7f,0xbe01be49,0x3d95bca1,0x3e5d3e1e
.long 0xbe46be7f,0x3e1bbcf1,0x3e22bca1,0x3e4c3e7e,0x3e22bca1,0x3e4c3e7e,0x3e463e7f,0xbe1b3cf1
.long 0xbe753ca1,0x3e013e1e,0x3d95be7f,0xbe5d3e49,0x3d95be7f,0xbe5d3e49,0x3e75bca1,0xbe01be1e
.long 0x3e22be7f,0xbe4c3cf1,0x3e46bca1,0x3e1bbe7e,0x3e46bca1,0x3e1bbe7e,0xbe223e7f,0x3e4cbcf1
.long 0x3e7c3e7d,0x3e7a3e7b,0x3d343d20,0x3d5b3d48,0xbd34bd20,0xbd5bbd48,0x3e7c3e7d,0x3e7a3e7b
.long 0xbe58be7d,0xbd34be0e,0xbe0abd20,0xbe7cbe55,0x3e0a3d20,0x3e7c3e55,0xbe58be7d,0xbd34be0e
.long 0xbd343e7d,0x3d5bbe7b,0x3e7c3d20,0xbe7abd48,0xbe7cbd20,0x3e7a3d48,0xbd343e7d,0x3d5bbe7b
.long 0x3e0abe7d,0xbe7c3e0e,0xbe58bd20,0x3d343e55,0x3e583d20,0xbd34be55,0x3e0abe7d,0xbe7c3e0e
.long 0xbe7abe7d,0xbe12be55,0x3d5bbd20,0x3e523e0e,0x3d5bbd20,0x3e523e0e,0x3e7a3e7d,0x3e123e55
.long 0x3e523e7d,0xbe0a3d48,0xbe123d20,0xbe58be7b,0xbe123d20,0xbe58be7b,0xbe52be7d,0x3e0abd48
.long 0x3d5bbe7d,0xbe523e55,0x3e7abd20,0xbe12be0e,0x3e7abd20,0xbe12be0e,0xbd5b3e7d,0x3e52be55
.long 0xbe123e7d,0x3e58bd48,0xbe523d20,0xbe0a3e7b,0xbe523d20,0xbe0a3e7b,0x3e12be7d,0xbe583d48
.long 0x3e783e79,0x3e753e76,0x3d813d6f,0x3d953d8b,0xbd81bd6f,0xbd95bd8b,0x3e783e79,0x3e753e76
.long 0x3e1b3d6f,0x3e7f3e5f,0xbe4cbe79,0xbcc9bdfa,0x3e4c3e79,0x3cc93dfa,0x3e1b3d6f,0x3e7f3e5f
.long 0xbd813e79,0x3d95be76,0x3e783d6f,0xbe75bd8b,0xbe78bd6f,0x3e753d8b,0xbd813e79,0x3d95be76
.long 0x3e4c3d6f,0xbcc9be5f,0x3e1bbe79,0xbe7f3dfa,0xbe1b3e79,0x3e7fbdfa,0x3e4c3d6f,0xbcc9be5f
.long 0x3d0cbd6f,0x3e463dfa,0x3e7e3e79,0x3e223e5f,0x3e7e3e79,0x3e223e5f,0xbd0c3d6f,0xbe46bdfa
.long 0xbe5dbe79,0x3df1bd8b,0x3e01bd6f,0x3e623e76,0x3e01bd6f,0x3e623e76,0x3e5d3e79,0xbdf13d8b
.long 0x3e7ebd6f,0xbe22bdfa,0xbd0c3e79,0x3e46be5f,0xbd0c3e79,0x3e46be5f,0xbe7e3d6f,0x3e223dfa
.long 0x3e01be79,0xbe623d8b,0x3e5dbd6f,0x3df1be76,0x3e5dbd6f,0x3df1be76,0xbe013e79,0x3e62bd8b
.long 0x3e313e80,0xbe3fbc21,0x3e390000,0x3e2a3e80,0xbe390000,0xbe2abe80,0x3e313e80,0xbe3fbc21
.long 0x3dbb3e80,0xbe66be3c,0x3e6e0000,0xbddf3e2e,0xbe6e0000,0x3ddfbe2e,0x3dbb3e80,0xbe66be3c
.long 0xbe393e80,0x3e2a3c21,0x3e310000,0x3e3fbe80,0xbe310000,0xbe3f3e80,0xbe393e80,0x3e2a3c21
.long 0xbe6e3e80,0xbddf3e3c,0x3dbb0000,0x3e66be2e,0xbdbb0000,0xbe663e2e,0xbe6e3e80,0xbddf3e3c
.long 0x3dcd3e80,0xbe72be2e,0xbe6b0000,0x3da8be3c,0xbe6b0000,0x3da8be3c,0xbdcdbe80,0x3e723e2e
.long 0x3ba13e80,0xbc71be80,0xbe800000,0x3e80bc21,0xbe800000,0x3e80bc21,0xbba1be80,0x3c713e80
.long 0xbe6b3e80,0xbda83e2e,0xbdcd0000,0xbe723e3c,0xbdcd0000,0xbe723e3c,0x3e6bbe80,0x3da8be2e
.long 0xbe803e80,0xbe803e80,0xbba10000,0xbc713c21,0xbba10000,0xbc713c21,0x3e80be80,0x3e80be80
.long 0xbe22be7f,0x3e4c3cf1,0xbe46bca1,0xbe1bbe7e,0x3e463ca1,0x3e1b3e7e,0xbe22be7f,0x3e4c3cf1
.long 0x3e753ca1,0xbe013e1e,0xbd95be7f,0x3e5d3e49,0x3d953e7f,0xbe5dbe49,0x3e753ca1,0xbe013e1e
.long 0x3e46be7f,0xbe1bbcf1,0xbe22bca1,0xbe4c3e7e,0x3e223ca1,0x3e4cbe7e,0x3e46be7f,0xbe1bbcf1
.long 0x3d953ca1,0x3e5dbe1e,0x3e75be7f,0x3e01be49,0xbe753e7f,0xbe013e49,0x3d953ca1,0x3e5dbe1e
.long 0x3e62bca1,0xbd813e49,0x3df13e7f,0xbe78be1e,0x3df13e7f,0xbe78be1e,0xbe623ca1,0x3d81be49
.long 0x3cc93e7f,0xbd0cbe7e,0xbe7f3ca1,0x3e7ebcf1,0xbe7f3ca1,0x3e7ebcf1,0xbcc9be7f,0x3d0c3e7e
.long 0x3df1bca1,0x3e78be49,0xbe623e7f,0xbd813e1e,0xbe623e7f,0xbd813e1e,0xbdf13ca1,0xbe783e49
.long 0xbe7f3e7f,0xbe7e3e7e,0xbcc93ca1,0xbd0c3cf1,0xbcc93ca1,0xbd0c3cf1,0x3e7fbe7f,0x3e7ebe7e
.long 0x3e123e7d,0xbe58bd48,0x3e523d20,0x3e0a3e7b,0xbe52bd20,0xbe0abe7b,0x3e123e7d,0xbe58bd48
.long 0xbd5bbe7d,0x3e523e55,0xbe7abd20,0x3e12be0e,0x3e7a3d20,0xbe123e0e,0xbd5bbe7d,0x3e523e55
.long 0xbe523e7d,0x3e0a3d48,0x3e123d20,0x3e58be7b,0xbe12bd20,0xbe583e7b,0xbe523e7d,0x3e0a3d48
.long 0x3e7abe7d,0x3e12be55,0xbd5bbd20,0xbe523e0e,0x3d5b3d20,0x3e52be0e,0x3e7abe7d,0x3e12be55
.long 0xbe0abe7d,0x3e7c3e0e,0x3e58bd20,0xbd343e55,0x3e58bd20,0xbd343e55,0x3e0a3e7d,0xbe7cbe0e
.long 0x3d343e7d,0xbd5bbe7b,0xbe7c3d20,0x3e7abd48,0xbe7c3d20,0x3e7abd48,0xbd34be7d,0x3d5b3e7b
.long 0x3e58be7d,0x3d34be0e,0x3e0abd20,0x3e7cbe55,0x3e0abd20,0x3e7cbe55,0xbe583e7d,0xbd343e0e
.long 0xbe7c3e7d,0xbe7a3e7b,0xbd343d20,0xbd5b3d48,0xbd343d20,0xbd5b3d48,0x3e7cbe7d,0x3e7abe7b
.long 0xbe01be79,0x3e623d8b,0xbe5dbd6f,0xbdf1be76,0x3e5d3d6f,0x3df13e76,0xbe01be79,0x3e623d8b
.long 0xbe7ebd6f,0x3e22bdfa,0x3d0c3e79,0xbe46be5f,0xbd0cbe79,0x3e463e5f,0xbe7ebd6f,0x3e22bdfa
.long 0x3e5dbe79,0xbdf1bd8b,0xbe01bd6f,0xbe623e76,0x3e013d6f,0x3e62be76,0x3e5dbe79,0xbdf1bd8b
.long 0xbd0cbd6f,0xbe463dfa,0xbe7e3e79,0xbe223e5f,0x3e7ebe79,0x3e22be5f,0xbd0cbd6f,0xbe463dfa
.long 0xbe4c3d6f,0x3cc9be5f,0xbe1bbe79,0x3e7f3dfa,0xbe1bbe79,0x3e7f3dfa,0x3e4cbd6f,0xbcc93e5f
.long 0x3d813e79,0xbd95be76,0xbe783d6f,0x3e75bd8b,0xbe783d6f,0x3e75bd8b,0xbd81be79,0x3d953e76
.long 0xbe1b3d6f,0xbe7f3e5f,0x3e4cbe79,0x3cc9bdfa,0x3e4cbe79,0x3cc9bdfa,0x3e1bbd6f,0x3e7fbe5f
.long 0xbe783e79,0xbe753e76,0xbd813d6f,0xbd953d8b,0xbd813d6f,0xbd953d8b,0x3e78be79,0x3e75be76
.long 0x3e803e80,0x3e7f3e80,0x3bf10000,0x3cb53c71,0xbbf10000,0xbcb5bc71,0x3e803e80,0x3e7f3e80
.long 0x3e6a3e80,0x3d993e2a,0x3dd20000,0x3e743e3f,0xbdd20000,0xbe74be3f,0x3e6a3e80,0x3d993e2a
.long 0xbbf13e80,0x3cb5be80,0x3e800000,0xbe7fbc71,0xbe800000,0x3e7f3c71,0xbbf13e80,0x3cb5be80
.long 0xbdd23e80,0x3e74be2a,0x3e6a0000,0xbd99be3f,0xbe6a0000,0x3d993e3f,0xbdd23e80,0x3e74be2a
.long 0x3e6f3e80,0x3ded3e3f,0xbdb60000,0xbe63be2a,0xbdb60000,0xbe63be2a,0xbe6fbe80,0xbdedbe3f
.long 0x3e3a3e80,0xbe243c71,0xbe300000,0xbe44be80,0xbe300000,0xbe44be80,0xbe3abe80,0x3e24bc71
.long 0xbdb63e80,0x3e63be3f,0xbe6f0000,0x3ded3e2a,0xbe6f0000,0x3ded3e2a,0x3db6be80,0xbe633e3f
.long 0xbe303e80,0x3e44bc71,0xbe3a0000,0xbe243e80,0xbe3a0000,0xbe243e80,0x3e30be80,0xbe443c71
.long 0x3e7d3e7e,0x3e7b3e7c,0x3d163cf1,0x3d523d34,0xbd16bcf1,0xbd52bd34,0x3e7d3e7e,0x3e7b3e7c
.long 0xbe04bcf1,0xbe7cbe52,0x3e5c3e7e,0x3d3e3e12,0xbe5cbe7e,0xbd3ebe12,0xbe04bcf1,0xbe7cbe52
.long 0xbd163e7e,0x3d52be7c,0x3e7d3cf1,0xbe7bbd34,0xbe7dbcf1,0x3e7b3d34,0xbd163e7e,0x3d52be7c
.long 0xbe5cbcf1,0x3d3e3e52,0xbe043e7e,0x3e7cbe12,0x3e04be7e,0xbe7c3e12,0xbe5cbcf1,0x3d3e3e52
.long 0xbd793cf1,0xbe53be12,0xbe78be7e,0xbe10be52,0xbe78be7e,0xbe10be52,0x3d79bcf1,0x3e533e12
.long 0xbe4ebe7e,0x3e0cbd34,0x3e18bcf1,0x3e563e7c,0x3e18bcf1,0x3e563e7c,0x3e4e3e7e,0xbe0c3d34
.long 0xbe783cf1,0x3e103e12,0x3d79be7e,0xbe533e52,0x3d79be7e,0xbe533e52,0x3e78bcf1,0xbe10be12
.long 0x3e18be7e,0xbe563d34,0x3e4ebcf1,0x3e0cbe7c,0x3e4ebcf1,0x3e0cbe7c,0xbe183e7e,0x3e56bd34
.long 0x3e773e79,0x3e733e75,0x3d863d6f,0x3da33d95,0xbd86bd6f,0xbda3bd95,0x3e773e79,0x3e733e75
.long 0xbe4bbe79,0xbc8dbdf1,0xbe1dbd6f,0xbe7fbe62,0x3e1d3d6f,0x3e7f3e62,0xbe4bbe79,0xbc8dbdf1
.long 0xbd863e79,0x3da3be75,0x3e773d6f,0xbe73bd95,0xbe77bd6f,0x3e733d95,0xbd863e79,0x3da3be75
.long 0x3e1dbe79,0xbe7f3df1,0xbe4bbd6f,0x3c8d3e62,0x3e4b3d6f,0xbc8dbe62,0x3e1dbe79,0xbe7f3df1
.long 0xbe7ebe79,0xbe28be62,0x3d02bd6f,0x3e413df1,0x3d02bd6f,0x3e413df1,0x3e7e3e79,0x3e283e62
.long 0x3e5e3e79,0xbde43d95,0xbdff3d6f,0xbe65be75,0xbdff3d6f,0xbe65be75,0xbe5ebe79,0x3de4bd95
.long 0x3d02be79,0xbe413e62,0x3e7ebd6f,0xbe28bdf1,0x3e7ebd6f,0xbe28bdf1,0xbd023e79,0x3e41be62
.long 0xbdff3e79,0x3e65bd95,0xbe5e3d6f,0xbde43e75,0xbe5e3d6f,0xbde43e75,0x3dffbe79,0xbe653d95
.long 0x3e6d3e70,0x3e673e6b,0x3dbf3db1,0x3ddb3dcd,0xbdbfbdb1,0xbddbbdcd,0x3e6d3e70,0x3e673e6b
.long 0x3e333db1,0x3e803e6e,0xbe37be70,0x3c49bdbb,0x3e373e70,0xbc493dbb,0x3e333db1,0x3e803e6e
.long 0xbdbf3e70,0x3ddbbe6b,0x3e6d3db1,0xbe67bdcd,0xbe6dbdb1,0x3e673dcd,0xbdbf3e70,0x3ddbbe6b
.long 0x3e373db1,0x3c49be6e,0x3e33be70,0xbe803dbb,0xbe333e70,0x3e80bdbb,0x3e373db1,0x3c49be6e
.long 0x3b21bdb1,0x3e2c3dbb,0x3e803e70,0x3e3e3e6e,0x3e803e70,0x3e3e3e6e,0xbb213db1,0xbe2cbdbb
.long 0xbe6cbe70,0x3dacbdcd,0x3dc9bdb1,0x3e713e6b,0x3dc9bdb1,0x3e713e6b,0x3e6c3e70,0xbdac3dcd
.long 0x3e80bdb1,0xbe3ebdbb,0xbb213e70,0x3e2cbe6e,0xbb213e70,0x3e2cbe6e,0xbe803db1,0x3e3e3dbb
.long 0x3dc9be70,0xbe713dcd,0x3e6cbdb1,0x3dacbe6b,0x3e6cbdb1,0x3dacbe6b,0xbdc93e70,0x3e71bdcd
.long 0x3e303e80,0xbe44bc71,0x3e3a0000,0x3e243e80,0xbe3a0000,0xbe24be80,0x3e303e80,0xbe44bc71
.long 0x3db63e80,0xbe63be3f,0x3e6f0000,0xbded3e2a,0xbe6f0000,0x3dedbe2a,0x3db63e80,0xbe63be3f
.long 0xbe3a3e80,0x3e243c71,0x3e300000,0x3e44be80,0xbe300000,0xbe443e80,0xbe3a3e80,0x3e243c71
.long 0xbe6f3e80,0xbded3e3f,0x3db60000,0x3e63be2a,0xbdb60000,0xbe633e2a,0xbe6f3e80,0xbded3e3f
.long 0x3dd23e80,0xbe74be2a,0xbe6a0000,0x3d99be3f,0xbe6a0000,0x3d99be3f,0xbdd2be80,0x3e743e2a
.long 0x3bf13e80,0xbcb5be80,0xbe800000,0x3e7fbc71,0xbe800000,0x3e7fbc71,0xbbf1be80,0x3cb53e80
.long 0xbe6a3e80,0xbd993e2a,0xbdd20000,0xbe743e3f,0xbdd20000,0xbe743e3f,0x3e6abe80,0x3d99be2a
.long 0xbe803e80,0xbe7f3e80,0xbbf10000,0xbcb53c71,0xbbf10000,0xbcb53c71,0x3e80be80,0x3e7fbe80
.long 0xbe18be7e,0x3e563d34,0xbe4ebcf1,0xbe0cbe7c,0x3e4e3cf1,0x3e0c3e7c,0xbe18be7e,0x3e563d34
.long 0x3e783cf1,0xbe103e12,0xbd79be7e,0x3e533e52,0x3d793e7e,0xbe53be52,0x3e783cf1,0xbe103e12
.long 0x3e4ebe7e,0xbe0cbd34,0xbe18bcf1,0xbe563e7c,0x3e183cf1,0x3e56be7c,0x3e4ebe7e,0xbe0cbd34
.long 0x3d793cf1,0x3e53be12,0x3e78be7e,0x3e10be52,0xbe783e7e,0xbe103e52,0x3d793cf1,0x3e53be12
.long 0x3e5cbcf1,0xbd3e3e52,0x3e043e7e,0xbe7cbe12,0x3e043e7e,0xbe7cbe12,0xbe5c3cf1,0x3d3ebe52
.long 0x3d163e7e,0xbd52be7c,0xbe7d3cf1,0x3e7bbd34,0xbe7d3cf1,0x3e7bbd34,0xbd16be7e,0x3d523e7c
.long 0x3e04bcf1,0x3e7cbe52,0xbe5c3e7e,0xbd3e3e12,0xbe5c3e7e,0xbd3e3e12,0xbe043cf1,0xbe7c3e52
.long 0xbe7d3e7e,0xbe7b3e7c,0xbd163cf1,0xbd523d34,0xbd163cf1,0xbd523d34,0x3e7dbe7e,0x3e7bbe7c
.long 0x3dff3e79,0xbe65bd95,0x3e5e3d6f,0x3de43e75,0xbe5ebd6f,0xbde4be75,0x3dff3e79,0xbe65bd95
.long 0xbd02be79,0x3e413e62,0xbe7ebd6f,0x3e28bdf1,0x3e7e3d6f,0xbe283df1,0xbd02be79,0x3e413e62
.long 0xbe5e3e79,0x3de43d95,0x3dff3d6f,0x3e65be75,0xbdffbd6f,0xbe653e75,0xbe5e3e79,0x3de43d95
.long 0x3e7ebe79,0x3e28be62,0xbd02bd6f,0xbe413df1,0x3d023d6f,0x3e41bdf1,0x3e7ebe79,0x3e28be62
.long 0xbe1dbe79,0x3e7f3df1,0x3e4bbd6f,0xbc8d3e62,0x3e4bbd6f,0xbc8d3e62,0x3e1d3e79,0xbe7fbdf1
.long 0x3d863e79,0xbda3be75,0xbe773d6f,0x3e73bd95,0xbe773d6f,0x3e73bd95,0xbd86be79,0x3da33e75
.long 0x3e4bbe79,0x3c8dbdf1,0x3e1dbd6f,0x3e7fbe62,0x3e1dbd6f,0x3e7fbe62,0xbe4b3e79,0xbc8d3df1
.long 0xbe773e79,0xbe733e75,0xbd863d6f,0xbda33d95,0xbd863d6f,0xbda33d95,0x3e77be79,0x3e73be75
.long 0xbdc9be70,0x3e713dcd,0xbe6cbdb1,0xbdacbe6b,0x3e6c3db1,0x3dac3e6b,0xbdc9be70,0x3e713dcd
.long 0xbe80bdb1,0x3e3ebdbb,0x3b213e70,0xbe2cbe6e,0xbb21be70,0x3e2c3e6e,0xbe80bdb1,0x3e3ebdbb
.long 0x3e6cbe70,0xbdacbdcd,0xbdc9bdb1,0xbe713e6b,0x3dc93db1,0x3e71be6b,0x3e6cbe70,0xbdacbdcd
.long 0xbb21bdb1,0xbe2c3dbb,0xbe803e70,0xbe3e3e6e,0x3e80be70,0x3e3ebe6e,0xbb21bdb1,0xbe2c3dbb
.long 0xbe373db1,0xbc49be6e,0xbe33be70,0x3e803dbb,0xbe33be70,0x3e803dbb,0x3e37bdb1,0x3c493e6e
.long 0x3dbf3e70,0xbddbbe6b,0xbe6d3db1,0x3e67bdcd,0xbe6d3db1,0x3e67bdcd,0xbdbfbe70,0x3ddb3e6b
.long 0xbe333db1,0xbe803e6e,0x3e37be70,0xbc49bdbb,0x3e37be70,0xbc49bdbb,0x3e33bdb1,0x3e80be6e
.long 0xbe6d3e70,0xbe673e6b,0xbdbf3db1,0xbddb3dcd,0xbdbf3db1,0xbddb3dcd,0x3e6dbe70,0x3e67be6b
.long 0x3e803e80,0x3e7e3e7f,0x3c210000,0x3cf13ca1,0xbc210000,0xbcf1bca1,0x3e803e80,0x3e7e3e7f
.long 0x3e683e80,0x3d8b3e26,0x3dd60000,0x3e763e43,0xbdd60000,0xbe76be43,0x3e683e80,0x3d8b3e26
.long 0xbc213e80,0x3cf1be7f,0x3e800000,0xbe7ebca1,0xbe800000,0x3e7e3ca1,0xbc213e80,0x3cf1be7f
.long 0xbdd63e80,0x3e76be26,0x3e680000,0xbd8bbe43,0xbe680000,0x3d8b3e43,0xbdd63e80,0x3e76be26
.long 0x3e703e80,0x3dfa3e43,0xbdb10000,0xbe5fbe26,0xbdb10000,0xbe5fbe26,0xbe70be80,0xbdfabe43
.long 0x3e3c3e80,0xbe1e3ca1,0xbe2e0000,0xbe49be7f,0xbe2e0000,0xbe49be7f,0xbe3cbe80,0x3e1ebca1
.long 0xbdb13e80,0x3e5fbe43,0xbe700000,0x3dfa3e26,0xbe700000,0x3dfa3e26,0x3db1be80,0xbe5f3e43
.long 0xbe2e3e80,0x3e49bca1,0xbe3c0000,0xbe1e3e7f,0xbe3c0000,0xbe1e3e7f,0x3e2ebe80,0xbe493ca1
.long 0x3e7b3e7d,0x3e763e79,0x3d483d20,0x3d8b3d6f,0xbd48bd20,0xbd8bbd6f,0x3e7b3e7d,0x3e763e79
.long 0xbe0ebd20,0xbe7ebe5a,0x3e553e7d,0x3cf13e06,0xbe55be7d,0xbcf1be06,0xbe0ebd20,0xbe7ebe5a
.long 0xbd483e7d,0x3d8bbe79,0x3e7b3d20,0xbe76bd6f,0xbe7bbd20,0x3e763d6f,0xbd483e7d,0x3d8bbe79
.long 0xbe55bd20,0x3cf13e5a,0xbe0e3e7d,0x3e7ebe06,0x3e0ebe7d,0xbe7e3e06,0xbe55bd20,0x3cf13e5a
.long 0xbd483d20,0xbe49be06,0xbe7bbe7d,0xbe1ebe5a,0xbe7bbe7d,0xbe1ebe5a,0x3d48bd20,0x3e493e06
.long 0xbe55be7d,0x3dfabd6f,0x3e0ebd20,0x3e5f3e79,0x3e0ebd20,0x3e5f3e79,0x3e553e7d,0xbdfa3d6f
.long 0xbe7b3d20,0x3e1e3e06,0x3d48be7d,0xbe493e5a,0x3d48be7d,0xbe493e5a,0x3e7bbd20,0xbe1ebe06
.long 0x3e0ebe7d,0xbe5f3d6f,0x3e55bd20,0x3dfabe79,0x3e55bd20,0x3dfabe79,0xbe0e3e7d,0x3e5fbd6f
.long 0x3e703e73,0x3e683e6d,0x3db13d9e,0x3dd63dc4,0xbdb1bd9e,0xbdd6bdc4,0x3e703e73,0x3e683e6d
.long 0xbe3cbe73,0x3c21bdc4,0xbe2ebd9e,0xbe80be6d,0x3e2e3d9e,0x3e803e6d,0xbe3cbe73,0x3c21bdc4
.long 0xbdb13e73,0x3dd6be6d,0x3e703d9e,0xbe68bdc4,0xbe70bd9e,0x3e683dc4,0xbdb13e73,0x3dd6be6d
.long 0x3e2ebe73,0xbe803dc4,0xbe3cbd9e,0xbc213e6d,0x3e3c3d9e,0x3c21be6d,0x3e2ebe73,0xbe803dc4
.long 0xbe80be73,0xbe3cbe6d,0x3c21bd9e,0x3e2e3dc4,0x3c21bd9e,0x3e2e3dc4,0x3e803e73,0x3e3c3e6d
.long 0x3e683e73,0xbdb13dc4,0xbdd63d9e,0xbe70be6d,0xbdd63d9e,0xbe70be6d,0xbe68be73,0x3db1bdc4
.long 0x3c21be73,0xbe2e3e6d,0x3e80bd9e,0xbe3cbdc4,0x3e80bd9e,0xbe3cbdc4,0xbc213e73,0x3e2ebe6d
.long 0xbdd63e73,0x3e70bdc4,0xbe683d9e,0xbdb13e6d,0xbe683d9e,0xbdb13e6d,0x3dd6be73,0xbe703dc4
.long 0x3e5f3e64,0x3e553e5a,0x3dfa3de8,0x3e0e3e06,0xbdfabde8,0xbe0ebe06,0x3e5f3e64,0x3e553e5a
.long 0x3e493de8,0x3e7b3e79,0xbe1ebe64,0x3d48bd6f,0x3e1e3e64,0xbd483d6f,0x3e493de8,0x3e7b3e79
.long 0xbdfa3e64,0x3e0ebe5a,0x3e5f3de8,0xbe55be06,0xbe5fbde8,0x3e553e06,0xbdfa3e64,0x3e0ebe5a
.long 0x3e1e3de8,0x3d48be79,0x3e49be64,0xbe7b3d6f,0xbe493e64,0x3e7bbd6f,0x3e1e3de8,0x3d48be79
.long 0xbcf1bde8,0x3e0e3d6f,0x3e7e3e64,0x3e553e79,0x3e7e3e64,0x3e553e79,0x3cf13de8,0xbe0ebd6f
.long 0xbe76be64,0x3d48be06,0x3d8bbde8,0x3e7b3e5a,0x3d8bbde8,0x3e7b3e5a,0x3e763e64,0xbd483e06
.long 0x3e7ebde8,0xbe55bd6f,0x3cf13e64,0x3e0ebe79,0x3cf13e64,0x3e0ebe79,0xbe7e3de8,0x3e553d6f
.long 0x3d8bbe64,0xbe7b3e06,0x3e76bde8,0x3d48be5a,0x3e76bde8,0x3d48be5a,0xbd8b3e64,0x3e7bbe06
.long 0x3e2e3e80,0xbe49bca1,0x3e3c0000,0x3e1e3e7f,0xbe3c0000,0xbe1ebe7f,0x3e2e3e80,0xbe49bca1
.long 0x3db13e80,0xbe5fbe43,0x3e700000,0xbdfa3e26,0xbe700000,0x3dfabe26,0x3db13e80,0xbe5fbe43
.long 0xbe3c3e80,0x3e1e3ca1,0x3e2e0000,0x3e49be7f,0xbe2e0000,0xbe493e7f,0xbe3c3e80,0x3e1e3ca1
.long 0xbe703e80,0xbdfa3e43,0x3db10000,0x3e5fbe26,0xbdb10000,0xbe5f3e26,0xbe703e80,0xbdfa3e43
.long 0x3dd63e80,0xbe76be26,0xbe680000,0x3d8bbe43,0xbe680000,0x3d8bbe43,0xbdd6be80,0x3e763e26
.long 0x3c213e80,0xbcf1be7f,0xbe800000,0x3e7ebca1,0xbe800000,0x3e7ebca1,0xbc21be80,0x3cf13e7f
.long 0xbe683e80,0xbd8b3e26,0xbdd60000,0xbe763e43,0xbdd60000,0xbe763e43,0x3e68be80,0x3d8bbe26
.long 0xbe803e80,0xbe7e3e7f,0xbc210000,0xbcf13ca1,0xbc210000,0xbcf13ca1,0x3e80be80,0x3e7ebe7f
.long 0xbe0ebe7d,0x3e5f3d6f,0xbe55bd20,0xbdfabe79,0x3e553d20,0x3dfa3e79,0xbe0ebe7d,0x3e5f3d6f
.long 0x3e7b3d20,0xbe1e3e06,0xbd48be7d,0x3e493e5a,0x3d483e7d,0xbe49be5a,0x3e7b3d20,0xbe1e3e06
.long 0x3e55be7d,0xbdfabd6f,0xbe0ebd20,0xbe5f3e79,0x3e0e3d20,0x3e5fbe79,0x3e55be7d,0xbdfabd6f
.long 0x3d483d20,0x3e49be06,0x3e7bbe7d,0x3e1ebe5a,0xbe7b3e7d,0xbe1e3e5a,0x3d483d20,0x3e49be06
.long 0x3e55bd20,0xbcf13e5a,0x3e0e3e7d,0xbe7ebe06,0x3e0e3e7d,0xbe7ebe06,0xbe553d20,0x3cf1be5a
.long 0x3d483e7d,0xbd8bbe79,0xbe7b3d20,0x3e76bd6f,0xbe7b3d20,0x3e76bd6f,0xbd48be7d,0x3d8b3e79
.long 0x3e0ebd20,0x3e7ebe5a,0xbe553e7d,0xbcf13e06,0xbe553e7d,0xbcf13e06,0xbe0e3d20,0xbe7e3e5a
.long 0xbe7b3e7d,0xbe763e79,0xbd483d20,0xbd8b3d6f,0xbd483d20,0xbd8b3d6f,0x3e7bbe7d,0x3e76be79
.long 0x3dd63e73,0xbe70bdc4,0x3e683d9e,0x3db13e6d,0xbe68bd9e,0xbdb1be6d,0x3dd63e73,0xbe70bdc4
.long 0xbc21be73,0x3e2e3e6d,0xbe80bd9e,0x3e3cbdc4,0x3e803d9e,0xbe3c3dc4,0xbc21be73,0x3e2e3e6d
.long 0xbe683e73,0x3db13dc4,0x3dd63d9e,0x3e70be6d,0xbdd6bd9e,0xbe703e6d,0xbe683e73,0x3db13dc4
.long 0x3e80be73,0x3e3cbe6d,0xbc21bd9e,0xbe2e3dc4,0x3c213d9e,0x3e2ebdc4,0x3e80be73,0x3e3cbe6d
.long 0xbe2ebe73,0x3e803dc4,0x3e3cbd9e,0x3c213e6d,0x3e3cbd9e,0x3c213e6d,0x3e2e3e73,0xbe80bdc4
.long 0x3db13e73,0xbdd6be6d,0xbe703d9e,0x3e68bdc4,0xbe703d9e,0x3e68bdc4,0xbdb1be73,0x3dd63e6d
.long 0x3e3cbe73,0xbc21bdc4,0x3e2ebd9e,0x3e80be6d,0x3e2ebd9e,0x3e80be6d,0xbe3c3e73,0x3c213dc4
.long 0xbe703e73,0xbe683e6d,0xbdb13d9e,0xbdd63dc4,0xbdb13d9e,0xbdd63dc4,0x3e70be73,0x3e68be6d
.long 0xbd8bbe64,0x3e7b3e06,0xbe76bde8,0xbd48be5a,0x3e763de8,0x3d483e5a,0xbd8bbe64,0x3e7b3e06
.long 0xbe7ebde8,0x3e55bd6f,0xbcf13e64,0xbe0ebe79,0x3cf1be64,0x3e0e3e79,0xbe7ebde8,0x3e55bd6f
.long 0x3e76be64,0xbd48be06,0xbd8bbde8,0xbe7b3e5a,0x3d8b3de8,0x3e7bbe5a,0x3e76be64,0xbd48be06
.long 0x3cf1bde8,0xbe0e3d6f,0xbe7e3e64,0xbe553e79,0x3e7ebe64,0x3e55be79,0x3cf1bde8,0xbe0e3d6f
.long 0xbe1e3de8,0xbd48be79,0xbe49be64,0x3e7b3d6f,0xbe49be64,0x3e7b3d6f,0x3e1ebde8,0x3d483e79
.long 0x3dfa3e64,0xbe0ebe5a,0xbe5f3de8,0x3e55be06,0xbe5f3de8,0x3e55be06,0xbdfabe64,0x3e0e3e5a
.long 0xbe493de8,0xbe7b3e79,0x3e1ebe64,0xbd48bd6f,0x3e1ebe64,0xbd48bd6f,0x3e49bde8,0x3e7bbe79
.long 0xbe5f3e64,0xbe553e5a,0xbdfa3de8,0xbe0e3e06,0xbdfa3de8,0xbe0e3e06,0x3e5fbe64,0x3e55be5a
.long 0x3e803e80,0x3e7d3e7f,0x3c490000,0x3d163cc9,0xbc490000,0xbd16bcc9,0x3e803e80,0x3e7d3e7f
.long 0x3e673e80,0x3d793e22,0x3ddb0000,0x3e783e46,0xbddb0000,0xbe78be46,0x3e673e80,0x3d793e22
.long 0xbc493e80,0x3d16be7f,0x3e800000,0xbe7dbcc9,0xbe800000,0x3e7d3cc9,0xbc493e80,0x3d16be7f
.long 0xbddb3e80,0x3e78be22,0x3e670000,0xbd79be46,0xbe670000,0x3d793e46,0xbddb3e80,0x3e78be22
.long 0x3e713e80,0x3e043e46,0xbdac0000,0xbe5cbe22,0xbdac0000,0xbe5cbe22,0xbe71be80,0xbe04be46
.long 0x3e3e3e80,0xbe183cc9,0xbe2c0000,0xbe4ebe7f,0xbe2c0000,0xbe4ebe7f,0xbe3ebe80,0x3e18bcc9
.long 0xbdac3e80,0x3e5cbe46,0xbe710000,0x3e043e22,0xbe710000,0x3e043e22,0x3dacbe80,0xbe5c3e46
.long 0xbe2c3e80,0x3e4ebcc9,0xbe3e0000,0xbe183e7f,0xbe3e0000,0xbe183e7f,0x3e2cbe80,0xbe4e3cc9
.long 0x3e783e7b,0x3e713e75,0x3d793d48,0x3dac3d95,0xbd79bd48,0xbdacbd95,0x3e783e7b,0x3e713e75
.long 0xbe18bd48,0xbe80be62,0x3e4e3e7b,0x3c493df1,0xbe4ebe7b,0xbc49bdf1,0xbe18bd48,0xbe80be62
.long 0xbd793e7b,0x3dacbe75,0x3e783d48,0xbe71bd95,0xbe78bd48,0x3e713d95,0xbd793e7b,0x3dacbe75
.long 0xbe4ebd48,0x3c493e62,0xbe183e7b,0x3e80bdf1,0x3e18be7b,0xbe803df1,0xbe4ebd48,0x3c493e62
.long 0xbd163d48,0xbe3ebdf1,0xbe7dbe7b,0xbe2cbe62,0xbe7dbe7b,0xbe2cbe62,0x3d16bd48,0x3e3e3df1
.long 0xbe5cbe7b,0x3ddbbd95,0x3e04bd48,0x3e673e75,0x3e04bd48,0x3e673e75,0x3e5c3e7b,0xbddb3d95
.long 0xbe7d3d48,0x3e2c3df1,0x3d16be7b,0xbe3e3e62,0x3d16be7b,0xbe3e3e62,0x3e7dbd48,0xbe2cbdf1
.long 0x3e04be7b,0xbe673d95,0x3e5cbd48,0x3ddbbe75,0x3e5cbd48,0x3ddbbe75,0xbe043e7b,0x3e67bd95
.long 0x3e673e6d,0x3e5c3e62,0x3ddb3dc4,0x3e043df1,0xbddbbdc4,0xbe04bdf1,0x3e673e6d,0x3e5c3e62
.long 0xbe2cbe6d,0x3d16bd95,0xbe3ebdc4,0xbe7dbe75,0x3e3e3dc4,0x3e7d3e75,0xbe2cbe6d,0x3d16bd95
.long 0xbddb3e6d,0x3e04be62,0x3e673dc4,0xbe5cbdf1,0xbe67bdc4,0x3e5c3df1,0xbddb3e6d,0x3e04be62
.long 0x3e3ebe6d,0xbe7d3d95,0xbe2cbdc4,0xbd163e75,0x3e2c3dc4,0x3d16be75,0x3e3ebe6d,0xbe7d3d95
.long 0xbe80be6d,0xbe4ebe75,0xbc49bdc4,0x3e183d95,0xbc49bdc4,0x3e183d95,0x3e803e6d,0x3e4e3e75
.long 0x3e713e6d,0xbd793df1,0xbdac3dc4,0xbe78be62,0xbdac3dc4,0xbe78be62,0xbe71be6d,0x3d79bdf1
.long 0xbc49be6d,0xbe183e75,0x3e80bdc4,0xbe4ebd95,0x3e80bdc4,0xbe4ebd95,0x3c493e6d,0x3e18be75
.long 0xbdac3e6d,0x3e78bdf1,0xbe713dc4,0xbd793e62,0xbe713dc4,0xbd793e62,0x3dacbe6d,0xbe783df1
.long 0x3e4e3e55,0x3e3e3e46,0x3e183e0e,0x3e2c3e22,0xbe18be0e,0xbe2cbe22,0x3e4e3e55,0x3e3e3e46
.long 0x3e5c3e0e,0x3e713e7f,0xbe04be55,0x3dacbcc9,0x3e043e55,0xbdac3cc9,0x3e5c3e0e,0x3e713e7f
.long 0xbe183e55,0x3e2cbe46,0x3e4e3e0e,0xbe3ebe22,0xbe4ebe0e,0x3e3e3e22,0xbe183e55,0x3e2cbe46
.long 0x3e043e0e,0x3dacbe7f,0x3e5cbe55,0xbe713cc9,0xbe5c3e55,0x3e71bcc9,0x3e043e0e,0x3dacbe7f
.long 0xbd79be0e,0x3ddb3cc9,0x3e783e55,0x3e673e7f,0x3e783e55,0x3e673e7f,0x3d793e0e,0xbddbbcc9
.long 0xbe7dbe55,0x3c49be22,0x3d16be0e,0x3e803e46,0x3d16be0e,0x3e803e46,0x3e7d3e55,0xbc493e22
.long 0x3e78be0e,0xbe67bcc9,0x3d793e55,0x3ddbbe7f,0x3d793e55,0x3ddbbe7f,0xbe783e0e,0x3e673cc9
.long 0x3d16be55,0xbe803e22,0x3e7dbe0e,0x3c49be46,0x3e7dbe0e,0x3c49be46,0xbd163e55,0x3e80be22
.long 0x3e2c3e80,0xbe4ebcc9,0x3e3e0000,0x3e183e7f,0xbe3e0000,0xbe18be7f,0x3e2c3e80,0xbe4ebcc9
.long 0x3dac3e80,0xbe5cbe46,0x3e710000,0xbe043e22,0xbe710000,0x3e04be22,0x3dac3e80,0xbe5cbe46
.long 0xbe3e3e80,0x3e183cc9,0x3e2c0000,0x3e4ebe7f,0xbe2c0000,0xbe4e3e7f,0xbe3e3e80,0x3e183cc9
.long 0xbe713e80,0xbe043e46,0x3dac0000,0x3e5cbe22,0xbdac0000,0xbe5c3e22,0xbe713e80,0xbe043e46
.long 0x3ddb3e80,0xbe78be22,0xbe670000,0x3d79be46,0xbe670000,0x3d79be46,0xbddbbe80,0x3e783e22
.long 0x3c493e80,0xbd16be7f,0xbe800000,0x3e7dbcc9,0xbe800000,0x3e7dbcc9,0xbc49be80,0x3d163e7f
.long 0xbe673e80,0xbd793e22,0xbddb0000,0xbe783e46,0xbddb0000,0xbe783e46,0x3e67be80,0x3d79be22
.long 0xbe803e80,0xbe7d3e7f,0xbc490000,0xbd163cc9,0xbc490000,0xbd163cc9,0x3e80be80,0x3e7dbe7f
.long 0xbe04be7b,0x3e673d95,0xbe5cbd48,0xbddbbe75,0x3e5c3d48,0x3ddb3e75,0xbe04be7b,0x3e673d95
.long 0x3e7d3d48,0xbe2c3df1,0xbd16be7b,0x3e3e3e62,0x3d163e7b,0xbe3ebe62,0x3e7d3d48,0xbe2c3df1
.long 0x3e5cbe7b,0xbddbbd95,0xbe04bd48,0xbe673e75,0x3e043d48,0x3e67be75,0x3e5cbe7b,0xbddbbd95
.long 0x3d163d48,0x3e3ebdf1,0x3e7dbe7b,0x3e2cbe62,0xbe7d3e7b,0xbe2c3e62,0x3d163d48,0x3e3ebdf1
.long 0x3e4ebd48,0xbc493e62,0x3e183e7b,0xbe80bdf1,0x3e183e7b,0xbe80bdf1,0xbe4e3d48,0x3c49be62
.long 0x3d793e7b,0xbdacbe75,0xbe783d48,0x3e71bd95,0xbe783d48,0x3e71bd95,0xbd79be7b,0x3dac3e75
.long 0x3e18bd48,0x3e80be62,0xbe4e3e7b,0xbc493df1,0xbe4e3e7b,0xbc493df1,0xbe183d48,0xbe803e62
.long 0xbe783e7b,0xbe713e75,0xbd793d48,0xbdac3d95,0xbd793d48,0xbdac3d95,0x3e78be7b,0x3e71be75
.long 0x3dac3e6d,0xbe78bdf1,0x3e713dc4,0x3d793e62,0xbe71bdc4,0xbd79be62,0x3dac3e6d,0xbe78bdf1
.long 0x3c49be6d,0x3e183e75,0xbe80bdc4,0x3e4ebd95,0x3e803dc4,0xbe4e3d95,0x3c49be6d,0x3e183e75
.long 0xbe713e6d,0x3d793df1,0x3dac3dc4,0x3e78be62,0xbdacbdc4,0xbe783e62,0xbe713e6d,0x3d793df1
.long 0x3e80be6d,0x3e4ebe75,0x3c49bdc4,0xbe183d95,0xbc493dc4,0x3e18bd95,0x3e80be6d,0x3e4ebe75
.long 0xbe3ebe6d,0x3e7d3d95,0x3e2cbdc4,0x3d163e75,0x3e2cbdc4,0x3d163e75,0x3e3e3e6d,0xbe7dbd95
.long 0x3ddb3e6d,0xbe04be62,0xbe673dc4,0x3e5cbdf1,0xbe673dc4,0x3e5cbdf1,0xbddbbe6d,0x3e043e62
.long 0x3e2cbe6d,0xbd16bd95,0x3e3ebdc4,0x3e7dbe75,0x3e3ebdc4,0x3e7dbe75,0xbe2c3e6d,0x3d163d95
.long 0xbe673e6d,0xbe5c3e62,0xbddb3dc4,0xbe043df1,0xbddb3dc4,0xbe043df1,0x3e67be6d,0x3e5cbe62
.long 0xbd16be55,0x3e803e22,0xbe7dbe0e,0xbc49be46,0x3e7d3e0e,0x3c493e46,0xbd16be55,0x3e803e22
.long 0xbe78be0e,0x3e67bcc9,0xbd793e55,0xbddbbe7f,0x3d79be55,0x3ddb3e7f,0xbe78be0e,0x3e67bcc9
.long 0x3e7dbe55,0xbc49be22,0xbd16be0e,0xbe803e46,0x3d163e0e,0x3e80be46,0x3e7dbe55,0xbc49be22
.long 0x3d79be0e,0xbddb3cc9,0xbe783e55,0xbe673e7f,0x3e78be55,0x3e67be7f,0x3d79be0e,0xbddb3cc9
.long 0xbe043e0e,0xbdacbe7f,0xbe5cbe55,0x3e713cc9,0xbe5cbe55,0x3e713cc9,0x3e04be0e,0x3dac3e7f
.long 0x3e183e55,0xbe2cbe46,0xbe4e3e0e,0x3e3ebe22,0xbe4e3e0e,0x3e3ebe22,0xbe18be55,0x3e2c3e46
.long 0xbe5c3e0e,0xbe713e7f,0x3e04be55,0xbdacbcc9,0x3e04be55,0xbdacbcc9,0x3e5cbe0e,0x3e71be7f
.long 0xbe4e3e55,0xbe3e3e46,0xbe183e0e,0xbe2c3e22,0xbe183e0e,0xbe2c3e22,0x3e4ebe55,0x3e3ebe46
.long 0x3e803e80,0x3e7c3e7e,0x3c710000,0x3d343cf1,0xbc710000,0xbd34bcf1,0x3e803e80,0x3e7c3e7e
.long 0x3e663e80,0x3d5b3e1e,0x3ddf0000,0x3e7a3e49,0xbddf0000,0xbe7abe49,0x3e663e80,0x3d5b3e1e
.long 0xbc713e80,0x3d34be7e,0x3e800000,0xbe7cbcf1,0xbe800000,0x3e7c3cf1,0xbc713e80,0x3d34be7e
.long 0xbddf3e80,0x3e7abe1e,0x3e660000,0xbd5bbe49,0xbe660000,0x3d5b3e49,0xbddf3e80,0x3e7abe1e
.long 0x3e723e80,0x3e0a3e49,0xbda80000,0xbe58be1e,0xbda80000,0xbe58be1e,0xbe72be80,0xbe0abe49
.long 0x3e3f3e80,0xbe123cf1,0xbe2a0000,0xbe52be7e,0xbe2a0000,0xbe52be7e,0xbe3fbe80,0x3e12bcf1
.long 0xbda83e80,0x3e58be49,0xbe720000,0x3e0a3e1e,0xbe720000,0x3e0a3e1e,0x3da8be80,0xbe583e49
.long 0xbe2a3e80,0x3e52bcf1,0xbe3f0000,0xbe123e7e,0xbe3f0000,0xbe123e7e,0x3e2abe80,0xbe523cf1
.long 0x3e753e79,0x3e6b3e70,0x3d953d6f,0x3dcd3db1,0xbd95bd6f,0xbdcdbdb1,0x3e753e79,0x3e6b3e70
.long 0xbe22bd6f,0xbe80be68,0x3e463e79,0xbba13dd6,0xbe46be79,0x3ba1bdd6,0xbe22bd6f,0xbe80be68
.long 0xbd953e79,0x3dcdbe70,0x3e753d6f,0xbe6bbdb1,0xbe75bd6f,0x3e6b3db1,0xbd953e79,0x3dcdbe70
.long 0xbe46bd6f,0xbba13e68,0xbe223e79,0x3e80bdd6,0x3e22be79,0xbe803dd6,0xbe46bd6f,0xbba13e68
.long 0xbcc93d6f,0xbe31bdd6,0xbe7fbe79,0xbe39be68,0xbe7fbe79,0xbe39be68,0x3cc9bd6f,0x3e313dd6
.long 0xbe62be79,0x3dbbbdb1,0x3df1bd6f,0x3e6e3e70,0x3df1bd6f,0x3e6e3e70,0x3e623e79,0xbdbb3db1
.long 0xbe7f3d6f,0x3e393dd6,0x3cc9be79,0xbe313e68,0x3cc9be79,0xbe313e68,0x3e7fbd6f,0xbe39bdd6
.long 0x3df1be79,0xbe6e3db1,0x3e62bd6f,0x3dbbbe70,0x3e62bd6f,0x3dbbbe70,0xbdf13e79,0x3e6ebdb1
.long 0x3e5d3e64,0x3e4c3e55,0x3e013de8,0x3e1b3e0e,0xbe01bde8,0xbe1bbe0e,0x3e5d3e64,0x3e4c3e55
.long 0xbe1bbe64,0x3d81bd48,0xbe4cbde8,0xbe78be7b,0x3e4c3de8,0x3e783e7b,0xbe1bbe64,0x3d81bd48
.long 0xbe013e64,0x3e1bbe55,0x3e5d3de8,0xbe4cbe0e,0xbe5dbde8,0x3e4c3e0e,0xbe013e64,0x3e1bbe55
.long 0x3e4cbe64,0xbe783d48,0xbe1bbde8,0xbd813e7b,0x3e1b3de8,0x3d81be7b,0x3e4cbe64,0xbe783d48
.long 0xbe7ebe64,0xbe5dbe7b,0xbd0cbde8,0x3e013d48,0xbd0cbde8,0x3e013d48,0x3e7e3e64,0x3e5d3e7b
.long 0x3e783e64,0xbd0c3e0e,0xbd813de8,0xbe7ebe55,0xbd813de8,0xbe7ebe55,0xbe78be64,0x3d0cbe0e
.long 0xbd0cbe64,0xbe013e7b,0x3e7ebde8,0xbe5dbd48,0x3e7ebde8,0xbe5dbd48,0x3d0c3e64,0x3e01be7b
.long 0xbd813e64,0x3e7ebe0e,0xbe783de8,0xbd0c3e55,0xbe783de8,0xbd0c3e55,0x3d81be64,0xbe7e3e0e
.long 0x3e393e43,0x3e223e2e,0x3e313e26,0x3e463e3c,0xbe31be26,0xbe46be3c,0x3e393e43,0x3e223e2e
.long 0x3e6b3e26,0x3e623e80,0xbdcdbe43,0x3df13c21,0x3dcd3e43,0xbdf1bc21,0x3e6b3e26,0x3e623e80
.long 0xbe313e43,0x3e46be2e,0x3e393e26,0xbe22be3c,0xbe39be26,0x3e223e3c,0xbe313e43,0x3e46be2e
.long 0x3dcd3e26,0x3df1be80,0x3e6bbe43,0xbe62bc21,0xbe6b3e43,0x3e623c21,0x3dcd3e26,0x3df1be80
.long 0xbdbbbe26,0x3d95bc21,0x3e6e3e43,0x3e753e80,0x3e6e3e43,0x3e753e80,0x3dbb3e26,0xbd953c21
.long 0xbe80be43,0xbcc9be3c,0x3ba1be26,0x3e7f3e2e,0x3ba1be26,0x3e7f3e2e,0x3e803e43,0x3cc93e3c
.long 0x3e6ebe26,0xbe753c21,0x3dbb3e43,0x3d95be80,0x3dbb3e43,0x3d95be80,0xbe6e3e26,0x3e75bc21
.long 0x3ba1be43,0xbe7f3e3c,0x3e80be26,0xbcc9be2e,0x3e80be26,0xbcc9be2e,0xbba13e43,0x3e7fbe3c
.long 0x3e2a3e80,0xbe52bcf1,0x3e3f0000,0x3e123e7e,0xbe3f0000,0xbe12be7e,0x3e2a3e80,0xbe52bcf1
.long 0x3da83e80,0xbe58be49,0x3e720000,0xbe0a3e1e,0xbe720000,0x3e0abe1e,0x3da83e80,0xbe58be49
.long 0xbe3f3e80,0x3e123cf1,0x3e2a0000,0x3e52be7e,0xbe2a0000,0xbe523e7e,0xbe3f3e80,0x3e123cf1
.long 0xbe723e80,0xbe0a3e49,0x3da80000,0x3e58be1e,0xbda80000,0xbe583e1e,0xbe723e80,0xbe0a3e49
.long 0x3ddf3e80,0xbe7abe1e,0xbe660000,0x3d5bbe49,0xbe660000,0x3d5bbe49,0xbddfbe80,0x3e7a3e1e
.long 0x3c713e80,0xbd34be7e,0xbe800000,0x3e7cbcf1,0xbe800000,0x3e7cbcf1,0xbc71be80,0x3d343e7e
.long 0xbe663e80,0xbd5b3e1e,0xbddf0000,0xbe7a3e49,0xbddf0000,0xbe7a3e49,0x3e66be80,0x3d5bbe1e
.long 0xbe803e80,0xbe7c3e7e,0xbc710000,0xbd343cf1,0xbc710000,0xbd343cf1,0x3e80be80,0x3e7cbe7e
.long 0xbdf1be79,0x3e6e3db1,0xbe62bd6f,0xbdbbbe70,0x3e623d6f,0x3dbb3e70,0xbdf1be79,0x3e6e3db1
.long 0x3e7f3d6f,0xbe393dd6,0xbcc9be79,0x3e313e68,0x3cc93e79,0xbe31be68,0x3e7f3d6f,0xbe393dd6
.long 0x3e62be79,0xbdbbbdb1,0xbdf1bd6f,0xbe6e3e70,0x3df13d6f,0x3e6ebe70,0x3e62be79,0xbdbbbdb1
.long 0x3cc93d6f,0x3e31bdd6,0x3e7fbe79,0x3e39be68,0xbe7f3e79,0xbe393e68,0x3cc93d6f,0x3e31bdd6
.long 0x3e46bd6f,0x3ba13e68,0x3e223e79,0xbe80bdd6,0x3e223e79,0xbe80bdd6,0xbe463d6f,0xbba1be68
.long 0x3d953e79,0xbdcdbe70,0xbe753d6f,0x3e6bbdb1,0xbe753d6f,0x3e6bbdb1,0xbd95be79,0x3dcd3e70
.long 0x3e22bd6f,0x3e80be68,0xbe463e79,0x3ba13dd6,0xbe463e79,0x3ba13dd6,0xbe223d6f,0xbe803e68
.long 0xbe753e79,0xbe6b3e70,0xbd953d6f,0xbdcd3db1,0xbd953d6f,0xbdcd3db1,0x3e75be79,0x3e6bbe70
.long 0x3d813e64,0xbe7ebe0e,0x3e783de8,0x3d0c3e55,0xbe78bde8,0xbd0cbe55,0x3d813e64,0xbe7ebe0e
.long 0x3d0cbe64,0x3e013e7b,0xbe7ebde8,0x3e5dbd48,0x3e7e3de8,0xbe5d3d48,0x3d0cbe64,0x3e013e7b
.long 0xbe783e64,0x3d0c3e0e,0x3d813de8,0x3e7ebe55,0xbd81bde8,0xbe7e3e55,0xbe783e64,0x3d0c3e0e
.long 0x3e7ebe64,0x3e5dbe7b,0x3d0cbde8,0xbe013d48,0xbd0c3de8,0x3e01bd48,0x3e7ebe64,0x3e5dbe7b
.long 0xbe4cbe64,0x3e783d48,0x3e1bbde8,0x3d813e7b,0x3e1bbde8,0x3d813e7b,0x3e4c3e64,0xbe78bd48
.long 0x3e013e64,0xbe1bbe55,0xbe5d3de8,0x3e4cbe0e,0xbe5d3de8,0x3e4cbe0e,0xbe01be64,0x3e1b3e55
.long 0x3e1bbe64,0xbd81bd48,0x3e4cbde8,0x3e78be7b,0x3e4cbde8,0x3e78be7b,0xbe1b3e64,0x3d813d48
.long 0xbe5d3e64,0xbe4c3e55,0xbe013de8,0xbe1b3e0e,0xbe013de8,0xbe1b3e0e,0x3e5dbe64,0x3e4cbe55
.long 0xbba1be43,0x3e7f3e3c,0xbe80be26,0x3cc9be2e,0x3e803e26,0xbcc93e2e,0xbba1be43,0x3e7f3e3c
.long 0xbe6ebe26,0x3e753c21,0xbdbb3e43,0xbd95be80,0x3dbbbe43,0x3d953e80,0xbe6ebe26,0x3e753c21
.long 0x3e80be43,0x3cc9be3c,0xbba1be26,0xbe7f3e2e,0x3ba13e26,0x3e7fbe2e,0x3e80be43,0x3cc9be3c
.long 0x3dbbbe26,0xbd95bc21,0xbe6e3e43,0xbe753e80,0x3e6ebe43,0x3e75be80,0x3dbbbe26,0xbd95bc21
.long 0xbdcd3e26,0xbdf1be80,0xbe6bbe43,0x3e62bc21,0xbe6bbe43,0x3e62bc21,0x3dcdbe26,0x3df13e80
.long 0x3e313e43,0xbe46be2e,0xbe393e26,0x3e22be3c,0xbe393e26,0x3e22be3c,0xbe31be43,0x3e463e2e
.long 0xbe6b3e26,0xbe623e80,0x3dcdbe43,0xbdf13c21,0x3dcdbe43,0xbdf13c21,0x3e6bbe26,0x3e62be80
.long 0xbe393e43,0xbe223e2e,0xbe313e26,0xbe463e3c,0xbe313e26,0xbe463e3c,0x3e39be43,0x3e22be2e
.long 0x3e7f3e80,0x3e7b3e7e,0x3c8d0000,0x3d523d0c,0xbc8d0000,0xbd52bd0c,0x3e7f3e80,0x3e7b3e7e
.long 0x3e653e80,0x3d3e3e1b,0x3de40000,0x3e7c3e4c,0xbde40000,0xbe7cbe4c,0x3e653e80,0x3d3e3e1b
.long 0xbc8d3e80,0x3d52be7e,0x3e7f0000,0xbe7bbd0c,0xbe7f0000,0x3e7b3d0c,0xbc8d3e80,0x3d52be7e
.long 0xbde43e80,0x3e7cbe1b,0x3e650000,0xbd3ebe4c,0xbe650000,0x3d3e3e4c,0xbde43e80,0x3e7cbe1b
.long 0x3e733e80,0x3e103e4c,0xbda30000,0xbe53be1b,0xbda30000,0xbe53be1b,0xbe73be80,0xbe10be4c
.long 0x3e413e80,0xbe0c3d0c,0xbe280000,0xbe56be7e,0xbe280000,0xbe56be7e,0xbe41be80,0x3e0cbd0c
.long 0xbda33e80,0x3e53be4c,0xbe730000,0x3e103e1b,0xbe730000,0x3e103e1b,0x3da3be80,0xbe533e4c
.long 0xbe283e80,0x3e56bd0c,0xbe410000,0xbe0c3e7e,0xbe410000,0xbe0c3e7e,0x3e28be80,0xbe563d0c
.long 0x3e713e76,0x3e633e6b,0x3dac3d8b,0x3ded3dcd,0xbdacbd8b,0xbdedbdcd,0x3e713e76,0x3e633e6b
.long 0xbe2cbd8b,0xbe7fbe6e,0x3e3e3e76,0xbcb53dbb,0xbe3ebe76,0x3cb5bdbb,0xbe2cbd8b,0xbe7fbe6e
.long 0xbdac3e76,0x3dedbe6b,0x3e713d8b,0xbe63bdcd,0xbe71bd8b,0x3e633dcd,0xbdac3e76,0x3dedbe6b
.long 0xbe3ebd8b,0xbcb53e6e,0xbe2c3e76,0x3e7fbdbb,0x3e2cbe76,0xbe7f3dbb,0xbe3ebd8b,0xbcb53e6e
.long 0xbc493d8b,0xbe24bdbb,0xbe80be76,0xbe44be6e,0xbe80be76,0xbe44be6e,0x3c49bd8b,0x3e243dbb
.long 0xbe67be76,0x3d99bdcd,0x3ddbbd8b,0x3e743e6b,0x3ddbbd8b,0x3e743e6b,0x3e673e76,0xbd993dcd
.long 0xbe803d8b,0x3e443dbb,0x3c49be76,0xbe243e6e,0x3c49be76,0xbe243e6e,0x3e80bd8b,0xbe44bdbb
.long 0x3ddbbe76,0xbe743dcd,0x3e67bd8b,0x3d99be6b,0x3e67bd8b,0x3d99be6b,0xbddb3e76,0x3e74bdcd
.long 0x3e513e5a,0x3e3a3e46,0x3e143e06,0x3e303e22,0xbe14be06,0xbe30be22,0x3e513e5a,0x3e3a3e46
.long 0xbe08be5a,0x3db6bcc9,0xbe59be06,0xbe6fbe7f,0x3e593e06,0x3e6f3e7f,0xbe08be5a,0x3db6bcc9
.long 0xbe143e5a,0x3e30be46,0x3e513e06,0xbe3abe22,0xbe51be06,0x3e3a3e22,0xbe143e5a,0x3e30be46
.long 0x3e59be5a,0xbe6f3cc9,0xbe08be06,0xbdb63e7f,0x3e083e06,0x3db6be7f,0x3e59be5a,0xbe6f3cc9
.long 0xbe7abe5a,0xbe6abe7f,0xbd65be06,0x3dd23cc9,0xbd65be06,0x3dd23cc9,0x3e7a3e5a,0x3e6a3e7f
.long 0x3e7c3e5a,0xbbf13e22,0xbd2a3e06,0xbe80be46,0xbd2a3e06,0xbe80be46,0xbe7cbe5a,0x3bf1be22
.long 0xbd65be5a,0xbdd23e7f,0x3e7abe06,0xbe6abcc9,0x3e7abe06,0xbe6abcc9,0x3d653e5a,0x3dd2be7f
.long 0xbd2a3e5a,0x3e80be22,0xbe7c3e06,0xbbf13e46,0xbe7c3e06,0xbbf13e46,0x3d2abe5a,0xbe803e22
.long 0x3e203e2e,0x3e043e12,0x3e473e3c,0x3e5c3e52,0xbe47be3c,0xbe5cbe52,0x3e203e2e,0x3e043e12
.long 0x3e763e3c,0x3e4e3e7c,0xbd90be2e,0x3e183d34,0x3d903e2e,0xbe18bd34,0x3e763e3c,0x3e4e3e7c
.long 0xbe473e2e,0x3e5cbe12,0x3e203e3c,0xbe04be52,0xbe20be3c,0x3e043e52,0xbe473e2e,0x3e5cbe12
.long 0x3d903e3c,0x3e18be7c,0x3e76be2e,0xbe4ebd34,0xbe763e2e,0x3e4e3d34,0x3d903e3c,0x3e18be7c
.long 0xbdf6be3c,0x3d16bd34,0x3e613e2e,0x3e7d3e7c,0x3e613e2e,0x3e7d3e7c,0x3df63e3c,0xbd163d34
.long 0xbe7fbe2e,0xbd79be52,0xbcddbe3c,0x3e783e12,0xbcddbe3c,0x3e783e12,0x3e7f3e2e,0x3d793e52
.long 0x3e61be3c,0xbe7d3d34,0x3df63e2e,0x3d16be7c,0x3df63e2e,0x3d16be7c,0xbe613e3c,0x3e7dbd34
.long 0xbcddbe2e,0xbe783e52,0x3e7fbe3c,0xbd79be12,0x3e7fbe3c,0xbd79be12,0x3cdd3e2e,0x3e78be52
.long 0x3e283e80,0xbe56bd0c,0x3e410000,0x3e0c3e7e,0xbe410000,0xbe0cbe7e,0x3e283e80,0xbe56bd0c
.long 0x3da33e80,0xbe53be4c,0x3e730000,0xbe103e1b,0xbe730000,0x3e10be1b,0x3da33e80,0xbe53be4c
.long 0xbe413e80,0x3e0c3d0c,0x3e280000,0x3e56be7e,0xbe280000,0xbe563e7e,0xbe413e80,0x3e0c3d0c
.long 0xbe733e80,0xbe103e4c,0x3da30000,0x3e53be1b,0xbda30000,0xbe533e1b,0xbe733e80,0xbe103e4c
.long 0x3de43e80,0xbe7cbe1b,0xbe650000,0x3d3ebe4c,0xbe650000,0x3d3ebe4c,0xbde4be80,0x3e7c3e1b
.long 0x3c8d3e80,0xbd52be7e,0xbe7f0000,0x3e7bbd0c,0xbe7f0000,0x3e7bbd0c,0xbc8dbe80,0x3d523e7e
.long 0xbe653e80,0xbd3e3e1b,0xbde40000,0xbe7c3e4c,0xbde40000,0xbe7c3e4c,0x3e65be80,0x3d3ebe1b
.long 0xbe7f3e80,0xbe7b3e7e,0xbc8d0000,0xbd523d0c,0xbc8d0000,0xbd523d0c,0x3e7fbe80,0x3e7bbe7e
.long 0xbddbbe76,0x3e743dcd,0xbe67bd8b,0xbd99be6b,0x3e673d8b,0x3d993e6b,0xbddbbe76,0x3e743dcd
.long 0x3e803d8b,0xbe443dbb,0xbc49be76,0x3e243e6e,0x3c493e76,0xbe24be6e,0x3e803d8b,0xbe443dbb
.long 0x3e67be76,0xbd99bdcd,0xbddbbd8b,0xbe743e6b,0x3ddb3d8b,0x3e74be6b,0x3e67be76,0xbd99bdcd
.long 0x3c493d8b,0x3e24bdbb,0x3e80be76,0x3e44be6e,0xbe803e76,0xbe443e6e,0x3c493d8b,0x3e24bdbb
.long 0x3e3ebd8b,0x3cb53e6e,0x3e2c3e76,0xbe7fbdbb,0x3e2c3e76,0xbe7fbdbb,0xbe3e3d8b,0xbcb5be6e
.long 0x3dac3e76,0xbdedbe6b,0xbe713d8b,0x3e63bdcd,0xbe713d8b,0x3e63bdcd,0xbdacbe76,0x3ded3e6b
.long 0x3e2cbd8b,0x3e7fbe6e,0xbe3e3e76,0x3cb53dbb,0xbe3e3e76,0x3cb53dbb,0xbe2c3d8b,0xbe7f3e6e
.long 0xbe713e76,0xbe633e6b,0xbdac3d8b,0xbded3dcd,0xbdac3d8b,0xbded3dcd,0x3e71be76,0x3e63be6b
.long 0x3d2a3e5a,0xbe80be22,0x3e7c3e06,0x3bf13e46,0xbe7cbe06,0xbbf1be46,0x3d2a3e5a,0xbe80be22
.long 0x3d65be5a,0x3dd23e7f,0xbe7abe06,0x3e6abcc9,0x3e7a3e06,0xbe6a3cc9,0x3d65be5a,0x3dd23e7f
.long 0xbe7c3e5a,0x3bf13e22,0x3d2a3e06,0x3e80be46,0xbd2abe06,0xbe803e46,0xbe7c3e5a,0x3bf13e22
.long 0x3e7abe5a,0x3e6abe7f,0x3d65be06,0xbdd23cc9,0xbd653e06,0x3dd2bcc9,0x3e7abe5a,0x3e6abe7f
.long 0xbe59be5a,0x3e6f3cc9,0x3e08be06,0x3db63e7f,0x3e08be06,0x3db63e7f,0x3e593e5a,0xbe6fbcc9
.long 0x3e143e5a,0xbe30be46,0xbe513e06,0x3e3abe22,0xbe513e06,0x3e3abe22,0xbe14be5a,0x3e303e46
.long 0x3e08be5a,0xbdb6bcc9,0x3e59be06,0x3e6fbe7f,0x3e59be06,0x3e6fbe7f,0xbe083e5a,0x3db63cc9
.long 0xbe513e5a,0xbe3a3e46,0xbe143e06,0xbe303e22,0xbe143e06,0xbe303e22,0x3e51be5a,0x3e3abe46
.long 0x3cddbe2e,0x3e783e52,0xbe7fbe3c,0x3d79be12,0x3e7f3e3c,0xbd793e12,0x3cddbe2e,0x3e783e52
.long 0xbe61be3c,0x3e7d3d34,0xbdf63e2e,0xbd16be7c,0x3df6be2e,0x3d163e7c,0xbe61be3c,0x3e7d3d34
.long 0x3e7fbe2e,0x3d79be52,0x3cddbe3c,0xbe783e12,0xbcdd3e3c,0x3e78be12,0x3e7fbe2e,0x3d79be52
.long 0x3df6be3c,0xbd16bd34,0xbe613e2e,0xbe7d3e7c,0x3e61be2e,0x3e7dbe7c,0x3df6be3c,0xbd16bd34
.long 0xbd903e3c,0xbe18be7c,0xbe76be2e,0x3e4ebd34,0xbe76be2e,0x3e4ebd34,0x3d90be3c,0x3e183e7c
.long 0x3e473e2e,0xbe5cbe12,0xbe203e3c,0x3e04be52,0xbe203e3c,0x3e04be52,0xbe47be2e,0x3e5c3e12
.long 0xbe763e3c,0xbe4e3e7c,0x3d90be2e,0xbe183d34,0x3d90be2e,0xbe183d34,0x3e76be3c,0x3e4ebe7c
.long 0xbe203e2e,0xbe043e12,0xbe473e3c,0xbe5c3e52,0xbe473e3c,0xbe5c3e52,0x3e20be2e,0x3e04be12
.long 0x3e7f3e80,0x3e793e7d,0x3ca10000,0x3d6f3d20,0xbca10000,0xbd6fbd20,0x3e7f3e80,0x3e793e7d
.long 0x3e643e80,0x3d203e16,0x3de80000,0x3e7d3e4f,0xbde80000,0xbe7dbe4f,0x3e643e80,0x3d203e16
.long 0xbca13e80,0x3d6fbe7d,0x3e7f0000,0xbe79bd20,0xbe7f0000,0x3e793d20,0xbca13e80,0x3d6fbe7d
.long 0xbde83e80,0x3e7dbe16,0x3e640000,0xbd20be4f,0xbe640000,0x3d203e4f,0xbde83e80,0x3e7dbe16
.long 0x3e733e80,0x3e163e4f,0xbd9e0000,0xbe4fbe16,0xbd9e0000,0xbe4fbe16,0xbe73be80,0xbe16be4f
.long 0x3e433e80,0xbe063d20,0xbe260000,0xbe5abe7d,0xbe260000,0xbe5abe7d,0xbe43be80,0x3e06bd20
.long 0xbd9e3e80,0x3e4fbe4f,0xbe730000,0x3e163e16,0xbe730000,0x3e163e16,0x3d9ebe80,0xbe4f3e4f
.long 0xbe263e80,0x3e5abd20,0xbe430000,0xbe063e7d,0xbe430000,0xbe063e7d,0x3e26be80,0xbe5a3d20
.long 0x3e6d3e73,0x3e5a3e64,0x3dc43d9e,0x3e063de8,0xbdc4bd9e,0xbe06bde8,0x3e6d3e73,0x3e5a3e64
.long 0xbe35bd9e,0xbe7dbe73,0x3e353e73,0xbd203d9e,0xbe35be73,0x3d20bd9e,0xbe35bd9e,0xbe7dbe73
.long 0xbdc43e73,0x3e06be64,0x3e6d3d9e,0xbe5abde8,0xbe6dbd9e,0x3e5a3de8,0xbdc43e73,0x3e06be64
.long 0xbe35bd9e,0xbd203e73,0xbe353e73,0x3e7dbd9e,0x3e35be73,0xbe7d3d9e,0xbe35bd9e,0xbd203e73
.long 0x3d9e,0xbe16bd9e,0xbe80be73,0xbe4fbe73,0xbe80be73,0xbe4fbe73,0xbd9e,0x3e163d9e
.long 0xbe6dbe73,0x3d6fbde8,0x3dc4bd9e,0x3e793e64,0x3dc4bd9e,0x3e793e64,0x3e6d3e73,0xbd6f3de8
.long 0xbe803d9e,0x3e4f3d9e,0xbe73,0xbe163e73,0xbe73,0xbe163e73,0x3e80bd9e,0xbe4fbd9e
.long 0x3dc4be73,0xbe793de8,0x3e6dbd9e,0x3d6fbe64,0x3e6dbd9e,0x3d6fbe64,0xbdc43e73,0x3e79bde8
.long 0x3e433e4f,0x3e263e35,0x3e263e16,0x3e433e35,0xbe26be16,0xbe43be35,0x3e433e4f,0x3e263e35
.long 0xbde8be4f,0x3de80000,0xbe64be16,0xbe64be80,0x3e643e16,0x3e643e80,0xbde8be4f,0x3de80000
.long 0xbe263e4f,0x3e43be35,0x3e433e16,0xbe26be35,0xbe43be16,0x3e263e35,0xbe263e4f,0x3e43be35
.long 0x3e64be4f,0xbe640000,0xbde8be16,0xbde83e80,0x3de83e16,0x3de8be80,0x3e64be4f,0xbe640000
.long 0xbe73be4f,0xbe73be80,0xbd9ebe16,0x3d9e0000,0xbd9ebe16,0x3d9e0000,0x3e733e4f,0x3e733e80
.long 0x3e7f3e4f,0x3ca13e35,0xbca13e16,0xbe7fbe35,0xbca13e16,0xbe7fbe35,0xbe7fbe4f,0xbca1be35
.long 0xbd9ebe4f,0xbd9e3e80,0x3e73be16,0xbe730000,0x3e73be16,0xbe730000,0x3d9e3e4f,0x3d9ebe80
.long 0xbca13e4f,0x3e7fbe35,0xbe7f3e16,0x3ca13e35,0xbe7f3e16,0x3ca13e35,0x3ca1be4f,0xbe7f3e35
.long 0x3e063e16,0x3dc43de8,0x3e5a3e4f,0x3e6d3e64,0xbe5abe4f,0xbe6dbe64,0x3e063e16,0x3dc43de8
.long 0x3e7d3e4f,0x3e353e73,0xbd20be16,0x3e353d9e,0x3d203e16,0xbe35bd9e,0x3e7d3e4f,0x3e353e73
.long 0xbe5a3e16,0x3e6dbde8,0x3e063e4f,0xbdc4be64,0xbe06be4f,0x3dc43e64,0xbe5a3e16,0x3e6dbde8
.long 0x3d203e4f,0x3e35be73,0x3e7dbe16,0xbe35bd9e,0xbe7d3e16,0x3e353d9e,0x3d203e4f,0x3e35be73
.long 0xbe16be4f,0xbd9e,0x3e4f3e16,0x3e803e73,0x3e4f3e16,0x3e803e73,0x3e163e4f,0x3d9e
.long 0xbe79be16,0xbdc4be64,0xbd6fbe4f,0x3e6d3de8,0xbd6fbe4f,0x3e6d3de8,0x3e793e16,0x3dc43e64
.long 0x3e4fbe4f,0xbe803d9e,0x3e163e16,0xbe73,0x3e163e16,0xbe73,0xbe4f3e4f,0x3e80bd9e
.long 0xbd6fbe16,0xbe6d3e64,0x3e79be4f,0xbdc4bde8,0x3e79be4f,0xbdc4bde8,0x3d6f3e16,0x3e6dbe64
.long 0x3e263e80,0xbe5abd20,0x3e430000,0x3e063e7d,0xbe430000,0xbe06be7d,0x3e263e80,0xbe5abd20
.long 0x3d9e3e80,0xbe4fbe4f,0x3e730000,0xbe163e16,0xbe730000,0x3e16be16,0x3d9e3e80,0xbe4fbe4f
.long 0xbe433e80,0x3e063d20,0x3e260000,0x3e5abe7d,0xbe260000,0xbe5a3e7d,0xbe433e80,0x3e063d20
.long 0xbe733e80,0xbe163e4f,0x3d9e0000,0x3e4fbe16,0xbd9e0000,0xbe4f3e16,0xbe733e80,0xbe163e4f
.long 0x3de83e80,0xbe7dbe16,0xbe640000,0x3d20be4f,0xbe640000,0x3d20be4f,0xbde8be80,0x3e7d3e16
.long 0x3ca13e80,0xbd6fbe7d,0xbe7f0000,0x3e79bd20,0xbe7f0000,0x3e79bd20,0xbca1be80,0x3d6f3e7d
.long 0xbe643e80,0xbd203e16,0xbde80000,0xbe7d3e4f,0xbde80000,0xbe7d3e4f,0x3e64be80,0x3d20be16
.long 0xbe7f3e80,0xbe793e7d,0xbca10000,0xbd6f3d20,0xbca10000,0xbd6f3d20,0x3e7fbe80,0x3e79be7d
.long 0xbdc4be73,0x3e793de8,0xbe6dbd9e,0xbd6fbe64,0x3e6d3d9e,0x3d6f3e64,0xbdc4be73,0x3e793de8
.long 0x3e803d9e,0xbe4f3d9e,0xbe73,0x3e163e73,0x3e73,0xbe16be73,0x3e803d9e,0xbe4f3d9e
.long 0x3e6dbe73,0xbd6fbde8,0xbdc4bd9e,0xbe793e64,0x3dc43d9e,0x3e79be64,0x3e6dbe73,0xbd6fbde8
.long 0x3d9e,0x3e16bd9e,0x3e80be73,0x3e4fbe73,0xbe803e73,0xbe4f3e73,0x3d9e,0x3e16bd9e
.long 0x3e35bd9e,0x3d203e73,0x3e353e73,0xbe7dbd9e,0x3e353e73,0xbe7dbd9e,0xbe353d9e,0xbd20be73
.long 0x3dc43e73,0xbe06be64,0xbe6d3d9e,0x3e5abde8,0xbe6d3d9e,0x3e5abde8,0xbdc4be73,0x3e063e64
.long 0x3e35bd9e,0x3e7dbe73,0xbe353e73,0x3d203d9e,0xbe353e73,0x3d203d9e,0xbe353d9e,0xbe7d3e73
.long 0xbe6d3e73,0xbe5a3e64,0xbdc43d9e,0xbe063de8,0xbdc43d9e,0xbe063de8,0x3e6dbe73,0x3e5abe64
.long 0x3ca13e4f,0xbe7fbe35,0x3e7f3e16,0xbca13e35,0xbe7fbe16,0x3ca1be35,0x3ca13e4f,0xbe7fbe35
.long 0x3d9ebe4f,0x3d9e3e80,0xbe73be16,0x3e730000,0x3e733e16,0xbe730000,0x3d9ebe4f,0x3d9e3e80
.long 0xbe7f3e4f,0xbca13e35,0x3ca13e16,0x3e7fbe35,0xbca1be16,0xbe7f3e35,0xbe7f3e4f,0xbca13e35
.long 0x3e73be4f,0x3e73be80,0x3d9ebe16,0xbd9e0000,0xbd9e3e16,0x3d9e0000,0x3e73be4f,0x3e73be80
.long 0xbe64be4f,0x3e640000,0x3de8be16,0x3de83e80,0x3de8be16,0x3de83e80,0x3e643e4f,0xbe640000
.long 0x3e263e4f,0xbe43be35,0xbe433e16,0x3e26be35,0xbe433e16,0x3e26be35,0xbe26be4f,0x3e433e35
.long 0x3de8be4f,0xbde80000,0x3e64be16,0x3e64be80,0x3e64be16,0x3e64be80,0xbde83e4f,0x3de80000
.long 0xbe433e4f,0xbe263e35,0xbe263e16,0xbe433e35,0xbe263e16,0xbe433e35,0x3e43be4f,0x3e26be35
.long 0x3d6fbe16,0x3e6d3e64,0xbe79be4f,0x3dc4bde8,0x3e793e4f,0xbdc43de8,0x3d6fbe16,0x3e6d3e64
.long 0xbe4fbe4f,0x3e803d9e,0xbe163e16,0xbe73,0x3e16be16,0x3e73,0xbe4fbe4f,0x3e803d9e
.long 0x3e79be16,0x3dc4be64,0x3d6fbe4f,0xbe6d3de8,0xbd6f3e4f,0x3e6dbde8,0x3e79be16,0x3dc4be64
.long 0x3e16be4f,0xbd9e,0xbe4f3e16,0xbe803e73,0x3e4fbe16,0x3e80be73,0x3e16be4f,0xbd9e
.long 0xbd203e4f,0xbe35be73,0xbe7dbe16,0x3e35bd9e,0xbe7dbe16,0x3e35bd9e,0x3d20be4f,0x3e353e73
.long 0x3e5a3e16,0xbe6dbde8,0xbe063e4f,0x3dc4be64,0xbe063e4f,0x3dc4be64,0xbe5abe16,0x3e6d3de8
.long 0xbe7d3e4f,0xbe353e73,0x3d20be16,0xbe353d9e,0x3d20be16,0xbe353d9e,0x3e7dbe4f,0x3e35be73
.long 0xbe063e16,0xbdc43de8,0xbe5a3e4f,0xbe6d3e64,0xbe5a3e4f,0xbe6d3e64,0x3e06be16,0x3dc4bde8
.long 0x3e7f3e80,0x3e773e7c,0x3cb50000,0x3d863d34,0xbcb50000,0xbd86bd34,0x3e7f3e80,0x3e773e7c
.long 0x3e633e80,0x3d023e12,0x3ded0000,0x3e7e3e52,0xbded0000,0xbe7ebe52,0x3e633e80,0x3d023e12
.long 0xbcb53e80,0x3d86be7c,0x3e7f0000,0xbe77bd34,0xbe7f0000,0x3e773d34,0xbcb53e80,0x3d86be7c
.long 0xbded3e80,0x3e7ebe12,0x3e630000,0xbd02be52,0xbe630000,0x3d023e52,0xbded3e80,0x3e7ebe12
.long 0x3e743e80,0x3e1d3e52,0xbd990000,0xbe4bbe12,0xbd990000,0xbe4bbe12,0xbe74be80,0xbe1dbe52
.long 0x3e443e80,0xbdff3d34,0xbe240000,0xbe5ebe7c,0xbe240000,0xbe5ebe7c,0xbe44be80,0x3dffbd34
.long 0xbd993e80,0x3e4bbe52,0xbe740000,0x3e1d3e12,0xbe740000,0x3e1d3e12,0x3d99be80,0xbe4b3e52
.long 0xbe243e80,0x3e5ebd34,0xbe440000,0xbdff3e7c,0xbe440000,0xbdff3e7c,0x3e24be80,0xbe5e3d34
.long 0x3e673e70,0x3e513e5d,0x3ddb3db1,0x3e143e01,0xbddbbdb1,0xbe14be01,0x3e673e70,0x3e513e5d
.long 0xbe3ebdb1,0xbe7abe78,0x3e2c3e70,0xbd653d81,0xbe2cbe70,0x3d65bd81,0xbe3ebdb1,0xbe7abe78
.long 0xbddb3e70,0x3e14be5d,0x3e673db1,0xbe51be01,0xbe67bdb1,0x3e513e01,0xbddb3e70,0x3e14be5d
.long 0xbe2cbdb1,0xbd653e78,0xbe3e3e70,0x3e7abd81,0x3e3ebe70,0xbe7a3d81,0xbe2cbdb1,0xbd653e78
.long 0x3c493db1,0xbe08bd81,0xbe80be70,0xbe59be78,0xbe80be70,0xbe59be78,0xbc49bdb1,0x3e083d81
.long 0xbe71be70,0x3d2abe01,0x3dacbdb1,0x3e7c3e5d,0x3dacbdb1,0x3e7c3e5d,0x3e713e70,0xbd2a3e01
.long 0xbe803db1,0x3e593d81,0xbc49be70,0xbe083e78,0xbc49be70,0xbe083e78,0x3e80bdb1,0xbe59bd81
.long 0x3dacbe70,0xbe7c3e01,0x3e71bdb1,0x3d2abe5d,0x3e71bdb1,0x3d2abe5d,0xbdac3e70,0x3e7cbe01
.long 0x3e333e43,0x3e103e22,0x3e373e26,0x3e533e46,0xbe37be26,0xbe53be46,0x3e333e43,0x3e103e22
.long 0xbdbfbe43,0x3e0c3cc9,0xbe6dbe26,0xbe56be7f,0x3e6d3e26,0x3e563e7f,0xbdbfbe43,0x3e0c3cc9
.long 0xbe373e43,0x3e53be22,0x3e333e26,0xbe10be46,0xbe33be26,0x3e103e46,0xbe373e43,0x3e53be22
.long 0x3e6dbe43,0xbe56bcc9,0xbdbfbe26,0xbe0c3e7f,0x3dbf3e26,0x3e0cbe7f,0x3e6dbe43,0xbe56bcc9
.long 0xbe6cbe43,0xbe7bbe7f,0xbdc9be26,0x3d52bcc9,0xbdc9be26,0x3d52bcc9,0x3e6c3e43,0x3e7b3e7f
.long 0x3e803e43,0x3d3e3e46,0x3b213e26,0xbe7cbe22,0x3b213e26,0xbe7cbe22,0xbe80be43,0xbd3ebe46
.long 0xbdc9be43,0xbd523e7f,0x3e6cbe26,0xbe7b3cc9,0x3e6cbe26,0xbe7b3cc9,0x3dc93e43,0x3d52be7f
.long 0x3b213e43,0x3e7cbe46,0xbe803e26,0x3d3e3e22,0xbe803e26,0x3d3e3e22,0xbb21be43,0xbe7c3e46
.long 0x3dd23dfa,0x3d793da8,0x3e6a3e5f,0x3e783e72,0xbe6abe5f,0xbe78be72,0x3dd23dfa,0x3d793da8
.long 0x3e803e5f,0x3e183e66,0xbbf1bdfa,0x3e4e3ddf,0x3bf13dfa,0xbe4ebddf,0x3e803e5f,0x3e183e66
.long 0xbe6a3dfa,0x3e78bda8,0x3dd23e5f,0xbd79be72,0xbdd2be5f,0x3d793e72,0xbe6a3dfa,0x3e78bda8
.long 0x3bf13e5f,0x3e4ebe66,0x3e80bdfa,0xbe18bddf,0xbe803dfa,0x3e183ddf,0x3bf13e5f,0x3e4ebe66
.long 0xbe30be5f,0xbd16bddf,0x3e3a3dfa,0x3e7d3e66,0x3e3a3dfa,0x3e7d3e66,0x3e303e5f,0x3d163ddf
.long 0xbe6fbdfa,0xbe04be72,0xbdb6be5f,0x3e5c3da8,0xbdb6be5f,0x3e5c3da8,0x3e6f3dfa,0x3e043e72
.long 0x3e3abe5f,0xbe7d3ddf,0x3e303dfa,0xbd16be66,0x3e303dfa,0xbd16be66,0xbe3a3e5f,0x3e7dbddf
.long 0xbdb6bdfa,0xbe5c3e72,0x3e6fbe5f,0xbe04bda8,0x3e6fbe5f,0xbe04bda8,0x3db63dfa,0x3e5cbe72
.long 0x3e243e80,0xbe5ebd34,0x3e440000,0x3dff3e7c,0xbe440000,0xbdffbe7c,0x3e243e80,0xbe5ebd34
.long 0x3d993e80,0xbe4bbe52,0x3e740000,0xbe1d3e12,0xbe740000,0x3e1dbe12,0x3d993e80,0xbe4bbe52
.long 0xbe443e80,0x3dff3d34,0x3e240000,0x3e5ebe7c,0xbe240000,0xbe5e3e7c,0xbe443e80,0x3dff3d34
.long 0xbe743e80,0xbe1d3e52,0x3d990000,0x3e4bbe12,0xbd990000,0xbe4b3e12,0xbe743e80,0xbe1d3e52
.long 0x3ded3e80,0xbe7ebe12,0xbe630000,0x3d02be52,0xbe630000,0x3d02be52,0xbdedbe80,0x3e7e3e12
.long 0x3cb53e80,0xbd86be7c,0xbe7f0000,0x3e77bd34,0xbe7f0000,0x3e77bd34,0xbcb5be80,0x3d863e7c
.long 0xbe633e80,0xbd023e12,0xbded0000,0xbe7e3e52,0xbded0000,0xbe7e3e52,0x3e63be80,0x3d02be12
.long 0xbe7f3e80,0xbe773e7c,0xbcb50000,0xbd863d34,0xbcb50000,0xbd863d34,0x3e7fbe80,0x3e77be7c
.long 0xbdacbe70,0x3e7c3e01,0xbe71bdb1,0xbd2abe5d,0x3e713db1,0x3d2a3e5d,0xbdacbe70,0x3e7c3e01
.long 0x3e803db1,0xbe593d81,0x3c49be70,0x3e083e78,0xbc493e70,0xbe08be78,0x3e803db1,0xbe593d81
.long 0x3e71be70,0xbd2abe01,0xbdacbdb1,0xbe7c3e5d,0x3dac3db1,0x3e7cbe5d,0x3e71be70,0xbd2abe01
.long 0xbc493db1,0x3e08bd81,0x3e80be70,0x3e59be78,0xbe803e70,0xbe593e78,0xbc493db1,0x3e08bd81
.long 0x3e2cbdb1,0x3d653e78,0x3e3e3e70,0xbe7abd81,0x3e3e3e70,0xbe7abd81,0xbe2c3db1,0xbd65be78
.long 0x3ddb3e70,0xbe14be5d,0xbe673db1,0x3e51be01,0xbe673db1,0x3e51be01,0xbddbbe70,0x3e143e5d
.long 0x3e3ebdb1,0x3e7abe78,0xbe2c3e70,0x3d653d81,0xbe2c3e70,0x3d653d81,0xbe3e3db1,0xbe7a3e78
.long 0xbe673e70,0xbe513e5d,0xbddb3db1,0xbe143e01,0xbddb3db1,0xbe143e01,0x3e67be70,0x3e51be5d
.long 0xbb213e43,0xbe7cbe46,0x3e803e26,0xbd3e3e22,0xbe80be26,0x3d3ebe22,0xbb213e43,0xbe7cbe46
.long 0x3dc9be43,0x3d523e7f,0xbe6cbe26,0x3e7b3cc9,0x3e6c3e26,0xbe7bbcc9,0x3dc9be43,0x3d523e7f
.long 0xbe803e43,0xbd3e3e46,0xbb213e26,0x3e7cbe22,0x3b21be26,0xbe7c3e22,0xbe803e43,0xbd3e3e46
.long 0x3e6cbe43,0x3e7bbe7f,0x3dc9be26,0xbd52bcc9,0xbdc93e26,0x3d523cc9,0x3e6cbe43,0x3e7bbe7f
.long 0xbe6dbe43,0x3e56bcc9,0x3dbfbe26,0x3e0c3e7f,0x3dbfbe26,0x3e0c3e7f,0x3e6d3e43,0xbe563cc9
.long 0x3e373e43,0xbe53be22,0xbe333e26,0x3e10be46,0xbe333e26,0x3e10be46,0xbe37be43,0x3e533e22
.long 0x3dbfbe43,0xbe0c3cc9,0x3e6dbe26,0x3e56be7f,0x3e6dbe26,0x3e56be7f,0xbdbf3e43,0x3e0cbcc9
.long 0xbe333e43,0xbe103e22,0xbe373e26,0xbe533e46,0xbe373e26,0xbe533e46,0x3e33be43,0x3e10be22
.long 0x3db6bdfa,0x3e5c3e72,0xbe6fbe5f,0x3e04bda8,0x3e6f3e5f,0xbe043da8,0x3db6bdfa,0x3e5c3e72
.long 0xbe3abe5f,0x3e7d3ddf,0xbe303dfa,0x3d16be66,0x3e30bdfa,0xbd163e66,0xbe3abe5f,0x3e7d3ddf
.long 0x3e6fbdfa,0x3e04be72,0x3db6be5f,0xbe5c3da8,0xbdb63e5f,0x3e5cbda8,0x3e6fbdfa,0x3e04be72
.long 0x3e30be5f,0x3d16bddf,0xbe3a3dfa,0xbe7d3e66,0x3e3abdfa,0x3e7dbe66,0x3e30be5f,0x3d16bddf
.long 0xbbf13e5f,0xbe4ebe66,0xbe80bdfa,0x3e18bddf,0xbe80bdfa,0x3e18bddf,0x3bf1be5f,0x3e4e3e66
.long 0x3e6a3dfa,0xbe78bda8,0xbdd23e5f,0x3d79be72,0xbdd23e5f,0x3d79be72,0xbe6abdfa,0x3e783da8
.long 0xbe803e5f,0xbe183e66,0x3bf1bdfa,0xbe4e3ddf,0x3bf1bdfa,0xbe4e3ddf,0x3e80be5f,0x3e18be66
.long 0xbdd23dfa,0xbd793da8,0xbe6a3e5f,0xbe783e72,0xbe6a3e5f,0xbe783e72,0x3dd2bdfa,0x3d79bda8
.long 0x3e7f3e80,0x3e753e7b,0x3cc90000,0x3d953d48,0xbcc90000,0xbd95bd48,0x3e7f3e80,0x3e753e7b
.long 0x3e623e80,0x3cc93e0e,0x3df10000,0x3e7f3e55,0xbdf10000,0xbe7fbe55,0x3e623e80,0x3cc93e0e
.long 0xbcc93e80,0x3d95be7b,0x3e7f0000,0xbe75bd48,0xbe7f0000,0x3e753d48,0xbcc93e80,0x3d95be7b
.long 0xbdf13e80,0x3e7fbe0e,0x3e620000,0xbcc9be55,0xbe620000,0x3cc93e55,0xbdf13e80,0x3e7fbe0e
.long 0x3e753e80,0x3e223e55,0xbd950000,0xbe46be0e,0xbd950000,0xbe46be0e,0xbe75be80,0xbe22be55
.long 0x3e463e80,0xbdf13d48,0xbe220000,0xbe62be7b,0xbe220000,0xbe62be7b,0xbe46be80,0x3df1bd48
.long 0xbd953e80,0x3e46be55,0xbe750000,0x3e223e0e,0xbe750000,0x3e223e0e,0x3d95be80,0xbe463e55
.long 0xbe223e80,0x3e62bd48,0xbe460000,0xbdf13e7b,0xbe460000,0xbdf13e7b,0x3e22be80,0xbe623d48
.long 0x3e623e6d,0x3e463e55,0x3df13dc4,0x3e223e0e,0xbdf1bdc4,0xbe22be0e,0x3e623e6d,0x3e463e55
.long 0xbe46bdc4,0xbe75be7b,0x3e223e6d,0xbd953d48,0xbe22be6d,0x3d95bd48,0xbe46bdc4,0xbe75be7b
.long 0xbdf13e6d,0x3e22be55,0x3e623dc4,0xbe46be0e,0xbe62bdc4,0x3e463e0e,0xbdf13e6d,0x3e22be55
.long 0xbe22bdc4,0xbd953e7b,0xbe463e6d,0x3e75bd48,0x3e46be6d,0xbe753d48,0xbe22bdc4,0xbd953e7b
.long 0x3cc93dc4,0xbdf1bd48,0xbe7fbe6d,0xbe62be7b,0xbe7fbe6d,0xbe62be7b,0xbcc9bdc4,0x3df13d48
.long 0xbe75be6d,0x3cc9be0e,0x3d95bdc4,0x3e7f3e55,0x3d95bdc4,0x3e7f3e55,0x3e753e6d,0xbcc93e0e
.long 0xbe7f3dc4,0x3e623d48,0xbcc9be6d,0xbdf13e7b,0xbcc9be6d,0xbdf13e7b,0x3e7fbdc4,0xbe62bd48
.long 0x3d95be6d,0xbe7f3e0e,0x3e75bdc4,0x3cc9be55,0x3e75bdc4,0x3cc9be55,0xbd953e6d,0x3e7fbe0e
.long 0x3e223e35,0x3df13e0e,0x3e463e35,0x3e623e55,0xbe46be35,0xbe62be55,0x3e223e35,0x3df13e0e
.long 0xbd95be35,0x3e223d48,0xbe75be35,0xbe46be7b,0x3e753e35,0x3e463e7b,0xbd95be35,0x3e223d48
.long 0xbe463e35,0x3e62be0e,0x3e223e35,0xbdf1be55,0xbe22be35,0x3df13e55,0xbe463e35,0x3e62be0e
.long 0x3e75be35,0xbe46bd48,0xbd95be35,0xbe223e7b,0x3d953e35,0x3e22be7b,0x3e75be35,0xbe46bd48
.long 0xbe62be35,0xbe7fbe7b,0xbdf1be35,0x3cc9bd48,0xbdf1be35,0x3cc9bd48,0x3e623e35,0x3e7f3e7b
.long 0x3e7f3e35,0x3d953e55,0x3cc93e35,0xbe75be0e,0x3cc93e35,0xbe75be0e,0xbe7fbe35,0xbd95be55
.long 0xbdf1be35,0xbcc93e7b,0x3e62be35,0xbe7f3d48,0x3e62be35,0xbe7f3d48,0x3df13e35,0x3cc9be7b
.long 0x3cc93e35,0x3e75be55,0xbe7f3e35,0x3d953e0e,0xbe7f3e35,0x3d953e0e,0xbcc9be35,0xbe753e55
.long 0x3d953dc4,0x3cc93d48,0x3e753e6d,0x3e7f3e7b,0xbe75be6d,0xbe7fbe7b,0x3d953dc4,0x3cc93d48
.long 0x3e7f3e6d,0x3df13e55,0x3cc9bdc4,0x3e623e0e,0xbcc93dc4,0xbe62be0e,0x3e7f3e6d,0x3df13e55
.long 0xbe753dc4,0x3e7fbd48,0x3d953e6d,0xbcc9be7b,0xbd95be6d,0x3cc93e7b,0xbe753dc4,0x3e7fbd48
.long 0xbcc93e6d,0x3e62be55,0x3e7fbdc4,0xbdf1be0e,0xbe7f3dc4,0x3df13e0e,0xbcc93e6d,0x3e62be55
.long 0xbe46be6d,0xbd95be0e,0x3e223dc4,0x3e753e55,0x3e223dc4,0x3e753e55,0x3e463e6d,0x3d953e0e
.long 0xbe62bdc4,0xbe22be7b,0xbdf1be6d,0x3e463d48,0xbdf1be6d,0x3e463d48,0x3e623dc4,0x3e223e7b
.long 0x3e22be6d,0xbe753e0e,0x3e463dc4,0xbd95be55,0x3e463dc4,0xbd95be55,0xbe223e6d,0x3e75be0e
.long 0xbdf1bdc4,0xbe463e7b,0x3e62be6d,0xbe22bd48,0x3e62be6d,0xbe22bd48,0x3df13dc4,0x3e46be7b
.long 0x3e223e80,0xbe62bd48,0x3e460000,0x3df13e7b,0xbe460000,0xbdf1be7b,0x3e223e80,0xbe62bd48
.long 0x3d953e80,0xbe46be55,0x3e750000,0xbe223e0e,0xbe750000,0x3e22be0e,0x3d953e80,0xbe46be55
.long 0xbe463e80,0x3df13d48,0x3e220000,0x3e62be7b,0xbe220000,0xbe623e7b,0xbe463e80,0x3df13d48
.long 0xbe753e80,0xbe223e55,0x3d950000,0x3e46be0e,0xbd950000,0xbe463e0e,0xbe753e80,0xbe223e55
.long 0x3df13e80,0xbe7fbe0e,0xbe620000,0x3cc9be55,0xbe620000,0x3cc9be55,0xbdf1be80,0x3e7f3e0e
.long 0x3cc93e80,0xbd95be7b,0xbe7f0000,0x3e75bd48,0xbe7f0000,0x3e75bd48,0xbcc9be80,0x3d953e7b
.long 0xbe623e80,0xbcc93e0e,0xbdf10000,0xbe7f3e55,0xbdf10000,0xbe7f3e55,0x3e62be80,0x3cc9be0e
.long 0xbe7f3e80,0xbe753e7b,0xbcc90000,0xbd953d48,0xbcc90000,0xbd953d48,0x3e7fbe80,0x3e75be7b
.long 0xbd95be6d,0x3e7f3e0e,0xbe75bdc4,0xbcc9be55,0x3e753dc4,0x3cc93e55,0xbd95be6d,0x3e7f3e0e
.long 0x3e7f3dc4,0xbe623d48,0x3cc9be6d,0x3df13e7b,0xbcc93e6d,0xbdf1be7b,0x3e7f3dc4,0xbe623d48
.long 0x3e75be6d,0xbcc9be0e,0xbd95bdc4,0xbe7f3e55,0x3d953dc4,0x3e7fbe55,0x3e75be6d,0xbcc9be0e
.long 0xbcc93dc4,0x3df1bd48,0x3e7fbe6d,0x3e62be7b,0xbe7f3e6d,0xbe623e7b,0xbcc93dc4,0x3df1bd48
.long 0x3e22bdc4,0x3d953e7b,0x3e463e6d,0xbe75bd48,0x3e463e6d,0xbe75bd48,0xbe223dc4,0xbd95be7b
.long 0x3df13e6d,0xbe22be55,0xbe623dc4,0x3e46be0e,0xbe623dc4,0x3e46be0e,0xbdf1be6d,0x3e223e55
.long 0x3e46bdc4,0x3e75be7b,0xbe223e6d,0x3d953d48,0xbe223e6d,0x3d953d48,0xbe463dc4,0xbe753e7b
.long 0xbe623e6d,0xbe463e55,0xbdf13dc4,0xbe223e0e,0xbdf13dc4,0xbe223e0e,0x3e62be6d,0x3e46be55
.long 0xbcc93e35,0xbe75be55,0x3e7f3e35,0xbd953e0e,0xbe7fbe35,0x3d95be0e,0xbcc93e35,0xbe75be55
.long 0x3df1be35,0x3cc93e7b,0xbe62be35,0x3e7f3d48,0x3e623e35,0xbe7fbd48,0x3df1be35,0x3cc93e7b
.long 0xbe7f3e35,0xbd953e55,0xbcc93e35,0x3e75be0e,0x3cc9be35,0xbe753e0e,0xbe7f3e35,0xbd953e55
.long 0x3e62be35,0x3e7fbe7b,0x3df1be35,0xbcc9bd48,0xbdf13e35,0x3cc93d48,0x3e62be35,0x3e7fbe7b
.long 0xbe75be35,0x3e46bd48,0x3d95be35,0x3e223e7b,0x3d95be35,0x3e223e7b,0x3e753e35,0xbe463d48
.long 0x3e463e35,0xbe62be0e,0xbe223e35,0x3df1be55,0xbe223e35,0x3df1be55,0xbe46be35,0x3e623e0e
.long 0x3d95be35,0xbe223d48,0x3e75be35,0x3e46be7b,0x3e75be35,0x3e46be7b,0xbd953e35,0x3e22bd48
.long 0xbe223e35,0xbdf13e0e,0xbe463e35,0xbe623e55,0xbe463e35,0xbe623e55,0x3e22be35,0x3df1be0e
.long 0x3df1bdc4,0x3e463e7b,0xbe62be6d,0x3e22bd48,0x3e623e6d,0xbe223d48,0x3df1bdc4,0x3e463e7b
.long 0xbe22be6d,0x3e753e0e,0xbe463dc4,0x3d95be55,0x3e46bdc4,0xbd953e55,0xbe22be6d,0x3e753e0e
.long 0x3e62bdc4,0x3e22be7b,0x3df1be6d,0xbe463d48,0xbdf13e6d,0x3e46bd48,0x3e62bdc4,0x3e22be7b
.long 0x3e46be6d,0x3d95be0e,0xbe223dc4,0xbe753e55,0x3e22bdc4,0x3e75be55,0x3e46be6d,0x3d95be0e
.long 0x3cc93e6d,0xbe62be55,0xbe7fbdc4,0x3df1be0e,0xbe7fbdc4,0x3df1be0e,0xbcc9be6d,0x3e623e55
.long 0x3e753dc4,0xbe7fbd48,0xbd953e6d,0x3cc9be7b,0xbd953e6d,0x3cc9be7b,0xbe75bdc4,0x3e7f3d48
.long 0xbe7f3e6d,0xbdf13e55,0xbcc9bdc4,0xbe623e0e,0xbcc9bdc4,0xbe623e0e,0x3e7fbe6d,0x3df1be55
.long 0xbd953dc4,0xbcc93d48,0xbe753e6d,0xbe7f3e7b,0xbe753e6d,0xbe7f3e7b,0x3d95bdc4,0x3cc9bd48
.long 0x3e7f3e80,0x3e733e7a,0x3cdd0000,0x3da33d5b,0xbcdd0000,0xbda3bd5b,0x3e7f3e80,0x3e733e7a
.long 0x3e613e80,0x3c8d3e0a,0x3df60000,0x3e7f3e58,0xbdf60000,0xbe7fbe58,0x3e613e80,0x3c8d3e0a
.long 0xbcdd3e80,0x3da3be7a,0x3e7f0000,0xbe73bd5b,0xbe7f0000,0x3e733d5b,0xbcdd3e80,0x3da3be7a
.long 0xbdf63e80,0x3e7fbe0a,0x3e610000,0xbc8dbe58,0xbe610000,0x3c8d3e58,0xbdf63e80,0x3e7fbe0a
.long 0x3e763e80,0x3e283e58,0xbd900000,0xbe41be0a,0xbd900000,0xbe41be0a,0xbe76be80,0xbe28be58
.long 0x3e473e80,0xbde43d5b,0xbe200000,0xbe65be7a,0xbe200000,0xbe65be7a,0xbe47be80,0x3de4bd5b
.long 0xbd903e80,0x3e41be58,0xbe760000,0x3e283e0a,0xbe760000,0x3e283e0a,0x3d90be80,0xbe413e58
.long 0xbe203e80,0x3e65bd5b,0xbe470000,0xbde43e7a,0xbe470000,0xbde43e7a,0x3e20be80,0xbe653d5b
.long 0x3e5c3e68,0x3e3a3e4c,0x3e043dd6,0x3e303e1b,0xbe04bdd6,0xbe30be1b,0x3e5c3e68,0x3e3a3e4c
.long 0xbe4ebdd6,0xbe6fbe7e,0x3e183e68,0xbdb63d0c,0xbe18be68,0x3db6bd0c,0xbe4ebdd6,0xbe6fbe7e
.long 0xbe043e68,0x3e30be4c,0x3e5c3dd6,0xbe3abe1b,0xbe5cbdd6,0x3e3a3e1b,0xbe043e68,0x3e30be4c
.long 0xbe18bdd6,0xbdb63e7e,0xbe4e3e68,0x3e6fbd0c,0x3e4ebe68,0xbe6f3d0c,0xbe18bdd6,0xbdb63e7e
.long 0x3d163dd6,0xbdd2bd0c,0xbe7dbe68,0xbe6abe7e,0xbe7dbe68,0xbe6abe7e,0xbd16bdd6,0x3dd23d0c
.long 0xbe78be68,0x3bf1be1b,0x3d79bdd6,0x3e803e4c,0x3d79bdd6,0x3e803e4c,0x3e783e68,0xbbf13e1b
.long 0xbe7d3dd6,0x3e6a3d0c,0xbd16be68,0xbdd23e7e,0xbd16be68,0xbdd23e7e,0x3e7dbdd6,0xbe6abd0c
.long 0x3d79be68,0xbe803e1b,0x3e78bdd6,0x3bf1be4c,0x3e78bdd6,0x3bf1be4c,0xbd793e68,0x3e80be1b
.long 0x3e103e26,0x3dbf3df1,0x3e533e43,0x3e6d3e62,0xbe53be43,0xbe6dbe62,0x3e103e26,0x3dbf3df1
.long 0xbd52be26,0x3e373d95,0xbe7bbe43,0xbe33be75,0x3e7b3e43,0x3e333e75,0xbd52be26,0x3e373d95
.long 0xbe533e26,0x3e6dbdf1,0x3e103e43,0xbdbfbe62,0xbe10be43,0x3dbf3e62,0xbe533e26,0x3e6dbdf1
.long 0x3e7bbe26,0xbe33bd95,0xbd52be43,0xbe373e75,0x3d523e43,0x3e37be75,0x3e7bbe26,0xbe33bd95
.long 0xbe56be26,0xbe80be75,0xbe0cbe43,0xbb21bd95,0xbe0cbe43,0xbb21bd95,0x3e563e26,0x3e803e75
.long 0x3e7c3e26,0x3dc93e62,0x3d3e3e43,0xbe6cbdf1,0x3d3e3e43,0xbe6cbdf1,0xbe7cbe26,0xbdc9be62
.long 0xbe0cbe26,0x3b213e75,0x3e56be43,0xbe803d95,0x3e56be43,0xbe803d95,0x3e0c3e26,0xbb21be75
.long 0x3d3e3e26,0x3e6cbe62,0xbe7c3e43,0x3dc93df1,0xbe7c3e43,0x3dc93df1,0xbd3ebe26,0xbe6c3e62
.long 0x3d2a3d8b,0xbc493c71,0x3e7c3e76,0x3e803e80,0xbe7cbe76,0xbe80be80,0x3d2a3d8b,0xbc493c71
.long 0x3e7a3e76,0x3dac3e3f,0x3d65bd8b,0x3e713e2a,0xbd653d8b,0xbe71be2a,0x3e7a3e76,0x3dac3e3f
.long 0xbe7c3d8b,0x3e80bc71,0x3d2a3e76,0x3c49be80,0xbd2abe76,0xbc493e80,0xbe7c3d8b,0x3e80bc71
.long 0xbd653e76,0x3e71be3f,0x3e7abd8b,0xbdacbe2a,0xbe7a3d8b,0x3dac3e2a,0xbd653e76,0x3e71be3f
.long 0xbe59be76,0xbddbbe2a,0x3e083d8b,0x3e673e3f,0x3e083d8b,0x3e673e3f,0x3e593e76,0x3ddb3e2a
.long 0xbe51bd8b,0xbe3ebe80,0xbe14be76,0x3e2c3c71,0xbe14be76,0x3e2c3c71,0x3e513d8b,0x3e3e3e80
.long 0x3e08be76,0xbe673e2a,0x3e593d8b,0xbddbbe3f,0x3e593d8b,0xbddbbe3f,0xbe083e76,0x3e67be2a
.long 0xbe14bd8b,0xbe2c3e80,0x3e51be76,0xbe3ebc71,0x3e51be76,0xbe3ebc71,0x3e143d8b,0x3e2cbe80
.long 0x3e203e80,0xbe65bd5b,0x3e470000,0x3de43e7a,0xbe470000,0xbde4be7a,0x3e203e80,0xbe65bd5b
.long 0x3d903e80,0xbe41be58,0x3e760000,0xbe283e0a,0xbe760000,0x3e28be0a,0x3d903e80,0xbe41be58
.long 0xbe473e80,0x3de43d5b,0x3e200000,0x3e65be7a,0xbe200000,0xbe653e7a,0xbe473e80,0x3de43d5b
.long 0xbe763e80,0xbe283e58,0x3d900000,0x3e41be0a,0xbd900000,0xbe413e0a,0xbe763e80,0xbe283e58
.long 0x3df63e80,0xbe7fbe0a,0xbe610000,0x3c8dbe58,0xbe610000,0x3c8dbe58,0xbdf6be80,0x3e7f3e0a
.long 0x3cdd3e80,0xbda3be7a,0xbe7f0000,0x3e73bd5b,0xbe7f0000,0x3e73bd5b,0xbcddbe80,0x3da33e7a
.long 0xbe613e80,0xbc8d3e0a,0xbdf60000,0xbe7f3e58,0xbdf60000,0xbe7f3e58,0x3e61be80,0x3c8dbe0a
.long 0xbe7f3e80,0xbe733e7a,0xbcdd0000,0xbda33d5b,0xbcdd0000,0xbda33d5b,0x3e7fbe80,0x3e73be7a
.long 0xbd79be68,0x3e803e1b,0xbe78bdd6,0xbbf1be4c,0x3e783dd6,0x3bf13e4c,0xbd79be68,0x3e803e1b
.long 0x3e7d3dd6,0xbe6a3d0c,0x3d16be68,0x3dd23e7e,0xbd163e68,0xbdd2be7e,0x3e7d3dd6,0xbe6a3d0c
.long 0x3e78be68,0xbbf1be1b,0xbd79bdd6,0xbe803e4c,0x3d793dd6,0x3e80be4c,0x3e78be68,0xbbf1be1b
.long 0xbd163dd6,0x3dd2bd0c,0x3e7dbe68,0x3e6abe7e,0xbe7d3e68,0xbe6a3e7e,0xbd163dd6,0x3dd2bd0c
.long 0x3e18bdd6,0x3db63e7e,0x3e4e3e68,0xbe6fbd0c,0x3e4e3e68,0xbe6fbd0c,0xbe183dd6,0xbdb6be7e
.long 0x3e043e68,0xbe30be4c,0xbe5c3dd6,0x3e3abe1b,0xbe5c3dd6,0x3e3abe1b,0xbe04be68,0x3e303e4c
.long 0x3e4ebdd6,0x3e6fbe7e,0xbe183e68,0x3db63d0c,0xbe183e68,0x3db63d0c,0xbe4e3dd6,0xbe6f3e7e
.long 0xbe5c3e68,0xbe3a3e4c,0xbe043dd6,0xbe303e1b,0xbe043dd6,0xbe303e1b,0x3e5cbe68,0x3e3abe4c
.long 0xbd3e3e26,0xbe6cbe62,0x3e7c3e43,0xbdc93df1,0xbe7cbe43,0x3dc9bdf1,0xbd3e3e26,0xbe6cbe62
.long 0x3e0cbe26,0xbb213e75,0xbe56be43,0x3e803d95,0x3e563e43,0xbe80bd95,0x3e0cbe26,0xbb213e75
.long 0xbe7c3e26,0xbdc93e62,0xbd3e3e43,0x3e6cbdf1,0x3d3ebe43,0xbe6c3df1,0xbe7c3e26,0xbdc93e62
.long 0x3e56be26,0x3e80be75,0x3e0cbe43,0x3b21bd95,0xbe0c3e43,0xbb213d95,0x3e56be26,0x3e80be75
.long 0xbe7bbe26,0x3e33bd95,0x3d52be43,0x3e373e75,0x3d52be43,0x3e373e75,0x3e7b3e26,0xbe333d95
.long 0x3e533e26,0xbe6dbdf1,0xbe103e43,0x3dbfbe62,0xbe103e43,0x3dbfbe62,0xbe53be26,0x3e6d3df1
.long 0x3d52be26,0xbe373d95,0x3e7bbe43,0x3e33be75,0x3e7bbe43,0x3e33be75,0xbd523e26,0x3e37bd95
.long 0xbe103e26,0xbdbf3df1,0xbe533e43,0xbe6d3e62,0xbe533e43,0xbe6d3e62,0x3e10be26,0x3dbfbdf1
.long 0x3e14bd8b,0x3e2c3e80,0xbe51be76,0x3e3ebc71,0x3e513e76,0xbe3e3c71,0x3e14bd8b,0x3e2c3e80
.long 0xbe08be76,0x3e673e2a,0xbe593d8b,0x3ddbbe3f,0x3e59bd8b,0xbddb3e3f,0xbe08be76,0x3e673e2a
.long 0x3e51bd8b,0x3e3ebe80,0x3e14be76,0xbe2c3c71,0xbe143e76,0x3e2cbc71,0x3e51bd8b,0x3e3ebe80
.long 0x3e59be76,0x3ddbbe2a,0xbe083d8b,0xbe673e3f,0x3e08bd8b,0x3e67be3f,0x3e59be76,0x3ddbbe2a
.long 0x3d653e76,0xbe71be3f,0xbe7abd8b,0x3dacbe2a,0xbe7abd8b,0x3dacbe2a,0xbd65be76,0x3e713e3f
.long 0x3e7c3d8b,0xbe80bc71,0xbd2a3e76,0xbc49be80,0xbd2a3e76,0xbc49be80,0xbe7cbd8b,0x3e803c71
.long 0xbe7a3e76,0xbdac3e3f,0xbd65bd8b,0xbe713e2a,0xbd65bd8b,0xbe713e2a,0x3e7abe76,0x3dacbe3f
.long 0xbd2a3d8b,0x3c493c71,0xbe7c3e76,0xbe803e80,0xbe7c3e76,0xbe803e80,0x3d2abd8b,0xbc49bc71
.long 0x3e7e3e80,0x3e703e79,0x3cf10000,0x3db13d6f,0xbcf10000,0xbdb1bd6f,0x3e7e3e80,0x3e703e79
.long 0x3e5f3e80,0x3c213e06,0x3dfa0000,0x3e803e5a,0xbdfa0000,0xbe80be5a,0x3e5f3e80,0x3c213e06
.long 0xbcf13e80,0x3db1be79,0x3e7e0000,0xbe70bd6f,0xbe7e0000,0x3e703d6f,0xbcf13e80,0x3db1be79
.long 0xbdfa3e80,0x3e80be06,0x3e5f0000,0xbc21be5a,0xbe5f0000,0x3c213e5a,0xbdfa3e80,0x3e80be06
.long 0x3e763e80,0x3e2e3e5a,0xbd8b0000,0xbe3cbe06,0xbd8b0000,0xbe3cbe06,0xbe76be80,0xbe2ebe5a
.long 0x3e493e80,0xbdd63d6f,0xbe1e0000,0xbe68be79,0xbe1e0000,0xbe68be79,0xbe49be80,0x3dd6bd6f
.long 0xbd8b3e80,0x3e3cbe5a,0xbe760000,0x3e2e3e06,0xbe760000,0x3e2e3e06,0x3d8bbe80,0xbe3c3e5a
.long 0xbe1e3e80,0x3e68bd6f,0xbe490000,0xbdd63e79,0xbe490000,0xbdd63e79,0x3e1ebe80,0xbe683d6f
.long 0x3e553e64,0x3e2e3e43,0x3e0e3de8,0x3e3c3e26,0xbe0ebde8,0xbe3cbe26,0x3e553e64,0x3e2e3e43
.long 0xbe55bde8,0xbe68be7f,0x3e0e3e64,0xbdd63ca1,0xbe0ebe64,0x3dd6bca1,0xbe55bde8,0xbe68be7f
.long 0xbe0e3e64,0x3e3cbe43,0x3e553de8,0xbe2ebe26,0xbe55bde8,0x3e2e3e26,0xbe0e3e64,0x3e3cbe43
.long 0xbe0ebde8,0xbdd63e7f,0xbe553e64,0x3e68bca1,0x3e55be64,0xbe683ca1,0xbe0ebde8,0xbdd63e7f
.long 0x3d483de8,0xbdb1bca1,0xbe7bbe64,0xbe70be7f,0xbe7bbe64,0xbe70be7f,0xbd48bde8,0x3db13ca1
.long 0xbe7bbe64,0xbc21be26,0x3d48bde8,0x3e803e43,0x3d48bde8,0x3e803e43,0x3e7b3e64,0x3c213e26
.long 0xbe7b3de8,0x3e703ca1,0xbd48be64,0xbdb13e7f,0xbd48be64,0xbdb13e7f,0x3e7bbde8,0xbe70bca1
.long 0x3d48be64,0xbe803e26,0x3e7bbde8,0xbc21be43,0x3e7bbde8,0xbc21be43,0xbd483e64,0x3e80be26
.long 0x3dfa3e16,0x3d8b3dc4,0x3e5f3e4f,0x3e763e6d,0xbe5fbe4f,0xbe76be6d,0x3dfa3e16,0x3d8b3dc4
.long 0xbcf1be16,0x3e493dc4,0xbe7ebe4f,0xbe1ebe6d,0x3e7e3e4f,0x3e1e3e6d,0xbcf1be16,0x3e493dc4
.long 0xbe5f3e16,0x3e76bdc4,0x3dfa3e4f,0xbd8bbe6d,0xbdfabe4f,0x3d8b3e6d,0xbe5f3e16,0x3e76bdc4
.long 0x3e7ebe16,0xbe1ebdc4,0xbcf1be4f,0xbe493e6d,0x3cf13e4f,0x3e49be6d,0x3e7ebe16,0xbe1ebdc4
.long 0xbe49be16,0xbe7ebe6d,0xbe1ebe4f,0xbcf1bdc4,0xbe1ebe4f,0xbcf1bdc4,0x3e493e16,0x3e7e3e6d
.long 0x3e763e16,0x3dfa3e6d,0x3d8b3e4f,0xbe5fbdc4,0x3d8b3e4f,0xbe5fbdc4,0xbe76be16,0xbdfabe6d
.long 0xbe1ebe16,0x3cf13e6d,0x3e49be4f,0xbe7e3dc4,0x3e49be4f,0xbe7e3dc4,0x3e1e3e16,0xbcf1be6d
.long 0x3d8b3e16,0x3e5fbe6d,0xbe763e4f,0x3dfa3dc4,0xbe763e4f,0x3dfa3dc4,0xbd8bbe16,0xbe5f3e6d
.long 0x3c213d20,0xbd48bca1,0x3e803e7d,0x3e7b3e7f,0xbe80be7d,0xbe7bbe7f,0x3c213d20,0xbd48bca1
.long 0x3e703e7d,0x3d483e26,0x3db1bd20,0x3e7b3e43,0xbdb13d20,0xbe7bbe43,0x3e703e7d,0x3d483e26
.long 0xbe803d20,0x3e7b3ca1,0x3c213e7d,0x3d48be7f,0xbc21be7d,0xbd483e7f,0xbe803d20,0x3e7b3ca1
.long 0xbdb13e7d,0x3e7bbe26,0x3e70bd20,0xbd48be43,0xbe703d20,0x3d483e43,0xbdb13e7d,0x3e7bbe26
.long 0xbe68be7d,0xbe0ebe43,0x3dd63d20,0x3e553e26,0x3dd63d20,0x3e553e26,0x3e683e7d,0x3e0e3e43
.long 0xbe3cbd20,0xbe55be7f,0xbe2ebe7d,0x3e0ebca1,0xbe2ebe7d,0x3e0ebca1,0x3e3c3d20,0x3e553e7f
.long 0x3dd6be7d,0xbe553e43,0x3e683d20,0xbe0ebe26,0x3e683d20,0xbe0ebe26,0xbdd63e7d,0x3e55be43
.long 0xbe2ebd20,0xbe0e3e7f,0x3e3cbe7d,0xbe553ca1,0x3e3cbe7d,0xbe553ca1,0x3e2e3d20,0x3e0ebe7f
.long 0x3e1e3e80,0xbe68bd6f,0x3e490000,0x3dd63e79,0xbe490000,0xbdd6be79,0x3e1e3e80,0xbe68bd6f
.long 0x3d8b3e80,0xbe3cbe5a,0x3e760000,0xbe2e3e06,0xbe760000,0x3e2ebe06,0x3d8b3e80,0xbe3cbe5a
.long 0xbe493e80,0x3dd63d6f,0x3e1e0000,0x3e68be79,0xbe1e0000,0xbe683e79,0xbe493e80,0x3dd63d6f
.long 0xbe763e80,0xbe2e3e5a,0x3d8b0000,0x3e3cbe06,0xbd8b0000,0xbe3c3e06,0xbe763e80,0xbe2e3e5a
.long 0x3dfa3e80,0xbe80be06,0xbe5f0000,0x3c21be5a,0xbe5f0000,0x3c21be5a,0xbdfabe80,0x3e803e06
.long 0x3cf13e80,0xbdb1be79,0xbe7e0000,0x3e70bd6f,0xbe7e0000,0x3e70bd6f,0xbcf1be80,0x3db13e79
.long 0xbe5f3e80,0xbc213e06,0xbdfa0000,0xbe803e5a,0xbdfa0000,0xbe803e5a,0x3e5fbe80,0x3c21be06
.long 0xbe7e3e80,0xbe703e79,0xbcf10000,0xbdb13d6f,0xbcf10000,0xbdb13d6f,0x3e7ebe80,0x3e70be79
.long 0xbd48be64,0x3e803e26,0xbe7bbde8,0x3c21be43,0x3e7b3de8,0xbc213e43,0xbd48be64,0x3e803e26
.long 0x3e7b3de8,0xbe703ca1,0x3d48be64,0x3db13e7f,0xbd483e64,0xbdb1be7f,0x3e7b3de8,0xbe703ca1
.long 0x3e7bbe64,0x3c21be26,0xbd48bde8,0xbe803e43,0x3d483de8,0x3e80be43,0x3e7bbe64,0x3c21be26
.long 0xbd483de8,0x3db1bca1,0x3e7bbe64,0x3e70be7f,0xbe7b3e64,0xbe703e7f,0xbd483de8,0x3db1bca1
.long 0x3e0ebde8,0x3dd63e7f,0x3e553e64,0xbe68bca1,0x3e553e64,0xbe68bca1,0xbe0e3de8,0xbdd6be7f
.long 0x3e0e3e64,0xbe3cbe43,0xbe553de8,0x3e2ebe26,0xbe553de8,0x3e2ebe26,0xbe0ebe64,0x3e3c3e43
.long 0x3e55bde8,0x3e68be7f,0xbe0e3e64,0x3dd63ca1,0xbe0e3e64,0x3dd63ca1,0xbe553de8,0xbe683e7f
.long 0xbe553e64,0xbe2e3e43,0xbe0e3de8,0xbe3c3e26,0xbe0e3de8,0xbe3c3e26,0x3e55be64,0x3e2ebe43
.long 0xbd8b3e16,0xbe5fbe6d,0x3e763e4f,0xbdfa3dc4,0xbe76be4f,0x3dfabdc4,0xbd8b3e16,0xbe5fbe6d
.long 0x3e1ebe16,0xbcf13e6d,0xbe49be4f,0x3e7e3dc4,0x3e493e4f,0xbe7ebdc4,0x3e1ebe16,0xbcf13e6d
.long 0xbe763e16,0xbdfa3e6d,0xbd8b3e4f,0x3e5fbdc4,0x3d8bbe4f,0xbe5f3dc4,0xbe763e16,0xbdfa3e6d
.long 0x3e49be16,0x3e7ebe6d,0x3e1ebe4f,0x3cf1bdc4,0xbe1e3e4f,0xbcf13dc4,0x3e49be16,0x3e7ebe6d
.long 0xbe7ebe16,0x3e1ebdc4,0x3cf1be4f,0x3e493e6d,0x3cf1be4f,0x3e493e6d,0x3e7e3e16,0xbe1e3dc4
.long 0x3e5f3e16,0xbe76bdc4,0xbdfa3e4f,0x3d8bbe6d,0xbdfa3e4f,0x3d8bbe6d,0xbe5fbe16,0x3e763dc4
.long 0x3cf1be16,0xbe493dc4,0x3e7ebe4f,0x3e1ebe6d,0x3e7ebe4f,0x3e1ebe6d,0xbcf13e16,0x3e49bdc4
.long 0xbdfa3e16,0xbd8b3dc4,0xbe5f3e4f,0xbe763e6d,0xbe5f3e4f,0xbe763e6d,0x3dfabe16,0x3d8bbdc4
.long 0x3e2ebd20,0x3e0e3e7f,0xbe3cbe7d,0x3e553ca1,0x3e3c3e7d,0xbe55bca1,0x3e2ebd20,0x3e0e3e7f
.long 0xbdd6be7d,0x3e553e43,0xbe683d20,0x3e0ebe26,0x3e68bd20,0xbe0e3e26,0xbdd6be7d,0x3e553e43
.long 0x3e3cbd20,0x3e55be7f,0x3e2ebe7d,0xbe0ebca1,0xbe2e3e7d,0x3e0e3ca1,0x3e3cbd20,0x3e55be7f
.long 0x3e68be7d,0x3e0ebe43,0xbdd63d20,0xbe553e26,0x3dd6bd20,0x3e55be26,0x3e68be7d,0x3e0ebe43
.long 0x3db13e7d,0xbe7bbe26,0xbe70bd20,0x3d48be43,0xbe70bd20,0x3d48be43,0xbdb1be7d,0x3e7b3e26
.long 0x3e803d20,0xbe7b3ca1,0xbc213e7d,0xbd48be7f,0xbc213e7d,0xbd48be7f,0xbe80bd20,0x3e7bbca1
.long 0xbe703e7d,0xbd483e26,0xbdb1bd20,0xbe7b3e43,0xbdb1bd20,0xbe7b3e43,0x3e70be7d,0x3d48be26
.long 0xbc213d20,0x3d48bca1,0xbe803e7d,0xbe7b3e7f,0xbe803e7d,0xbe7b3e7f,0x3c21bd20,0xbd483ca1
.long 0x3e7e3e80,0x3e6d3e78,0x3d020000,0x3dbf3d81,0xbd020000,0xbdbfbd81,0x3e7e3e80,0x3e6d3e78
.long 0x3e5e3e80,0x3b213e01,0x3dff0000,0x3e803e5d,0xbdff0000,0xbe80be5d,0x3e5e3e80,0x3b213e01
.long 0xbd023e80,0x3dbfbe78,0x3e7e0000,0xbe6dbd81,0xbe7e0000,0x3e6d3d81,0xbd023e80,0x3dbfbe78
.long 0xbdff3e80,0x3e80be01,0x3e5e0000,0xbb21be5d,0xbe5e0000,0x3b213e5d,0xbdff3e80,0x3e80be01
.long 0x3e773e80,0x3e333e5d,0xbd860000,0xbe37be01,0xbd860000,0xbe37be01,0xbe77be80,0xbe33be5d
.long 0x3e4b3e80,0xbdc93d81,0xbe1d0000,0xbe6cbe78,0xbe1d0000,0xbe6cbe78,0xbe4bbe80,0x3dc9bd81
.long 0xbd863e80,0x3e37be5d,0xbe770000,0x3e333e01,0xbe770000,0x3e333e01,0x3d86be80,0xbe373e5d
.long 0xbe1d3e80,0x3e6cbd81,0xbe4b0000,0xbdc93e78,0xbe4b0000,0xbdc93e78,0x3e1dbe80,0xbe6c3d81
.long 0x3e4e3e5f,0x3e203e39,0x3e183dfa,0x3e473e31,0xbe18bdfa,0xbe47be31,0x3e4e3e5f,0x3e203e39
.long 0xbe5cbdfa,0xbe61be80,0x3e043e5f,0xbdf63ba1,0xbe04be5f,0x3df6bba1,0xbe5cbdfa,0xbe61be80
.long 0xbe183e5f,0x3e47be39,0x3e4e3dfa,0xbe20be31,0xbe4ebdfa,0x3e203e31,0xbe183e5f,0x3e47be39
.long 0xbe04bdfa,0xbdf63e80,0xbe5c3e5f,0x3e61bba1,0x3e5cbe5f,0xbe613ba1,0xbe04bdfa,0xbdf63e80
.long 0x3d793dfa,0xbd90bba1,0xbe78be5f,0xbe76be80,0xbe78be5f,0xbe76be80,0xbd79bdfa,0x3d903ba1
.long 0xbe7dbe5f,0xbcddbe31,0x3d16bdfa,0x3e7f3e39,0x3d16bdfa,0x3e7f3e39,0x3e7d3e5f,0x3cdd3e31
.long 0xbe783dfa,0x3e763ba1,0xbd79be5f,0xbd903e80,0xbd79be5f,0xbd903e80,0x3e78bdfa,0xbe76bba1
.long 0x3d16be5f,0xbe7f3e31,0x3e7dbdfa,0xbcddbe39,0x3e7dbdfa,0xbcddbe39,0xbd163e5f,0x3e7fbe31
.long 0x3dd23e06,0x3d2a3d95,0x3e6a3e5a,0x3e7c3e75,0xbe6abe5a,0xbe7cbe75,0x3dd23e06,0x3d2a3d95
.long 0xbbf1be06,0x3e593df1,0xbe80be5a,0xbe08be62,0x3e803e5a,0x3e083e62,0xbbf1be06,0x3e593df1
.long 0xbe6a3e06,0x3e7cbd95,0x3dd23e5a,0xbd2abe75,0xbdd2be5a,0x3d2a3e75,0xbe6a3e06,0x3e7cbd95
.long 0x3e80be06,0xbe08bdf1,0xbbf1be5a,0xbe593e62,0x3bf13e5a,0x3e59be62,0x3e80be06,0xbe08bdf1
.long 0xbe3abe06,0xbe7abe62,0xbe30be5a,0xbd65bdf1,0xbe30be5a,0xbd65bdf1,0x3e3a3e06,0x3e7a3e62
.long 0x3e6f3e06,0x3e143e75,0x3db63e5a,0xbe51bd95,0x3db63e5a,0xbe51bd95,0xbe6fbe06,0xbe14be75
.long 0xbe30be06,0x3d653e62,0x3e3abe5a,0xbe7a3df1,0x3e3abe5a,0xbe7a3df1,0x3e303e06,0xbd65be62
.long 0x3db63e06,0x3e51be75,0xbe6f3e5a,0x3e143d95,0xbe6f3e5a,0x3e143d95,0xbdb6be06,0xbe513e75
.long 0xbcb53c21,0xbdacbd5b,0x3e7f3e80,0x3e713e7a,0xbe7fbe80,0xbe71be7a,0xbcb53c21,0xbdacbd5b
.long 0x3e633e80,0x3c493e0a,0x3dedbc21,0x3e803e58,0xbded3c21,0xbe80be58,0x3e633e80,0x3c493e0a
.long 0xbe7f3c21,0x3e713d5b,0xbcb53e80,0x3dacbe7a,0x3cb5be80,0xbdac3e7a,0xbe7f3c21,0x3e713d5b
.long 0xbded3e80,0x3e80be0a,0x3e63bc21,0xbc49be58,0xbe633c21,0x3c493e58,0xbded3e80,0x3e80be0a
.long 0xbe74be80,0xbe2cbe58,0x3d993c21,0x3e3e3e0a,0x3d993c21,0x3e3e3e0a,0x3e743e80,0x3e2c3e58
.long 0xbe24bc21,0xbe67be7a,0xbe44be80,0x3ddbbd5b,0xbe44be80,0x3ddbbd5b,0x3e243c21,0x3e673e7a
.long 0x3d99be80,0xbe3e3e58,0x3e743c21,0xbe2cbe0a,0x3e743c21,0xbe2cbe0a,0xbd993e80,0x3e3ebe58
.long 0xbe44bc21,0xbddb3e7a,0x3e24be80,0xbe673d5b,0x3e24be80,0xbe673d5b,0x3e443c21,0x3ddbbe7a
.long 0x3e1d3e80,0xbe6cbd81,0x3e4b0000,0x3dc93e78,0xbe4b0000,0xbdc9be78,0x3e1d3e80,0xbe6cbd81
.long 0x3d863e80,0xbe37be5d,0x3e770000,0xbe333e01,0xbe770000,0x3e33be01,0x3d863e80,0xbe37be5d
.long 0xbe4b3e80,0x3dc93d81,0x3e1d0000,0x3e6cbe78,0xbe1d0000,0xbe6c3e78,0xbe4b3e80,0x3dc93d81
.long 0xbe773e80,0xbe333e5d,0x3d860000,0x3e37be01,0xbd860000,0xbe373e01,0xbe773e80,0xbe333e5d
.long 0x3dff3e80,0xbe80be01,0xbe5e0000,0x3b21be5d,0xbe5e0000,0x3b21be5d,0xbdffbe80,0x3e803e01
.long 0x3d023e80,0xbdbfbe78,0xbe7e0000,0x3e6dbd81,0xbe7e0000,0x3e6dbd81,0xbd02be80,0x3dbf3e78
.long 0xbe5e3e80,0xbb213e01,0xbdff0000,0xbe803e5d,0xbdff0000,0xbe803e5d,0x3e5ebe80,0x3b21be01
.long 0xbe7e3e80,0xbe6d3e78,0xbd020000,0xbdbf3d81,0xbd020000,0xbdbf3d81,0x3e7ebe80,0x3e6dbe78
.long 0xbd16be5f,0x3e7f3e31,0xbe7dbdfa,0x3cddbe39,0x3e7d3dfa,0xbcdd3e39,0xbd16be5f,0x3e7f3e31
.long 0x3e783dfa,0xbe763ba1,0x3d79be5f,0x3d903e80,0xbd793e5f,0xbd90be80,0x3e783dfa,0xbe763ba1
.long 0x3e7dbe5f,0x3cddbe31,0xbd16bdfa,0xbe7f3e39,0x3d163dfa,0x3e7fbe39,0x3e7dbe5f,0x3cddbe31
.long 0xbd793dfa,0x3d90bba1,0x3e78be5f,0x3e76be80,0xbe783e5f,0xbe763e80,0xbd793dfa,0x3d90bba1
.long 0x3e04bdfa,0x3df63e80,0x3e5c3e5f,0xbe61bba1,0x3e5c3e5f,0xbe61bba1,0xbe043dfa,0xbdf6be80
.long 0x3e183e5f,0xbe47be39,0xbe4e3dfa,0x3e20be31,0xbe4e3dfa,0x3e20be31,0xbe18be5f,0x3e473e39
.long 0x3e5cbdfa,0x3e61be80,0xbe043e5f,0x3df63ba1,0xbe043e5f,0x3df63ba1,0xbe5c3dfa,0xbe613e80
.long 0xbe4e3e5f,0xbe203e39,0xbe183dfa,0xbe473e31,0xbe183dfa,0xbe473e31,0x3e4ebe5f,0x3e20be39
.long 0xbdb63e06,0xbe51be75,0x3e6f3e5a,0xbe143d95,0xbe6fbe5a,0x3e14bd95,0xbdb63e06,0xbe51be75
.long 0x3e30be06,0xbd653e62,0xbe3abe5a,0x3e7a3df1,0x3e3a3e5a,0xbe7abdf1,0x3e30be06,0xbd653e62
.long 0xbe6f3e06,0xbe143e75,0xbdb63e5a,0x3e51bd95,0x3db6be5a,0xbe513d95,0xbe6f3e06,0xbe143e75
.long 0x3e3abe06,0x3e7abe62,0x3e30be5a,0x3d65bdf1,0xbe303e5a,0xbd653df1,0x3e3abe06,0x3e7abe62
.long 0xbe80be06,0x3e08bdf1,0x3bf1be5a,0x3e593e62,0x3bf1be5a,0x3e593e62,0x3e803e06,0xbe083df1
.long 0x3e6a3e06,0xbe7cbd95,0xbdd23e5a,0x3d2abe75,0xbdd23e5a,0x3d2abe75,0xbe6abe06,0x3e7c3d95
.long 0x3bf1be06,0xbe593df1,0x3e80be5a,0x3e08be62,0x3e80be5a,0x3e08be62,0xbbf13e06,0x3e59bdf1
.long 0xbdd23e06,0xbd2a3d95,0xbe6a3e5a,0xbe7c3e75,0xbe6a3e5a,0xbe7c3e75,0x3dd2be06,0x3d2abd95
.long 0x3e44bc21,0x3ddb3e7a,0xbe24be80,0x3e673d5b,0x3e243e80,0xbe67bd5b,0x3e44bc21,0x3ddb3e7a
.long 0xbd99be80,0x3e3e3e58,0xbe743c21,0x3e2cbe0a,0x3e74bc21,0xbe2c3e0a,0xbd99be80,0x3e3e3e58
.long 0x3e24bc21,0x3e67be7a,0x3e44be80,0xbddbbd5b,0xbe443e80,0x3ddb3d5b,0x3e24bc21,0x3e67be7a
.long 0x3e74be80,0x3e2cbe58,0xbd993c21,0xbe3e3e0a,0x3d99bc21,0x3e3ebe0a,0x3e74be80,0x3e2cbe58
.long 0x3ded3e80,0xbe80be0a,0xbe63bc21,0x3c49be58,0xbe63bc21,0x3c49be58,0xbdedbe80,0x3e803e0a
.long 0x3e7f3c21,0xbe713d5b,0x3cb53e80,0xbdacbe7a,0x3cb53e80,0xbdacbe7a,0xbe7fbc21,0x3e71bd5b
.long 0xbe633e80,0xbc493e0a,0xbdedbc21,0xbe803e58,0xbdedbc21,0xbe803e58,0x3e63be80,0x3c49be0a
.long 0x3cb53c21,0x3dacbd5b,0xbe7f3e80,0xbe713e7a,0xbe7f3e80,0xbe713e7a,0xbcb5bc21,0xbdac3d5b
.long 0x3e7e3e80,0x3e6b3e76,0x3d0c0000,0x3dcd3d8b,0xbd0c0000,0xbdcdbd8b,0x3e7e3e80,0x3e6b3e76
.long 0x3e5d3e80,0xbba13dfa,0x3e010000,0x3e803e5f,0xbe010000,0xbe80be5f,0x3e5d3e80,0xbba13dfa
.long 0xbd0c3e80,0x3dcdbe76,0x3e7e0000,0xbe6bbd8b,0xbe7e0000,0x3e6b3d8b,0xbd0c3e80,0x3dcdbe76
.long 0xbe013e80,0x3e80bdfa,0x3e5d0000,0x3ba1be5f,0xbe5d0000,0xbba13e5f,0xbe013e80,0x3e80bdfa
.long 0x3e783e80,0x3e393e5f,0xbd810000,0xbe31bdfa,0xbd810000,0xbe31bdfa,0xbe78be80,0xbe39be5f
.long 0x3e4c3e80,0xbdbb3d8b,0xbe1b0000,0xbe6ebe76,0xbe1b0000,0xbe6ebe76,0xbe4cbe80,0x3dbbbd8b
.long 0xbd813e80,0x3e31be5f,0xbe780000,0x3e393dfa,0xbe780000,0x3e393dfa,0x3d81be80,0xbe313e5f
.long 0xbe1b3e80,0x3e6ebd8b,0xbe4c0000,0xbdbb3e76,0xbe4c0000,0xbdbb3e76,0x3e1bbe80,0xbe6e3d8b
.long 0x3e463e5a,0x3e123e2e,0x3e223e06,0x3e523e3c,0xbe22be06,0xbe52be3c,0x3e463e5a,0x3e123e2e
.long 0xbe62be06,0xbe58be80,0x3df13e5a,0xbe0abc21,0xbdf1be5a,0x3e0a3c21,0xbe62be06,0xbe58be80
.long 0xbe223e5a,0x3e52be2e,0x3e463e06,0xbe12be3c,0xbe46be06,0x3e123e3c,0xbe223e5a,0x3e52be2e
.long 0xbdf1be06,0xbe0a3e80,0xbe623e5a,0x3e583c21,0x3e62be5a,0xbe58bc21,0xbdf1be06,0xbe0a3e80
.long 0x3d953e06,0xbd5b3c21,0xbe75be5a,0xbe7abe80,0xbe75be5a,0xbe7abe80,0xbd95be06,0x3d5bbc21
.long 0xbe7fbe5a,0xbd34be3c,0x3cc9be06,0x3e7c3e2e,0x3cc9be06,0x3e7c3e2e,0x3e7f3e5a,0x3d343e3c
.long 0xbe753e06,0x3e7abc21,0xbd95be5a,0xbd5b3e80,0xbd95be5a,0xbd5b3e80,0x3e75be06,0xbe7a3c21
.long 0x3cc9be5a,0xbe7c3e3c,0x3e7fbe06,0xbd34be2e,0x3e7fbe06,0xbd34be2e,0xbcc93e5a,0x3e7cbe3c
.long 0x3da83de8,0x3c713d48,0x3e723e64,0x3e803e7b,0xbe72be64,0xbe80be7b,0x3da83de8,0x3c713d48
.long 0x3c71bde8,0x3e663e0e,0xbe80be64,0xbddfbe55,0x3e803e64,0x3ddf3e55,0x3c71bde8,0x3e663e0e
.long 0xbe723de8,0x3e80bd48,0x3da83e64,0xbc71be7b,0xbda8be64,0x3c713e7b,0xbe723de8,0x3e80bd48
.long 0x3e80bde8,0xbddfbe0e,0x3c71be64,0xbe663e55,0xbc713e64,0x3e66be55,0x3e80bde8,0xbddfbe0e
.long 0xbe2abde8,0xbe72be55,0xbe3fbe64,0xbda8be0e,0xbe3fbe64,0xbda8be0e,0x3e2a3de8,0x3e723e55
.long 0x3e663de8,0x3e2a3e7b,0x3ddf3e64,0xbe3fbd48,0x3ddf3e64,0xbe3fbd48,0xbe66bde8,0xbe2abe7b
.long 0xbe3fbde8,0x3da83e55,0x3e2abe64,0xbe723e0e,0x3e2abe64,0xbe723e0e,0x3e3f3de8,0xbda8be55
.long 0x3ddf3de8,0x3e3fbe7b,0xbe663e64,0x3e2a3d48,0xbe663e64,0x3e2a3d48,0xbddfbde8,0xbe3f3e7b
.long 0xbd5bbca1,0xbdf1bdb1,0x3e7a3e7f,0x3e623e70,0xbe7abe7f,0xbe62be70,0xbd5bbca1,0xbdf1bdb1
.long 0x3e523e7f,0xbcc93dd6,0x3e123ca1,0x3e7f3e68,0xbe12bca1,0xbe7fbe68,0x3e523e7f,0xbcc93dd6
.long 0xbe7abca1,0x3e623db1,0xbd5b3e7f,0x3df1be70,0x3d5bbe7f,0xbdf13e70,0xbe7abca1,0x3e623db1
.long 0xbe123e7f,0x3e7fbdd6,0x3e523ca1,0x3cc9be68,0xbe52bca1,0xbcc93e68,0xbe123e7f,0x3e7fbdd6
.long 0xbe7cbe7f,0xbe46be68,0x3d34bca1,0x3e223dd6,0x3d34bca1,0x3e223dd6,0x3e7c3e7f,0x3e463e68
.long 0xbe0a3ca1,0xbe75be70,0xbe58be7f,0x3d95bdb1,0xbe58be7f,0x3d95bdb1,0x3e0abca1,0x3e753e70
.long 0x3d34be7f,0xbe223e68,0x3e7cbca1,0xbe46bdd6,0x3e7cbca1,0xbe46bdd6,0xbd343e7f,0x3e22be68
.long 0xbe583ca1,0xbd953e70,0x3e0abe7f,0xbe753db1,0x3e0abe7f,0xbe753db1,0x3e58bca1,0x3d95be70
.long 0x3e1b3e80,0xbe6ebd8b,0x3e4c0000,0x3dbb3e76,0xbe4c0000,0xbdbbbe76,0x3e1b3e80,0xbe6ebd8b
.long 0x3d813e80,0xbe31be5f,0x3e780000,0xbe393dfa,0xbe780000,0x3e39bdfa,0x3d813e80,0xbe31be5f
.long 0xbe4c3e80,0x3dbb3d8b,0x3e1b0000,0x3e6ebe76,0xbe1b0000,0xbe6e3e76,0xbe4c3e80,0x3dbb3d8b
.long 0xbe783e80,0xbe393e5f,0x3d810000,0x3e31bdfa,0xbd810000,0xbe313dfa,0xbe783e80,0xbe393e5f
.long 0x3e013e80,0xbe80bdfa,0xbe5d0000,0xbba1be5f,0xbe5d0000,0xbba1be5f,0xbe01be80,0x3e803dfa
.long 0x3d0c3e80,0xbdcdbe76,0xbe7e0000,0x3e6bbd8b,0xbe7e0000,0x3e6bbd8b,0xbd0cbe80,0x3dcd3e76
.long 0xbe5d3e80,0x3ba13dfa,0xbe010000,0xbe803e5f,0xbe010000,0xbe803e5f,0x3e5dbe80,0xbba1bdfa
.long 0xbe7e3e80,0xbe6b3e76,0xbd0c0000,0xbdcd3d8b,0xbd0c0000,0xbdcd3d8b,0x3e7ebe80,0x3e6bbe76
.long 0xbcc9be5a,0x3e7c3e3c,0xbe7fbe06,0x3d34be2e,0x3e7f3e06,0xbd343e2e,0xbcc9be5a,0x3e7c3e3c
.long 0x3e753e06,0xbe7abc21,0x3d95be5a,0x3d5b3e80,0xbd953e5a,0xbd5bbe80,0x3e753e06,0xbe7abc21
.long 0x3e7fbe5a,0x3d34be3c,0xbcc9be06,0xbe7c3e2e,0x3cc93e06,0x3e7cbe2e,0x3e7fbe5a,0x3d34be3c
.long 0xbd953e06,0x3d5b3c21,0x3e75be5a,0x3e7abe80,0xbe753e5a,0xbe7a3e80,0xbd953e06,0x3d5b3c21
.long 0x3df1be06,0x3e0a3e80,0x3e623e5a,0xbe583c21,0x3e623e5a,0xbe583c21,0xbdf13e06,0xbe0abe80
.long 0x3e223e5a,0xbe52be2e,0xbe463e06,0x3e12be3c,0xbe463e06,0x3e12be3c,0xbe22be5a,0x3e523e2e
.long 0x3e62be06,0x3e58be80,0xbdf13e5a,0x3e0abc21,0xbdf13e5a,0x3e0abc21,0xbe623e06,0xbe583e80
.long 0xbe463e5a,0xbe123e2e,0xbe223e06,0xbe523e3c,0xbe223e06,0xbe523e3c,0x3e46be5a,0x3e12be2e
.long 0xbddf3de8,0xbe3fbe7b,0x3e663e64,0xbe2a3d48,0xbe66be64,0x3e2abd48,0xbddf3de8,0xbe3fbe7b
.long 0x3e3fbde8,0xbda83e55,0xbe2abe64,0x3e723e0e,0x3e2a3e64,0xbe72be0e,0x3e3fbde8,0xbda83e55
.long 0xbe663de8,0xbe2a3e7b,0xbddf3e64,0x3e3fbd48,0x3ddfbe64,0xbe3f3d48,0xbe663de8,0xbe2a3e7b
.long 0x3e2abde8,0x3e72be55,0x3e3fbe64,0x3da8be0e,0xbe3f3e64,0xbda83e0e,0x3e2abde8,0x3e72be55
.long 0xbe80bde8,0x3ddfbe0e,0xbc71be64,0x3e663e55,0xbc71be64,0x3e663e55,0x3e803de8,0xbddf3e0e
.long 0x3e723de8,0xbe80bd48,0xbda83e64,0x3c71be7b,0xbda83e64,0x3c71be7b,0xbe72bde8,0x3e803d48
.long 0xbc71bde8,0xbe663e0e,0x3e80be64,0x3ddfbe55,0x3e80be64,0x3ddfbe55,0x3c713de8,0x3e66be0e
.long 0xbda83de8,0xbc713d48,0xbe723e64,0xbe803e7b,0xbe723e64,0xbe803e7b,0x3da8bde8,0x3c71bd48
.long 0x3e583ca1,0x3d953e70,0xbe0abe7f,0x3e753db1,0x3e0a3e7f,0xbe75bdb1,0x3e583ca1,0x3d953e70
.long 0xbd34be7f,0x3e223e68,0xbe7cbca1,0x3e46bdd6,0x3e7c3ca1,0xbe463dd6,0xbd34be7f,0x3e223e68
.long 0x3e0a3ca1,0x3e75be70,0x3e58be7f,0xbd95bdb1,0xbe583e7f,0x3d953db1,0x3e0a3ca1,0x3e75be70
.long 0x3e7cbe7f,0x3e46be68,0xbd34bca1,0xbe223dd6,0x3d343ca1,0x3e22bdd6,0x3e7cbe7f,0x3e46be68
.long 0x3e123e7f,0xbe7fbdd6,0xbe523ca1,0xbcc9be68,0xbe523ca1,0xbcc9be68,0xbe12be7f,0x3e7f3dd6
.long 0x3e7abca1,0xbe623db1,0x3d5b3e7f,0xbdf1be70,0x3d5b3e7f,0xbdf1be70,0xbe7a3ca1,0x3e62bdb1
.long 0xbe523e7f,0x3cc93dd6,0xbe123ca1,0xbe7f3e68,0xbe123ca1,0xbe7f3e68,0x3e52be7f,0xbcc9bdd6
.long 0x3d5bbca1,0x3df1bdb1,0xbe7a3e7f,0xbe623e70,0xbe7a3e7f,0xbe623e70,0xbd5b3ca1,0xbdf13db1
.long 0x3e7d3e80,0x3e673e75,0x3d160000,0x3ddb3d95,0xbd160000,0xbddbbd95,0x3e7d3e80,0x3e673e75
.long 0x3e5c3e80,0xbc493df1,0x3e040000,0x3e803e62,0xbe040000,0xbe80be62,0x3e5c3e80,0xbc493df1
.long 0xbd163e80,0x3ddbbe75,0x3e7d0000,0xbe67bd95,0xbe7d0000,0x3e673d95,0xbd163e80,0x3ddbbe75
.long 0xbe043e80,0x3e80bdf1,0x3e5c0000,0x3c49be62,0xbe5c0000,0xbc493e62,0xbe043e80,0x3e80bdf1
.long 0x3e783e80,0x3e3e3e62,0xbd790000,0xbe2cbdf1,0xbd790000,0xbe2cbdf1,0xbe78be80,0xbe3ebe62
.long 0x3e4e3e80,0xbdac3d95,0xbe180000,0xbe71be75,0xbe180000,0xbe71be75,0xbe4ebe80,0x3dacbd95
.long 0xbd793e80,0x3e2cbe62,0xbe780000,0x3e3e3df1,0xbe780000,0x3e3e3df1,0x3d79be80,0xbe2c3e62
.long 0xbe183e80,0x3e71bd95,0xbe4e0000,0xbdac3e75,0xbe4e0000,0xbdac3e75,0x3e18be80,0xbe713d95
.long 0x3e3e3e55,0x3e043e22,0x3e2c3e0e,0x3e5c3e46,0xbe2cbe0e,0xbe5cbe46,0x3e3e3e55,0x3e043e22
.long 0xbe67be0e,0xbe4ebe7f,0x3ddb3e55,0xbe18bcc9,0xbddbbe55,0x3e183cc9,0xbe67be0e,0xbe4ebe7f
.long 0xbe2c3e55,0x3e5cbe22,0x3e3e3e0e,0xbe04be46,0xbe3ebe0e,0x3e043e46,0xbe2c3e55,0x3e5cbe22
.long 0xbddbbe0e,0xbe183e7f,0xbe673e55,0x3e4e3cc9,0x3e67be55,0xbe4ebcc9,0xbddbbe0e,0xbe183e7f
.long 0x3dac3e0e,0xbd163cc9,0xbe71be55,0xbe7dbe7f,0xbe71be55,0xbe7dbe7f,0xbdacbe0e,0x3d16bcc9
.long 0xbe80be55,0xbd79be46,0x3c49be0e,0x3e783e22,0x3c49be0e,0x3e783e22,0x3e803e55,0x3d793e46
.long 0xbe713e0e,0x3e7dbcc9,0xbdacbe55,0xbd163e7f,0xbdacbe55,0xbd163e7f,0x3e71be0e,0xbe7d3cc9
.long 0x3c49be55,0xbe783e46,0x3e80be0e,0xbd79be22,0x3e80be0e,0xbd79be22,0xbc493e55,0x3e78be46
.long 0x3d793dc4,0xbc493cc9,0x3e783e6d,0x3e803e7f,0xbe78be6d,0xbe80be7f,0x3d793dc4,0xbc493cc9
.long 0x3d16bdc4,0x3e713e22,0xbe7dbe6d,0xbdacbe46,0x3e7d3e6d,0x3dac3e46,0x3d16bdc4,0x3e713e22
.long 0xbe783dc4,0x3e80bcc9,0x3d793e6d,0x3c49be7f,0xbd79be6d,0xbc493e7f,0xbe783dc4,0x3e80bcc9
.long 0x3e7dbdc4,0xbdacbe22,0x3d16be6d,0xbe713e46,0xbd163e6d,0x3e71be46,0x3e7dbdc4,0xbdacbe22
.long 0xbe18bdc4,0xbe67be46,0xbe4ebe6d,0xbddbbe22,0xbe4ebe6d,0xbddbbe22,0x3e183dc4,0x3e673e46
.long 0x3e5c3dc4,0x3e3e3e7f,0x3e043e6d,0xbe2cbcc9,0x3e043e6d,0xbe2cbcc9,0xbe5cbdc4,0xbe3ebe7f
.long 0xbe4ebdc4,0x3ddb3e46,0x3e18be6d,0xbe673e22,0x3e18be6d,0xbe673e22,0x3e4e3dc4,0xbddbbe46
.long 0x3e043dc4,0x3e2cbe7f,0xbe5c3e6d,0x3e3e3cc9,0xbe5c3e6d,0x3e3e3cc9,0xbe04bdc4,0xbe2c3e7f
.long 0xbdacbd48,0xbe18bdf1,0x3e713e7b,0x3e4e3e62,0xbe71be7b,0xbe4ebe62,0xbdacbd48,0xbe18bdf1
.long 0x3e3e3e7b,0xbd793d95,0x3e2c3d48,0x3e783e75,0xbe2cbd48,0xbe78be75,0x3e3e3e7b,0xbd793d95
.long 0xbe71bd48,0x3e4e3df1,0xbdac3e7b,0x3e18be62,0x3dacbe7b,0xbe183e62,0xbe71bd48,0x3e4e3df1
.long 0xbe2c3e7b,0x3e78bd95,0x3e3e3d48,0x3d79be75,0xbe3ebd48,0xbd793e75,0xbe2c3e7b,0x3e78bd95
.long 0xbe80be7b,0xbe5cbe75,0x3c49bd48,0x3e043d95,0x3c49bd48,0x3e043d95,0x3e803e7b,0x3e5c3e75
.long 0xbddb3d48,0xbe7dbe62,0xbe67be7b,0x3d16bdf1,0xbe67be7b,0x3d16bdf1,0x3ddbbd48,0x3e7d3e62
.long 0x3c49be7b,0xbe043e75,0x3e80bd48,0xbe5cbd95,0x3e80bd48,0xbe5cbd95,0xbc493e7b,0x3e04be75
.long 0xbe673d48,0xbd163e62,0x3ddbbe7b,0xbe7d3df1,0x3ddbbe7b,0xbe7d3df1,0x3e67bd48,0x3d16be62
.long 0x3e183e80,0xbe71bd95,0x3e4e0000,0x3dac3e75,0xbe4e0000,0xbdacbe75,0x3e183e80,0xbe71bd95
.long 0x3d793e80,0xbe2cbe62,0x3e780000,0xbe3e3df1,0xbe780000,0x3e3ebdf1,0x3d793e80,0xbe2cbe62
.long 0xbe4e3e80,0x3dac3d95,0x3e180000,0x3e71be75,0xbe180000,0xbe713e75,0xbe4e3e80,0x3dac3d95
.long 0xbe783e80,0xbe3e3e62,0x3d790000,0x3e2cbdf1,0xbd790000,0xbe2c3df1,0xbe783e80,0xbe3e3e62
.long 0x3e043e80,0xbe80bdf1,0xbe5c0000,0xbc49be62,0xbe5c0000,0xbc49be62,0xbe04be80,0x3e803df1
.long 0x3d163e80,0xbddbbe75,0xbe7d0000,0x3e67bd95,0xbe7d0000,0x3e67bd95,0xbd16be80,0x3ddb3e75
.long 0xbe5c3e80,0x3c493df1,0xbe040000,0xbe803e62,0xbe040000,0xbe803e62,0x3e5cbe80,0xbc49bdf1
.long 0xbe7d3e80,0xbe673e75,0xbd160000,0xbddb3d95,0xbd160000,0xbddb3d95,0x3e7dbe80,0x3e67be75
.long 0xbc49be55,0x3e783e46,0xbe80be0e,0x3d79be22,0x3e803e0e,0xbd793e22,0xbc49be55,0x3e783e46
.long 0x3e713e0e,0xbe7dbcc9,0x3dacbe55,0x3d163e7f,0xbdac3e55,0xbd16be7f,0x3e713e0e,0xbe7dbcc9
.long 0x3e80be55,0x3d79be46,0xbc49be0e,0xbe783e22,0x3c493e0e,0x3e78be22,0x3e80be55,0x3d79be46
.long 0xbdac3e0e,0x3d163cc9,0x3e71be55,0x3e7dbe7f,0xbe713e55,0xbe7d3e7f,0xbdac3e0e,0x3d163cc9
.long 0x3ddbbe0e,0x3e183e7f,0x3e673e55,0xbe4e3cc9,0x3e673e55,0xbe4e3cc9,0xbddb3e0e,0xbe18be7f
.long 0x3e2c3e55,0xbe5cbe22,0xbe3e3e0e,0x3e04be46,0xbe3e3e0e,0x3e04be46,0xbe2cbe55,0x3e5c3e22
.long 0x3e67be0e,0x3e4ebe7f,0xbddb3e55,0x3e18bcc9,0xbddb3e55,0x3e18bcc9,0xbe673e0e,0xbe4e3e7f
.long 0xbe3e3e55,0xbe043e22,0xbe2c3e0e,0xbe5c3e46,0xbe2c3e0e,0xbe5c3e46,0x3e3ebe55,0x3e04be22
.long 0xbe043dc4,0xbe2cbe7f,0x3e5c3e6d,0xbe3e3cc9,0xbe5cbe6d,0x3e3ebcc9,0xbe043dc4,0xbe2cbe7f
.long 0x3e4ebdc4,0xbddb3e46,0xbe18be6d,0x3e673e22,0x3e183e6d,0xbe67be22,0x3e4ebdc4,0xbddb3e46
.long 0xbe5c3dc4,0xbe3e3e7f,0xbe043e6d,0x3e2cbcc9,0x3e04be6d,0xbe2c3cc9,0xbe5c3dc4,0xbe3e3e7f
.long 0x3e18bdc4,0x3e67be46,0x3e4ebe6d,0x3ddbbe22,0xbe4e3e6d,0xbddb3e22,0x3e18bdc4,0x3e67be46
.long 0xbe7dbdc4,0x3dacbe22,0xbd16be6d,0x3e713e46,0xbd16be6d,0x3e713e46,0x3e7d3dc4,0xbdac3e22
.long 0x3e783dc4,0xbe80bcc9,0xbd793e6d,0xbc49be7f,0xbd793e6d,0xbc49be7f,0xbe78bdc4,0x3e803cc9
.long 0xbd16bdc4,0xbe713e22,0x3e7dbe6d,0x3dacbe46,0x3e7dbe6d,0x3dacbe46,0x3d163dc4,0x3e71be22
.long 0xbd793dc4,0x3c493cc9,0xbe783e6d,0xbe803e7f,0xbe783e6d,0xbe803e7f,0x3d79bdc4,0xbc49bcc9
.long 0x3e673d48,0x3d163e62,0xbddbbe7b,0x3e7d3df1,0x3ddb3e7b,0xbe7dbdf1,0x3e673d48,0x3d163e62
.long 0xbc49be7b,0x3e043e75,0xbe80bd48,0x3e5cbd95,0x3e803d48,0xbe5c3d95,0xbc49be7b,0x3e043e75
.long 0x3ddb3d48,0x3e7dbe62,0x3e67be7b,0xbd16bdf1,0xbe673e7b,0x3d163df1,0x3ddb3d48,0x3e7dbe62
.long 0x3e80be7b,0x3e5cbe75,0xbc49bd48,0xbe043d95,0x3c493d48,0x3e04bd95,0x3e80be7b,0x3e5cbe75
.long 0x3e2c3e7b,0xbe78bd95,0xbe3e3d48,0xbd79be75,0xbe3e3d48,0xbd79be75,0xbe2cbe7b,0x3e783d95
.long 0x3e71bd48,0xbe4e3df1,0x3dac3e7b,0xbe18be62,0x3dac3e7b,0xbe18be62,0xbe713d48,0x3e4ebdf1
.long 0xbe3e3e7b,0x3d793d95,0xbe2c3d48,0xbe783e75,0xbe2c3d48,0xbe783e75,0x3e3ebe7b,0xbd79bd95
.long 0x3dacbd48,0x3e18bdf1,0xbe713e7b,0xbe4e3e62,0xbe713e7b,0xbe4e3e62,0xbdac3d48,0xbe183df1
.long 0x3e7d3e80,0x3e643e73,0x3d200000,0x3de83d9e,0xbd200000,0xbde8bd9e,0x3e7d3e80,0x3e643e73
.long 0x3e5a3e80,0xbca13de8,0x3e060000,0x3e7f3e64,0xbe060000,0xbe7fbe64,0x3e5a3e80,0xbca13de8
.long 0xbd203e80,0x3de8be73,0x3e7d0000,0xbe64bd9e,0xbe7d0000,0x3e643d9e,0xbd203e80,0x3de8be73
.long 0xbe063e80,0x3e7fbde8,0x3e5a0000,0x3ca1be64,0xbe5a0000,0xbca13e64,0xbe063e80,0x3e7fbde8
.long 0x3e793e80,0x3e433e64,0xbd6f0000,0xbe26bde8,0xbd6f0000,0xbe26bde8,0xbe79be80,0xbe43be64
.long 0x3e4f3e80,0xbd9e3d9e,0xbe160000,0xbe73be73,0xbe160000,0xbe73be73,0xbe4fbe80,0x3d9ebd9e
.long 0xbd6f3e80,0x3e26be64,0xbe790000,0x3e433de8,0xbe790000,0x3e433de8,0x3d6fbe80,0xbe263e64
.long 0xbe163e80,0x3e73bd9e,0xbe4f0000,0xbd9e3e73,0xbe4f0000,0xbd9e3e73,0x3e16be80,0xbe733d9e
.long 0x3e353e4f,0x3de83e16,0x3e353e16,0x3e643e4f,0xbe35be16,0xbe64be4f,0x3e353e4f,0x3de83e16
.long 0xbe6dbe16,0xbe43be7d,0x3dc43e4f,0xbe26bd20,0xbdc4be4f,0x3e263d20,0xbe6dbe16,0xbe43be7d
.long 0xbe353e4f,0x3e64be16,0x3e353e16,0xbde8be4f,0xbe35be16,0x3de83e4f,0xbe353e4f,0x3e64be16
.long 0xbdc4be16,0xbe263e7d,0xbe6d3e4f,0x3e433d20,0x3e6dbe4f,0xbe43bd20,0xbdc4be16,0xbe263e7d
.long 0x3dc43e16,0xbca13d20,0xbe6dbe4f,0xbe7fbe7d,0xbe6dbe4f,0xbe7fbe7d,0xbdc4be16,0x3ca1bd20
.long 0xbe80be4f,0xbd9ebe4f,0xbe16,0x3e733e16,0xbe16,0x3e733e16,0x3e803e4f,0x3d9e3e4f
.long 0xbe6d3e16,0x3e7fbd20,0xbdc4be4f,0xbca13e7d,0xbdc4be4f,0xbca13e7d,0x3e6dbe16,0xbe7f3d20
.long 0xbe4f,0xbe733e4f,0x3e80be16,0xbd9ebe16,0x3e80be16,0xbd9ebe16,0x3e4f,0x3e73be4f
.long 0x3d203d9e,0xbd200000,0x3e7d3e73,0x3e7d3e80,0xbe7dbe73,0xbe7dbe80,0x3d203d9e,0xbd200000
.long 0x3d6fbd9e,0x3e793e35,0xbe79be73,0xbd6fbe35,0x3e793e73,0x3d6f3e35,0x3d6fbd9e,0x3e793e35
.long 0xbe7d3d9e,0x3e7d0000,0x3d203e73,0x3d20be80,0xbd20be73,0xbd203e80,0xbe7d3d9e,0x3e7d0000
.long 0x3e79bd9e,0xbd6fbe35,0x3d6fbe73,0xbe793e35,0xbd6f3e73,0x3e79be35,0x3e79bd9e,0xbd6fbe35
.long 0xbe06bd9e,0xbe5abe35,0xbe5abe73,0xbe06be35,0xbe5abe73,0xbe06be35,0x3e063d9e,0x3e5a3e35
.long 0x3e4f3d9e,0x3e4f3e80,0x3e163e73,0xbe160000,0x3e163e73,0xbe160000,0xbe4fbd9e,0xbe4fbe80
.long 0xbe5abd9e,0x3e063e35,0x3e06be73,0xbe5a3e35,0x3e06be73,0xbe5a3e35,0x3e5a3d9e,0xbe06be35
.long 0x3e163d9e,0x3e16be80,0xbe4f3e73,0x3e4f0000,0xbe4f3e73,0x3e4f0000,0xbe16bd9e,0xbe163e80
.long 0xbde8bd9e,0xbe35be16,0x3e643e73,0x3e353e4f,0xbe64be73,0xbe35be4f,0xbde8bd9e,0xbe35be16
.long 0x3e263e73,0xbdc43d20,0x3e433d9e,0x3e6d3e7d,0xbe43bd9e,0xbe6dbe7d,0x3e263e73,0xbdc43d20
.long 0xbe64bd9e,0x3e353e16,0xbde83e73,0x3e35be4f,0x3de8be73,0xbe353e4f,0xbe64bd9e,0x3e353e16
.long 0xbe433e73,0x3e6dbd20,0x3e263d9e,0x3dc4be7d,0xbe26bd9e,0xbdc43e7d,0xbe433e73,0x3e6dbd20
.long 0xbe7fbe73,0xbe6dbe7d,0xbca1bd9e,0x3dc43d20,0xbca1bd9e,0x3dc43d20,0x3e7f3e73,0x3e6d3e7d
.long 0xbd9e3d9e,0xbe80be4f,0xbe73be73,0xbe16,0xbe73be73,0xbe16,0x3d9ebd9e,0x3e803e4f
.long 0xbca1be73,0xbdc43e7d,0x3e7fbd9e,0xbe6dbd20,0x3e7fbd9e,0xbe6dbd20,0x3ca13e73,0x3dc4be7d
.long 0xbe733d9e,0x3e4f,0x3d9ebe73,0xbe803e16,0x3d9ebe73,0xbe803e16,0x3e73bd9e,0xbe4f
.long 0x3e163e80,0xbe73bd9e,0x3e4f0000,0x3d9e3e73,0xbe4f0000,0xbd9ebe73,0x3e163e80,0xbe73bd9e
.long 0x3d6f3e80,0xbe26be64,0x3e790000,0xbe433de8,0xbe790000,0x3e43bde8,0x3d6f3e80,0xbe26be64
.long 0xbe4f3e80,0x3d9e3d9e,0x3e160000,0x3e73be73,0xbe160000,0xbe733e73,0xbe4f3e80,0x3d9e3d9e
.long 0xbe793e80,0xbe433e64,0x3d6f0000,0x3e26bde8,0xbd6f0000,0xbe263de8,0xbe793e80,0xbe433e64
.long 0x3e063e80,0xbe7fbde8,0xbe5a0000,0xbca1be64,0xbe5a0000,0xbca1be64,0xbe06be80,0x3e7f3de8
.long 0x3d203e80,0xbde8be73,0xbe7d0000,0x3e64bd9e,0xbe7d0000,0x3e64bd9e,0xbd20be80,0x3de83e73
.long 0xbe5a3e80,0x3ca13de8,0xbe060000,0xbe7f3e64,0xbe060000,0xbe7f3e64,0x3e5abe80,0xbca1bde8
.long 0xbe7d3e80,0xbe643e73,0xbd200000,0xbde83d9e,0xbd200000,0xbde83d9e,0x3e7dbe80,0x3e64be73
.long 0xbe4f,0x3e733e4f,0xbe80be16,0x3d9ebe16,0x3e803e16,0xbd9e3e16,0xbe4f,0x3e733e4f
.long 0x3e6d3e16,0xbe7fbd20,0x3dc4be4f,0x3ca13e7d,0xbdc43e4f,0xbca1be7d,0x3e6d3e16,0xbe7fbd20
.long 0x3e80be4f,0x3d9ebe4f,0xbe16,0xbe733e16,0x3e16,0x3e73be16,0x3e80be4f,0x3d9ebe4f
.long 0xbdc43e16,0x3ca13d20,0x3e6dbe4f,0x3e7fbe7d,0xbe6d3e4f,0xbe7f3e7d,0xbdc43e16,0x3ca13d20
.long 0x3dc4be16,0x3e263e7d,0x3e6d3e4f,0xbe433d20,0x3e6d3e4f,0xbe433d20,0xbdc43e16,0xbe26be7d
.long 0x3e353e4f,0xbe64be16,0xbe353e16,0x3de8be4f,0xbe353e16,0x3de8be4f,0xbe35be4f,0x3e643e16
.long 0x3e6dbe16,0x3e43be7d,0xbdc43e4f,0x3e26bd20,0xbdc43e4f,0x3e26bd20,0xbe6d3e16,0xbe433e7d
.long 0xbe353e4f,0xbde83e16,0xbe353e16,0xbe643e4f,0xbe353e16,0xbe643e4f,0x3e35be4f,0x3de8be16
.long 0xbe163d9e,0xbe16be80,0x3e4f3e73,0xbe4f0000,0xbe4fbe73,0x3e4f0000,0xbe163d9e,0xbe16be80
.long 0x3e5abd9e,0xbe063e35,0xbe06be73,0x3e5a3e35,0x3e063e73,0xbe5abe35,0x3e5abd9e,0xbe063e35
.long 0xbe4f3d9e,0xbe4f3e80,0xbe163e73,0x3e160000,0x3e16be73,0xbe160000,0xbe4f3d9e,0xbe4f3e80
.long 0x3e06bd9e,0x3e5abe35,0x3e5abe73,0x3e06be35,0xbe5a3e73,0xbe063e35,0x3e06bd9e,0x3e5abe35
.long 0xbe79bd9e,0x3d6fbe35,0xbd6fbe73,0x3e793e35,0xbd6fbe73,0x3e793e35,0x3e793d9e,0xbd6f3e35
.long 0x3e7d3d9e,0xbe7d0000,0xbd203e73,0xbd20be80,0xbd203e73,0xbd20be80,0xbe7dbd9e,0x3e7d0000
.long 0xbd6fbd9e,0xbe793e35,0x3e79be73,0x3d6fbe35,0x3e79be73,0x3d6fbe35,0x3d6f3d9e,0x3e79be35
.long 0xbd203d9e,0x3d200000,0xbe7d3e73,0xbe7d3e80,0xbe7d3e73,0xbe7d3e80,0x3d20bd9e,0xbd200000
.long 0x3e733d9e,0x3e4f,0xbd9ebe73,0x3e803e16,0x3d9e3e73,0xbe80be16,0x3e733d9e,0x3e4f
.long 0x3ca1be73,0x3dc43e7d,0xbe7fbd9e,0x3e6dbd20,0x3e7f3d9e,0xbe6d3d20,0x3ca1be73,0x3dc43e7d
.long 0x3d9e3d9e,0x3e80be4f,0x3e73be73,0xbe16,0xbe733e73,0x3e16,0x3d9e3d9e,0x3e80be4f
.long 0x3e7fbe73,0x3e6dbe7d,0x3ca1bd9e,0xbdc43d20,0xbca13d9e,0x3dc4bd20,0x3e7fbe73,0x3e6dbe7d
.long 0x3e433e73,0xbe6dbd20,0xbe263d9e,0xbdc4be7d,0xbe263d9e,0xbdc4be7d,0xbe43be73,0x3e6d3d20
.long 0x3e64bd9e,0xbe353e16,0x3de83e73,0xbe35be4f,0x3de83e73,0xbe35be4f,0xbe643d9e,0x3e35be16
.long 0xbe263e73,0x3dc43d20,0xbe433d9e,0xbe6d3e7d,0xbe433d9e,0xbe6d3e7d,0x3e26be73,0xbdc4bd20
.long 0x3de8bd9e,0x3e35be16,0xbe643e73,0xbe353e4f,0xbe643e73,0xbe353e4f,0xbde83d9e,0xbe353e16
.long 0x3e7c3e80,0x3e613e72,0x3d2a0000,0x3df63da8,0xbd2a0000,0xbdf6bda8,0x3e7c3e80,0x3e613e72
.long 0x3e593e80,0xbcdd3ddf,0x3e080000,0x3e7f3e66,0xbe080000,0xbe7fbe66,0x3e593e80,0xbcdd3ddf
.long 0xbd2a3e80,0x3df6be72,0x3e7c0000,0xbe61bda8,0xbe7c0000,0x3e613da8,0xbd2a3e80,0x3df6be72
.long 0xbe083e80,0x3e7fbddf,0x3e590000,0x3cddbe66,0xbe590000,0xbcdd3e66,0xbe083e80,0x3e7fbddf
.long 0x3e7a3e80,0x3e473e66,0xbd650000,0xbe20bddf,0xbd650000,0xbe20bddf,0xbe7abe80,0xbe47be66
.long 0x3e513e80,0xbd903da8,0xbe140000,0xbe76be72,0xbe140000,0xbe76be72,0xbe51be80,0x3d90bda8
.long 0xbd653e80,0x3e20be66,0xbe7a0000,0x3e473ddf,0xbe7a0000,0x3e473ddf,0x3d65be80,0xbe203e66
.long 0xbe143e80,0x3e76bda8,0xbe510000,0xbd903e72,0xbe510000,0xbd903e72,0x3e14be80,0xbe763da8
.long 0x3e2c3e49,0x3dc93e0a,0x3e3e3e1e,0x3e6c3e58,0xbe3ebe1e,0xbe6cbe58,0x3e2c3e49,0x3dc93e0a
.long 0xbe71be1e,0xbe37be7a,0x3dac3e49,0xbe33bd5b,0xbdacbe49,0x3e333d5b,0xbe71be1e,0xbe37be7a
.long 0xbe3e3e49,0x3e6cbe0a,0x3e2c3e1e,0xbdc9be58,0xbe2cbe1e,0x3dc93e58,0xbe3e3e49,0x3e6cbe0a
.long 0xbdacbe1e,0xbe333e7a,0xbe713e49,0x3e373d5b,0x3e71be49,0xbe37bd5b,0xbdacbe1e,0xbe333e7a
.long 0x3ddb3e1e,0xbb213d5b,0xbe67be49,0xbe80be7a,0xbe67be49,0xbe80be7a,0xbddbbe1e,0x3b21bd5b
.long 0xbe80be49,0xbdbfbe58,0xbc49be1e,0x3e6d3e0a,0xbc49be1e,0x3e6d3e0a,0x3e803e49,0x3dbf3e58
.long 0xbe673e1e,0x3e80bd5b,0xbddbbe49,0xbb213e7a,0xbddbbe49,0xbb213e7a,0x3e67be1e,0xbe803d5b
.long 0xbc49be49,0xbe6d3e58,0x3e80be1e,0xbdbfbe0a,0x3e80be1e,0xbdbfbe0a,0x3c493e49,0x3e6dbe58
.long 0x3c8d3d6f,0xbd86bcc9,0x3e7f3e79,0x3e773e7f,0xbe7fbe79,0xbe77be7f,0x3c8d3d6f,0xbd86bcc9
.long 0x3da3bd6f,0x3e7e3e46,0xbe73be79,0xbd02be22,0x3e733e79,0x3d023e22,0x3da3bd6f,0x3e7e3e46
.long 0xbe7f3d6f,0x3e773cc9,0x3c8d3e79,0x3d86be7f,0xbc8dbe79,0xbd863e7f,0xbe7f3d6f,0x3e773cc9
.long 0x3e73bd6f,0xbd02be46,0x3da3be79,0xbe7e3e22,0xbda33e79,0x3e7ebe22,0x3e73bd6f,0xbd02be46
.long 0xbde4bd6f,0xbe4bbe22,0xbe65be79,0xbe1dbe46,0xbe65be79,0xbe1dbe46,0x3de43d6f,0x3e4b3e22
.long 0x3e413d6f,0x3e5e3e7f,0x3e283e79,0xbdff3cc9,0x3e283e79,0xbdff3cc9,0xbe41bd6f,0xbe5ebe7f
.long 0xbe65bd6f,0x3e1d3e22,0x3de4be79,0xbe4b3e46,0x3de4be79,0xbe4b3e46,0x3e653d6f,0xbe1dbe22
.long 0x3e283d6f,0x3dffbe7f,0xbe413e79,0x3e5ebcc9,0xbe413e79,0x3e5ebcc9,0xbe28bd6f,0xbdff3e7f
.long 0xbe10bdd6,0xbe4ebe31,0x3e533e68,0x3e183e39,0xbe53be68,0xbe18be39,0xbe10bdd6,0xbe4ebe31
.long 0x3e0c3e68,0xbe043ba1,0x3e563dd6,0x3e5c3e80,0xbe56bdd6,0xbe5cbe80,0x3e0c3e68,0xbe043ba1
.long 0xbe53bdd6,0x3e183e31,0xbe103e68,0x3e4ebe39,0x3e10be68,0xbe4e3e39,0xbe53bdd6,0x3e183e31
.long 0xbe563e68,0x3e5cbba1,0x3e0c3dd6,0x3e04be80,0xbe0cbdd6,0xbe043e80,0xbe563e68,0x3e5cbba1
.long 0xbe7bbe68,0xbe78be80,0xbd52bdd6,0x3d793ba1,0xbd52bdd6,0x3d793ba1,0x3e7b3e68,0x3e783e80
.long 0xbd3e3dd6,0xbe7dbe39,0xbe7cbe68,0xbd16be31,0xbe7cbe68,0xbd16be31,0x3d3ebdd6,0x3e7d3e39
.long 0xbd52be68,0xbd793e80,0x3e7bbdd6,0xbe78bba1,0x3e7bbdd6,0xbe78bba1,0x3d523e68,0x3d79be80
.long 0xbe7c3dd6,0x3d163e39,0x3d3ebe68,0xbe7d3e31,0x3d3ebe68,0xbe7d3e31,0x3e7cbdd6,0xbd16be39
.long 0x3e143e80,0xbe76bda8,0x3e510000,0x3d903e72,0xbe510000,0xbd90be72,0x3e143e80,0xbe76bda8
.long 0x3d653e80,0xbe20be66,0x3e7a0000,0xbe473ddf,0xbe7a0000,0x3e47bddf,0x3d653e80,0xbe20be66
.long 0xbe513e80,0x3d903da8,0x3e140000,0x3e76be72,0xbe140000,0xbe763e72,0xbe513e80,0x3d903da8
.long 0xbe7a3e80,0xbe473e66,0x3d650000,0x3e20bddf,0xbd650000,0xbe203ddf,0xbe7a3e80,0xbe473e66
.long 0x3e083e80,0xbe7fbddf,0xbe590000,0xbcddbe66,0xbe590000,0xbcddbe66,0xbe08be80,0x3e7f3ddf
.long 0x3d2a3e80,0xbdf6be72,0xbe7c0000,0x3e61bda8,0xbe7c0000,0x3e61bda8,0xbd2abe80,0x3df63e72
.long 0xbe593e80,0x3cdd3ddf,0xbe080000,0xbe7f3e66,0xbe080000,0xbe7f3e66,0x3e59be80,0xbcddbddf
.long 0xbe7c3e80,0xbe613e72,0xbd2a0000,0xbdf63da8,0xbd2a0000,0xbdf63da8,0x3e7cbe80,0x3e61be72
.long 0x3c49be49,0x3e6d3e58,0xbe80be1e,0x3dbfbe0a,0x3e803e1e,0xbdbf3e0a,0x3c49be49,0x3e6d3e58
.long 0x3e673e1e,0xbe80bd5b,0x3ddbbe49,0x3b213e7a,0xbddb3e49,0xbb21be7a,0x3e673e1e,0xbe80bd5b
.long 0x3e80be49,0x3dbfbe58,0x3c49be1e,0xbe6d3e0a,0xbc493e1e,0x3e6dbe0a,0x3e80be49,0x3dbfbe58
.long 0xbddb3e1e,0x3b213d5b,0x3e67be49,0x3e80be7a,0xbe673e49,0xbe803e7a,0xbddb3e1e,0x3b213d5b
.long 0x3dacbe1e,0x3e333e7a,0x3e713e49,0xbe373d5b,0x3e713e49,0xbe373d5b,0xbdac3e1e,0xbe33be7a
.long 0x3e3e3e49,0xbe6cbe0a,0xbe2c3e1e,0x3dc9be58,0xbe2c3e1e,0x3dc9be58,0xbe3ebe49,0x3e6c3e0a
.long 0x3e71be1e,0x3e37be7a,0xbdac3e49,0x3e33bd5b,0xbdac3e49,0x3e33bd5b,0xbe713e1e,0xbe373e7a
.long 0xbe2c3e49,0xbdc93e0a,0xbe3e3e1e,0xbe6c3e58,0xbe3e3e1e,0xbe6c3e58,0x3e2cbe49,0x3dc9be0a
.long 0xbe283d6f,0xbdffbe7f,0x3e413e79,0xbe5ebcc9,0xbe41be79,0x3e5e3cc9,0xbe283d6f,0xbdffbe7f
.long 0x3e65bd6f,0xbe1d3e22,0xbde4be79,0x3e4b3e46,0x3de43e79,0xbe4bbe46,0x3e65bd6f,0xbe1d3e22
.long 0xbe413d6f,0xbe5e3e7f,0xbe283e79,0x3dff3cc9,0x3e28be79,0xbdffbcc9,0xbe413d6f,0xbe5e3e7f
.long 0x3de4bd6f,0x3e4bbe22,0x3e65be79,0x3e1dbe46,0xbe653e79,0xbe1d3e46,0x3de4bd6f,0x3e4bbe22
.long 0xbe73bd6f,0x3d02be46,0xbda3be79,0x3e7e3e22,0xbda3be79,0x3e7e3e22,0x3e733d6f,0xbd023e46
.long 0x3e7f3d6f,0xbe773cc9,0xbc8d3e79,0xbd86be7f,0xbc8d3e79,0xbd86be7f,0xbe7fbd6f,0x3e77bcc9
.long 0xbda3bd6f,0xbe7e3e46,0x3e73be79,0x3d02be22,0x3e73be79,0x3d02be22,0x3da33d6f,0x3e7ebe46
.long 0xbc8d3d6f,0x3d86bcc9,0xbe7f3e79,0xbe773e7f,0xbe7f3e79,0xbe773e7f,0x3c8dbd6f,0xbd863cc9
.long 0x3e7c3dd6,0xbd163e39,0xbd3ebe68,0x3e7d3e31,0x3d3e3e68,0xbe7dbe31,0x3e7c3dd6,0xbd163e39
.long 0x3d52be68,0x3d793e80,0xbe7bbdd6,0x3e78bba1,0x3e7b3dd6,0xbe783ba1,0x3d52be68,0x3d793e80
.long 0x3d3e3dd6,0x3e7dbe39,0x3e7cbe68,0x3d16be31,0xbe7c3e68,0xbd163e31,0x3d3e3dd6,0x3e7dbe39
.long 0x3e7bbe68,0x3e78be80,0x3d52bdd6,0xbd793ba1,0xbd523dd6,0x3d79bba1,0x3e7bbe68,0x3e78be80
.long 0x3e563e68,0xbe5cbba1,0xbe0c3dd6,0xbe04be80,0xbe0c3dd6,0xbe04be80,0xbe56be68,0x3e5c3ba1
.long 0x3e53bdd6,0xbe183e31,0x3e103e68,0xbe4ebe39,0x3e103e68,0xbe4ebe39,0xbe533dd6,0x3e18be31
.long 0xbe0c3e68,0x3e043ba1,0xbe563dd6,0xbe5c3e80,0xbe563dd6,0xbe5c3e80,0x3e0cbe68,0xbe04bba1
.long 0x3e10bdd6,0x3e4ebe31,0xbe533e68,0xbe183e39,0xbe533e68,0xbe183e39,0xbe103dd6,0xbe4e3e31
.long 0x3e7c3e80,0x3e5d3e70,0x3d340000,0x3e013db1,0xbd340000,0xbe01bdb1,0x3e7c3e80,0x3e5d3e70
.long 0x3e583e80,0xbd0c3dd6,0x3e0a0000,0x3e7e3e68,0xbe0a0000,0xbe7ebe68,0x3e583e80,0xbd0c3dd6
.long 0xbd343e80,0x3e01be70,0x3e7c0000,0xbe5dbdb1,0xbe7c0000,0x3e5d3db1,0xbd343e80,0x3e01be70
.long 0xbe0a3e80,0x3e7ebdd6,0x3e580000,0x3d0cbe68,0xbe580000,0xbd0c3e68,0xbe0a3e80,0x3e7ebdd6
.long 0x3e7a3e80,0x3e4c3e68,0xbd5b0000,0xbe1bbdd6,0xbd5b0000,0xbe1bbdd6,0xbe7abe80,0xbe4cbe68
.long 0x3e523e80,0xbd813db1,0xbe120000,0xbe78be70,0xbe120000,0xbe78be70,0xbe52be80,0x3d81bdb1
.long 0xbd5b3e80,0x3e1bbe68,0xbe7a0000,0x3e4c3dd6,0xbe7a0000,0x3e4c3dd6,0x3d5bbe80,0xbe1b3e68
.long 0xbe123e80,0x3e78bdb1,0xbe520000,0xbd813e70,0xbe520000,0xbd813e70,0x3e12be80,0xbe783db1
.long 0x3e223e43,0x3da83dfa,0x3e463e26,0x3e723e5f,0xbe46be26,0xbe72be5f,0x3e223e43,0x3da83dfa
.long 0xbe75be26,0xbe2abe76,0x3d953e43,0xbe3fbd8b,0xbd95be43,0x3e3f3d8b,0xbe75be26,0xbe2abe76
.long 0xbe463e43,0x3e72bdfa,0x3e223e26,0xbda8be5f,0xbe22be26,0x3da83e5f,0xbe463e43,0x3e72bdfa
.long 0xbd95be26,0xbe3f3e76,0xbe753e43,0x3e2a3d8b,0x3e75be43,0xbe2abd8b,0xbd95be26,0xbe3f3e76
.long 0x3df13e26,0x3c713d8b,0xbe62be43,0xbe80be76,0xbe62be43,0xbe80be76,0xbdf1be26,0xbc71bd8b
.long 0xbe7fbe43,0xbddfbe5f,0xbcc9be26,0x3e663dfa,0xbcc9be26,0x3e663dfa,0x3e7f3e43,0x3ddf3e5f
.long 0xbe623e26,0x3e80bd8b,0xbdf1be43,0x3c713e76,0xbdf1be43,0x3c713e76,0x3e62be26,0xbe803d8b
.long 0xbcc9be43,0xbe663e5f,0x3e7fbe26,0xbddfbdfa,0x3e7fbe26,0xbddfbdfa,0x3cc93e43,0x3e66be5f
.long 0xbba13d20,0xbdbbbd48,0x3e803e7d,0x3e6e3e7b,0xbe80be7d,0xbe6ebe7b,0xbba13d20,0xbdbbbd48
.long 0x3dcdbd20,0x3e803e55,0xbe6bbe7d,0xbba1be0e,0x3e6b3e7d,0x3ba13e0e,0x3dcdbd20,0x3e803e55
.long 0xbe803d20,0x3e6e3d48,0xbba13e7d,0x3dbbbe7b,0x3ba1be7d,0xbdbb3e7b,0xbe803d20,0x3e6e3d48
.long 0x3e6bbd20,0xbba1be55,0x3dcdbe7d,0xbe803e0e,0xbdcd3e7d,0x3e80be0e,0x3e6bbd20,0xbba1be55
.long 0xbdbbbd20,0xbe39be0e,0xbe6ebe7d,0xbe31be55,0xbe6ebe7d,0xbe31be55,0x3dbb3d20,0x3e393e0e
.long 0x3e313d20,0x3e6b3e7b,0x3e393e7d,0xbdcd3d48,0x3e393e7d,0xbdcd3d48,0xbe31bd20,0xbe6bbe7b
.long 0xbe6ebd20,0x3e313e0e,0x3dbbbe7d,0xbe393e55,0x3dbbbe7d,0xbe393e55,0x3e6e3d20,0xbe31be0e
.long 0x3e393d20,0x3dcdbe7b,0xbe313e7d,0x3e6bbd48,0xbe313e7d,0x3e6bbd48,0xbe39bd20,0xbdcd3e7b
.long 0xbe2abe06,0xbe62be49,0x3e3f3e5a,0x3df13e1e,0xbe3fbe5a,0xbdf1be1e,0xbe2abe06,0xbe62be49
.long 0x3ddf3e5a,0xbe22bcf1,0x3e663e06,0x3e463e7e,0xbe66be06,0xbe46be7e,0x3ddf3e5a,0xbe22bcf1
.long 0xbe3fbe06,0x3df13e49,0xbe2a3e5a,0x3e62be1e,0x3e2abe5a,0xbe623e1e,0xbe3fbe06,0x3df13e49
.long 0xbe663e5a,0x3e463cf1,0x3ddf3e06,0x3e22be7e,0xbddfbe06,0xbe223e7e,0xbe663e5a,0x3e463cf1
.long 0xbe72be5a,0xbe7fbe7e,0xbda8be06,0x3cc9bcf1,0xbda8be06,0x3cc9bcf1,0x3e723e5a,0x3e7f3e7e
.long 0xbc713e06,0xbe75be1e,0xbe80be5a,0xbd95be49,0xbe80be5a,0xbd95be49,0x3c71be06,0x3e753e1e
.long 0xbda8be5a,0xbcc93e7e,0x3e72be06,0xbe7f3cf1,0x3e72be06,0xbe7f3cf1,0x3da83e5a,0x3cc9be7e
.long 0xbe803e06,0x3d953e1e,0x3c71be5a,0xbe753e49,0x3c71be5a,0xbe753e49,0x3e80be06,0xbd95be1e
.long 0x3e123e80,0xbe78bdb1,0x3e520000,0x3d813e70,0xbe520000,0xbd81be70,0x3e123e80,0xbe78bdb1
.long 0x3d5b3e80,0xbe1bbe68,0x3e7a0000,0xbe4c3dd6,0xbe7a0000,0x3e4cbdd6,0x3d5b3e80,0xbe1bbe68
.long 0xbe523e80,0x3d813db1,0x3e120000,0x3e78be70,0xbe120000,0xbe783e70,0xbe523e80,0x3d813db1
.long 0xbe7a3e80,0xbe4c3e68,0x3d5b0000,0x3e1bbdd6,0xbd5b0000,0xbe1b3dd6,0xbe7a3e80,0xbe4c3e68
.long 0x3e0a3e80,0xbe7ebdd6,0xbe580000,0xbd0cbe68,0xbe580000,0xbd0cbe68,0xbe0abe80,0x3e7e3dd6
.long 0x3d343e80,0xbe01be70,0xbe7c0000,0x3e5dbdb1,0xbe7c0000,0x3e5dbdb1,0xbd34be80,0x3e013e70
.long 0xbe583e80,0x3d0c3dd6,0xbe0a0000,0xbe7e3e68,0xbe0a0000,0xbe7e3e68,0x3e58be80,0xbd0cbdd6
.long 0xbe7c3e80,0xbe5d3e70,0xbd340000,0xbe013db1,0xbd340000,0xbe013db1,0x3e7cbe80,0x3e5dbe70
.long 0x3cc9be43,0x3e663e5f,0xbe7fbe26,0x3ddfbdfa,0x3e7f3e26,0xbddf3dfa,0x3cc9be43,0x3e663e5f
.long 0x3e623e26,0xbe80bd8b,0x3df1be43,0xbc713e76,0xbdf13e43,0x3c71be76,0x3e623e26,0xbe80bd8b
.long 0x3e7fbe43,0x3ddfbe5f,0x3cc9be26,0xbe663dfa,0xbcc93e26,0x3e66bdfa,0x3e7fbe43,0x3ddfbe5f
.long 0xbdf13e26,0xbc713d8b,0x3e62be43,0x3e80be76,0xbe623e43,0xbe803e76,0xbdf13e26,0xbc713d8b
.long 0x3d95be26,0x3e3f3e76,0x3e753e43,0xbe2a3d8b,0x3e753e43,0xbe2a3d8b,0xbd953e26,0xbe3fbe76
.long 0x3e463e43,0xbe72bdfa,0xbe223e26,0x3da8be5f,0xbe223e26,0x3da8be5f,0xbe46be43,0x3e723dfa
.long 0x3e75be26,0x3e2abe76,0xbd953e43,0x3e3fbd8b,0xbd953e43,0x3e3fbd8b,0xbe753e26,0xbe2a3e76
.long 0xbe223e43,0xbda83dfa,0xbe463e26,0xbe723e5f,0xbe463e26,0xbe723e5f,0x3e22be43,0x3da8bdfa
.long 0xbe393d20,0xbdcdbe7b,0x3e313e7d,0xbe6bbd48,0xbe31be7d,0x3e6b3d48,0xbe393d20,0xbdcdbe7b
.long 0x3e6ebd20,0xbe313e0e,0xbdbbbe7d,0x3e393e55,0x3dbb3e7d,0xbe39be55,0x3e6ebd20,0xbe313e0e
.long 0xbe313d20,0xbe6b3e7b,0xbe393e7d,0x3dcd3d48,0x3e39be7d,0xbdcdbd48,0xbe313d20,0xbe6b3e7b
.long 0x3dbbbd20,0x3e39be0e,0x3e6ebe7d,0x3e31be55,0xbe6e3e7d,0xbe313e55,0x3dbbbd20,0x3e39be0e
.long 0xbe6bbd20,0x3ba1be55,0xbdcdbe7d,0x3e803e0e,0xbdcdbe7d,0x3e803e0e,0x3e6b3d20,0xbba13e55
.long 0x3e803d20,0xbe6e3d48,0x3ba13e7d,0xbdbbbe7b,0x3ba13e7d,0xbdbbbe7b,0xbe80bd20,0x3e6ebd48
.long 0xbdcdbd20,0xbe803e55,0x3e6bbe7d,0x3ba1be0e,0x3e6bbe7d,0x3ba1be0e,0x3dcd3d20,0x3e80be55
.long 0x3ba13d20,0x3dbbbd48,0xbe803e7d,0xbe6e3e7b,0xbe803e7d,0xbe6e3e7b,0xbba1bd20,0xbdbb3d48
.long 0x3e803e06,0xbd953e1e,0xbc71be5a,0x3e753e49,0x3c713e5a,0xbe75be49,0x3e803e06,0xbd953e1e
.long 0x3da8be5a,0x3cc93e7e,0xbe72be06,0x3e7f3cf1,0x3e723e06,0xbe7fbcf1,0x3da8be5a,0x3cc93e7e
.long 0x3c713e06,0x3e75be1e,0x3e80be5a,0x3d95be49,0xbe803e5a,0xbd953e49,0x3c713e06,0x3e75be1e
.long 0x3e72be5a,0x3e7fbe7e,0x3da8be06,0xbcc9bcf1,0xbda83e06,0x3cc93cf1,0x3e72be5a,0x3e7fbe7e
.long 0x3e663e5a,0xbe463cf1,0xbddf3e06,0xbe22be7e,0xbddf3e06,0xbe22be7e,0xbe66be5a,0x3e46bcf1
.long 0x3e3fbe06,0xbdf13e49,0x3e2a3e5a,0xbe62be1e,0x3e2a3e5a,0xbe62be1e,0xbe3f3e06,0x3df1be49
.long 0xbddf3e5a,0x3e22bcf1,0xbe663e06,0xbe463e7e,0xbe663e06,0xbe463e7e,0x3ddfbe5a,0xbe223cf1
.long 0x3e2abe06,0x3e62be49,0xbe3f3e5a,0xbdf13e1e,0xbe3f3e5a,0xbdf13e1e,0xbe2a3e06,0xbe623e49
.long 0x3e7c3e80,0x3e593e6e,0x3d3e0000,0x3e083dbb,0xbd3e0000,0xbe08bdbb,0x3e7c3e80,0x3e593e6e
.long 0x3e563e80,0xbd2a3dcd,0x3e0c0000,0x3e7c3e6b,0xbe0c0000,0xbe7cbe6b,0x3e563e80,0xbd2a3dcd
.long 0xbd3e3e80,0x3e08be6e,0x3e7c0000,0xbe59bdbb,0xbe7c0000,0x3e593dbb,0xbd3e3e80,0x3e08be6e
.long 0xbe0c3e80,0x3e7cbdcd,0x3e560000,0x3d2abe6b,0xbe560000,0xbd2a3e6b,0xbe0c3e80,0x3e7cbdcd
.long 0x3e7b3e80,0x3e513e6b,0xbd520000,0xbe14bdcd,0xbd520000,0xbe14bdcd,0xbe7bbe80,0xbe51be6b
.long 0x3e533e80,0xbd653dbb,0xbe100000,0xbe7abe6e,0xbe100000,0xbe7abe6e,0xbe53be80,0x3d65bdbb
.long 0xbd523e80,0x3e14be6b,0xbe7b0000,0x3e513dcd,0xbe7b0000,0x3e513dcd,0x3d52be80,0xbe143e6b
.long 0xbe103e80,0x3e7abdbb,0xbe530000,0xbd653e6e,0xbe530000,0xbd653e6e,0x3e10be80,0xbe7a3dbb
.long 0x3e183e3c,0x3d863ddf,0x3e4e3e2e,0x3e773e66,0xbe4ebe2e,0xbe77be66,0x3e183e3c,0x3d863ddf
.long 0xbe78be2e,0xbe1dbe72,0x3d793e3c,0xbe4bbda8,0xbd79be3c,0x3e4b3da8,0xbe78be2e,0xbe1dbe72
.long 0xbe4e3e3c,0x3e77bddf,0x3e183e2e,0xbd86be66,0xbe18be2e,0x3d863e66,0xbe4e3e3c,0x3e77bddf
.long 0xbd79be2e,0xbe4b3e72,0xbe783e3c,0x3e1d3da8,0x3e78be3c,0xbe1dbda8,0xbd79be2e,0xbe4b3e72
.long 0x3e043e2e,0x3d023da8,0xbe5cbe3c,0xbe7ebe72,0xbe5cbe3c,0xbe7ebe72,0xbe04be2e,0xbd02bda8
.long 0xbe7dbe3c,0xbdffbe66,0xbd16be2e,0x3e5e3ddf,0xbd16be2e,0x3e5e3ddf,0x3e7d3e3c,0x3dff3e66
.long 0xbe5c3e2e,0x3e7ebda8,0xbe04be3c,0x3d023e72,0xbe04be3c,0x3d023e72,0x3e5cbe2e,0xbe7e3da8
.long 0xbd16be3c,0xbe5e3e66,0x3e7dbe2e,0xbdffbddf,0x3e7dbe2e,0xbdffbddf,0x3d163e3c,0x3e5ebe66
.long 0xbcdd3ca1,0xbdedbd95,0x3e7f3e7f,0x3e633e75,0xbe7fbe7f,0xbe63be75,0xbcdd3ca1,0xbdedbd95
.long 0x3df6bca1,0x3e7f3e62,0xbe61be7f,0x3cb5bdf1,0x3e613e7f,0xbcb53df1,0x3df6bca1,0x3e7f3e62
.long 0xbe7f3ca1,0x3e633d95,0xbcdd3e7f,0x3dedbe75,0x3cddbe7f,0xbded3e75,0xbe7f3ca1,0x3e633d95
.long 0x3e61bca1,0x3cb5be62,0x3df6be7f,0xbe7f3df1,0xbdf63e7f,0x3e7fbdf1,0x3e61bca1,0x3cb5be62
.long 0xbd90bca1,0xbe24bdf1,0xbe76be7f,0xbe44be62,0xbe76be7f,0xbe44be62,0x3d903ca1,0x3e243df1
.long 0x3e203ca1,0x3e743e75,0x3e473e7f,0xbd993d95,0x3e473e7f,0xbd993d95,0xbe20bca1,0xbe74be75
.long 0xbe76bca1,0x3e443df1,0x3d90be7f,0xbe243e62,0x3d90be7f,0xbe243e62,0x3e763ca1,0xbe44bdf1
.long 0x3e473ca1,0x3d99be75,0xbe203e7f,0x3e74bd95,0xbe203e7f,0x3e74bd95,0xbe47bca1,0xbd993e75
.long 0xbe41be1e,0xbe71be5d,0x3e283e49,0x3dac3e01,0xbe28be49,0xbdacbe01,0xbe41be1e,0xbe71be5d
.long 0x3da33e49,0xbe3ebd81,0x3e733e1e,0x3e2c3e78,0xbe73be1e,0xbe2cbe78,0x3da33e49,0xbe3ebd81
.long 0xbe28be1e,0x3dac3e5d,0xbe413e49,0x3e71be01,0x3e41be49,0xbe713e01,0xbe28be1e,0x3dac3e5d
.long 0xbe733e49,0x3e2c3d81,0x3da33e1e,0x3e3ebe78,0xbda3be1e,0xbe3e3e78,0xbe733e49,0x3e2c3d81
.long 0xbe65be49,0xbe80be78,0xbde4be1e,0xbc49bd81,0xbde4be1e,0xbc49bd81,0x3e653e49,0x3e803e78
.long 0x3c8d3e1e,0xbe67be01,0xbe7fbe49,0xbddbbe5d,0xbe7fbe49,0xbddbbe5d,0xbc8dbe1e,0x3e673e01
.long 0xbde4be49,0x3c493e78,0x3e65be1e,0xbe803d81,0x3e65be1e,0xbe803d81,0x3de43e49,0xbc49be78
.long 0xbe7f3e1e,0x3ddb3e01,0xbc8dbe49,0xbe673e5d,0xbc8dbe49,0xbe673e5d,0x3e7fbe1e,0xbddbbe01
.long 0x3e103e80,0xbe7abdbb,0x3e530000,0x3d653e6e,0xbe530000,0xbd65be6e,0x3e103e80,0xbe7abdbb
.long 0x3d523e80,0xbe14be6b,0x3e7b0000,0xbe513dcd,0xbe7b0000,0x3e51bdcd,0x3d523e80,0xbe14be6b
.long 0xbe533e80,0x3d653dbb,0x3e100000,0x3e7abe6e,0xbe100000,0xbe7a3e6e,0xbe533e80,0x3d653dbb
.long 0xbe7b3e80,0xbe513e6b,0x3d520000,0x3e14bdcd,0xbd520000,0xbe143dcd,0xbe7b3e80,0xbe513e6b
.long 0x3e0c3e80,0xbe7cbdcd,0xbe560000,0xbd2abe6b,0xbe560000,0xbd2abe6b,0xbe0cbe80,0x3e7c3dcd
.long 0x3d3e3e80,0xbe08be6e,0xbe7c0000,0x3e59bdbb,0xbe7c0000,0x3e59bdbb,0xbd3ebe80,0x3e083e6e
.long 0xbe563e80,0x3d2a3dcd,0xbe0c0000,0xbe7c3e6b,0xbe0c0000,0xbe7c3e6b,0x3e56be80,0xbd2abdcd
.long 0xbe7c3e80,0xbe593e6e,0xbd3e0000,0xbe083dbb,0xbd3e0000,0xbe083dbb,0x3e7cbe80,0x3e59be6e
.long 0x3d16be3c,0x3e5e3e66,0xbe7dbe2e,0x3dffbddf,0x3e7d3e2e,0xbdff3ddf,0x3d16be3c,0x3e5e3e66
.long 0x3e5c3e2e,0xbe7ebda8,0x3e04be3c,0xbd023e72,0xbe043e3c,0x3d02be72,0x3e5c3e2e,0xbe7ebda8
.long 0x3e7dbe3c,0x3dffbe66,0x3d16be2e,0xbe5e3ddf,0xbd163e2e,0x3e5ebddf,0x3e7dbe3c,0x3dffbe66
.long 0xbe043e2e,0xbd023da8,0x3e5cbe3c,0x3e7ebe72,0xbe5c3e3c,0xbe7e3e72,0xbe043e2e,0xbd023da8
.long 0x3d79be2e,0x3e4b3e72,0x3e783e3c,0xbe1d3da8,0x3e783e3c,0xbe1d3da8,0xbd793e2e,0xbe4bbe72
.long 0x3e4e3e3c,0xbe77bddf,0xbe183e2e,0x3d86be66,0xbe183e2e,0x3d86be66,0xbe4ebe3c,0x3e773ddf
.long 0x3e78be2e,0x3e1dbe72,0xbd793e3c,0x3e4bbda8,0xbd793e3c,0x3e4bbda8,0xbe783e2e,0xbe1d3e72
.long 0xbe183e3c,0xbd863ddf,0xbe4e3e2e,0xbe773e66,0xbe4e3e2e,0xbe773e66,0x3e18be3c,0x3d86bddf
.long 0xbe473ca1,0xbd99be75,0x3e203e7f,0xbe74bd95,0xbe20be7f,0x3e743d95,0xbe473ca1,0xbd99be75
.long 0x3e76bca1,0xbe443df1,0xbd90be7f,0x3e243e62,0x3d903e7f,0xbe24be62,0x3e76bca1,0xbe443df1
.long 0xbe203ca1,0xbe743e75,0xbe473e7f,0x3d993d95,0x3e47be7f,0xbd99bd95,0xbe203ca1,0xbe743e75
.long 0x3d90bca1,0x3e24bdf1,0x3e76be7f,0x3e44be62,0xbe763e7f,0xbe443e62,0x3d90bca1,0x3e24bdf1
.long 0xbe61bca1,0xbcb5be62,0xbdf6be7f,0x3e7f3df1,0xbdf6be7f,0x3e7f3df1,0x3e613ca1,0x3cb53e62
.long 0x3e7f3ca1,0xbe633d95,0x3cdd3e7f,0xbdedbe75,0x3cdd3e7f,0xbdedbe75,0xbe7fbca1,0x3e63bd95
.long 0xbdf6bca1,0xbe7f3e62,0x3e61be7f,0xbcb5bdf1,0x3e61be7f,0xbcb5bdf1,0x3df63ca1,0x3e7fbe62
.long 0x3cdd3ca1,0x3dedbd95,0xbe7f3e7f,0xbe633e75,0xbe7f3e7f,0xbe633e75,0xbcddbca1,0xbded3d95
.long 0x3e7f3e1e,0xbddb3e01,0x3c8dbe49,0x3e673e5d,0xbc8d3e49,0xbe67be5d,0x3e7f3e1e,0xbddb3e01
.long 0x3de4be49,0xbc493e78,0xbe65be1e,0x3e803d81,0x3e653e1e,0xbe80bd81,0x3de4be49,0xbc493e78
.long 0xbc8d3e1e,0x3e67be01,0x3e7fbe49,0x3ddbbe5d,0xbe7f3e49,0xbddb3e5d,0xbc8d3e1e,0x3e67be01
.long 0x3e65be49,0x3e80be78,0x3de4be1e,0x3c49bd81,0xbde43e1e,0xbc493d81,0x3e65be49,0x3e80be78
.long 0x3e733e49,0xbe2c3d81,0xbda33e1e,0xbe3ebe78,0xbda33e1e,0xbe3ebe78,0xbe73be49,0x3e2cbd81
.long 0x3e28be1e,0xbdac3e5d,0x3e413e49,0xbe71be01,0x3e413e49,0xbe71be01,0xbe283e1e,0x3dacbe5d
.long 0xbda33e49,0x3e3ebd81,0xbe733e1e,0xbe2c3e78,0xbe733e1e,0xbe2c3e78,0x3da3be49,0xbe3e3d81
.long 0x3e41be1e,0x3e71be5d,0xbe283e49,0xbdac3e01,0xbe283e49,0xbdac3e01,0xbe413e1e,0xbe713e5d
.long 0xc00,0xc10,0xc20,0xc30,0xc80,0xc90,0xca0,0xcb0
.long 0xc40,0xc50,0xc60,0xc70,0xcc0,0xcd0,0xce0,0xcf0
.long 0x580,0x590,0x5a0,0x5b0,0x5c0,0x5d0,0x5e0,0x5f0
.long 0xd00,0xd10,0xd20,0xd30,0xd80,0xd90,0xda0,0xdb0
.long 0xd40,0xd50,0xd60,0xd70,0xdc0,0xdd0,0xde0,0xdf0
.long 0x32c00,0x32c10,0x32c20,0x32c30,0x32c80,0x32c90,0x32ca0,0x32cb0
.long 0x32c40,0x32c50,0x32c60,0x32c70,0x32cc0,0x32cd0,0x32ce0,0x32cf0
.long 0x32580,0x32590,0x325a0,0x325b0,0x325c0,0x325d0,0x325e0,0x325f0
.long 0x32d00,0x32d10,0x32d20,0x32d30,0x32d80,0x32d90,0x32da0,0x32db0
.long 0x32d40,0x32d50,0x32d60,0x32d70,0x32dc0,0x32dd0,0x32de0,0x32df0
.long 0x64c00,0x64c10,0x64c20,0x64c30,0x64c80,0x64c90,0x64ca0,0x64cb0
.long 0x64c40,0x64c50,0x64c60,0x64c70,0x64cc0,0x64cd0,0x64ce0,0x64cf0
.long 0x64580,0x64590,0x645a0,0x645b0,0x645c0,0x645d0,0x645e0,0x645f0
.long 0x64d00,0x64d10,0x64d20,0x64d30,0x64d80,0x64d90,0x64da0,0x64db0
.long 0x64d40,0x64d50,0x64d60,0x64d70,0x64dc0,0x64dd0,0x64de0,0x64df0
.long 0x96c00,0x96c10,0x96c20,0x96c30,0x96c80,0x96c90,0x96ca0,0x96cb0
.long 0x96c40,0x96c50,0x96c60,0x96c70,0x96cc0,0x96cd0,0x96ce0,0x96cf0
.long 0x96580,0x96590,0x965a0,0x965b0,0x965c0,0x965d0,0x965e0,0x965f0
.long 0x96d00,0x96d10,0x96d20,0x96d30,0x96d80,0x96d90,0x96da0,0x96db0
.long 0x96d40,0x96d50,0x96d60,0x96d70,0x96dc0,0x96dd0,0x96de0,0x96df0
.long 0xc8c00,0xc8c10,0xc8c20,0xc8c30,0xc8c80,0xc8c90,0xc8ca0,0xc8cb0
.long 0xc8c40,0xc8c50,0xc8c60,0xc8c70,0xc8cc0,0xc8cd0,0xc8ce0,0xc8cf0
.long 0xc8580,0xc8590,0xc85a0,0xc85b0,0xc85c0,0xc85d0,0xc85e0,0xc85f0
.long 0xc8d00,0xc8d10,0xc8d20,0xc8d30,0xc8d80,0xc8d90,0xc8da0,0xc8db0
.long 0xc8d40,0xc8d50,0xc8d60,0xc8d70,0xc8dc0,0xc8dd0,0xc8de0,0xc8df0
.long 0xfac00,0xfac10,0xfac20,0xfac30,0xfac80,0xfac90,0xfaca0,0xfacb0
.long 0xfac40,0xfac50,0xfac60,0xfac70,0xfacc0,0xfacd0,0xface0,0xfacf0
.long 0xfa580,0xfa590,0xfa5a0,0xfa5b0,0xfa5c0,0xfa5d0,0xfa5e0,0xfa5f0
.long 0xfad00,0xfad10,0xfad20,0xfad30,0xfad80,0xfad90,0xfada0,0xfadb0
.long 0xfad40,0xfad50,0xfad60,0xfad70,0xfadc0,0xfadd0,0xfade0,0xfadf0
.long 0x12cc00,0x12cc10,0x12cc20,0x12cc30,0x12cc80,0x12cc90,0x12cca0,0x12ccb0
.long 0x12cc40,0x12cc50,0x12cc60,0x12cc70,0x12ccc0,0x12ccd0,0x12cce0,0x12ccf0
.long 0x12c580,0x12c590,0x12c5a0,0x12c5b0,0x12c5c0,0x12c5d0,0x12c5e0,0x12c5f0
.long 0x12cd00,0x12cd10,0x12cd20,0x12cd30,0x12cd80,0x12cd90,0x12cda0,0x12cdb0
.long 0x12cd40,0x12cd50,0x12cd60,0x12cd70,0x12cdc0,0x12cdd0,0x12cde0,0x12cdf0
.long 0x15ec00,0x15ec10,0x15ec20,0x15ec30,0x15ec80,0x15ec90,0x15eca0,0x15ecb0
.long 0x15ec40,0x15ec50,0x15ec60,0x15ec70,0x15ecc0,0x15ecd0,0x15ece0,0x15ecf0
.long 0x15e580,0x15e590,0x15e5a0,0x15e5b0,0x15e5c0,0x15e5d0,0x15e5e0,0x15e5f0
.long 0x15ed00,0x15ed10,0x15ed20,0x15ed30,0x15ed80,0x15ed90,0x15eda0,0x15edb0
.long 0x15ed40,0x15ed50,0x15ed60,0x15ed70,0x15edc0,0x15edd0,0x15ede0,0x15edf0
.long 0x190c00,0x190c10,0x190c20,0x190c30,0x190c80,0x190c90,0x190ca0,0x190cb0
.long 0x190c40,0x190c50,0x190c60,0x190c70,0x190cc0,0x190cd0,0x190ce0,0x190cf0
.long 0x190580,0x190590,0x1905a0,0x1905b0,0x1905c0,0x1905d0,0x1905e0,0x1905f0
.long 0x190d00,0x190d10,0x190d20,0x190d30,0x190d80,0x190d90,0x190da0,0x190db0
.long 0x190d40,0x190d50,0x190d60,0x190d70,0x190dc0,0x190dd0,0x190de0,0x190df0
.long 0x1c2c00,0x1c2c10,0x1c2c20,0x1c2c30,0x1c2c80,0x1c2c90,0x1c2ca0,0x1c2cb0
.long 0x1c2c40,0x1c2c50,0x1c2c60,0x1c2c70,0x1c2cc0,0x1c2cd0,0x1c2ce0,0x1c2cf0
.long 0x1c2580,0x1c2590,0x1c25a0,0x1c25b0,0x1c25c0,0x1c25d0,0x1c25e0,0x1c25f0
.long 0x1c2d00,0x1c2d10,0x1c2d20,0x1c2d30,0x1c2d80,0x1c2d90,0x1c2da0,0x1c2db0
.long 0x1c2d40,0x1c2d50,0x1c2d60,0x1c2d70,0x1c2dc0,0x1c2dd0,0x1c2de0,0x1c2df0
.long 0x1f4c00,0x1f4c10,0x1f4c20,0x1f4c30,0x1f4c80,0x1f4c90,0x1f4ca0,0x1f4cb0
.long 0x1f4c40,0x1f4c50,0x1f4c60,0x1f4c70,0x1f4cc0,0x1f4cd0,0x1f4ce0,0x1f4cf0
.long 0x1f4580,0x1f4590,0x1f45a0,0x1f45b0,0x1f45c0,0x1f45d0,0x1f45e0,0x1f45f0
.long 0x1f4d00,0x1f4d10,0x1f4d20,0x1f4d30,0x1f4d80,0x1f4d90,0x1f4da0,0x1f4db0
.long 0x1f4d40,0x1f4d50,0x1f4d60,0x1f4d70,0x1f4dc0,0x1f4dd0,0x1f4de0,0x1f4df0
.long 0x226c00,0x226c10,0x226c20,0x226c30,0x226c80,0x226c90,0x226ca0,0x226cb0
.long 0x226c40,0x226c50,0x226c60,0x226c70,0x226cc0,0x226cd0,0x226ce0,0x226cf0
.long 0x226580,0x226590,0x2265a0,0x2265b0,0x2265c0,0x2265d0,0x2265e0,0x2265f0
.long 0x226d00,0x226d10,0x226d20,0x226d30,0x226d80,0x226d90,0x226da0,0x226db0
.long 0x226d40,0x226d50,0x226d60,0x226d70,0x226dc0,0x226dd0,0x226de0,0x226df0
.long 0x258c00,0x258c10,0x258c20,0x258c30,0x258c80,0x258c90,0x258ca0,0x258cb0
.long 0x258c40,0x258c50,0x258c60,0x258c70,0x258cc0,0x258cd0,0x258ce0,0x258cf0
.long 0x258580,0x258590,0x2585a0,0x2585b0,0x2585c0,0x2585d0,0x2585e0,0x2585f0
.long 0x258d00,0x258d10,0x258d20,0x258d30,0x258d80,0x258d90,0x258da0,0x258db0
.long 0x258d40,0x258d50,0x258d60,0x258d70,0x258dc0,0x258dd0,0x258de0,0x258df0
.long 0x28ac00,0x28ac10,0x28ac20,0x28ac30,0x28ac80,0x28ac90,0x28aca0,0x28acb0
.long 0x28ac40,0x28ac50,0x28ac60,0x28ac70,0x28acc0,0x28acd0,0x28ace0,0x28acf0
.long 0x28a580,0x28a590,0x28a5a0,0x28a5b0,0x28a5c0,0x28a5d0,0x28a5e0,0x28a5f0
.long 0x28ad00,0x28ad10,0x28ad20,0x28ad30,0x28ad80,0x28ad90,0x28ada0,0x28adb0
.long 0x28ad40,0x28ad50,0x28ad60,0x28ad70,0x28adc0,0x28add0,0x28ade0,0x28adf0
.long 0x2bcc00,0x2bcc10,0x2bcc20,0x2bcc30,0x2bcc80,0x2bcc90,0x2bcca0,0x2bccb0
.long 0x2bcc40,0x2bcc50,0x2bcc60,0x2bcc70,0x2bccc0,0x2bccd0,0x2bcce0,0x2bccf0
.long 0x2bc580,0x2bc590,0x2bc5a0,0x2bc5b0,0x2bc5c0,0x2bc5d0,0x2bc5e0,0x2bc5f0
.long 0x2bcd00,0x2bcd10,0x2bcd20,0x2bcd30,0x2bcd80,0x2bcd90,0x2bcda0,0x2bcdb0
.long 0x2bcd40,0x2bcd50,0x2bcd60,0x2bcd70,0x2bcdc0,0x2bcdd0,0x2bcde0,0x2bcdf0
.long 0x2eec00,0x2eec10,0x2eec20,0x2eec30,0x2eec80,0x2eec90,0x2eeca0,0x2eecb0
.long 0x2eec40,0x2eec50,0x2eec60,0x2eec70,0x2eecc0,0x2eecd0,0x2eece0,0x2eecf0
.long 0x2ee580,0x2ee590,0x2ee5a0,0x2ee5b0,0x2ee5c0,0x2ee5d0,0x2ee5e0,0x2ee5f0
.long 0x2eed00,0x2eed10,0x2eed20,0x2eed30,0x2eed80,0x2eed90,0x2eeda0,0x2eedb0
.long 0x2eed40,0x2eed50,0x2eed60,0x2eed70,0x2eedc0,0x2eedd0,0x2eede0,0x2eedf0
.long 0x0,0x10,0x20,0x30,0x40,0x50,0x60,0x70
.long 0x80,0x90,0xa0,0xb0,0xc0,0xd0,0xe0,0xf0
.long 0x100,0x110,0x120,0x130,0x140,0x150,0x160,0x170
.long 0x180,0x190,0x1a0,0x1b0,0x1c0,0x1d0,0x1e0,0x1f0
.long 0x400,0x410,0x420,0x430,0x440,0x450,0x460,0x470
.long 0x32000,0x32010,0x32020,0x32030,0x32040,0x32050,0x32060,0x32070
.long 0x32080,0x32090,0x320a0,0x320b0,0x320c0,0x320d0,0x320e0,0x320f0
.long 0x32100,0x32110,0x32120,0x32130,0x32140,0x32150,0x32160,0x32170
.long 0x32180,0x32190,0x321a0,0x321b0,0x321c0,0x321d0,0x321e0,0x321f0
.long 0x32400,0x32410,0x32420,0x32430,0x32440,0x32450,0x32460,0x32470
.long 0x64000,0x64010,0x64020,0x64030,0x64040,0x64050,0x64060,0x64070
.long 0x64080,0x64090,0x640a0,0x640b0,0x640c0,0x640d0,0x640e0,0x640f0
.long 0x64100,0x64110,0x64120,0x64130,0x64140,0x64150,0x64160,0x64170
.long 0x64180,0x64190,0x641a0,0x641b0,0x641c0,0x641d0,0x641e0,0x641f0
.long 0x64400,0x64410,0x64420,0x64430,0x64440,0x64450,0x64460,0x64470
.long 0x96000,0x96010,0x96020,0x96030,0x96040,0x96050,0x96060,0x96070
.long 0x96080,0x96090,0x960a0,0x960b0,0x960c0,0x960d0,0x960e0,0x960f0
.long 0x96100,0x96110,0x96120,0x96130,0x96140,0x96150,0x96160,0x96170
.long 0x96180,0x96190,0x961a0,0x961b0,0x961c0,0x961d0,0x961e0,0x961f0
.long 0x96400,0x96410,0x96420,0x96430,0x96440,0x96450,0x96460,0x96470
.long 0xc8000,0xc8010,0xc8020,0xc8030,0xc8040,0xc8050,0xc8060,0xc8070
.long 0xc8080,0xc8090,0xc80a0,0xc80b0,0xc80c0,0xc80d0,0xc80e0,0xc80f0
.long 0xc8100,0xc8110,0xc8120,0xc8130,0xc8140,0xc8150,0xc8160,0xc8170
.long 0xc8180,0xc8190,0xc81a0,0xc81b0,0xc81c0,0xc81d0,0xc81e0,0xc81f0
.long 0xc8400,0xc8410,0xc8420,0xc8430,0xc8440,0xc8450,0xc8460,0xc8470
.long 0xfa000,0xfa010,0xfa020,0xfa030,0xfa040,0xfa050,0xfa060,0xfa070
.long 0xfa080,0xfa090,0xfa0a0,0xfa0b0,0xfa0c0,0xfa0d0,0xfa0e0,0xfa0f0
.long 0xfa100,0xfa110,0xfa120,0xfa130,0xfa140,0xfa150,0xfa160,0xfa170
.long 0xfa180,0xfa190,0xfa1a0,0xfa1b0,0xfa1c0,0xfa1d0,0xfa1e0,0xfa1f0
.long 0xfa400,0xfa410,0xfa420,0xfa430,0xfa440,0xfa450,0xfa460,0xfa470
.long 0x12c000,0x12c010,0x12c020,0x12c030,0x12c040,0x12c050,0x12c060,0x12c070
.long 0x12c080,0x12c090,0x12c0a0,0x12c0b0,0x12c0c0,0x12c0d0,0x12c0e0,0x12c0f0
.long 0x12c100,0x12c110,0x12c120,0x12c130,0x12c140,0x12c150,0x12c160,0x12c170
.long 0x12c180,0x12c190,0x12c1a0,0x12c1b0,0x12c1c0,0x12c1d0,0x12c1e0,0x12c1f0
.long 0x12c400,0x12c410,0x12c420,0x12c430,0x12c440,0x12c450,0x12c460,0x12c470
.long 0x15e000,0x15e010,0x15e020,0x15e030,0x15e040,0x15e050,0x15e060,0x15e070
.long 0x15e080,0x15e090,0x15e0a0,0x15e0b0,0x15e0c0,0x15e0d0,0x15e0e0,0x15e0f0
.long 0x15e100,0x15e110,0x15e120,0x15e130,0x15e140,0x15e150,0x15e160,0x15e170
.long 0x15e180,0x15e190,0x15e1a0,0x15e1b0,0x15e1c0,0x15e1d0,0x15e1e0,0x15e1f0
.long 0x15e400,0x15e410,0x15e420,0x15e430,0x15e440,0x15e450,0x15e460,0x15e470
.long 0x190000,0x190010,0x190020,0x190030,0x190040,0x190050,0x190060,0x190070
.long 0x190080,0x190090,0x1900a0,0x1900b0,0x1900c0,0x1900d0,0x1900e0,0x1900f0
.long 0x190100,0x190110,0x190120,0x190130,0x190140,0x190150,0x190160,0x190170
.long 0x190180,0x190190,0x1901a0,0x1901b0,0x1901c0,0x1901d0,0x1901e0,0x1901f0
.long 0x190400,0x190410,0x190420,0x190430,0x190440,0x190450,0x190460,0x190470
.long 0x1c2000,0x1c2010,0x1c2020,0x1c2030,0x1c2040,0x1c2050,0x1c2060,0x1c2070
.long 0x1c2080,0x1c2090,0x1c20a0,0x1c20b0,0x1c20c0,0x1c20d0,0x1c20e0,0x1c20f0
.long 0x1c2100,0x1c2110,0x1c2120,0x1c2130,0x1c2140,0x1c2150,0x1c2160,0x1c2170
.long 0x1c2180,0x1c2190,0x1c21a0,0x1c21b0,0x1c21c0,0x1c21d0,0x1c21e0,0x1c21f0
.long 0x1c2400,0x1c2410,0x1c2420,0x1c2430,0x1c2440,0x1c2450,0x1c2460,0x1c2470
.long 0x1f4000,0x1f4010,0x1f4020,0x1f4030,0x1f4040,0x1f4050,0x1f4060,0x1f4070
.long 0x1f4080,0x1f4090,0x1f40a0,0x1f40b0,0x1f40c0,0x1f40d0,0x1f40e0,0x1f40f0
.long 0x1f4100,0x1f4110,0x1f4120,0x1f4130,0x1f4140,0x1f4150,0x1f4160,0x1f4170
.long 0x1f4180,0x1f4190,0x1f41a0,0x1f41b0,0x1f41c0,0x1f41d0,0x1f41e0,0x1f41f0
.long 0x1f4400,0x1f4410,0x1f4420,0x1f4430,0x1f4440,0x1f4450,0x1f4460,0x1f4470
.long 0x226000,0x226010,0x226020,0x226030,0x226040,0x226050,0x226060,0x226070
.long 0x226080,0x226090,0x2260a0,0x2260b0,0x2260c0,0x2260d0,0x2260e0,0x2260f0
.long 0x226100,0x226110,0x226120,0x226130,0x226140,0x226150,0x226160,0x226170
.long 0x226180,0x226190,0x2261a0,0x2261b0,0x2261c0,0x2261d0,0x2261e0,0x2261f0
.long 0x226400,0x226410,0x226420,0x226430,0x226440,0x226450,0x226460,0x226470
.long 0x258000,0x258010,0x258020,0x258030,0x258040,0x258050,0x258060,0x258070
.long 0x258080,0x258090,0x2580a0,0x2580b0,0x2580c0,0x2580d0,0x2580e0,0x2580f0
.long 0x258100,0x258110,0x258120,0x258130,0x258140,0x258150,0x258160,0x258170
.long 0x258180,0x258190,0x2581a0,0x2581b0,0x2581c0,0x2581d0,0x2581e0,0x2581f0
.long 0x258400,0x258410,0x258420,0x258430,0x258440,0x258450,0x258460,0x258470
.long 0x28a000,0x28a010,0x28a020,0x28a030,0x28a040,0x28a050,0x28a060,0x28a070
.long 0x28a080,0x28a090,0x28a0a0,0x28a0b0,0x28a0c0,0x28a0d0,0x28a0e0,0x28a0f0
.long 0x28a100,0x28a110,0x28a120,0x28a130,0x28a140,0x28a150,0x28a160,0x28a170
.long 0x28a180,0x28a190,0x28a1a0,0x28a1b0,0x28a1c0,0x28a1d0,0x28a1e0,0x28a1f0
.long 0x28a400,0x28a410,0x28a420,0x28a430,0x28a440,0x28a450,0x28a460,0x28a470
.long 0x2bc000,0x2bc010,0x2bc020,0x2bc030,0x2bc040,0x2bc050,0x2bc060,0x2bc070
.long 0x2bc080,0x2bc090,0x2bc0a0,0x2bc0b0,0x2bc0c0,0x2bc0d0,0x2bc0e0,0x2bc0f0
.long 0x2bc100,0x2bc110,0x2bc120,0x2bc130,0x2bc140,0x2bc150,0x2bc160,0x2bc170
.long 0x2bc180,0x2bc190,0x2bc1a0,0x2bc1b0,0x2bc1c0,0x2bc1d0,0x2bc1e0,0x2bc1f0
.long 0x2bc400,0x2bc410,0x2bc420,0x2bc430,0x2bc440,0x2bc450,0x2bc460,0x2bc470
.long 0x2ee000,0x2ee010,0x2ee020,0x2ee030,0x2ee040,0x2ee050,0x2ee060,0x2ee070
.long 0x2ee080,0x2ee090,0x2ee0a0,0x2ee0b0,0x2ee0c0,0x2ee0d0,0x2ee0e0,0x2ee0f0
.long 0x2ee100,0x2ee110,0x2ee120,0x2ee130,0x2ee140,0x2ee150,0x2ee160,0x2ee170
.long 0x2ee180,0x2ee190,0x2ee1a0,0x2ee1b0,0x2ee1c0,0x2ee1d0,0x2ee1e0,0x2ee1f0
.long 0x2ee400,0x2ee410,0x2ee420,0x2ee430,0x2ee440,0x2ee450,0x2ee460,0x2ee470
.long 0x480,0x490,0x4a0,0x4b0,0x4c0,0x4d0,0x4e0,0x4f0
.long 0x500,0x510,0x520,0x530,0x540,0x550,0x560,0x570
.long 0x800,0x810,0x820,0x830,0x8c0,0x8d0,0x8e0,0x8f0
.long 0x900,0x910,0x920,0x930,0x940,0x950,0x960,0x970
.long 0x980,0x990,0x9a0,0x9b0,0x9c0,0x9d0,0x9e0,0x9f0
.long 0x32480,0x32490,0x324a0,0x324b0,0x324c0,0x324d0,0x324e0,0x324f0
.long 0x32500,0x32510,0x32520,0x32530,0x32540,0x32550,0x32560,0x32570
.long 0x32800,0x32810,0x32820,0x32830,0x328c0,0x328d0,0x328e0,0x328f0
.long 0x32900,0x32910,0x32920,0x32930,0x32940,0x32950,0x32960,0x32970
.long 0x32980,0x32990,0x329a0,0x329b0,0x329c0,0x329d0,0x329e0,0x329f0
.long 0x64480,0x64490,0x644a0,0x644b0,0x644c0,0x644d0,0x644e0,0x644f0
.long 0x64500,0x64510,0x64520,0x64530,0x64540,0x64550,0x64560,0x64570
.long 0x64800,0x64810,0x64820,0x64830,0x648c0,0x648d0,0x648e0,0x648f0
.long 0x64900,0x64910,0x64920,0x64930,0x64940,0x64950,0x64960,0x64970
.long 0x64980,0x64990,0x649a0,0x649b0,0x649c0,0x649d0,0x649e0,0x649f0
.long 0x96480,0x96490,0x964a0,0x964b0,0x964c0,0x964d0,0x964e0,0x964f0
.long 0x96500,0x96510,0x96520,0x96530,0x96540,0x96550,0x96560,0x96570
.long 0x96800,0x96810,0x96820,0x96830,0x968c0,0x968d0,0x968e0,0x968f0
.long 0x96900,0x96910,0x96920,0x96930,0x96940,0x96950,0x96960,0x96970
.long 0x96980,0x96990,0x969a0,0x969b0,0x969c0,0x969d0,0x969e0,0x969f0
.long 0xc8480,0xc8490,0xc84a0,0xc84b0,0xc84c0,0xc84d0,0xc84e0,0xc84f0
.long 0xc8500,0xc8510,0xc8520,0xc8530,0xc8540,0xc8550,0xc8560,0xc8570
.long 0xc8800,0xc8810,0xc8820,0xc8830,0xc88c0,0xc88d0,0xc88e0,0xc88f0
.long 0xc8900,0xc8910,0xc8920,0xc8930,0xc8940,0xc8950,0xc8960,0xc8970
.long 0xc8980,0xc8990,0xc89a0,0xc89b0,0xc89c0,0xc89d0,0xc89e0,0xc89f0
.long 0xfa480,0xfa490,0xfa4a0,0xfa4b0,0xfa4c0,0xfa4d0,0xfa4e0,0xfa4f0
.long 0xfa500,0xfa510,0xfa520,0xfa530,0xfa540,0xfa550,0xfa560,0xfa570
.long 0xfa800,0xfa810,0xfa820,0xfa830,0xfa8c0,0xfa8d0,0xfa8e0,0xfa8f0
.long 0xfa900,0xfa910,0xfa920,0xfa930,0xfa940,0xfa950,0xfa960,0xfa970
.long 0xfa980,0xfa990,0xfa9a0,0xfa9b0,0xfa9c0,0xfa9d0,0xfa9e0,0xfa9f0
.long 0x12c480,0x12c490,0x12c4a0,0x12c4b0,0x12c4c0,0x12c4d0,0x12c4e0,0x12c4f0
.long 0x12c500,0x12c510,0x12c520,0x12c530,0x12c540,0x12c550,0x12c560,0x12c570
.long 0x12c800,0x12c810,0x12c820,0x12c830,0x12c8c0,0x12c8d0,0x12c8e0,0x12c8f0
.long 0x12c900,0x12c910,0x12c920,0x12c930,0x12c940,0x12c950,0x12c960,0x12c970
.long 0x12c980,0x12c990,0x12c9a0,0x12c9b0,0x12c9c0,0x12c9d0,0x12c9e0,0x12c9f0
.long 0x15e480,0x15e490,0x15e4a0,0x15e4b0,0x15e4c0,0x15e4d0,0x15e4e0,0x15e4f0
.long 0x15e500,0x15e510,0x15e520,0x15e530,0x15e540,0x15e550,0x15e560,0x15e570
.long 0x15e800,0x15e810,0x15e820,0x15e830,0x15e8c0,0x15e8d0,0x15e8e0,0x15e8f0
.long 0x15e900,0x15e910,0x15e920,0x15e930,0x15e940,0x15e950,0x15e960,0x15e970
.long 0x15e980,0x15e990,0x15e9a0,0x15e9b0,0x15e9c0,0x15e9d0,0x15e9e0,0x15e9f0
.long 0x190480,0x190490,0x1904a0,0x1904b0,0x1904c0,0x1904d0,0x1904e0,0x1904f0
.long 0x190500,0x190510,0x190520,0x190530,0x190540,0x190550,0x190560,0x190570
.long 0x190800,0x190810,0x190820,0x190830,0x1908c0,0x1908d0,0x1908e0,0x1908f0
.long 0x190900,0x190910,0x190920,0x190930,0x190940,0x190950,0x190960,0x190970
.long 0x190980,0x190990,0x1909a0,0x1909b0,0x1909c0,0x1909d0,0x1909e0,0x1909f0
.long 0x1c2480,0x1c2490,0x1c24a0,0x1c24b0,0x1c24c0,0x1c24d0,0x1c24e0,0x1c24f0
.long 0x1c2500,0x1c2510,0x1c2520,0x1c2530,0x1c2540,0x1c2550,0x1c2560,0x1c2570
.long 0x1c2800,0x1c2810,0x1c2820,0x1c2830,0x1c28c0,0x1c28d0,0x1c28e0,0x1c28f0
.long 0x1c2900,0x1c2910,0x1c2920,0x1c2930,0x1c2940,0x1c2950,0x1c2960,0x1c2970
.long 0x1c2980,0x1c2990,0x1c29a0,0x1c29b0,0x1c29c0,0x1c29d0,0x1c29e0,0x1c29f0
.long 0x1f4480,0x1f4490,0x1f44a0,0x1f44b0,0x1f44c0,0x1f44d0,0x1f44e0,0x1f44f0
.long 0x1f4500,0x1f4510,0x1f4520,0x1f4530,0x1f4540,0x1f4550,0x1f4560,0x1f4570
.long 0x1f4800,0x1f4810,0x1f4820,0x1f4830,0x1f48c0,0x1f48d0,0x1f48e0,0x1f48f0
.long 0x1f4900,0x1f4910,0x1f4920,0x1f4930,0x1f4940,0x1f4950,0x1f4960,0x1f4970
.long 0x1f4980,0x1f4990,0x1f49a0,0x1f49b0,0x1f49c0,0x1f49d0,0x1f49e0,0x1f49f0
.long 0x226480,0x226490,0x2264a0,0x2264b0,0x2264c0,0x2264d0,0x2264e0,0x2264f0
.long 0x226500,0x226510,0x226520,0x226530,0x226540,0x226550,0x226560,0x226570
.long 0x226800,0x226810,0x226820,0x226830,0x2268c0,0x2268d0,0x2268e0,0x2268f0
.long 0x226900,0x226910,0x226920,0x226930,0x226940,0x226950,0x226960,0x226970
.long 0x226980,0x226990,0x2269a0,0x2269b0,0x2269c0,0x2269d0,0x2269e0,0x2269f0
.long 0x258480,0x258490,0x2584a0,0x2584b0,0x2584c0,0x2584d0,0x2584e0,0x2584f0
.long 0x258500,0x258510,0x258520,0x258530,0x258540,0x258550,0x258560,0x258570
.long 0x258800,0x258810,0x258820,0x258830,0x2588c0,0x2588d0,0x2588e0,0x2588f0
.long 0x258900,0x258910,0x258920,0x258930,0x258940,0x258950,0x258960,0x258970
.long 0x258980,0x258990,0x2589a0,0x2589b0,0x2589c0,0x2589d0,0x2589e0,0x2589f0
.long 0x28a480,0x28a490,0x28a4a0,0x28a4b0,0x28a4c0,0x28a4d0,0x28a4e0,0x28a4f0
.long 0x28a500,0x28a510,0x28a520,0x28a530,0x28a540,0x28a550,0x28a560,0x28a570
.long 0x28a800,0x28a810,0x28a820,0x28a830,0x28a8c0,0x28a8d0,0x28a8e0,0x28a8f0
.long 0x28a900,0x28a910,0x28a920,0x28a930,0x28a940,0x28a950,0x28a960,0x28a970
.long 0x28a980,0x28a990,0x28a9a0,0x28a9b0,0x28a9c0,0x28a9d0,0x28a9e0,0x28a9f0
.long 0x2bc480,0x2bc490,0x2bc4a0,0x2bc4b0,0x2bc4c0,0x2bc4d0,0x2bc4e0,0x2bc4f0
.long 0x2bc500,0x2bc510,0x2bc520,0x2bc530,0x2bc540,0x2bc550,0x2bc560,0x2bc570
.long 0x2bc800,0x2bc810,0x2bc820,0x2bc830,0x2bc8c0,0x2bc8d0,0x2bc8e0,0x2bc8f0
.long 0x2bc900,0x2bc910,0x2bc920,0x2bc930,0x2bc940,0x2bc950,0x2bc960,0x2bc970
.long 0x2bc980,0x2bc990,0x2bc9a0,0x2bc9b0,0x2bc9c0,0x2bc9d0,0x2bc9e0,0x2bc9f0
.long 0x2ee480,0x2ee490,0x2ee4a0,0x2ee4b0,0x2ee4c0,0x2ee4d0,0x2ee4e0,0x2ee4f0
.long 0x2ee500,0x2ee510,0x2ee520,0x2ee530,0x2ee540,0x2ee550,0x2ee560,0x2ee570
.long 0x2ee800,0x2ee810,0x2ee820,0x2ee830,0x2ee8c0,0x2ee8d0,0x2ee8e0,0x2ee8f0
.long 0x2ee900,0x2ee910,0x2ee920,0x2ee930,0x2ee940,0x2ee950,0x2ee960,0x2ee970
.long 0x2ee980,0x2ee990,0x2ee9a0,0x2ee9b0,0x2ee9c0,0x2ee9d0,0x2ee9e0,0x2ee9f0
.long 0x1000,0x1010,0x1020,0x1030,0x1080,0x1090,0x10a0,0x10b0
.long 0x1040,0x1050,0x1060,0x1070,0x10c0,0x10d0,0x10e0,0x10f0
.long 0x1100,0x1110,0x1120,0x1130,0x1180,0x1190,0x11a0,0x11b0
.long 0x1140,0x1150,0x1160,0x1170,0x11c0,0x11d0,0x11e0,0x11f0
.long 0x880,0x890,0x8a0,0x8b0,0x840,0x850,0x860,0x870
.long 0x33000,0x33010,0x33020,0x33030,0x33080,0x33090,0x330a0,0x330b0
.long 0x33040,0x33050,0x33060,0x33070,0x330c0,0x330d0,0x330e0,0x330f0
.long 0x33100,0x33110,0x33120,0x33130,0x33180,0x33190,0x331a0,0x331b0
.long 0x33140,0x33150,0x33160,0x33170,0x331c0,0x331d0,0x331e0,0x331f0
.long 0x32880,0x32890,0x328a0,0x328b0,0x32840,0x32850,0x32860,0x32870
.long 0x65000,0x65010,0x65020,0x65030,0x65080,0x65090,0x650a0,0x650b0
.long 0x65040,0x65050,0x65060,0x65070,0x650c0,0x650d0,0x650e0,0x650f0
.long 0x65100,0x65110,0x65120,0x65130,0x65180,0x65190,0x651a0,0x651b0
.long 0x65140,0x65150,0x65160,0x65170,0x651c0,0x651d0,0x651e0,0x651f0
.long 0x64880,0x64890,0x648a0,0x648b0,0x64840,0x64850,0x64860,0x64870
.long 0x97000,0x97010,0x97020,0x97030,0x97080,0x97090,0x970a0,0x970b0
.long 0x97040,0x97050,0x97060,0x97070,0x970c0,0x970d0,0x970e0,0x970f0
.long 0x97100,0x97110,0x97120,0x97130,0x97180,0x97190,0x971a0,0x971b0
.long 0x97140,0x97150,0x97160,0x97170,0x971c0,0x971d0,0x971e0,0x971f0
.long 0x96880,0x96890,0x968a0,0x968b0,0x96840,0x96850,0x96860,0x96870
.long 0xc9000,0xc9010,0xc9020,0xc9030,0xc9080,0xc9090,0xc90a0,0xc90b0
.long 0xc9040,0xc9050,0xc9060,0xc9070,0xc90c0,0xc90d0,0xc90e0,0xc90f0
.long 0xc9100,0xc9110,0xc9120,0xc9130,0xc9180,0xc9190,0xc91a0,0xc91b0
.long 0xc9140,0xc9150,0xc9160,0xc9170,0xc91c0,0xc91d0,0xc91e0,0xc91f0
.long 0xc8880,0xc8890,0xc88a0,0xc88b0,0xc8840,0xc8850,0xc8860,0xc8870
.long 0xfb000,0xfb010,0xfb020,0xfb030,0xfb080,0xfb090,0xfb0a0,0xfb0b0
.long 0xfb040,0xfb050,0xfb060,0xfb070,0xfb0c0,0xfb0d0,0xfb0e0,0xfb0f0
.long 0xfb100,0xfb110,0xfb120,0xfb130,0xfb180,0xfb190,0xfb1a0,0xfb1b0
.long 0xfb140,0xfb150,0xfb160,0xfb170,0xfb1c0,0xfb1d0,0xfb1e0,0xfb1f0
.long 0xfa880,0xfa890,0xfa8a0,0xfa8b0,0xfa840,0xfa850,0xfa860,0xfa870
.long 0x12d000,0x12d010,0x12d020,0x12d030,0x12d080,0x12d090,0x12d0a0,0x12d0b0
.long 0x12d040,0x12d050,0x12d060,0x12d070,0x12d0c0,0x12d0d0,0x12d0e0,0x12d0f0
.long 0x12d100,0x12d110,0x12d120,0x12d130,0x12d180,0x12d190,0x12d1a0,0x12d1b0
.long 0x12d140,0x12d150,0x12d160,0x12d170,0x12d1c0,0x12d1d0,0x12d1e0,0x12d1f0
.long 0x12c880,0x12c890,0x12c8a0,0x12c8b0,0x12c840,0x12c850,0x12c860,0x12c870
.long 0x15f000,0x15f010,0x15f020,0x15f030,0x15f080,0x15f090,0x15f0a0,0x15f0b0
.long 0x15f040,0x15f050,0x15f060,0x15f070,0x15f0c0,0x15f0d0,0x15f0e0,0x15f0f0
.long 0x15f100,0x15f110,0x15f120,0x15f130,0x15f180,0x15f190,0x15f1a0,0x15f1b0
.long 0x15f140,0x15f150,0x15f160,0x15f170,0x15f1c0,0x15f1d0,0x15f1e0,0x15f1f0
.long 0x15e880,0x15e890,0x15e8a0,0x15e8b0,0x15e840,0x15e850,0x15e860,0x15e870
.long 0x191000,0x191010,0x191020,0x191030,0x191080,0x191090,0x1910a0,0x1910b0
.long 0x191040,0x191050,0x191060,0x191070,0x1910c0,0x1910d0,0x1910e0,0x1910f0
.long 0x191100,0x191110,0x191120,0x191130,0x191180,0x191190,0x1911a0,0x1911b0
.long 0x191140,0x191150,0x191160,0x191170,0x1911c0,0x1911d0,0x1911e0,0x1911f0
.long 0x190880,0x190890,0x1908a0,0x1908b0,0x190840,0x190850,0x190860,0x190870
.long 0x1c3000,0x1c3010,0x1c3020,0x1c3030,0x1c3080,0x1c3090,0x1c30a0,0x1c30b0
.long 0x1c3040,0x1c3050,0x1c3060,0x1c3070,0x1c30c0,0x1c30d0,0x1c30e0,0x1c30f0
.long 0x1c3100,0x1c3110,0x1c3120,0x1c3130,0x1c3180,0x1c3190,0x1c31a0,0x1c31b0
.long 0x1c3140,0x1c3150,0x1c3160,0x1c3170,0x1c31c0,0x1c31d0,0x1c31e0,0x1c31f0
.long 0x1c2880,0x1c2890,0x1c28a0,0x1c28b0,0x1c2840,0x1c2850,0x1c2860,0x1c2870
.long 0x1f5000,0x1f5010,0x1f5020,0x1f5030,0x1f5080,0x1f5090,0x1f50a0,0x1f50b0
.long 0x1f5040,0x1f5050,0x1f5060,0x1f5070,0x1f50c0,0x1f50d0,0x1f50e0,0x1f50f0
.long 0x1f5100,0x1f5110,0x1f5120,0x1f5130,0x1f5180,0x1f5190,0x1f51a0,0x1f51b0
.long 0x1f5140,0x1f5150,0x1f5160,0x1f5170,0x1f51c0,0x1f51d0,0x1f51e0,0x1f51f0
.long 0x1f4880,0x1f4890,0x1f48a0,0x1f48b0,0x1f4840,0x1f4850,0x1f4860,0x1f4870
.long 0x227000,0x227010,0x227020,0x227030,0x227080,0x227090,0x2270a0,0x2270b0
.long 0x227040,0x227050,0x227060,0x227070,0x2270c0,0x2270d0,0x2270e0,0x2270f0
.long 0x227100,0x227110,0x227120,0x227130,0x227180,0x227190,0x2271a0,0x2271b0
.long 0x227140,0x227150,0x227160,0x227170,0x2271c0,0x2271d0,0x2271e0,0x2271f0
.long 0x226880,0x226890,0x2268a0,0x2268b0,0x226840,0x226850,0x226860,0x226870
.long 0x259000,0x259010,0x259020,0x259030,0x259080,0x259090,0x2590a0,0x2590b0
.long 0x259040,0x259050,0x259060,0x259070,0x2590c0,0x2590d0,0x2590e0,0x2590f0
.long 0x259100,0x259110,0x259120,0x259130,0x259180,0x259190,0x2591a0,0x2591b0
.long 0x259140,0x259150,0x259160,0x259170,0x2591c0,0x2591d0,0x2591e0,0x2591f0
.long 0x258880,0x258890,0x2588a0,0x2588b0,0x258840,0x258850,0x258860,0x258870
.long 0x28b000,0x28b010,0x28b020,0x28b030,0x28b080,0x28b090,0x28b0a0,0x28b0b0
.long 0x28b040,0x28b050,0x28b060,0x28b070,0x28b0c0,0x28b0d0,0x28b0e0,0x28b0f0
.long 0x28b100,0x28b110,0x28b120,0x28b130,0x28b180,0x28b190,0x28b1a0,0x28b1b0
.long 0x28b140,0x28b150,0x28b160,0x28b170,0x28b1c0,0x28b1d0,0x28b1e0,0x28b1f0
.long 0x28a880,0x28a890,0x28a8a0,0x28a8b0,0x28a840,0x28a850,0x28a860,0x28a870
.long 0x2bd000,0x2bd010,0x2bd020,0x2bd030,0x2bd080,0x2bd090,0x2bd0a0,0x2bd0b0
.long 0x2bd040,0x2bd050,0x2bd060,0x2bd070,0x2bd0c0,0x2bd0d0,0x2bd0e0,0x2bd0f0
.long 0x2bd100,0x2bd110,0x2bd120,0x2bd130,0x2bd180,0x2bd190,0x2bd1a0,0x2bd1b0
.long 0x2bd140,0x2bd150,0x2bd160,0x2bd170,0x2bd1c0,0x2bd1d0,0x2bd1e0,0x2bd1f0
.long 0x2bc880,0x2bc890,0x2bc8a0,0x2bc8b0,0x2bc840,0x2bc850,0x2bc860,0x2bc870
.long 0x2ef000,0x2ef010,0x2ef020,0x2ef030,0x2ef080,0x2ef090,0x2ef0a0,0x2ef0b0
.long 0x2ef040,0x2ef050,0x2ef060,0x2ef070,0x2ef0c0,0x2ef0d0,0x2ef0e0,0x2ef0f0
.long 0x2ef100,0x2ef110,0x2ef120,0x2ef130,0x2ef180,0x2ef190,0x2ef1a0,0x2ef1b0
.long 0x2ef140,0x2ef150,0x2ef160,0x2ef170,0x2ef1c0,0x2ef1d0,0x2ef1e0,0x2ef1f0
.long 0x2ee880,0x2ee890,0x2ee8a0,0x2ee8b0,0x2ee840,0x2ee850,0x2ee860,0x2ee870
.long 0x0,0x10,0x20,0x30,0x400,0x410,0x420,0x430
.long 0x40,0x50,0x60,0x70,0x440,0x450,0x460,0x470
.long 0x80,0x90,0xa0,0xb0,0x480,0x490,0x4a0,0x4b0
.long 0xc0,0xd0,0xe0,0xf0,0x4c0,0x4d0,0x4e0,0x4f0
.long 0x800,0x810,0x820,0x830,0xc00,0xc10,0xc20,0xc30
.long 0x840,0x850,0x860,0x870,0xc40,0xc50,0xc60,0xc70
.long 0x880,0x890,0x8a0,0x8b0,0xc80,0xc90,0xca0,0xcb0
.long 0x8c0,0x8d0,0x8e0,0x8f0,0xcc0,0xcd0,0xce0,0xcf0
.long 0x1000,0x1010,0x1020,0x1030,0x1040,0x1050,0x1060,0x1070
.long 0x1080,0x1090,0x10a0,0x10b0,0x10c0,0x10d0,0x10e0,0x10f0
.long 0x19000,0x19010,0x19020,0x19030,0x19400,0x19410,0x19420,0x19430
.long 0x19040,0x19050,0x19060,0x19070,0x19440,0x19450,0x19460,0x19470
.long 0x19080,0x19090,0x190a0,0x190b0,0x19480,0x19490,0x194a0,0x194b0
.long 0x190c0,0x190d0,0x190e0,0x190f0,0x194c0,0x194d0,0x194e0,0x194f0
.long 0x19800,0x19810,0x19820,0x19830,0x19c00,0x19c10,0x19c20,0x19c30
.long 0x19840,0x19850,0x19860,0x19870,0x19c40,0x19c50,0x19c60,0x19c70
.long 0x19880,0x19890,0x198a0,0x198b0,0x19c80,0x19c90,0x19ca0,0x19cb0
.long 0x198c0,0x198d0,0x198e0,0x198f0,0x19cc0,0x19cd0,0x19ce0,0x19cf0
.long 0x1a000,0x1a010,0x1a020,0x1a030,0x1a040,0x1a050,0x1a060,0x1a070
.long 0x1a080,0x1a090,0x1a0a0,0x1a0b0,0x1a0c0,0x1a0d0,0x1a0e0,0x1a0f0
.long 0x32000,0x32010,0x32020,0x32030,0x32400,0x32410,0x32420,0x32430
.long 0x32040,0x32050,0x32060,0x32070,0x32440,0x32450,0x32460,0x32470
.long 0x32080,0x32090,0x320a0,0x320b0,0x32480,0x32490,0x324a0,0x324b0
.long 0x320c0,0x320d0,0x320e0,0x320f0,0x324c0,0x324d0,0x324e0,0x324f0
.long 0x32800,0x32810,0x32820,0x32830,0x32c00,0x32c10,0x32c20,0x32c30
.long 0x32840,0x32850,0x32860,0x32870,0x32c40,0x32c50,0x32c60,0x32c70
.long 0x32880,0x32890,0x328a0,0x328b0,0x32c80,0x32c90,0x32ca0,0x32cb0
.long 0x328c0,0x328d0,0x328e0,0x328f0,0x32cc0,0x32cd0,0x32ce0,0x32cf0
.long 0x33000,0x33010,0x33020,0x33030,0x33040,0x33050,0x33060,0x33070
.long 0x33080,0x33090,0x330a0,0x330b0,0x330c0,0x330d0,0x330e0,0x330f0
.long 0x4b000,0x4b010,0x4b020,0x4b030,0x4b400,0x4b410,0x4b420,0x4b430
.long 0x4b040,0x4b050,0x4b060,0x4b070,0x4b440,0x4b450,0x4b460,0x4b470
.long 0x4b080,0x4b090,0x4b0a0,0x4b0b0,0x4b480,0x4b490,0x4b4a0,0x4b4b0
.long 0x4b0c0,0x4b0d0,0x4b0e0,0x4b0f0,0x4b4c0,0x4b4d0,0x4b4e0,0x4b4f0
.long 0x4b800,0x4b810,0x4b820,0x4b830,0x4bc00,0x4bc10,0x4bc20,0x4bc30
.long 0x4b840,0x4b850,0x4b860,0x4b870,0x4bc40,0x4bc50,0x4bc60,0x4bc70
.long 0x4b880,0x4b890,0x4b8a0,0x4b8b0,0x4bc80,0x4bc90,0x4bca0,0x4bcb0
.long 0x4b8c0,0x4b8d0,0x4b8e0,0x4b8f0,0x4bcc0,0x4bcd0,0x4bce0,0x4bcf0
.long 0x4c000,0x4c010,0x4c020,0x4c030,0x4c040,0x4c050,0x4c060,0x4c070
.long 0x4c080,0x4c090,0x4c0a0,0x4c0b0,0x4c0c0,0x4c0d0,0x4c0e0,0x4c0f0
.long 0x64000,0x64010,0x64020,0x64030,0x64400,0x64410,0x64420,0x64430
.long 0x64040,0x64050,0x64060,0x64070,0x64440,0x64450,0x64460,0x64470
.long 0x64080,0x64090,0x640a0,0x640b0,0x64480,0x64490,0x644a0,0x644b0
.long 0x640c0,0x640d0,0x640e0,0x640f0,0x644c0,0x644d0,0x644e0,0x644f0
.long 0x64800,0x64810,0x64820,0x64830,0x64c00,0x64c10,0x64c20,0x64c30
.long 0x64840,0x64850,0x64860,0x64870,0x64c40,0x64c50,0x64c60,0x64c70
.long 0x64880,0x64890,0x648a0,0x648b0,0x64c80,0x64c90,0x64ca0,0x64cb0
.long 0x648c0,0x648d0,0x648e0,0x648f0,0x64cc0,0x64cd0,0x64ce0,0x64cf0
.long 0x65000,0x65010,0x65020,0x65030,0x65040,0x65050,0x65060,0x65070
.long 0x65080,0x65090,0x650a0,0x650b0,0x650c0,0x650d0,0x650e0,0x650f0
.long 0x7d000,0x7d010,0x7d020,0x7d030,0x7d400,0x7d410,0x7d420,0x7d430
.long 0x7d040,0x7d050,0x7d060,0x7d070,0x7d440,0x7d450,0x7d460,0x7d470
.long 0x7d080,0x7d090,0x7d0a0,0x7d0b0,0x7d480,0x7d490,0x7d4a0,0x7d4b0
.long 0x7d0c0,0x7d0d0,0x7d0e0,0x7d0f0,0x7d4c0,0x7d4d0,0x7d4e0,0x7d4f0
.long 0x7d800,0x7d810,0x7d820,0x7d830,0x7dc00,0x7dc10,0x7dc20,0x7dc30
.long 0x7d840,0x7d850,0x7d860,0x7d870,0x7dc40,0x7dc50,0x7dc60,0x7dc70
.long 0x7d880,0x7d890,0x7d8a0,0x7d8b0,0x7dc80,0x7dc90,0x7dca0,0x7dcb0
.long 0x7d8c0,0x7d8d0,0x7d8e0,0x7d8f0,0x7dcc0,0x7dcd0,0x7dce0,0x7dcf0
.long 0x7e000,0x7e010,0x7e020,0x7e030,0x7e040,0x7e050,0x7e060,0x7e070
.long 0x7e080,0x7e090,0x7e0a0,0x7e0b0,0x7e0c0,0x7e0d0,0x7e0e0,0x7e0f0
.long 0x96000,0x96010,0x96020,0x96030,0x96400,0x96410,0x96420,0x96430
.long 0x96040,0x96050,0x96060,0x96070,0x96440,0x96450,0x96460,0x96470
.long 0x96080,0x96090,0x960a0,0x960b0,0x96480,0x96490,0x964a0,0x964b0
.long 0x960c0,0x960d0,0x960e0,0x960f0,0x964c0,0x964d0,0x964e0,0x964f0
.long 0x96800,0x96810,0x96820,0x96830,0x96c00,0x96c10,0x96c20,0x96c30
.long 0x96840,0x96850,0x96860,0x96870,0x96c40,0x96c50,0x96c60,0x96c70
.long 0x96880,0x96890,0x968a0,0x968b0,0x96c80,0x96c90,0x96ca0,0x96cb0
.long 0x968c0,0x968d0,0x968e0,0x968f0,0x96cc0,0x96cd0,0x96ce0,0x96cf0
.long 0x97000,0x97010,0x97020,0x97030,0x97040,0x97050,0x97060,0x97070
.long 0x97080,0x97090,0x970a0,0x970b0,0x970c0,0x970d0,0x970e0,0x970f0
.long 0xaf000,0xaf010,0xaf020,0xaf030,0xaf400,0xaf410,0xaf420,0xaf430
.long 0xaf040,0xaf050,0xaf060,0xaf070,0xaf440,0xaf450,0xaf460,0xaf470
.long 0xaf080,0xaf090,0xaf0a0,0xaf0b0,0xaf480,0xaf490,0xaf4a0,0xaf4b0
.long 0xaf0c0,0xaf0d0,0xaf0e0,0xaf0f0,0xaf4c0,0xaf4d0,0xaf4e0,0xaf4f0
.long 0xaf800,0xaf810,0xaf820,0xaf830,0xafc00,0xafc10,0xafc20,0xafc30
.long 0xaf840,0xaf850,0xaf860,0xaf870,0xafc40,0xafc50,0xafc60,0xafc70
.long 0xaf880,0xaf890,0xaf8a0,0xaf8b0,0xafc80,0xafc90,0xafca0,0xafcb0
.long 0xaf8c0,0xaf8d0,0xaf8e0,0xaf8f0,0xafcc0,0xafcd0,0xafce0,0xafcf0
.long 0xb0000,0xb0010,0xb0020,0xb0030,0xb0040,0xb0050,0xb0060,0xb0070
.long 0xb0080,0xb0090,0xb00a0,0xb00b0,0xb00c0,0xb00d0,0xb00e0,0xb00f0
.long 0x0,0x20000,0x40000,0x60000,0x80000,0xa0000,0xc0000,0xe0000
.long 0x100000,0x120000,0x140000,0x160000,0x180000,0x1a0000,0x1c0000,0x1e0000
.long 0x200000,0x220000,0x240000,0x260000,0x10000,0x270000,0x250000,0x230000
.long 0x210000,0x1f0000,0x1d0000,0x1b0000,0x190000,0x170000,0x150000,0x130000
.long 0x110000,0xf0000,0xd0000,0xb0000,0x90000,0x70000,0x50000,0x30000
.long 0x2000,0x22000,0x42000,0x62000,0x82000,0xa2000,0xc2000,0xe2000
.long 0x102000,0x122000,0x142000,0x162000,0x182000,0x1a2000,0x1c2000,0x1e2000
.long 0x202000,0x222000,0x242000,0x262000,0x12000,0x272000,0x252000,0x232000
.long 0x212000,0x1f2000,0x1d2000,0x1b2000,0x192000,0x172000,0x152000,0x132000
.long 0x112000,0xf2000,0xd2000,0xb2000,0x92000,0x72000,0x52000,0x32000
.long 0x4000,0x24000,0x44000,0x64000,0x84000,0xa4000,0xc4000,0xe4000
.long 0x104000,0x124000,0x144000,0x164000,0x184000,0x1a4000,0x1c4000,0x1e4000
.long 0x204000,0x224000,0x244000,0x264000,0x14000,0x274000,0x254000,0x234000
.long 0x214000,0x1f4000,0x1d4000,0x1b4000,0x194000,0x174000,0x154000,0x134000
.long 0x114000,0xf4000,0xd4000,0xb4000,0x94000,0x74000,0x54000,0x34000
.long 0x6000,0x26000,0x46000,0x66000,0x86000,0xa6000,0xc6000,0xe6000
.long 0x106000,0x126000,0x146000,0x166000,0x186000,0x1a6000,0x1c6000,0x1e6000
.long 0x206000,0x226000,0x246000,0x266000,0x16000,0x276000,0x256000,0x236000
.long 0x216000,0x1f6000,0x1d6000,0x1b6000,0x196000,0x176000,0x156000,0x136000
.long 0x116000,0xf6000,0xd6000,0xb6000,0x96000,0x76000,0x56000,0x36000
.long 0x8000,0x28000,0x48000,0x68000,0x88000,0xa8000,0xc8000,0xe8000
.long 0x108000,0x128000,0x148000,0x168000,0x188000,0x1a8000,0x1c8000,0x1e8000
.long 0x208000,0x228000,0x248000,0x268000,0x18000,0x278000,0x258000,0x238000
.long 0x218000,0x1f8000,0x1d8000,0x1b8000,0x198000,0x178000,0x158000,0x138000
.long 0x118000,0xf8000,0xd8000,0xb8000,0x98000,0x78000,0x58000,0x38000
.long 0xa000,0x2a000,0x4a000,0x6a000,0x8a000,0xaa000,0xca000,0xea000
.long 0x10a000,0x12a000,0x14a000,0x16a000,0x18a000,0x1aa000,0x1ca000,0x1ea000
.long 0x20a000,0x22a000,0x24a000,0x26a000,0x1a000,0x27a000,0x25a000,0x23a000
.long 0x21a000,0x1fa000,0x1da000,0x1ba000,0x19a000,0x17a000,0x15a000,0x13a000
.long 0x11a000,0xfa000,0xda000,0xba000,0x9a000,0x7a000,0x5a000,0x3a000
.long 0xc000,0x2c000,0x4c000,0x6c000,0x8c000,0xac000,0xcc000,0xec000
.long 0x10c000,0x12c000,0x14c000,0x16c000,0x18c000,0x1ac000,0x1cc000,0x1ec000
.long 0x20c000,0x22c000,0x24c000,0x26c000,0x1c000,0x27c000,0x25c000,0x23c000
.long 0x21c000,0x1fc000,0x1dc000,0x1bc000,0x19c000,0x17c000,0x15c000,0x13c000
.long 0x11c000,0xfc000,0xdc000,0xbc000,0x9c000,0x7c000,0x5c000,0x3c000
.long 0xe000,0x2e000,0x4e000,0x6e000,0x8e000,0xae000,0xce000,0xee000
.long 0x10e000,0x12e000,0x14e000,0x16e000,0x18e000,0x1ae000,0x1ce000,0x1ee000
.long 0x20e000,0x22e000,0x24e000,0x26e000,0x1e000,0x27e000,0x25e000,0x23e000
.long 0x21e000,0x1fe000,0x1de000,0x1be000,0x19e000,0x17e000,0x15e000,0x13e000
.long 0x11e000,0xfe000,0xde000,0xbe000,0x9e000,0x7e000,0x5e000,0x3e000
.long 0x0,0x0,0x0,0x0,0x0,0x400,0x800,0xc00
.long 0x1000,0x1040,0x19080,0x19480,0x19880,0x19c80,0x0,0x800
.long 0x1000,0x19080,0x19880,0x0,0x10,0x410,0x810,0xc10
.long 0x1010,0x1050,0x19090,0x19490,0x19890,0x19c90,0x10,0x810
.long 0x1010,0x19090,0x19890,0x0,0x20,0x420,0x820,0xc20
.long 0x1020,0x1060,0x190a0,0x194a0,0x198a0,0x19ca0,0x20,0x820
.long 0x1020,0x190a0,0x198a0,0x0,0x30,0x430,0x830,0xc30
.long 0x1030,0x1070,0x190b0,0x194b0,0x198b0,0x19cb0,0x30,0x830
.long 0x1030,0x190b0,0x198b0,0x0,0x40,0x440,0x840,0xc40
.long 0x1080,0x10c0,0x190c0,0x194c0,0x198c0,0x19cc0,0x400,0xc00
.long 0x1040,0x19480,0x19c80,0x0,0x50,0x450,0x850,0xc50
.long 0x1090,0x10d0,0x190d0,0x194d0,0x198d0,0x19cd0,0x410,0xc10
.long 0x1050,0x19490,0x19c90,0x0,0x60,0x460,0x860,0xc60
.long 0x10a0,0x10e0,0x190e0,0x194e0,0x198e0,0x19ce0,0x420,0xc20
.long 0x1060,0x194a0,0x19ca0,0x0,0x70,0x470,0x870,0xc70
.long 0x10b0,0x10f0,0x190f0,0x194f0,0x198f0,0x19cf0,0x430,0xc30
.long 0x1070,0x194b0,0x19cb0,0x0,0x80,0x480,0x880,0xc80
.long 0x19000,0x19400,0x19800,0x19c00,0x1a000,0x1a040,0x40,0x840
.long 0x1080,0x190c0,0x198c0,0x0,0x90,0x490,0x890,0xc90
.long 0x19010,0x19410,0x19810,0x19c10,0x1a010,0x1a050,0x50,0x850
.long 0x1090,0x190d0,0x198d0,0x0,0xa0,0x4a0,0x8a0,0xca0
.long 0x19020,0x19420,0x19820,0x19c20,0x1a020,0x1a060,0x60,0x860
.long 0x10a0,0x190e0,0x198e0,0x0,0xb0,0x4b0,0x8b0,0xcb0
.long 0x19030,0x19430,0x19830,0x19c30,0x1a030,0x1a070,0x70,0x870
.long 0x10b0,0x190f0,0x198f0,0x0,0xc0,0x4c0,0x8c0,0xcc0
.long 0x19040,0x19440,0x19840,0x19c40,0x1a080,0x1a0c0,0x440,0xc40
.long 0x10c0,0x194c0,0x19cc0,0x0,0xd0,0x4d0,0x8d0,0xcd0
.long 0x19050,0x19450,0x19850,0x19c50,0x1a090,0x1a0d0,0x450,0xc50
.long 0x10d0,0x194d0,0x19cd0,0x0,0xe0,0x4e0,0x8e0,0xce0
.long 0x19060,0x19460,0x19860,0x19c60,0x1a0a0,0x1a0e0,0x460,0xc60
.long 0x10e0,0x194e0,0x19ce0,0x0,0xf0,0x4f0,0x8f0,0xcf0
.long 0x19070,0x19470,0x19870,0x19c70,0x1a0b0,0x1a0f0,0x470,0xc70
.long 0x10f0,0x194f0,0x19cf0,0x0,0x0,0x400,0x800,0xc00
.long 0x1000,0x1040,0x19080,0x19480,0x19880,0x19c80,0x80,0x880
.long 0x19000,0x19800,0x1a000,0x0,0x10,0x410,0x810,0xc10
.long 0x1010,0x1050,0x19090,0x19490,0x19890,0x19c90,0x90,0x890
.long 0x19010,0x19810,0x1a010,0x0,0x20,0x420,0x820,0xc20
.long 0x1020,0x1060,0x190a0,0x194a0,0x198a0,0x19ca0,0xa0,0x8a0
.long 0x19020,0x19820,0x1a020,0x0,0x30,0x430,0x830,0xc30
.long 0x1030,0x1070,0x190b0,0x194b0,0x198b0,0x19cb0,0xb0,0x8b0
.long 0x19030,0x19830,0x1a030,0x0,0x40,0x440,0x840,0xc40
.long 0x1080,0x10c0,0x190c0,0x194c0,0x198c0,0x19cc0,0x480,0xc80
.long 0x19400,0x19c00,0x1a040,0x0,0x50,0x450,0x850,0xc50
.long 0x1090,0x10d0,0x190d0,0x194d0,0x198d0,0x19cd0,0x490,0xc90
.long 0x19410,0x19c10,0x1a050,0x0,0x60,0x460,0x860,0xc60
.long 0x10a0,0x10e0,0x190e0,0x194e0,0x198e0,0x19ce0,0x4a0,0xca0
.long 0x19420,0x19c20,0x1a060,0x0,0x70,0x470,0x870,0xc70
.long 0x10b0,0x10f0,0x190f0,0x194f0,0x198f0,0x19cf0,0x4b0,0xcb0
.long 0x19430,0x19c30,0x1a070,0x0,0x80,0x480,0x880,0xc80
.long 0x19000,0x19400,0x19800,0x19c00,0x1a000,0x1a040,0xc0,0x8c0
.long 0x19040,0x19840,0x1a080,0x0,0x90,0x490,0x890,0xc90
.long 0x19010,0x19410,0x19810,0x19c10,0x1a010,0x1a050,0xd0,0x8d0
.long 0x19050,0x19850,0x1a090,0x0,0xa0,0x4a0,0x8a0,0xca0
.long 0x19020,0x19420,0x19820,0x19c20,0x1a020,0x1a060,0xe0,0x8e0
.long 0x19060,0x19860,0x1a0a0,0x0,0xb0,0x4b0,0x8b0,0xcb0
.long 0x19030,0x19430,0x19830,0x19c30,0x1a030,0x1a070,0xf0,0x8f0
.long 0x19070,0x19870,0x1a0b0,0x0,0xc0,0x4c0,0x8c0,0xcc0
.long 0x19040,0x19440,0x19840,0x19c40,0x1a080,0x1a0c0,0x4c0,0xcc0
.long 0x19440,0x19c40,0x1a0c0,0x0,0xd0,0x4d0,0x8d0,0xcd0
.long 0x19050,0x19450,0x19850,0x19c50,0x1a090,0x1a0d0,0x4d0,0xcd0
.long 0x19450,0x19c50,0x1a0d0,0x0,0xe0,0x4e0,0x8e0,0xce0
.long 0x19060,0x19460,0x19860,0x19c60,0x1a0a0,0x1a0e0,0x4e0,0xce0
.long 0x19460,0x19c60,0x1a0e0,0x0,0xf0,0x4f0,0x8f0,0xcf0
.long 0x19070,0x19470,0x19870,0x19c70,0x1a0b0,0x1a0f0,0x4f0,0xcf0
.long 0x19470,0x19c70,0x1a0f0,0x0,0x32000,0x32400,0x32800,0x32c00
.long 0x33000,0x33040,0x4b080,0x4b480,0x4b880,0x4bc80,0x32000,0x32800
.long 0x33000,0x4b080,0x4b880,0x0,0x32010,0x32410,0x32810,0x32c10
.long 0x33010,0x33050,0x4b090,0x4b490,0x4b890,0x4bc90,0x32010,0x32810
.long 0x33010,0x4b090,0x4b890,0x0,0x32020,0x32420,0x32820,0x32c20
.long 0x33020,0x33060,0x4b0a0,0x4b4a0,0x4b8a0,0x4bca0,0x32020,0x32820
.long 0x33020,0x4b0a0,0x4b8a0,0x0,0x32030,0x32430,0x32830,0x32c30
.long 0x33030,0x33070,0x4b0b0,0x4b4b0,0x4b8b0,0x4bcb0,0x32030,0x32830
.long 0x33030,0x4b0b0,0x4b8b0,0x0,0x32040,0x32440,0x32840,0x32c40
.long 0x33080,0x330c0,0x4b0c0,0x4b4c0,0x4b8c0,0x4bcc0,0x32400,0x32c00
.long 0x33040,0x4b480,0x4bc80,0x0,0x32050,0x32450,0x32850,0x32c50
.long 0x33090,0x330d0,0x4b0d0,0x4b4d0,0x4b8d0,0x4bcd0,0x32410,0x32c10
.long 0x33050,0x4b490,0x4bc90,0x0,0x32060,0x32460,0x32860,0x32c60
.long 0x330a0,0x330e0,0x4b0e0,0x4b4e0,0x4b8e0,0x4bce0,0x32420,0x32c20
.long 0x33060,0x4b4a0,0x4bca0,0x0,0x32070,0x32470,0x32870,0x32c70
.long 0x330b0,0x330f0,0x4b0f0,0x4b4f0,0x4b8f0,0x4bcf0,0x32430,0x32c30
.long 0x33070,0x4b4b0,0x4bcb0,0x0,0x32080,0x32480,0x32880,0x32c80
.long 0x4b000,0x4b400,0x4b800,0x4bc00,0x4c000,0x4c040,0x32040,0x32840
.long 0x33080,0x4b0c0,0x4b8c0,0x0,0x32090,0x32490,0x32890,0x32c90
.long 0x4b010,0x4b410,0x4b810,0x4bc10,0x4c010,0x4c050,0x32050,0x32850
.long 0x33090,0x4b0d0,0x4b8d0,0x0,0x320a0,0x324a0,0x328a0,0x32ca0
.long 0x4b020,0x4b420,0x4b820,0x4bc20,0x4c020,0x4c060,0x32060,0x32860
.long 0x330a0,0x4b0e0,0x4b8e0,0x0,0x320b0,0x324b0,0x328b0,0x32cb0
.long 0x4b030,0x4b430,0x4b830,0x4bc30,0x4c030,0x4c070,0x32070,0x32870
.long 0x330b0,0x4b0f0,0x4b8f0,0x0,0x320c0,0x324c0,0x328c0,0x32cc0
.long 0x4b040,0x4b440,0x4b840,0x4bc40,0x4c080,0x4c0c0,0x32440,0x32c40
.long 0x330c0,0x4b4c0,0x4bcc0,0x0,0x320d0,0x324d0,0x328d0,0x32cd0
.long 0x4b050,0x4b450,0x4b850,0x4bc50,0x4c090,0x4c0d0,0x32450,0x32c50
.long 0x330d0,0x4b4d0,0x4bcd0,0x0,0x320e0,0x324e0,0x328e0,0x32ce0
.long 0x4b060,0x4b460,0x4b860,0x4bc60,0x4c0a0,0x4c0e0,0x32460,0x32c60
.long 0x330e0,0x4b4e0,0x4bce0,0x0,0x320f0,0x324f0,0x328f0,0x32cf0
.long 0x4b070,0x4b470,0x4b870,0x4bc70,0x4c0b0,0x4c0f0,0x32470,0x32c70
.long 0x330f0,0x4b4f0,0x4bcf0,0x0,0x32000,0x32400,0x32800,0x32c00
.long 0x33000,0x33040,0x4b080,0x4b480,0x4b880,0x4bc80,0x32080,0x32880
.long 0x4b000,0x4b800,0x4c000,0x0,0x32010,0x32410,0x32810,0x32c10
.long 0x33010,0x33050,0x4b090,0x4b490,0x4b890,0x4bc90,0x32090,0x32890
.long 0x4b010,0x4b810,0x4c010,0x0,0x32020,0x32420,0x32820,0x32c20
.long 0x33020,0x33060,0x4b0a0,0x4b4a0,0x4b8a0,0x4bca0,0x320a0,0x328a0
.long 0x4b020,0x4b820,0x4c020,0x0,0x32030,0x32430,0x32830,0x32c30
.long 0x33030,0x33070,0x4b0b0,0x4b4b0,0x4b8b0,0x4bcb0,0x320b0,0x328b0
.long 0x4b030,0x4b830,0x4c030,0x0,0x32040,0x32440,0x32840,0x32c40
.long 0x33080,0x330c0,0x4b0c0,0x4b4c0,0x4b8c0,0x4bcc0,0x32480,0x32c80
.long 0x4b400,0x4bc00,0x4c040,0x0,0x32050,0x32450,0x32850,0x32c50
.long 0x33090,0x330d0,0x4b0d0,0x4b4d0,0x4b8d0,0x4bcd0,0x32490,0x32c90
.long 0x4b410,0x4bc10,0x4c050,0x0,0x32060,0x32460,0x32860,0x32c60
.long 0x330a0,0x330e0,0x4b0e0,0x4b4e0,0x4b8e0,0x4bce0,0x324a0,0x32ca0
.long 0x4b420,0x4bc20,0x4c060,0x0,0x32070,0x32470,0x32870,0x32c70
.long 0x330b0,0x330f0,0x4b0f0,0x4b4f0,0x4b8f0,0x4bcf0,0x324b0,0x32cb0
.long 0x4b430,0x4bc30,0x4c070,0x0,0x32080,0x32480,0x32880,0x32c80
.long 0x4b000,0x4b400,0x4b800,0x4bc00,0x4c000,0x4c040,0x320c0,0x328c0
.long 0x4b040,0x4b840,0x4c080,0x0,0x32090,0x32490,0x32890,0x32c90
.long 0x4b010,0x4b410,0x4b810,0x4bc10,0x4c010,0x4c050,0x320d0,0x328d0
.long 0x4b050,0x4b850,0x4c090,0x0,0x320a0,0x324a0,0x328a0,0x32ca0
.long 0x4b020,0x4b420,0x4b820,0x4bc20,0x4c020,0x4c060,0x320e0,0x328e0
.long 0x4b060,0x4b860,0x4c0a0,0x0,0x320b0,0x324b0,0x328b0,0x32cb0
.long 0x4b030,0x4b430,0x4b830,0x4bc30,0x4c030,0x4c070,0x320f0,0x328f0
.long 0x4b070,0x4b870,0x4c0b0,0x0,0x320c0,0x324c0,0x328c0,0x32cc0
.long 0x4b040,0x4b440,0x4b840,0x4bc40,0x4c080,0x4c0c0,0x324c0,0x32cc0
.long 0x4b440,0x4bc40,0x4c0c0,0x0,0x320d0,0x324d0,0x328d0,0x32cd0
.long 0x4b050,0x4b450,0x4b850,0x4bc50,0x4c090,0x4c0d0,0x324d0,0x32cd0
.long 0x4b450,0x4bc50,0x4c0d0,0x0,0x320e0,0x324e0,0x328e0,0x32ce0
.long 0x4b060,0x4b460,0x4b860,0x4bc60,0x4c0a0,0x4c0e0,0x324e0,0x32ce0
.long 0x4b460,0x4bc60,0x4c0e0,0x0,0x320f0,0x324f0,0x328f0,0x32cf0
.long 0x4b070,0x4b470,0x4b870,0x4bc70,0x4c0b0,0x4c0f0,0x324f0,0x32cf0
.long 0x4b470,0x4bc70,0x4c0f0,0x0,0x64000,0x64400,0x64800,0x64c00
.long 0x65000,0x65040,0x7d080,0x7d480,0x7d880,0x7dc80,0x64000,0x64800
.long 0x65000,0x7d080,0x7d880,0x0,0x64010,0x64410,0x64810,0x64c10
.long 0x65010,0x65050,0x7d090,0x7d490,0x7d890,0x7dc90,0x64010,0x64810
.long 0x65010,0x7d090,0x7d890,0x0,0x64020,0x64420,0x64820,0x64c20
.long 0x65020,0x65060,0x7d0a0,0x7d4a0,0x7d8a0,0x7dca0,0x64020,0x64820
.long 0x65020,0x7d0a0,0x7d8a0,0x0,0x64030,0x64430,0x64830,0x64c30
.long 0x65030,0x65070,0x7d0b0,0x7d4b0,0x7d8b0,0x7dcb0,0x64030,0x64830
.long 0x65030,0x7d0b0,0x7d8b0,0x0,0x64040,0x64440,0x64840,0x64c40
.long 0x65080,0x650c0,0x7d0c0,0x7d4c0,0x7d8c0,0x7dcc0,0x64400,0x64c00
.long 0x65040,0x7d480,0x7dc80,0x0,0x64050,0x64450,0x64850,0x64c50
.long 0x65090,0x650d0,0x7d0d0,0x7d4d0,0x7d8d0,0x7dcd0,0x64410,0x64c10
.long 0x65050,0x7d490,0x7dc90,0x0,0x64060,0x64460,0x64860,0x64c60
.long 0x650a0,0x650e0,0x7d0e0,0x7d4e0,0x7d8e0,0x7dce0,0x64420,0x64c20
.long 0x65060,0x7d4a0,0x7dca0,0x0,0x64070,0x64470,0x64870,0x64c70
.long 0x650b0,0x650f0,0x7d0f0,0x7d4f0,0x7d8f0,0x7dcf0,0x64430,0x64c30
.long 0x65070,0x7d4b0,0x7dcb0,0x0,0x64080,0x64480,0x64880,0x64c80
.long 0x7d000,0x7d400,0x7d800,0x7dc00,0x7e000,0x7e040,0x64040,0x64840
.long 0x65080,0x7d0c0,0x7d8c0,0x0,0x64090,0x64490,0x64890,0x64c90
.long 0x7d010,0x7d410,0x7d810,0x7dc10,0x7e010,0x7e050,0x64050,0x64850
.long 0x65090,0x7d0d0,0x7d8d0,0x0,0x640a0,0x644a0,0x648a0,0x64ca0
.long 0x7d020,0x7d420,0x7d820,0x7dc20,0x7e020,0x7e060,0x64060,0x64860
.long 0x650a0,0x7d0e0,0x7d8e0,0x0,0x640b0,0x644b0,0x648b0,0x64cb0
.long 0x7d030,0x7d430,0x7d830,0x7dc30,0x7e030,0x7e070,0x64070,0x64870
.long 0x650b0,0x7d0f0,0x7d8f0,0x0,0x640c0,0x644c0,0x648c0,0x64cc0
.long 0x7d040,0x7d440,0x7d840,0x7dc40,0x7e080,0x7e0c0,0x64440,0x64c40
.long 0x650c0,0x7d4c0,0x7dcc0,0x0,0x640d0,0x644d0,0x648d0,0x64cd0
.long 0x7d050,0x7d450,0x7d850,0x7dc50,0x7e090,0x7e0d0,0x64450,0x64c50
.long 0x650d0,0x7d4d0,0x7dcd0,0x0,0x640e0,0x644e0,0x648e0,0x64ce0
.long 0x7d060,0x7d460,0x7d860,0x7dc60,0x7e0a0,0x7e0e0,0x64460,0x64c60
.long 0x650e0,0x7d4e0,0x7dce0,0x0,0x640f0,0x644f0,0x648f0,0x64cf0
.long 0x7d070,0x7d470,0x7d870,0x7dc70,0x7e0b0,0x7e0f0,0x64470,0x64c70
.long 0x650f0,0x7d4f0,0x7dcf0,0x0,0x64000,0x64400,0x64800,0x64c00
.long 0x65000,0x65040,0x7d080,0x7d480,0x7d880,0x7dc80,0x64080,0x64880
.long 0x7d000,0x7d800,0x7e000,0x0,0x64010,0x64410,0x64810,0x64c10
.long 0x65010,0x65050,0x7d090,0x7d490,0x7d890,0x7dc90,0x64090,0x64890
.long 0x7d010,0x7d810,0x7e010,0x0,0x64020,0x64420,0x64820,0x64c20
.long 0x65020,0x65060,0x7d0a0,0x7d4a0,0x7d8a0,0x7dca0,0x640a0,0x648a0
.long 0x7d020,0x7d820,0x7e020,0x0,0x64030,0x64430,0x64830,0x64c30
.long 0x65030,0x65070,0x7d0b0,0x7d4b0,0x7d8b0,0x7dcb0,0x640b0,0x648b0
.long 0x7d030,0x7d830,0x7e030,0x0,0x64040,0x64440,0x64840,0x64c40
.long 0x65080,0x650c0,0x7d0c0,0x7d4c0,0x7d8c0,0x7dcc0,0x64480,0x64c80
.long 0x7d400,0x7dc00,0x7e040,0x0,0x64050,0x64450,0x64850,0x64c50
.long 0x65090,0x650d0,0x7d0d0,0x7d4d0,0x7d8d0,0x7dcd0,0x64490,0x64c90
.long 0x7d410,0x7dc10,0x7e050,0x0,0x64060,0x64460,0x64860,0x64c60
.long 0x650a0,0x650e0,0x7d0e0,0x7d4e0,0x7d8e0,0x7dce0,0x644a0,0x64ca0
.long 0x7d420,0x7dc20,0x7e060,0x0,0x64070,0x64470,0x64870,0x64c70
.long 0x650b0,0x650f0,0x7d0f0,0x7d4f0,0x7d8f0,0x7dcf0,0x644b0,0x64cb0
.long 0x7d430,0x7dc30,0x7e070,0x0,0x64080,0x64480,0x64880,0x64c80
.long 0x7d000,0x7d400,0x7d800,0x7dc00,0x7e000,0x7e040,0x640c0,0x648c0
.long 0x7d040,0x7d840,0x7e080,0x0,0x64090,0x64490,0x64890,0x64c90
.long 0x7d010,0x7d410,0x7d810,0x7dc10,0x7e010,0x7e050,0x640d0,0x648d0
.long 0x7d050,0x7d850,0x7e090,0x0,0x640a0,0x644a0,0x648a0,0x64ca0
.long 0x7d020,0x7d420,0x7d820,0x7dc20,0x7e020,0x7e060,0x640e0,0x648e0
.long 0x7d060,0x7d860,0x7e0a0,0x0,0x640b0,0x644b0,0x648b0,0x64cb0
.long 0x7d030,0x7d430,0x7d830,0x7dc30,0x7e030,0x7e070,0x640f0,0x648f0
.long 0x7d070,0x7d870,0x7e0b0,0x0,0x640c0,0x644c0,0x648c0,0x64cc0
.long 0x7d040,0x7d440,0x7d840,0x7dc40,0x7e080,0x7e0c0,0x644c0,0x64cc0
.long 0x7d440,0x7dc40,0x7e0c0,0x0,0x640d0,0x644d0,0x648d0,0x64cd0
.long 0x7d050,0x7d450,0x7d850,0x7dc50,0x7e090,0x7e0d0,0x644d0,0x64cd0
.long 0x7d450,0x7dc50,0x7e0d0,0x0,0x640e0,0x644e0,0x648e0,0x64ce0
.long 0x7d060,0x7d460,0x7d860,0x7dc60,0x7e0a0,0x7e0e0,0x644e0,0x64ce0
.long 0x7d460,0x7dc60,0x7e0e0,0x0,0x640f0,0x644f0,0x648f0,0x64cf0
.long 0x7d070,0x7d470,0x7d870,0x7dc70,0x7e0b0,0x7e0f0,0x644f0,0x64cf0
.long 0x7d470,0x7dc70,0x7e0f0,0x0,0x96000,0x96400,0x96800,0x96c00
.long 0x97000,0x97040,0xaf080,0xaf480,0xaf880,0xafc80,0x96000,0x96800
.long 0x97000,0xaf080,0xaf880,0x0,0x96010,0x96410,0x96810,0x96c10
.long 0x97010,0x97050,0xaf090,0xaf490,0xaf890,0xafc90,0x96010,0x96810
.long 0x97010,0xaf090,0xaf890,0x0,0x96020,0x96420,0x96820,0x96c20
.long 0x97020,0x97060,0xaf0a0,0xaf4a0,0xaf8a0,0xafca0,0x96020,0x96820
.long 0x97020,0xaf0a0,0xaf8a0,0x0,0x96030,0x96430,0x96830,0x96c30
.long 0x97030,0x97070,0xaf0b0,0xaf4b0,0xaf8b0,0xafcb0,0x96030,0x96830
.long 0x97030,0xaf0b0,0xaf8b0,0x0,0x96040,0x96440,0x96840,0x96c40
.long 0x97080,0x970c0,0xaf0c0,0xaf4c0,0xaf8c0,0xafcc0,0x96400,0x96c00
.long 0x97040,0xaf480,0xafc80,0x0,0x96050,0x96450,0x96850,0x96c50
.long 0x97090,0x970d0,0xaf0d0,0xaf4d0,0xaf8d0,0xafcd0,0x96410,0x96c10
.long 0x97050,0xaf490,0xafc90,0x0,0x96060,0x96460,0x96860,0x96c60
.long 0x970a0,0x970e0,0xaf0e0,0xaf4e0,0xaf8e0,0xafce0,0x96420,0x96c20
.long 0x97060,0xaf4a0,0xafca0,0x0,0x96070,0x96470,0x96870,0x96c70
.long 0x970b0,0x970f0,0xaf0f0,0xaf4f0,0xaf8f0,0xafcf0,0x96430,0x96c30
.long 0x97070,0xaf4b0,0xafcb0,0x0,0x96080,0x96480,0x96880,0x96c80
.long 0xaf000,0xaf400,0xaf800,0xafc00,0xb0000,0xb0040,0x96040,0x96840
.long 0x97080,0xaf0c0,0xaf8c0,0x0,0x96090,0x96490,0x96890,0x96c90
.long 0xaf010,0xaf410,0xaf810,0xafc10,0xb0010,0xb0050,0x96050,0x96850
.long 0x97090,0xaf0d0,0xaf8d0,0x0,0x960a0,0x964a0,0x968a0,0x96ca0
.long 0xaf020,0xaf420,0xaf820,0xafc20,0xb0020,0xb0060,0x96060,0x96860
.long 0x970a0,0xaf0e0,0xaf8e0,0x0,0x960b0,0x964b0,0x968b0,0x96cb0
.long 0xaf030,0xaf430,0xaf830,0xafc30,0xb0030,0xb0070,0x96070,0x96870
.long 0x970b0,0xaf0f0,0xaf8f0,0x0,0x960c0,0x964c0,0x968c0,0x96cc0
.long 0xaf040,0xaf440,0xaf840,0xafc40,0xb0080,0xb00c0,0x96440,0x96c40
.long 0x970c0,0xaf4c0,0xafcc0,0x0,0x960d0,0x964d0,0x968d0,0x96cd0
.long 0xaf050,0xaf450,0xaf850,0xafc50,0xb0090,0xb00d0,0x96450,0x96c50
.long 0x970d0,0xaf4d0,0xafcd0,0x0,0x960e0,0x964e0,0x968e0,0x96ce0
.long 0xaf060,0xaf460,0xaf860,0xafc60,0xb00a0,0xb00e0,0x96460,0x96c60
.long 0x970e0,0xaf4e0,0xafce0,0x0,0x960f0,0x964f0,0x968f0,0x96cf0
.long 0xaf070,0xaf470,0xaf870,0xafc70,0xb00b0,0xb00f0,0x96470,0x96c70
.long 0x970f0,0xaf4f0,0xafcf0,0x0,0x96000,0x96400,0x96800,0x96c00
.long 0x97000,0x97040,0xaf080,0xaf480,0xaf880,0xafc80,0x96080,0x96880
.long 0xaf000,0xaf800,0xb0000,0x0,0x96010,0x96410,0x96810,0x96c10
.long 0x97010,0x97050,0xaf090,0xaf490,0xaf890,0xafc90,0x96090,0x96890
.long 0xaf010,0xaf810,0xb0010,0x0,0x96020,0x96420,0x96820,0x96c20
.long 0x97020,0x97060,0xaf0a0,0xaf4a0,0xaf8a0,0xafca0,0x960a0,0x968a0
.long 0xaf020,0xaf820,0xb0020,0x0,0x96030,0x96430,0x96830,0x96c30
.long 0x97030,0x97070,0xaf0b0,0xaf4b0,0xaf8b0,0xafcb0,0x960b0,0x968b0
.long 0xaf030,0xaf830,0xb0030,0x0,0x96040,0x96440,0x96840,0x96c40
.long 0x97080,0x970c0,0xaf0c0,0xaf4c0,0xaf8c0,0xafcc0,0x96480,0x96c80
.long 0xaf400,0xafc00,0xb0040,0x0,0x96050,0x96450,0x96850,0x96c50
.long 0x97090,0x970d0,0xaf0d0,0xaf4d0,0xaf8d0,0xafcd0,0x96490,0x96c90
.long 0xaf410,0xafc10,0xb0050,0x0,0x96060,0x96460,0x96860,0x96c60
.long 0x970a0,0x970e0,0xaf0e0,0xaf4e0,0xaf8e0,0xafce0,0x964a0,0x96ca0
.long 0xaf420,0xafc20,0xb0060,0x0,0x96070,0x96470,0x96870,0x96c70
.long 0x970b0,0x970f0,0xaf0f0,0xaf4f0,0xaf8f0,0xafcf0,0x964b0,0x96cb0
.long 0xaf430,0xafc30,0xb0070,0x0,0x96080,0x96480,0x96880,0x96c80
.long 0xaf000,0xaf400,0xaf800,0xafc00,0xb0000,0xb0040,0x960c0,0x968c0
.long 0xaf040,0xaf840,0xb0080,0x0,0x96090,0x96490,0x96890,0x96c90
.long 0xaf010,0xaf410,0xaf810,0xafc10,0xb0010,0xb0050,0x960d0,0x968d0
.long 0xaf050,0xaf850,0xb0090,0x0,0x960a0,0x964a0,0x968a0,0x96ca0
.long 0xaf020,0xaf420,0xaf820,0xafc20,0xb0020,0xb0060,0x960e0,0x968e0
.long 0xaf060,0xaf860,0xb00a0,0x0,0x960b0,0x964b0,0x968b0,0x96cb0
.long 0xaf030,0xaf430,0xaf830,0xafc30,0xb0030,0xb0070,0x960f0,0x968f0
.long 0xaf070,0xaf870,0xb00b0,0x0,0x960c0,0x964c0,0x968c0,0x96cc0
.long 0xaf040,0xaf440,0xaf840,0xafc40,0xb0080,0xb00c0,0x964c0,0x96cc0
.long 0xaf440,0xafc40,0xb00c0,0x0,0x960d0,0x964d0,0x968d0,0x96cd0
.long 0xaf050,0xaf450,0xaf850,0xafc50,0xb0090,0xb00d0,0x964d0,0x96cd0
.long 0xaf450,0xafc50,0xb00d0,0x0,0x960e0,0x964e0,0x968e0,0x96ce0
.long 0xaf060,0xaf460,0xaf860,0xafc60,0xb00a0,0xb00e0,0x964e0,0x96ce0
.long 0xaf460,0xafc60,0xb00e0,0x0,0x960f0,0x964f0,0x968f0,0x96cf0
.long 0xaf070,0xaf470,0xaf870,0xafc70,0xb00b0,0xb00f0,0x964f0,0x96cf0
.long 0xaf470,0xafc70,0xb00f0,0x0,0x3f800000,0x3f800000,0x3f800000,0x3f800000
.long 0x3f800000,0x3f7fffb1,0x3f7ffec4,0x3f7ffd39,0x3f800000,0x3f7ffec4,0x3f7ffb11,0x3f7ff4e6
.long 0x3f800000,0x3f7ffd39,0x3f7ff4e6,0x3f7fe705,0x3f800000,0x3f7ffb11,0x3f7fec43,0x3f7fd397
.long 0x3f800000,0x3f7ff84a,0x3f7fe129,0x3f7fba9e,0x3f800000,0x3f7ff4e6,0x3f7fd397,0x3f7f9c18
.long 0x3f800000,0x3f7ff0e3,0x3f7fc38f,0x3f7f7808,0x3f800000,0x3f7fec43,0x3f7fb10f,0x3f7f4e6d
.long 0x3f800000,0x3f7fe705,0x3f7f9c18,0x3f7f1f49,0x3f800000,0x3f7fe129,0x3f7f84ab,0x3f7eea9d
.long 0x3f800000,0x3f7fdaaf,0x3f7f6ac7,0x3f7eb069,0x3f800000,0x3f7fd397,0x3f7f4e6d,0x3f7e70b0
.long 0x3f800000,0x3f7fcbe2,0x3f7f2f9d,0x3f7e2b72,0x3f800000,0x3f7fc38f,0x3f7f0e58,0x3f7de0b1
.long 0x3f800000,0x3f7fba9e,0x3f7eea9d,0x3f7d906e,0x3f800000,0x3f800000,0x3f800000,0x3f800000
.long 0x3f7ffb11,0x3f7ff84a,0x3f7ff4e6,0x3f7ff0e3,0x3f7fec43,0x3f7fe129,0x3f7fd397,0x3f7fc38f
.long 0x3f7fd397,0x3f7fba9e,0x3f7f9c18,0x3f7f7808,0x3f7fb10f,0x3f7f84ab,0x3f7f4e6d,0x3f7f0e58
.long 0x3f7f84ab,0x3f7f3f54,0x3f7eea9d,0x3f7e868b,0x3f7f4e6d,0x3f7eea9d,0x3f7e70b0,0x3f7de0b1
.long 0x3f7f0e58,0x3f7e868b,0x3f7de0b1,0x3f7d1cdd,0x3f7ec46d,0x3f7e1324,0x3f7d3aac,0x3f7c3b28
.long 0x3f7e70b0,0x3f7d906e,0x3f7c7eb0,0x3f7b3bab,0x3f7e1324,0x3f7cfe73,0x3f7baccd,0x3f7a1e84
.long 0x3f7dabcc,0x3f7c5d3a,0x3f7ac516,0x3f78e3d6,0x3f7d3aac,0x3f7baccd,0x3f79c79d,0x3f778bc5
.long 0x3f7cbfc9,0x3f7aed37,0x3f78b47b,0x3f76167a,0x3f7c3b28,0x3f7a1e84,0x3f778bc5,0x3f748422
.long 0x3f7baccd,0x3f7940c0,0x3f764d97,0x3f72d4eb,0x3f800000,0x3f800000,0x3f800000,0x3f800000
.long 0x3f7fec43,0x3f7fe705,0x3f7fe129,0x3f7fdaaf,0x3f7fb10f,0x3f7f9c18,0x3f7f84ab,0x3f7f6ac7
.long 0x3f7f4e6d,0x3f7f1f49,0x3f7eea9d,0x3f7eb069,0x3f7ec46d,0x3f7e70b0,0x3f7e1324,0x3f7dabcc
.long 0x3f7e1324,0x3f7d906e,0x3f7cfe73,0x3f7c5d3a,0x3f7d3aac,0x3f7c7eb0,0x3f7baccd,0x3f7ac516
.long 0x3f7c3b28,0x3f7b3bab,0x3f7a1e84,0x3f78e3d6,0x3f7b14be,0x3f79c79d,0x3f7853f8,0x3f76ba07
.long 0x3f79c79d,0x3f7822d1,0x3f764d97,0x3f74484b,0x3f7853f8,0x3f764d97,0x3f740bdd,0x3f718f57
.long 0x3f76ba07,0x3f74484b,0x3f718f57,0x3f6e8ff8,0x3f74fa0b,0x3f721352,0x3f6ed89e,0x3f6b4b0c
.long 0x3f731447,0x3f6faf1b,0x3f6be858,0x3f67c187,0x3f710908,0x3f6d1c1d,0x3f68bf3c,0x3f63f473
.long 0x3f6ed89e,0x3f6a5ad9,0x3f655e0b,0x3f5fe4e9,0x3f800000,0x3f800000,0x3f800000,0x3f800000
.long 0x3f7fd397,0x3f7fcbe2,0x3f7fc38f,0x3f7fba9e,0x3f7f4e6d,0x3f7f2f9d,0x3f7f0e58,0x3f7eea9d
.long 0x3f7e70b0,0x3f7e2b72,0x3f7de0b1,0x3f7d906e,0x3f7d3aac,0x3f7cbfc9,0x3f7c3b28,0x3f7baccd
.long 0x3f7baccd,0x3f7aed37,0x3f7a1e84,0x3f7940c0,0x3f79c79d,0x3f78b47b,0x3f778bc5,0x3f764d97
.long 0x3f778bc5,0x3f76167a,0x3f748422,0x3f72d4eb,0x3f74fa0b,0x3f731447,0x3f710908,0x3f6ed89e
.long 0x3f721352,0x3f6faf1b,0x3f6d1c1d,0x3f6a5ad9,0x3f6ed89e,0x3f6be858,0x3f68bf3c,0x3f655e0b
.long 0x3f6b4b0c,0x3f67c187,0x3f63f473,0x3f5fe4e9,0x3f676bd8,0x3f633c5a,0x3f5ebe05,0x3f59f26a
.long 0x3f633c5a,0x3f5e5aa6,0x3f591e6a,0x3f5389c7,0x3f5ebe05,0x3f591e6a,0x3f531849,0x3f4cae79
.long 0x3f59f26a,0x3f5389c7,0x3f4cae79,0x3f456439,0x0,0x0,0x0,0x0
.long 0x0,0x3b490fc6,0x3bc90f88,0x3c16cb58,0x0,0x3bc90f88,0x3c490e90,0x3c96c9b6
.long 0x0,0x3c16cb58,0x3c96c9b6,0x3ce22a7a,0x0,0x3c490e90,0x3cc90ab0,0x3d16c32c
.long 0x0,0x3c7b514b,0x3cfb49ba,0x3d3c6dd5,0x0,0x3c96c9b6,0x3d16c32c,0x3d621469
.long 0x0,0x3cafea69,0x3d2fe007,0x3d83db0a,0x0,0x3cc90ab0,0x3d48fb30,0x3d96a905
.long 0x0,0x3ce22a7a,0x3d621469,0x3da973ba,0x0,0x3cfb49ba,0x3d7b2b74,0x3dbc3ac3
.long 0x0,0x3d0a342f,0x3d8a200a,0x3dcefdb7,0x0,0x3d16c32c,0x3d96a905,0x3de1bc2e
.long 0x0,0x3d2351cb,0x3da3308c,0x3df475c0,0x0,0x3d2fe007,0x3dafb680,0x3e039502
.long 0x0,0x3d3c6dd5,0x3dbc3ac3,0x3e0cec4a,0x0,0x0,0x0,0x0
.long 0x3c490e90,0x3c7b514b,0x3c96c9b6,0x3cafea69,0x3cc90ab0,0x3cfb49ba,0x3d16c32c,0x3d2fe007
.long 0x3d16c32c,0x3d3c6dd5,0x3d621469,0x3d83db0a,0x3d48fb30,0x3d7b2b74,0x3d96a905,0x3dafb680
.long 0x3d7b2b74,0x3d9cecf9,0x3dbc3ac3,0x3ddb7d37,0x3d96a905,0x3dbc3ac3,0x3de1bc2e,0x3e039502
.long 0x3dafb680,0x3ddb7d37,0x3e039502,0x3e195be0,0x3dc8bd36,0x3dfab273,0x3e164083,0x3e2f10a2
.long 0x3de1bc2e,0x3e0cec4a,0x3e28defc,0x3e44b0b9,0x3dfab273,0x3e1c76de,0x3e3b6ecf,0x3e5a3997
.long 0x3e09cf86,0x3e2bf804,0x3e4dee60,0x3e6fa8b2,0x3e164083,0x3e3b6ecf,0x3e605c13,0x3e827dc0
.long 0x3e22abb6,0x3e4ada4f,0x3e72b651,0x3e8d17c0,0x3e2f10a2,0x3e5a3997,0x3e827dc0,0x3e97a117
.long 0x3e3b6ecf,0x3e698bba,0x3e8b9507,0x3ea21887,0x0,0x0,0x0,0x0
.long 0x3cc90ab0,0x3ce22a7a,0x3cfb49ba,0x3d0a342f,0x3d48fb30,0x3d621469,0x3d7b2b74,0x3d8a200a
.long 0x3d96a905,0x3da973ba,0x3dbc3ac3,0x3dcefdb7,0x3dc8bd36,0x3de1bc2e,0x3dfab273,0x3e09cf86
.long 0x3dfab273,0x3e0cec4a,0x3e1c76de,0x3e2bf804,0x3e164083,0x3e28defc,0x3e3b6ecf,0x3e4dee60
.long 0x3e2f10a2,0x3e44b0b9,0x3e5a3997,0x3e6fa8b2,0x3e47c5c2,0x3e605c13,0x3e78cfcc,0x3e888e93
.long 0x3e605c13,0x3e7bdba4,0x3e8b9507,0x3e9920fe,0x3e78cfcc,0x3e8b9507,0x3e9aa086,0x3ea986c4
.long 0x3e888e93,0x3e9920fe,0x3ea986c4,0x3eb9bb1e,0x3e94a031,0x3ea68f12,0x3eb8442a,0x3ec9b953
.long 0x3ea09ae5,0x3eb3dca5,0x3ec6d529,0x3ed97cb9,0x3eac7cd4,0x3ec1071e,0x3ed53641,0x3ee900b7
.long 0x3eb8442a,0x3ece0bea,0x3ee363fa,0x3ef840c8,0x0,0x0,0x0,0x0
.long 0x3d16c32c,0x3d2351cb,0x3d2fe007,0x3d3c6dd5,0x3d96a905,0x3da3308c,0x3dafb680,0x3dbc3ac3
.long 0x3de1bc2e,0x3df475c0,0x3e039502,0x3e0cec4a,0x3e164083,0x3e22abb6,0x3e2f10a2,0x3e3b6ecf
.long 0x3e3b6ecf,0x3e4ada4f,0x3e5a3997,0x3e698bba,0x3e605c13,0x3e72b651,0x3e827dc0,0x3e8b9507
.long 0x3e827dc0,0x3e8d17c0,0x3e97a117,0x3ea21887,0x3e94a031,0x3ea09ae5,0x3eac7cd4,0x3eb8442a
.long 0x3ea68f12,0x3eb3dca5,0x3ec1071e,0x3ece0bea,0x3eb8442a,0x3ec6d529,0x3ed53641,0x3ee363fa
.long 0x3ec9b953,0x3ed97cb9,0x3ee900b7,0x3ef840c8,0x3edae880,0x3eebcbbb,0x3efc5d27,0x3f064b82
.long 0x3eebcbbb,0x3efdbabb,0x3f07a136,0x3f102dd5,0x3efc5d27,0x3f07a136,0x3f10d3cd,0x3f19c200
.long 0x3f064b82,0x3f102dd5,0x3f19c200,0x3f2302d3,0x3f800000,0x3f800000,0x3f800000,0x3f800000
.long 0x3f7fb10f,0x3f7fa6e3,0x3f7f9c18,0x3f7f90b1,0x3f7ec46d,0x3f7e9bc9,0x3f7e70b0,0x3f7e4323
.long 0x3f7d3aac,0x3f7cdf6c,0x3f7c7eb0,0x3f7c187a,0x3f7b14be,0x3f7a7302,0x3f79c79d,0x3f791298
.long 0x3f7853f8,0x3f77583a,0x3f764d97,0x3f75341d,0x3f74fa0b,0x3f73913f,0x3f721352,0x3f708066
.long 0x3f710908,0x3f6f20b0,0x3f6d1c1d,0x3f6afb8c,0x3f6c835e,0x3f6a09a7,0x3f676bd8,0x3f64aa59
.long 0x3f676bd8,0x3f644fac,0x3f6106f2,0x3f5d924d,0x3f61c598,0x3f5df6be,0x3f59f26a,0x3f55b993
.long 0x3f5b941a,0x3f570348,0x3f5233c6,0x3f4d26fd,0x3f54db31,0x3f4f7a1f,0x3f49d112,0x3f43e200
.long 0x3f4d9f02,0x3f476085,0x3f40d0da,0x3f39f2ac,0x3f45e403,0x3f3ebc1b,0x3f373a23,0x3f2f61a5
.long 0x3f3daef9,0x3f3592e7,0x3f2d1469,0x3f24381a,0x3f800000,0x3f800000,0x3f800000,0x3f800000
.long 0x3f7f84ab,0x3f7f7808,0x3f7f6ac7,0x3f7f5ce9,0x3f7e1324,0x3f7de0b1,0x3f7dabcc,0x3f7d7474
.long 0x3f7baccd,0x3f7b3bab,0x3f7ac516,0x3f7a4910,0x3f7853f8,0x3f778bc5,0x3f76ba07,0x3f75dec6
.long 0x3f740bdd,0x3f72d4eb,0x3f718f57,0x3f703b37,0x3f6ed89e,0x3f6d1c1d,0x3f6b4b0c,0x3f696591
.long 0x3f68bf3c,0x3f666771,0x3f63f473,0x3f61668a,0x3f61c598,0x3f5ebe05,0x3f5b941a,0x3f584853
.long 0x3f59f26a,0x3f5627fe,0x3f5233c6,0x3f4e1689,0x3f514d3d,0x3f4cae79,0x3f47de65,0x3f42de29
.long 0x3f47de65,0x3f425b89,0x3f3ca003,0x3f36ad7f,0x3f3daef9,0x3f373a23,0x3f3085bb,0x3f299415
.long 0x3f32c8c9,0x3f2b561b,0x3f239da9,0x3f1ba299,0x3f273656,0x3f1ebc12,0x3f15f6d9,0x3f0cead0
.long 0x3f1b02c6,0x3f11796b,0x3f07a136,0x3efafef7,0x3f800000,0x3f800000,0x3f800000,0x3f800000
.long 0x3f7f4e6d,0x3f7f3f54,0x3f7f2f9d,0x3f7f1f49,0x3f7d3aac,0x3f7cfe73,0x3f7cbfc9,0x3f7c7eb0
.long 0x3f79c79d,0x3f7940c0,0x3f78b47b,0x3f7822d1,0x3f74fa0b,0x3f740bdd,0x3f731447,0x3f721352
.long 0x3f6ed89e,0x3f6d67a1,0x3f6be858,0x3f6a5ad9,0x3f676bd8,0x3f655e0b,0x3f633c5a,0x3f6106f2
.long 0x3f5ebe05,0x3f5bfb34,0x3f591e6a,0x3f5627fe,0x3f54db31,0x3f514d3d,0x3f4d9f02,0x3f49d112
.long 0x3f49d112,0x3f456439,0x3f40d0da,0x3f3c17d9,0x3f3daef9,0x3f385216,0x3f32c8c9,0x3f2d1469
.long 0x3f3085bb,0x3f2a2a80,0x3f239da9,0x3f1ce11f,0x3f226799,0x3f1b02c6,0x3f13682a,0x3f0b9a6b
.long 0x3f13682a,0x3f0af1b7,0x3f0242b1,0x3ef2bd43,0x3f039c3d,0x3ef41f07,0x3ee0924f,0x3ecc9b8b
.long 0x3ee63375,0x3ed0eb2a,0x3ebb31a0,0x3ea5129f,0x3f800000,0x3f800000,0x3f800000,0x3f800000
.long 0x3f7f0e58,0x3f7efcc9,0x3f7eea9d,0x3f7ed7d4,0x3f7c3b28,0x3f7bf531,0x3f7baccd,0x3f7b61fc
.long 0x3f778bc5,0x3f76ef5b,0x3f764d97,0x3f75a67b,0x3f710908,0x3f6ff573,0x3f6ed89e,0x3f6db293
.long 0x3f68bf3c,0x3f671599,0x3f655e0b,0x3f6398ac,0x3f5ebe05,0x3f5c61c7,0x3f59f26a,0x3f577026
.long 0x3f531849,0x3f4fefa8,0x3f4cae79,0x3f495521,0x3f45e403,0x3f41d870,0x3f3daef9,0x3f396842
.long 0x3f373a23,0x3f3238aa,0x3f2d1469,0x3f27ce61,0x3f273656,0x3f212ff9,0x3f1b02c6,0x3f14b039
.long 0x3f15f6d9,0x3f0ee0db,0x3f07a136,0x3f003a06,0x3f039c3d,0x3ef6e0cb,0x3ee63375,0x3ed53641
.long 0x3ee0924f,0x3ece0bea,0x3ebb31a0,0x3ea80b1f,0x3eb8442a,0x3ea395c5,0x3e8e9a22,0x3e72b651
.long 0x3e8e9a22,0x3e6fa8b2,0x3e419b37,0x3e1324ca,0x0,0x0,0x0,0x0
.long 0x3d48fb30,0x3d55880e,0x3d621469,0x3d6ea038,0x3dc8bd36,0x3dd53db9,0x3de1bc2e,0x3dee3876
.long 0x3e164083,0x3e1f917b,0x3e28defc,0x3e3228d4,0x3e47c5c2,0x3e541501,0x3e605c13,0x3e6c9a7f
.long 0x3e78cfcc,0x3e840270,0x3e8b9507,0x3e931f35,0x3e94a031,0x3e9d9e78,0x3ea68f12,0x3eaf713a
.long 0x3eac7cd4,0x3eb6ccc3,0x3ec1071e,0x3ecb2aae,0x3ec3ef15,0x3ecf7bca,0x3edae880,0x3ee63375
.long 0x3edae880,0x3ee79a5d,0x3ef41f07,0x3f003a06,0x3ef15aea,0x3eff17b2,0x3f064b82,0x3f0cead0
.long 0x3f039c3d,0x3f0af1b7,0x3f121eb0,0x3f19210f,0x3f0e39da,0x3f15f6d9,0x3f1d7fd1,0x3f24d225
.long 0x3f187fc0,0x3f209393,0x3f286605,0x3f2ff3e6,0x3f226799,0x3f2ac082,0x3f32c8c9,0x3f3a7ca4
.long 0x3f2beb4a,0x3f34768f,0x3f3ca003,0x3f446337,0x0,0x0,0x0,0x0
.long 0x3d7b2b74,0x3d83db0a,0x3d8a200a,0x3d9064b4,0x3dfab273,0x3e039502,0x3e09cf86,0x3e1008b7
.long 0x3e3b6ecf,0x3e44b0b9,0x3e4dee60,0x3e57278f,0x3e78cfcc,0x3e827dc0,0x3e888e93,0x3e8e9a22
.long 0x3e9aa086,0x3ea21887,0x3ea986c4,0x3eb0eacb,0x3eb8442a,0x3ec1071e,0x3ec9b953,0x3ed25a09
.long 0x3ed53641,0x3edf28a9,0x3ee900b7,0x3ef2bd43,0x3ef15aea,0x3efc5d27,0x3f039c3d,0x3f08f59b
.long 0x3f064b82,0x3f0c42c9,0x3f121eb0,0x3f17de12,0x3f13682a,0x3f19c200,0x3f1ff6cb,0x3f26050a
.long 0x3f1ff6cb,0x3f269de3,0x3f2d1469,0x3f33587a,0x3f2beb4a,0x3f32c8c9,0x3f396842,0x3f3fc767
.long 0x3f373a23,0x3f3e35c5,0x3f44e3f5,0x3f4b41fa,0x3f41d870,0x3f48d8b3,0x3f4f7a1f,0x3f55b993
.long 0x3f4bbbf8,0x3f52a649,0x3f591e6a,0x3f5f20db,0x0,0x0,0x0,0x0
.long 0x3d96a905,0x3d9cecf9,0x3da3308c,0x3da973ba,0x3e164083,0x3e1c76de,0x3e22abb6,0x3e28defc
.long 0x3e605c13,0x3e698bba,0x3e72b651,0x3e7bdba4,0x3e94a031,0x3e9aa086,0x3ea09ae5,0x3ea68f12
.long 0x3eb8442a,0x3ebf926f,0x3ec6d529,0x3ece0bea,0x3edae880,0x3ee363fa,0x3eebcbbb,0x3ef41f07
.long 0x3efc5d27,0x3f02ef9f,0x3f07a136,0x3f0c42c9,0x3f0e39da,0x3f13682a,0x3f187fc0,0x3f1d7fd1
.long 0x3f1d7fd1,0x3f2302d3,0x3f286605,0x3f2da859,0x3f2beb4a,0x3f31a81d,0x3f373a23,0x3f3ca003
.long 0x3f396842,0x3f3f41fc,0x3f44e3f5,0x3f4a4c87,0x3f45e403,0x3f4bbbf8,0x3f514d3d,0x3f5695e5
.long 0x3f514d3d,0x3f570348,0x3f5c61c7,0x3f61668a,0x3f5b941a,0x3f6106f2,0x3f660f88,0x3f6aab7b
.long 0x3f64aa59,0x3f69b7e4,0x3f6e46be,0x3f725470,0x0,0x0,0x0,0x0
.long 0x3dafb680,0x3db5f8da,0x3dbc3ac3,0x3dc27c39,0x3e2f10a2,0x3e354098,0x3e3b6ecf,0x3e419b37
.long 0x3e827dc0,0x3e870ada,0x3e8b9507,0x3e901c2c,0x3eac7cd4,0x3eb263ef,0x3eb8442a,0x3ebe1d4a
.long 0x3ed53641,0x3edc53c1,0x3ee363fa,0x3eea6681,0x3efc5d27,0x3f0242b1,0x3f064b82,0x3f0a48ad
.long 0x3f10d3cd,0x3f1553b7,0x3f19c200,0x3f1e1e22,0x3f226799,0x3f273656,0x3f2beb4a,0x3f3085bb
.long 0x3f32c8c9,0x3f37c655,0x3f3ca003,0x3f4154e1,0x3f41d870,0x3f46e22a,0x3f4bbbf8,0x3f5064af
.long 0x3f4f7a1f,0x3f546b3b,0x3f591e6a,0x3f5d924d,0x3f5b941a,0x3f604621,0x3f64aa59,0x3f68bf3c
.long 0x3f660f88,0x3f6a5ad9,0x3f6e46be,0x3f71d19f,0x3f6ed89e,0x3f7294f8,0x3f75dec6,0x3f78b47b
.long 0x3f75dec6,0x3f78e3d6,0x3f7b61fc,0x3f7d57de,0x3f800000,0x3f800000,0x3f800000,0x3f800000
.long 0x3f800000,0x3f7fffb1,0x3f7ffec4,0x3f7ffd39,0x3f800000,0x3f7ffec4,0x3f7ffb11,0x3f7ff4e6
.long 0x3f800000,0x3f7ffd39,0x3f7ff4e6,0x3f7fe705,0x3f800000,0x3f7ffb11,0x3f7fec43,0x3f7fd397
.long 0x3f800000,0x3f7ff84a,0x3f7fe129,0x3f7fba9e,0x3f800000,0x3f7ff4e6,0x3f7fd397,0x3f7f9c18
.long 0x3f800000,0x3f7ff0e3,0x3f7fc38f,0x3f7f7808,0x3f800000,0x3f7fec43,0x3f7fb10f,0x3f7f4e6d
.long 0x3f800000,0x3f7fe705,0x3f7f9c18,0x3f7f1f49,0x3f800000,0x3f7fe129,0x3f7f84ab,0x3f7eea9d
.long 0x3f800000,0x3f7fdaaf,0x3f7f6ac7,0x3f7eb069,0x3f800000,0x3f7fd397,0x3f7f4e6d,0x3f7e70b0
.long 0x3f800000,0x3f7fcbe2,0x3f7f2f9d,0x3f7e2b72,0x3f800000,0x3f7fc38f,0x3f7f0e58,0x3f7de0b1
.long 0x3f800000,0x3f7fba9e,0x3f7eea9d,0x3f7d906e,0x3f800000,0x3f800000,0x3f800000,0x3f800000
.long 0x3f7ffb11,0x3f7ff84a,0x3f7ff4e6,0x3f7ff0e3,0x3f7fec43,0x3f7fe129,0x3f7fd397,0x3f7fc38f
.long 0x3f7fd397,0x3f7fba9e,0x3f7f9c18,0x3f7f7808,0x3f7fb10f,0x3f7f84ab,0x3f7f4e6d,0x3f7f0e58
.long 0x3f7f84ab,0x3f7f3f54,0x3f7eea9d,0x3f7e868b,0x3f7f4e6d,0x3f7eea9d,0x3f7e70b0,0x3f7de0b1
.long 0x3f7f0e58,0x3f7e868b,0x3f7de0b1,0x3f7d1cdd,0x3f7ec46d,0x3f7e1324,0x3f7d3aac,0x3f7c3b28
.long 0x3f7e70b0,0x3f7d906e,0x3f7c7eb0,0x3f7b3bab,0x3f7e1324,0x3f7cfe73,0x3f7baccd,0x3f7a1e84
.long 0x3f7dabcc,0x3f7c5d3a,0x3f7ac516,0x3f78e3d6,0x3f7d3aac,0x3f7baccd,0x3f79c79d,0x3f778bc5
.long 0x3f7cbfc9,0x3f7aed37,0x3f78b47b,0x3f76167a,0x3f7c3b28,0x3f7a1e84,0x3f778bc5,0x3f748422
.long 0x3f7baccd,0x3f7940c0,0x3f764d97,0x3f72d4eb,0x3f800000,0x3f800000,0x3f800000,0x3f800000
.long 0x3f7fec43,0x3f7fe705,0x3f7fe129,0x3f7fdaaf,0x3f7fb10f,0x3f7f9c18,0x3f7f84ab,0x3f7f6ac7
.long 0x3f7f4e6d,0x3f7f1f49,0x3f7eea9d,0x3f7eb069,0x3f7ec46d,0x3f7e70b0,0x3f7e1324,0x3f7dabcc
.long 0x3f7e1324,0x3f7d906e,0x3f7cfe73,0x3f7c5d3a,0x3f7d3aac,0x3f7c7eb0,0x3f7baccd,0x3f7ac516
.long 0x3f7c3b28,0x3f7b3bab,0x3f7a1e84,0x3f78e3d6,0x3f7b14be,0x3f79c79d,0x3f7853f8,0x3f76ba07
.long 0x3f79c79d,0x3f7822d1,0x3f764d97,0x3f74484b,0x3f7853f8,0x3f764d97,0x3f740bdd,0x3f718f57
.long 0x3f76ba07,0x3f74484b,0x3f718f57,0x3f6e8ff8,0x3f74fa0b,0x3f721352,0x3f6ed89e,0x3f6b4b0c
.long 0x3f731447,0x3f6faf1b,0x3f6be858,0x3f67c187,0x3f710908,0x3f6d1c1d,0x3f68bf3c,0x3f63f473
.long 0x3f6ed89e,0x3f6a5ad9,0x3f655e0b,0x3f5fe4e9,0x3f800000,0x3f800000,0x3f800000,0x3f800000
.long 0x3f7fd397,0x3f7fcbe2,0x3f7fc38f,0x3f7fba9e,0x3f7f4e6d,0x3f7f2f9d,0x3f7f0e58,0x3f7eea9d
.long 0x3f7e70b0,0x3f7e2b72,0x3f7de0b1,0x3f7d906e,0x3f7d3aac,0x3f7cbfc9,0x3f7c3b28,0x3f7baccd
.long 0x3f7baccd,0x3f7aed37,0x3f7a1e84,0x3f7940c0,0x3f79c79d,0x3f78b47b,0x3f778bc5,0x3f764d97
.long 0x3f778bc5,0x3f76167a,0x3f748422,0x3f72d4eb,0x3f74fa0b,0x3f731447,0x3f710908,0x3f6ed89e
.long 0x3f721352,0x3f6faf1b,0x3f6d1c1d,0x3f6a5ad9,0x3f6ed89e,0x3f6be858,0x3f68bf3c,0x3f655e0b
.long 0x3f6b4b0c,0x3f67c187,0x3f63f473,0x3f5fe4e9,0x3f676bd8,0x3f633c5a,0x3f5ebe05,0x3f59f26a
.long 0x3f633c5a,0x3f5e5aa6,0x3f591e6a,0x3f5389c7,0x3f5ebe05,0x3f591e6a,0x3f531849,0x3f4cae79
.long 0x3f59f26a,0x3f5389c7,0x3f4cae79,0x3f456439,0x0,0x0,0x0,0x0
.long 0x0,0x3b490fc6,0x3bc90f88,0x3c16cb58,0x0,0x3bc90f88,0x3c490e90,0x3c96c9b6
.long 0x0,0x3c16cb58,0x3c96c9b6,0x3ce22a7a,0x0,0x3c490e90,0x3cc90ab0,0x3d16c32c
.long 0x0,0x3c7b514b,0x3cfb49ba,0x3d3c6dd5,0x0,0x3c96c9b6,0x3d16c32c,0x3d621469
.long 0x0,0x3cafea69,0x3d2fe007,0x3d83db0a,0x0,0x3cc90ab0,0x3d48fb30,0x3d96a905
.long 0x0,0x3ce22a7a,0x3d621469,0x3da973ba,0x0,0x3cfb49ba,0x3d7b2b74,0x3dbc3ac3
.long 0x0,0x3d0a342f,0x3d8a200a,0x3dcefdb7,0x0,0x3d16c32c,0x3d96a905,0x3de1bc2e
.long 0x0,0x3d2351cb,0x3da3308c,0x3df475c0,0x0,0x3d2fe007,0x3dafb680,0x3e039502
.long 0x0,0x3d3c6dd5,0x3dbc3ac3,0x3e0cec4a,0x0,0x0,0x0,0x0
.long 0x3c490e90,0x3c7b514b,0x3c96c9b6,0x3cafea69,0x3cc90ab0,0x3cfb49ba,0x3d16c32c,0x3d2fe007
.long 0x3d16c32c,0x3d3c6dd5,0x3d621469,0x3d83db0a,0x3d48fb30,0x3d7b2b74,0x3d96a905,0x3dafb680
.long 0x3d7b2b74,0x3d9cecf9,0x3dbc3ac3,0x3ddb7d37,0x3d96a905,0x3dbc3ac3,0x3de1bc2e,0x3e039502
.long 0x3dafb680,0x3ddb7d37,0x3e039502,0x3e195be0,0x3dc8bd36,0x3dfab273,0x3e164083,0x3e2f10a2
.long 0x3de1bc2e,0x3e0cec4a,0x3e28defc,0x3e44b0b9,0x3dfab273,0x3e1c76de,0x3e3b6ecf,0x3e5a3997
.long 0x3e09cf86,0x3e2bf804,0x3e4dee60,0x3e6fa8b2,0x3e164083,0x3e3b6ecf,0x3e605c13,0x3e827dc0
.long 0x3e22abb6,0x3e4ada4f,0x3e72b651,0x3e8d17c0,0x3e2f10a2,0x3e5a3997,0x3e827dc0,0x3e97a117
.long 0x3e3b6ecf,0x3e698bba,0x3e8b9507,0x3ea21887,0x0,0x0,0x0,0x0
.long 0x3cc90ab0,0x3ce22a7a,0x3cfb49ba,0x3d0a342f,0x3d48fb30,0x3d621469,0x3d7b2b74,0x3d8a200a
.long 0x3d96a905,0x3da973ba,0x3dbc3ac3,0x3dcefdb7,0x3dc8bd36,0x3de1bc2e,0x3dfab273,0x3e09cf86
.long 0x3dfab273,0x3e0cec4a,0x3e1c76de,0x3e2bf804,0x3e164083,0x3e28defc,0x3e3b6ecf,0x3e4dee60
.long 0x3e2f10a2,0x3e44b0b9,0x3e5a3997,0x3e6fa8b2,0x3e47c5c2,0x3e605c13,0x3e78cfcc,0x3e888e93
.long 0x3e605c13,0x3e7bdba4,0x3e8b9507,0x3e9920fe,0x3e78cfcc,0x3e8b9507,0x3e9aa086,0x3ea986c4
.long 0x3e888e93,0x3e9920fe,0x3ea986c4,0x3eb9bb1e,0x3e94a031,0x3ea68f12,0x3eb8442a,0x3ec9b953
.long 0x3ea09ae5,0x3eb3dca5,0x3ec6d529,0x3ed97cb9,0x3eac7cd4,0x3ec1071e,0x3ed53641,0x3ee900b7
.long 0x3eb8442a,0x3ece0bea,0x3ee363fa,0x3ef840c8,0x0,0x0,0x0,0x0
.long 0x3d16c32c,0x3d2351cb,0x3d2fe007,0x3d3c6dd5,0x3d96a905,0x3da3308c,0x3dafb680,0x3dbc3ac3
.long 0x3de1bc2e,0x3df475c0,0x3e039502,0x3e0cec4a,0x3e164083,0x3e22abb6,0x3e2f10a2,0x3e3b6ecf
.long 0x3e3b6ecf,0x3e4ada4f,0x3e5a3997,0x3e698bba,0x3e605c13,0x3e72b651,0x3e827dc0,0x3e8b9507
.long 0x3e827dc0,0x3e8d17c0,0x3e97a117,0x3ea21887,0x3e94a031,0x3ea09ae5,0x3eac7cd4,0x3eb8442a
.long 0x3ea68f12,0x3eb3dca5,0x3ec1071e,0x3ece0bea,0x3eb8442a,0x3ec6d529,0x3ed53641,0x3ee363fa
.long 0x3ec9b953,0x3ed97cb9,0x3ee900b7,0x3ef840c8,0x3edae880,0x3eebcbbb,0x3efc5d27,0x3f064b82
.long 0x3eebcbbb,0x3efdbabb,0x3f07a136,0x3f102dd5,0x3efc5d27,0x3f07a136,0x3f10d3cd,0x3f19c200
.long 0x3f064b82,0x3f102dd5,0x3f19c200,0x3f2302d3,0x3f800000,0x3f7fb10f,0x3f7ec46d,0x3f7d3aac
.long 0x3f800000,0x3f7fa6e3,0x3f7e9bc9,0x3f7cdf6c,0x3f800000,0x3f7f9c18,0x3f7e70b0,0x3f7c7eb0
.long 0x3f800000,0x3f7f90b1,0x3f7e4323,0x3f7c187a,0x3f800000,0x3f7f84ab,0x3f7e1324,0x3f7baccd
.long 0x3f800000,0x3f7f7808,0x3f7de0b1,0x3f7b3bab,0x3f800000,0x3f7f6ac7,0x3f7dabcc,0x3f7ac516
.long 0x3f800000,0x3f7f5ce9,0x3f7d7474,0x3f7a4910,0x3f800000,0x3f7f4e6d,0x3f7d3aac,0x3f79c79d
.long 0x3f800000,0x3f7f3f54,0x3f7cfe73,0x3f7940c0,0x3f800000,0x3f7f2f9d,0x3f7cbfc9,0x3f78b47b
.long 0x3f800000,0x3f7f1f49,0x3f7c7eb0,0x3f7822d1,0x3f800000,0x3f7f0e58,0x3f7c3b28,0x3f778bc5
.long 0x3f800000,0x3f7efcc9,0x3f7bf531,0x3f76ef5b,0x3f800000,0x3f7eea9d,0x3f7baccd,0x3f764d97
.long 0x3f800000,0x3f7ed7d4,0x3f7b61fc,0x3f75a67b,0x3f7b14be,0x3f7853f8,0x3f74fa0b,0x3f710908
.long 0x3f7a7302,0x3f77583a,0x3f73913f,0x3f6f20b0,0x3f79c79d,0x3f764d97,0x3f721352,0x3f6d1c1d
.long 0x3f791298,0x3f75341d,0x3f708066,0x3f6afb8c,0x3f7853f8,0x3f740bdd,0x3f6ed89e,0x3f68bf3c
.long 0x3f778bc5,0x3f72d4eb,0x3f6d1c1d,0x3f666771,0x3f76ba07,0x3f718f57,0x3f6b4b0c,0x3f63f473
.long 0x3f75dec6,0x3f703b37,0x3f696591,0x3f61668a,0x3f74fa0b,0x3f6ed89e,0x3f676bd8,0x3f5ebe05
.long 0x3f740bdd,0x3f6d67a1,0x3f655e0b,0x3f5bfb34,0x3f731447,0x3f6be858,0x3f633c5a,0x3f591e6a
.long 0x3f721352,0x3f6a5ad9,0x3f6106f2,0x3f5627fe,0x3f710908,0x3f68bf3c,0x3f5ebe05,0x3f531849
.long 0x3f6ff573,0x3f671599,0x3f5c61c7,0x3f4fefa8,0x3f6ed89e,0x3f655e0b,0x3f59f26a,0x3f4cae79
.long 0x3f6db293,0x3f6398ac,0x3f577026,0x3f495521,0x3f6c835e,0x3f676bd8,0x3f61c598,0x3f5b941a
.long 0x3f6a09a7,0x3f644fac,0x3f5df6be,0x3f570348,0x3f676bd8,0x3f6106f2,0x3f59f26a,0x3f5233c6
.long 0x3f64aa59,0x3f5d924d,0x3f55b993,0x3f4d26fd,0x3f61c598,0x3f59f26a,0x3f514d3d,0x3f47de65
.long 0x3f5ebe05,0x3f5627fe,0x3f4cae79,0x3f425b89,0x3f5b941a,0x3f5233c6,0x3f47de65,0x3f3ca003
.long 0x3f584853,0x3f4e1689,0x3f42de29,0x3f36ad7f,0x3f54db31,0x3f49d112,0x3f3daef9,0x3f3085bb
.long 0x3f514d3d,0x3f456439,0x3f385216,0x3f2a2a80,0x3f4d9f02,0x3f40d0da,0x3f32c8c9,0x3f239da9
.long 0x3f49d112,0x3f3c17d9,0x3f2d1469,0x3f1ce11f,0x3f45e403,0x3f373a23,0x3f273656,0x3f15f6d9
.long 0x3f41d870,0x3f3238aa,0x3f212ff9,0x3f0ee0db,0x3f3daef9,0x3f2d1469,0x3f1b02c6,0x3f07a136
.long 0x3f396842,0x3f27ce61,0x3f14b039,0x3f003a06,0x3f54db31,0x3f4d9f02,0x3f45e403,0x3f3daef9
.long 0x3f4f7a1f,0x3f476085,0x3f3ebc1b,0x3f3592e7,0x3f49d112,0x3f40d0da,0x3f373a23,0x3f2d1469
.long 0x3f43e200,0x3f39f2ac,0x3f2f61a5,0x3f24381a,0x3f3daef9,0x3f32c8c9,0x3f273656,0x3f1b02c6
.long 0x3f373a23,0x3f2b561b,0x3f1ebc12,0x3f11796b,0x3f3085bb,0x3f239da9,0x3f15f6d9,0x3f07a136
.long 0x3f299415,0x3f1ba299,0x3f0cead0,0x3efafef7,0x3f226799,0x3f13682a,0x3f039c3d,0x3ee63375
.long 0x3f1b02c6,0x3f0af1b7,0x3ef41f07,0x3ed0eb2a,0x3f13682a,0x3f0242b1,0x3ee0924f,0x3ebb31a0
.long 0x3f0b9a6b,0x3ef2bd43,0x3ecc9b8b,0x3ea5129f,0x3f039c3d,0x3ee0924f,0x3eb8442a,0x3e8e9a22
.long 0x3ef6e0cb,0x3ece0bea,0x3ea395c5,0x3e6fa8b2,0x3ee63375,0x3ebb31a0,0x3e8e9a22,0x3e419b37
.long 0x3ed53641,0x3ea80b1f,0x3e72b651,0x3e1324ca,0x0,0x3d48fb30,0x3dc8bd36,0x3e164083
.long 0x0,0x3d55880e,0x3dd53db9,0x3e1f917b,0x0,0x3d621469,0x3de1bc2e,0x3e28defc
.long 0x0,0x3d6ea038,0x3dee3876,0x3e3228d4,0x0,0x3d7b2b74,0x3dfab273,0x3e3b6ecf
.long 0x0,0x3d83db0a,0x3e039502,0x3e44b0b9,0x0,0x3d8a200a,0x3e09cf86,0x3e4dee60
.long 0x0,0x3d9064b4,0x3e1008b7,0x3e57278f,0x0,0x3d96a905,0x3e164083,0x3e605c13
.long 0x0,0x3d9cecf9,0x3e1c76de,0x3e698bba,0x0,0x3da3308c,0x3e22abb6,0x3e72b651
.long 0x0,0x3da973ba,0x3e28defc,0x3e7bdba4,0x0,0x3dafb680,0x3e2f10a2,0x3e827dc0
.long 0x0,0x3db5f8da,0x3e354098,0x3e870ada,0x0,0x3dbc3ac3,0x3e3b6ecf,0x3e8b9507
.long 0x0,0x3dc27c39,0x3e419b37,0x3e901c2c,0x3e47c5c2,0x3e78cfcc,0x3e94a031,0x3eac7cd4
.long 0x3e541501,0x3e840270,0x3e9d9e78,0x3eb6ccc3,0x3e605c13,0x3e8b9507,0x3ea68f12,0x3ec1071e
.long 0x3e6c9a7f,0x3e931f35,0x3eaf713a,0x3ecb2aae,0x3e78cfcc,0x3e9aa086,0x3eb8442a,0x3ed53641
.long 0x3e827dc0,0x3ea21887,0x3ec1071e,0x3edf28a9,0x3e888e93,0x3ea986c4,0x3ec9b953,0x3ee900b7
.long 0x3e8e9a22,0x3eb0eacb,0x3ed25a09,0x3ef2bd43,0x3e94a031,0x3eb8442a,0x3edae880,0x3efc5d27
.long 0x3e9aa086,0x3ebf926f,0x3ee363fa,0x3f02ef9f,0x3ea09ae5,0x3ec6d529,0x3eebcbbb,0x3f07a136
.long 0x3ea68f12,0x3ece0bea,0x3ef41f07,0x3f0c42c9,0x3eac7cd4,0x3ed53641,0x3efc5d27,0x3f10d3cd
.long 0x3eb263ef,0x3edc53c1,0x3f0242b1,0x3f1553b7,0x3eb8442a,0x3ee363fa,0x3f064b82,0x3f19c200
.long 0x3ebe1d4a,0x3eea6681,0x3f0a48ad,0x3f1e1e22,0x3ec3ef15,0x3edae880,0x3ef15aea,0x3f039c3d
.long 0x3ecf7bca,0x3ee79a5d,0x3eff17b2,0x3f0af1b7,0x3edae880,0x3ef41f07,0x3f064b82,0x3f121eb0
.long 0x3ee63375,0x3f003a06,0x3f0cead0,0x3f19210f,0x3ef15aea,0x3f064b82,0x3f13682a,0x3f1ff6cb
.long 0x3efc5d27,0x3f0c42c9,0x3f19c200,0x3f269de3,0x3f039c3d,0x3f121eb0,0x3f1ff6cb,0x3f2d1469
.long 0x3f08f59b,0x3f17de12,0x3f26050a,0x3f33587a,0x3f0e39da,0x3f1d7fd1,0x3f2beb4a,0x3f396842
.long 0x3f13682a,0x3f2302d3,0x3f31a81d,0x3f3f41fc,0x3f187fc0,0x3f286605,0x3f373a23,0x3f44e3f5
.long 0x3f1d7fd1,0x3f2da859,0x3f3ca003,0x3f4a4c87,0x3f226799,0x3f32c8c9,0x3f41d870,0x3f4f7a1f
.long 0x3f273656,0x3f37c655,0x3f46e22a,0x3f546b3b,0x3f2beb4a,0x3f3ca003,0x3f4bbbf8,0x3f591e6a
.long 0x3f3085bb,0x3f4154e1,0x3f5064af,0x3f5d924d,0x3f0e39da,0x3f187fc0,0x3f226799,0x3f2beb4a
.long 0x3f15f6d9,0x3f209393,0x3f2ac082,0x3f34768f,0x3f1d7fd1,0x3f286605,0x3f32c8c9,0x3f3ca003
.long 0x3f24d225,0x3f2ff3e6,0x3f3a7ca4,0x3f446337,0x3f2beb4a,0x3f373a23,0x3f41d870,0x3f4bbbf8
.long 0x3f32c8c9,0x3f3e35c5,0x3f48d8b3,0x3f52a649,0x3f396842,0x3f44e3f5,0x3f4f7a1f,0x3f591e6a
.long 0x3f3fc767,0x3f4b41fa,0x3f55b993,0x3f5f20db,0x3f45e403,0x3f514d3d,0x3f5b941a,0x3f64aa59
.long 0x3f4bbbf8,0x3f570348,0x3f6106f2,0x3f69b7e4,0x3f514d3d,0x3f5c61c7,0x3f660f88,0x3f6e46be
.long 0x3f5695e5,0x3f61668a,0x3f6aab7b,0x3f725470,0x3f5b941a,0x3f660f88,0x3f6ed89e,0x3f75dec6
.long 0x3f604621,0x3f6a5ad9,0x3f7294f8,0x3f78e3d6,0x3f64aa59,0x3f6e46be,0x3f75dec6,0x3f7b61fc
.long 0x3f68bf3c,0x3f71d19f,0x3f78b47b,0x3f7d57de,0x3f800000,0x3f7fb10f,0x3f7ec46d,0x3f7d3aac
.long 0x3f800000,0x3f7fa6e3,0x3f7e9bc9,0x3f7cdf6c,0x3f800000,0x3f7f9c18,0x3f7e70b0,0x3f7c7eb0
.long 0x3f800000,0x3f7f90b1,0x3f7e4323,0x3f7c187a,0x3f800000,0x3f7f84ab,0x3f7e1324,0x3f7baccd
.long 0x3f800000,0x3f7f7808,0x3f7de0b1,0x3f7b3bab,0x3f800000,0x3f7f6ac7,0x3f7dabcc,0x3f7ac516
.long 0x3f800000,0x3f7f5ce9,0x3f7d7474,0x3f7a4910,0x3f800000,0x3f7f4e6d,0x3f7d3aac,0x3f79c79d
.long 0x3f800000,0x3f7f3f54,0x3f7cfe73,0x3f7940c0,0x3f800000,0x3f7f2f9d,0x3f7cbfc9,0x3f78b47b
.long 0x3f800000,0x3f7f1f49,0x3f7c7eb0,0x3f7822d1,0x3f800000,0x3f7f0e58,0x3f7c3b28,0x3f778bc5
.long 0x3f800000,0x3f7efcc9,0x3f7bf531,0x3f76ef5b,0x3f800000,0x3f7eea9d,0x3f7baccd,0x3f764d97
.long 0x3f800000,0x3f7ed7d4,0x3f7b61fc,0x3f75a67b,0x3f7b14be,0x3f7853f8,0x3f74fa0b,0x3f710908
.long 0x3f7a7302,0x3f77583a,0x3f73913f,0x3f6f20b0,0x3f79c79d,0x3f764d97,0x3f721352,0x3f6d1c1d
.long 0x3f791298,0x3f75341d,0x3f708066,0x3f6afb8c,0x3f7853f8,0x3f740bdd,0x3f6ed89e,0x3f68bf3c
.long 0x3f778bc5,0x3f72d4eb,0x3f6d1c1d,0x3f666771,0x3f76ba07,0x3f718f57,0x3f6b4b0c,0x3f63f473
.long 0x3f75dec6,0x3f703b37,0x3f696591,0x3f61668a,0x3f74fa0b,0x3f6ed89e,0x3f676bd8,0x3f5ebe05
.long 0x3f740bdd,0x3f6d67a1,0x3f655e0b,0x3f5bfb34,0x3f731447,0x3f6be858,0x3f633c5a,0x3f591e6a
.long 0x3f721352,0x3f6a5ad9,0x3f6106f2,0x3f5627fe,0x3f710908,0x3f68bf3c,0x3f5ebe05,0x3f531849
.long 0x3f6ff573,0x3f671599,0x3f5c61c7,0x3f4fefa8,0x3f6ed89e,0x3f655e0b,0x3f59f26a,0x3f4cae79
.long 0x3f6db293,0x3f6398ac,0x3f577026,0x3f495521,0x3f6c835e,0x3f676bd8,0x3f61c598,0x3f5b941a
.long 0x3f6a09a7,0x3f644fac,0x3f5df6be,0x3f570348,0x3f676bd8,0x3f6106f2,0x3f59f26a,0x3f5233c6
.long 0x3f64aa59,0x3f5d924d,0x3f55b993,0x3f4d26fd,0x3f61c598,0x3f59f26a,0x3f514d3d,0x3f47de65
.long 0x3f5ebe05,0x3f5627fe,0x3f4cae79,0x3f425b89,0x3f5b941a,0x3f5233c6,0x3f47de65,0x3f3ca003
.long 0x3f584853,0x3f4e1689,0x3f42de29,0x3f36ad7f,0x3f54db31,0x3f49d112,0x3f3daef9,0x3f3085bb
.long 0x3f514d3d,0x3f456439,0x3f385216,0x3f2a2a80,0x3f4d9f02,0x3f40d0da,0x3f32c8c9,0x3f239da9
.long 0x3f49d112,0x3f3c17d9,0x3f2d1469,0x3f1ce11f,0x3f45e403,0x3f373a23,0x3f273656,0x3f15f6d9
.long 0x3f41d870,0x3f3238aa,0x3f212ff9,0x3f0ee0db,0x3f3daef9,0x3f2d1469,0x3f1b02c6,0x3f07a136
.long 0x3f396842,0x3f27ce61,0x3f14b039,0x3f003a06,0x3f54db31,0x3f4d9f02,0x3f45e403,0x3f3daef9
.long 0x3f4f7a1f,0x3f476085,0x3f3ebc1b,0x3f3592e7,0x3f49d112,0x3f40d0da,0x3f373a23,0x3f2d1469
.long 0x3f43e200,0x3f39f2ac,0x3f2f61a5,0x3f24381a,0x3f3daef9,0x3f32c8c9,0x3f273656,0x3f1b02c6
.long 0x3f373a23,0x3f2b561b,0x3f1ebc12,0x3f11796b,0x3f3085bb,0x3f239da9,0x3f15f6d9,0x3f07a136
.long 0x3f299415,0x3f1ba299,0x3f0cead0,0x3efafef7,0x3f226799,0x3f13682a,0x3f039c3d,0x3ee63375
.long 0x3f1b02c6,0x3f0af1b7,0x3ef41f07,0x3ed0eb2a,0x3f13682a,0x3f0242b1,0x3ee0924f,0x3ebb31a0
.long 0x3f0b9a6b,0x3ef2bd43,0x3ecc9b8b,0x3ea5129f,0x3f039c3d,0x3ee0924f,0x3eb8442a,0x3e8e9a22
.long 0x3ef6e0cb,0x3ece0bea,0x3ea395c5,0x3e6fa8b2,0x3ee63375,0x3ebb31a0,0x3e8e9a22,0x3e419b37
.long 0x3ed53641,0x3ea80b1f,0x3e72b651,0x3e1324ca,0x0,0x3d48fb30,0x3dc8bd36,0x3e164083
.long 0x0,0x3d55880e,0x3dd53db9,0x3e1f917b,0x0,0x3d621469,0x3de1bc2e,0x3e28defc
.long 0x0,0x3d6ea038,0x3dee3876,0x3e3228d4,0x0,0x3d7b2b74,0x3dfab273,0x3e3b6ecf
.long 0x0,0x3d83db0a,0x3e039502,0x3e44b0b9,0x0,0x3d8a200a,0x3e09cf86,0x3e4dee60
.long 0x0,0x3d9064b4,0x3e1008b7,0x3e57278f,0x0,0x3d96a905,0x3e164083,0x3e605c13
.long 0x0,0x3d9cecf9,0x3e1c76de,0x3e698bba,0x0,0x3da3308c,0x3e22abb6,0x3e72b651
.long 0x0,0x3da973ba,0x3e28defc,0x3e7bdba4,0x0,0x3dafb680,0x3e2f10a2,0x3e827dc0
.long 0x0,0x3db5f8da,0x3e354098,0x3e870ada,0x0,0x3dbc3ac3,0x3e3b6ecf,0x3e8b9507
.long 0x0,0x3dc27c39,0x3e419b37,0x3e901c2c,0x3e47c5c2,0x3e78cfcc,0x3e94a031,0x3eac7cd4
.long 0x3e541501,0x3e840270,0x3e9d9e78,0x3eb6ccc3,0x3e605c13,0x3e8b9507,0x3ea68f12,0x3ec1071e
.long 0x3e6c9a7f,0x3e931f35,0x3eaf713a,0x3ecb2aae,0x3e78cfcc,0x3e9aa086,0x3eb8442a,0x3ed53641
.long 0x3e827dc0,0x3ea21887,0x3ec1071e,0x3edf28a9,0x3e888e93,0x3ea986c4,0x3ec9b953,0x3ee900b7
.long 0x3e8e9a22,0x3eb0eacb,0x3ed25a09,0x3ef2bd43,0x3e94a031,0x3eb8442a,0x3edae880,0x3efc5d27
.long 0x3e9aa086,0x3ebf926f,0x3ee363fa,0x3f02ef9f,0x3ea09ae5,0x3ec6d529,0x3eebcbbb,0x3f07a136
.long 0x3ea68f12,0x3ece0bea,0x3ef41f07,0x3f0c42c9,0x3eac7cd4,0x3ed53641,0x3efc5d27,0x3f10d3cd
.long 0x3eb263ef,0x3edc53c1,0x3f0242b1,0x3f1553b7,0x3eb8442a,0x3ee363fa,0x3f064b82,0x3f19c200
.long 0x3ebe1d4a,0x3eea6681,0x3f0a48ad,0x3f1e1e22,0x3ec3ef15,0x3edae880,0x3ef15aea,0x3f039c3d
.long 0x3ecf7bca,0x3ee79a5d,0x3eff17b2,0x3f0af1b7,0x3edae880,0x3ef41f07,0x3f064b82,0x3f121eb0
.long 0x3ee63375,0x3f003a06,0x3f0cead0,0x3f19210f,0x3ef15aea,0x3f064b82,0x3f13682a,0x3f1ff6cb
.long 0x3efc5d27,0x3f0c42c9,0x3f19c200,0x3f269de3,0x3f039c3d,0x3f121eb0,0x3f1ff6cb,0x3f2d1469
.long 0x3f08f59b,0x3f17de12,0x3f26050a,0x3f33587a,0x3f0e39da,0x3f1d7fd1,0x3f2beb4a,0x3f396842
.long 0x3f13682a,0x3f2302d3,0x3f31a81d,0x3f3f41fc,0x3f187fc0,0x3f286605,0x3f373a23,0x3f44e3f5
.long 0x3f1d7fd1,0x3f2da859,0x3f3ca003,0x3f4a4c87,0x3f226799,0x3f32c8c9,0x3f41d870,0x3f4f7a1f
.long 0x3f273656,0x3f37c655,0x3f46e22a,0x3f546b3b,0x3f2beb4a,0x3f3ca003,0x3f4bbbf8,0x3f591e6a
.long 0x3f3085bb,0x3f4154e1,0x3f5064af,0x3f5d924d,0x3f0e39da,0x3f187fc0,0x3f226799,0x3f2beb4a
.long 0x3f15f6d9,0x3f209393,0x3f2ac082,0x3f34768f,0x3f1d7fd1,0x3f286605,0x3f32c8c9,0x3f3ca003
.long 0x3f24d225,0x3f2ff3e6,0x3f3a7ca4,0x3f446337,0x3f2beb4a,0x3f373a23,0x3f41d870,0x3f4bbbf8
.long 0x3f32c8c9,0x3f3e35c5,0x3f48d8b3,0x3f52a649,0x3f396842,0x3f44e3f5,0x3f4f7a1f,0x3f591e6a
.long 0x3f3fc767,0x3f4b41fa,0x3f55b993,0x3f5f20db,0x3f45e403,0x3f514d3d,0x3f5b941a,0x3f64aa59
.long 0x3f4bbbf8,0x3f570348,0x3f6106f2,0x3f69b7e4,0x3f514d3d,0x3f5c61c7,0x3f660f88,0x3f6e46be
.long 0x3f5695e5,0x3f61668a,0x3f6aab7b,0x3f725470,0x3f5b941a,0x3f660f88,0x3f6ed89e,0x3f75dec6
.long 0x3f604621,0x3f6a5ad9,0x3f7294f8,0x3f78e3d6,0x3f64aa59,0x3f6e46be,0x3f75dec6,0x3f7b61fc
.long 0x3f68bf3c,0x3f71d19f,0x3f78b47b,0x3f7d57de,0x3f3504f3,0x3f2beb4a,0x3f226799,0x3f187fc0
.long 0x3f2beb4a,0x3f21cbfb,0x3f173c07,0x3f0c42c9,0x3f226799,0x3f173c07,0x3f0b9a6b,0x3eff17b2
.long 0x3f187fc0,0x3f0c42c9,0x3eff17b2,0x3ee4cbfe,0x3f0e39da,0x3f00e7e4,0x3ee63375,0x3ec9b953
.long 0x3f039c3d,0x3eea6681,0x3ecc9b8b,0x3eadf73c,0x3ef15aea,0x3ed25a09,0x3eb263ef,0x3e919ddd
.long 0x3edae880,0x3eb9bb1e,0x3e97a117,0x3e698bba,0x3ec3ef15,0x3ea09ae5,0x3e78cfcc,0x3e2f10a2
.long 0x3eac7cd4,0x3e870ada,0x3e419b37,0x3de7fa9a,0x3e94a031,0x3e5a3997,0x3e09cf86,0x3d621469
.long 0x3e78cfcc,0x3e25c58c,0x3da3308c,0xbb490fc6,0x3e47c5c2,0x3de1bc2e,0x3cc90ab0,0xbd7b2b74
.long 0x3e164083,0x3d6ea038,0xbcfb49ba,0xbdf475c0,0x3dc8bd36,0x3bc90f88,0xbdafb680,0xbe354098
.long 0x3d48fb30,0xbd3c6dd5,0xbe1008b7,0xbe6fa8b2,0x3f0e39da,0x3f039c3d,0x3ef15aea,0x3edae880
.long 0x3f00e7e4,0x3eea6681,0x3ed25a09,0x3eb9bb1e,0x3ee63375,0x3ecc9b8b,0x3eb263ef,0x3e97a117
.long 0x3ec9b953,0x3eadf73c,0x3e919ddd,0x3e698bba,0x3eac7cd4,0x3e8e9a22,0x3e605c13,0x3e22abb6
.long 0x3e8e9a22,0x3e5d4b1a,0x3e1c76de,0x3db5f8da,0x3e605c13,0x3e1c76de,0x3dafb680,0x3c96c9b6
.long 0x3e22abb6,0x3db5f8da,0x3c96c9b6,0xbd55880e,0x3dc8bd36,0x3cc90ab0,0xbd48fb30,0xbdfab273
.long 0x3d16c32c,0xbd2351cb,0xbdee3876,0xbe44b0b9,0xbcc90ab0,0xbdd53db9,0xbe3b6ecf,0xbe8586ce
.long 0xbdafb680,0xbe2bf804,0xbe7ee6e1,0xbea80b1f,0xbe164083,0xbe6c9a7f,0xbea09ae5,0xbec9b953
.long 0xbe541501,0xbe9620d2,0xbec1071e,0xbeea6681,0xbe888e93,0xbeb554ec,0xbee0924f,0xbf04f484
.long 0xbea68f12,0xbed3c867,0xbeff17b2,0xbf140c5f,0x3ec3ef15,0x3eac7cd4,0x3e94a031,0x3e78cfcc
.long 0x3ea09ae5,0x3e870ada,0x3e5a3997,0x3e25c58c,0x3e78cfcc,0x3e419b37,0x3e09cf86,0x3da3308c
.long 0x3e2f10a2,0x3de7fa9a,0x3d621469,0xbb490fc6,0x3dc8bd36,0x3d16c32c,0xbcc90ab0,0xbdafb680
.long 0x3cc90ab0,0xbd2351cb,0xbdd53db9,0xbe2bf804,0xbd48fb30,0xbdee3876,0xbe3b6ecf,0xbe7ee6e1
.long 0xbdfab273,0xbe44b0b9,0xbe8586ce,0xbea80b1f,0xbe47c5c2,0xbe888e93,0xbeac7cd4,0xbecf7bca
.long 0xbe888e93,0xbeadf73c,0xbed25a09,0xbef58035,0xbeac7cd4,0xbed25a09,0xbef6e0cb,0xbf0cead0
.long 0xbecf7bca,0xbef58035,0xbf0cead0,0xbf1e1e22,0xbef15aea,0xbf0b9a6b,0xbf1d7fd1,0xbf2e3bde
.long 0xbf08f59b,0xbf1ba299,0xbf2d1469,0xbf3d27b8,0xbf187fc0,0xbf2ac082,0xbf3b8f3b,0xbf4ac77f
.long 0xbf273656,0xbf38dd65,0xbf48d8b3,0xbf570348,0x3e47c5c2,0x3e164083,0x3dc8bd36,0x3d48fb30
.long 0x3de1bc2e,0x3d6ea038,0x3bc90f88,0xbd3c6dd5,0x3cc90ab0,0xbcfb49ba,0xbdafb680,0xbe1008b7
.long 0xbd7b2b74,0xbdf475c0,0xbe354098,0xbe6fa8b2,0xbe164083,0xbe541501,0xbe888e93,0xbea68f12
.long 0xbe6c9a7f,0xbe9620d2,0xbeb554ec,0xbed3c867,0xbea09ae5,0xbec1071e,0xbee0924f,0xbeff17b2
.long 0xbec9b953,0xbeea6681,0xbf04f484,0xbf140c5f,0xbef15aea,0xbf08f59b,0xbf187fc0,0xbf273656
.long 0xbf0b9a6b,0xbf1ba299,0xbf2ac082,0xbf38dd65,0xbf1d7fd1,0xbf2d1469,0xbf3b8f3b,0xbf48d8b3
.long 0xbf2e3bde,0xbf3d27b8,0xbf4ac77f,0xbf570348,0xbf3daef9,0xbf4bbbf8,0xbf584853,0xbf633c5a
.long 0xbf4bbbf8,0xbf58b3a1,0xbf63f473,0xbf6d67a1,0xbf584853,0xbf63f473,0xbf6db293,0xbf756d97
.long 0xbf633c5a,0xbf6d67a1,0xbf756d97,0xbf7b3bab,0x3f3504f3,0x3f3daef9,0x3f45e403,0x3f4d9f02
.long 0x3f3daef9,0x3f466354,0x3f4e8d90,0x3f5627fe,0x3f45e403,0x3f4e8d90,0x3f5695e5,0x3f5df6be
.long 0x3f4d9f02,0x3f5627fe,0x3f5df6be,0x3f650479,0x3f54db31,0x3f5d2d53,0x3f64aa59,0x3f6b4b0c
.long 0x3f5b941a,0x3f6398ac,0x3f6aab7b,0x3f70c501,0x3f61c598,0x3f696591,0x3f6ff573,0x3f756d97
.long 0x3f676bd8,0x3f6e8ff8,0x3f748422,0x3f7940c0,0x3f6c835e,0x3f731447,0x3f7853f8,0x3f7c3b28
.long 0x3f710908,0x3f76ef5b,0x3f7b61fc,0x3f7e5a38,0x3f74fa0b,0x3f7a1e84,0x3f7dabcc,0x3f7f9c18
.long 0x3f7853f8,0x3f7c9f8a,0x3f7f2f9d,0x3f7fffb1,0x3f7b14be,0x3f7e70b0,0x3f7fec43,0x3f7f84ab
.long 0x3f7d3aac,0x3f7f90b1,0x3f7fe129,0x3f7e2b72,0x3f7ec46d,0x3f7ffec4,0x3f7f0e58,0x3f7bf531
.long 0x3f7fb10f,0x3f7fba9e,0x3f7d7474,0x3f78e3d6,0x3f54db31,0x3f5b941a,0x3f61c598,0x3f676bd8
.long 0x3f5d2d53,0x3f6398ac,0x3f696591,0x3f6e8ff8,0x3f64aa59,0x3f6aab7b,0x3f6ff573,0x3f748422
.long 0x3f6b4b0c,0x3f70c501,0x3f756d97,0x3f7940c0,0x3f710908,0x3f75dec6,0x3f79c79d,0x3f7cbfc9
.long 0x3f75dec6,0x3f79f35e,0x3f7cfe73,0x3f7efcc9,0x3f79c79d,0x3f7cfe73,0x3f7f0e58,0x3f7ff4e6
.long 0x3f7cbfc9,0x3f7efcc9,0x3f7ff4e6,0x3f7fa6e3,0x3f7ec46d,0x3f7fec43,0x3f7fb10f,0x3f7e1324
.long 0x3f7fd397,0x3f7fcbe2,0x3f7e4323,0x3f7b3bab,0x3f7fec43,0x3f7e9bc9,0x3f7baccd,0x3f772417
.long 0x3f7f0e58,0x3f7c5d3a,0x3f77f110,0x3f71d19f,0x3f7d3aac,0x3f791298,0x3f731447,0x3f6b4b0c
.long 0x3f7a7302,0x3f74bf62,0x3f6d1c1d,0x3f6398ac,0x3f76ba07,0x3f6f6830,0x3f660f88,0x3f5ac450
.long 0x3f721352,0x3f6912ae,0x3f5df6be,0x3f50d937,0x3f6c835e,0x3f710908,0x3f74fa0b,0x3f7853f8
.long 0x3f731447,0x3f76ef5b,0x3f7a1e84,0x3f7c9f8a,0x3f7853f8,0x3f7b61fc,0x3f7dabcc,0x3f7f2f9d
.long 0x3f7c3b28,0x3f7e5a38,0x3f7f9c18,0x3f7fffb1,0x3f7ec46d,0x3f7fd397,0x3f7fec43,0x3f7f0e58
.long 0x3f7fec43,0x3f7fcbe2,0x3f7e9bc9,0x3f7c5d3a,0x3f7fb10f,0x3f7e4323,0x3f7baccd,0x3f77f110
.long 0x3f7e1324,0x3f7b3bab,0x3f772417,0x3f71d19f,0x3f7b14be,0x3f76ba07,0x3f710908,0x3f6a09a7
.long 0x3f76ba07,0x3f70c501,0x3f696591,0x3f60a6cf,0x3f710908,0x3f696591,0x3f604621,0x3f55b993
.long 0x3f6a09a7,0x3f60a6cf,0x3f55b993,0x3f495521,0x3f61c598,0x3f5695e5,0x3f49d112,0x3f3b8f3b
.long 0x3f584853,0x3f4b41fa,0x3f3ca003,0x3f2c800f,0x3f4d9f02,0x3f3ebc1b,0x3f2e3bde,0x3f1c420c
.long 0x3f41d870,0x3f311722,0x3f1ebc12,0x3f0af1b7,0x3f7b14be,0x3f7d3aac,0x3f7ec46d,0x3f7fb10f
.long 0x3f7e70b0,0x3f7f90b1,0x3f7ffec4,0x3f7fba9e,0x3f7fec43,0x3f7fe129,0x3f7f0e58,0x3f7d7474
.long 0x3f7f84ab,0x3f7e2b72,0x3f7bf531,0x3f78e3d6,0x3f7d3aac,0x3f7a7302,0x3f76ba07,0x3f721352
.long 0x3f791298,0x3f74bf62,0x3f6f6830,0x3f6912ae,0x3f731447,0x3f6d1c1d,0x3f660f88,0x3f5df6be
.long 0x3f6b4b0c,0x3f6398ac,0x3f5ac450,0x3f50d937,0x3f61c598,0x3f584853,0x3f4d9f02,0x3f41d870
.long 0x3f5695e5,0x3f4b41fa,0x3f3ebc1b,0x3f311722,0x3f49d112,0x3f3ca003,0x3f2e3bde,0x3f1ebc12
.long 0x3f3b8f3b,0x3f2c800f,0x3f1c420c,0x3f0af1b7,0x3f2beb4a,0x3f1b02c6,0x3f08f59b,0x3eebcbbb
.long 0x3f1b02c6,0x3f084b92,0x3ee900b7,0x3ebf926f,0x3f08f59b,0x3ee900b7,0x3ebe1d4a,0x3e919ddd
.long 0x3eebcbbb,0x3ebf926f,0x3e919ddd,0x3e44b0b9,0x3f800000,0x3f800000,0x3f800000,0x3f800000
.long 0x3f7fb10f,0x3f7fa6e3,0x3f7f9c18,0x3f7f90b1,0x3f7ec46d,0x3f7e9bc9,0x3f7e70b0,0x3f7e4323
.long 0x3f7d3aac,0x3f7cdf6c,0x3f7c7eb0,0x3f7c187a,0x3f7b14be,0x3f7a7302,0x3f79c79d,0x3f791298
.long 0x3f7853f8,0x3f77583a,0x3f764d97,0x3f75341d,0x3f74fa0b,0x3f73913f,0x3f721352,0x3f708066
.long 0x3f710908,0x3f6f20b0,0x3f6d1c1d,0x3f6afb8c,0x3f6c835e,0x3f6a09a7,0x3f676bd8,0x3f64aa59
.long 0x3f676bd8,0x3f644fac,0x3f6106f2,0x3f5d924d,0x3f61c598,0x3f5df6be,0x3f59f26a,0x3f55b993
.long 0x3f5b941a,0x3f570348,0x3f5233c6,0x3f4d26fd,0x3f54db31,0x3f4f7a1f,0x3f49d112,0x3f43e200
.long 0x3f4d9f02,0x3f476085,0x3f40d0da,0x3f39f2ac,0x3f45e403,0x3f3ebc1b,0x3f373a23,0x3f2f61a5
.long 0x3f3daef9,0x3f3592e7,0x3f2d1469,0x3f24381a,0x3f800000,0x3f800000,0x3f800000,0x3f800000
.long 0x3f7f84ab,0x3f7f7808,0x3f7f6ac7,0x3f7f5ce9,0x3f7e1324,0x3f7de0b1,0x3f7dabcc,0x3f7d7474
.long 0x3f7baccd,0x3f7b3bab,0x3f7ac516,0x3f7a4910,0x3f7853f8,0x3f778bc5,0x3f76ba07,0x3f75dec6
.long 0x3f740bdd,0x3f72d4eb,0x3f718f57,0x3f703b37,0x3f6ed89e,0x3f6d1c1d,0x3f6b4b0c,0x3f696591
.long 0x3f68bf3c,0x3f666771,0x3f63f473,0x3f61668a,0x3f61c598,0x3f5ebe05,0x3f5b941a,0x3f584853
.long 0x3f59f26a,0x3f5627fe,0x3f5233c6,0x3f4e1689,0x3f514d3d,0x3f4cae79,0x3f47de65,0x3f42de29
.long 0x3f47de65,0x3f425b89,0x3f3ca003,0x3f36ad7f,0x3f3daef9,0x3f373a23,0x3f3085bb,0x3f299415
.long 0x3f32c8c9,0x3f2b561b,0x3f239da9,0x3f1ba299,0x3f273656,0x3f1ebc12,0x3f15f6d9,0x3f0cead0
.long 0x3f1b02c6,0x3f11796b,0x3f07a136,0x3efafef7,0x3f800000,0x3f800000,0x3f800000,0x3f800000
.long 0x3f7f4e6d,0x3f7f3f54,0x3f7f2f9d,0x3f7f1f49,0x3f7d3aac,0x3f7cfe73,0x3f7cbfc9,0x3f7c7eb0
.long 0x3f79c79d,0x3f7940c0,0x3f78b47b,0x3f7822d1,0x3f74fa0b,0x3f740bdd,0x3f731447,0x3f721352
.long 0x3f6ed89e,0x3f6d67a1,0x3f6be858,0x3f6a5ad9,0x3f676bd8,0x3f655e0b,0x3f633c5a,0x3f6106f2
.long 0x3f5ebe05,0x3f5bfb34,0x3f591e6a,0x3f5627fe,0x3f54db31,0x3f514d3d,0x3f4d9f02,0x3f49d112
.long 0x3f49d112,0x3f456439,0x3f40d0da,0x3f3c17d9,0x3f3daef9,0x3f385216,0x3f32c8c9,0x3f2d1469
.long 0x3f3085bb,0x3f2a2a80,0x3f239da9,0x3f1ce11f,0x3f226799,0x3f1b02c6,0x3f13682a,0x3f0b9a6b
.long 0x3f13682a,0x3f0af1b7,0x3f0242b1,0x3ef2bd43,0x3f039c3d,0x3ef41f07,0x3ee0924f,0x3ecc9b8b
.long 0x3ee63375,0x3ed0eb2a,0x3ebb31a0,0x3ea5129f,0x3f800000,0x3f800000,0x3f800000,0x3f800000
.long 0x3f7f0e58,0x3f7efcc9,0x3f7eea9d,0x3f7ed7d4,0x3f7c3b28,0x3f7bf531,0x3f7baccd,0x3f7b61fc
.long 0x3f778bc5,0x3f76ef5b,0x3f764d97,0x3f75a67b,0x3f710908,0x3f6ff573,0x3f6ed89e,0x3f6db293
.long 0x3f68bf3c,0x3f671599,0x3f655e0b,0x3f6398ac,0x3f5ebe05,0x3f5c61c7,0x3f59f26a,0x3f577026
.long 0x3f531849,0x3f4fefa8,0x3f4cae79,0x3f495521,0x3f45e403,0x3f41d870,0x3f3daef9,0x3f396842
.long 0x3f373a23,0x3f3238aa,0x3f2d1469,0x3f27ce61,0x3f273656,0x3f212ff9,0x3f1b02c6,0x3f14b039
.long 0x3f15f6d9,0x3f0ee0db,0x3f07a136,0x3f003a06,0x3f039c3d,0x3ef6e0cb,0x3ee63375,0x3ed53641
.long 0x3ee0924f,0x3ece0bea,0x3ebb31a0,0x3ea80b1f,0x3eb8442a,0x3ea395c5,0x3e8e9a22,0x3e72b651
.long 0x3e8e9a22,0x3e6fa8b2,0x3e419b37,0x3e1324ca,0x0,0x0,0x0,0x0
.long 0x3d48fb30,0x3d55880e,0x3d621469,0x3d6ea038,0x3dc8bd36,0x3dd53db9,0x3de1bc2e,0x3dee3876
.long 0x3e164083,0x3e1f917b,0x3e28defc,0x3e3228d4,0x3e47c5c2,0x3e541501,0x3e605c13,0x3e6c9a7f
.long 0x3e78cfcc,0x3e840270,0x3e8b9507,0x3e931f35,0x3e94a031,0x3e9d9e78,0x3ea68f12,0x3eaf713a
.long 0x3eac7cd4,0x3eb6ccc3,0x3ec1071e,0x3ecb2aae,0x3ec3ef15,0x3ecf7bca,0x3edae880,0x3ee63375
.long 0x3edae880,0x3ee79a5d,0x3ef41f07,0x3f003a06,0x3ef15aea,0x3eff17b2,0x3f064b82,0x3f0cead0
.long 0x3f039c3d,0x3f0af1b7,0x3f121eb0,0x3f19210f,0x3f0e39da,0x3f15f6d9,0x3f1d7fd1,0x3f24d225
.long 0x3f187fc0,0x3f209393,0x3f286605,0x3f2ff3e6,0x3f226799,0x3f2ac082,0x3f32c8c9,0x3f3a7ca4
.long 0x3f2beb4a,0x3f34768f,0x3f3ca003,0x3f446337,0x0,0x0,0x0,0x0
.long 0x3d7b2b74,0x3d83db0a,0x3d8a200a,0x3d9064b4,0x3dfab273,0x3e039502,0x3e09cf86,0x3e1008b7
.long 0x3e3b6ecf,0x3e44b0b9,0x3e4dee60,0x3e57278f,0x3e78cfcc,0x3e827dc0,0x3e888e93,0x3e8e9a22
.long 0x3e9aa086,0x3ea21887,0x3ea986c4,0x3eb0eacb,0x3eb8442a,0x3ec1071e,0x3ec9b953,0x3ed25a09
.long 0x3ed53641,0x3edf28a9,0x3ee900b7,0x3ef2bd43,0x3ef15aea,0x3efc5d27,0x3f039c3d,0x3f08f59b
.long 0x3f064b82,0x3f0c42c9,0x3f121eb0,0x3f17de12,0x3f13682a,0x3f19c200,0x3f1ff6cb,0x3f26050a
.long 0x3f1ff6cb,0x3f269de3,0x3f2d1469,0x3f33587a,0x3f2beb4a,0x3f32c8c9,0x3f396842,0x3f3fc767
.long 0x3f373a23,0x3f3e35c5,0x3f44e3f5,0x3f4b41fa,0x3f41d870,0x3f48d8b3,0x3f4f7a1f,0x3f55b993
.long 0x3f4bbbf8,0x3f52a649,0x3f591e6a,0x3f5f20db,0x0,0x0,0x0,0x0
.long 0x3d96a905,0x3d9cecf9,0x3da3308c,0x3da973ba,0x3e164083,0x3e1c76de,0x3e22abb6,0x3e28defc
.long 0x3e605c13,0x3e698bba,0x3e72b651,0x3e7bdba4,0x3e94a031,0x3e9aa086,0x3ea09ae5,0x3ea68f12
.long 0x3eb8442a,0x3ebf926f,0x3ec6d529,0x3ece0bea,0x3edae880,0x3ee363fa,0x3eebcbbb,0x3ef41f07
.long 0x3efc5d27,0x3f02ef9f,0x3f07a136,0x3f0c42c9,0x3f0e39da,0x3f13682a,0x3f187fc0,0x3f1d7fd1
.long 0x3f1d7fd1,0x3f2302d3,0x3f286605,0x3f2da859,0x3f2beb4a,0x3f31a81d,0x3f373a23,0x3f3ca003
.long 0x3f396842,0x3f3f41fc,0x3f44e3f5,0x3f4a4c87,0x3f45e403,0x3f4bbbf8,0x3f514d3d,0x3f5695e5
.long 0x3f514d3d,0x3f570348,0x3f5c61c7,0x3f61668a,0x3f5b941a,0x3f6106f2,0x3f660f88,0x3f6aab7b
.long 0x3f64aa59,0x3f69b7e4,0x3f6e46be,0x3f725470,0x0,0x0,0x0,0x0
.long 0x3dafb680,0x3db5f8da,0x3dbc3ac3,0x3dc27c39,0x3e2f10a2,0x3e354098,0x3e3b6ecf,0x3e419b37
.long 0x3e827dc0,0x3e870ada,0x3e8b9507,0x3e901c2c,0x3eac7cd4,0x3eb263ef,0x3eb8442a,0x3ebe1d4a
.long 0x3ed53641,0x3edc53c1,0x3ee363fa,0x3eea6681,0x3efc5d27,0x3f0242b1,0x3f064b82,0x3f0a48ad
.long 0x3f10d3cd,0x3f1553b7,0x3f19c200,0x3f1e1e22,0x3f226799,0x3f273656,0x3f2beb4a,0x3f3085bb
.long 0x3f32c8c9,0x3f37c655,0x3f3ca003,0x3f4154e1,0x3f41d870,0x3f46e22a,0x3f4bbbf8,0x3f5064af
.long 0x3f4f7a1f,0x3f546b3b,0x3f591e6a,0x3f5d924d,0x3f5b941a,0x3f604621,0x3f64aa59,0x3f68bf3c
.long 0x3f660f88,0x3f6a5ad9,0x3f6e46be,0x3f71d19f,0x3f6ed89e,0x3f7294f8,0x3f75dec6,0x3f78b47b
.long 0x3f75dec6,0x3f78e3d6,0x3f7b61fc,0x3f7d57de,0x3f3504f3,0x3f2beb4a,0x3f226799,0x3f187fc0
.long 0x3f2beb4a,0x3f21cbfb,0x3f173c07,0x3f0c42c9,0x3f226799,0x3f173c07,0x3f0b9a6b,0x3eff17b2
.long 0x3f187fc0,0x3f0c42c9,0x3eff17b2,0x3ee4cbfe,0x3f0e39da,0x3f00e7e4,0x3ee63375,0x3ec9b953
.long 0x3f039c3d,0x3eea6681,0x3ecc9b8b,0x3eadf73c,0x3ef15aea,0x3ed25a09,0x3eb263ef,0x3e919ddd
.long 0x3edae880,0x3eb9bb1e,0x3e97a117,0x3e698bba,0x3ec3ef15,0x3ea09ae5,0x3e78cfcc,0x3e2f10a2
.long 0x3eac7cd4,0x3e870ada,0x3e419b37,0x3de7fa9a,0x3e94a031,0x3e5a3997,0x3e09cf86,0x3d621469
.long 0x3e78cfcc,0x3e25c58c,0x3da3308c,0xbb490fc6,0x3e47c5c2,0x3de1bc2e,0x3cc90ab0,0xbd7b2b74
.long 0x3e164083,0x3d6ea038,0xbcfb49ba,0xbdf475c0,0x3dc8bd36,0x3bc90f88,0xbdafb680,0xbe354098
.long 0x3d48fb30,0xbd3c6dd5,0xbe1008b7,0xbe6fa8b2,0x3f0e39da,0x3f039c3d,0x3ef15aea,0x3edae880
.long 0x3f00e7e4,0x3eea6681,0x3ed25a09,0x3eb9bb1e,0x3ee63375,0x3ecc9b8b,0x3eb263ef,0x3e97a117
.long 0x3ec9b953,0x3eadf73c,0x3e919ddd,0x3e698bba,0x3eac7cd4,0x3e8e9a22,0x3e605c13,0x3e22abb6
.long 0x3e8e9a22,0x3e5d4b1a,0x3e1c76de,0x3db5f8da,0x3e605c13,0x3e1c76de,0x3dafb680,0x3c96c9b6
.long 0x3e22abb6,0x3db5f8da,0x3c96c9b6,0xbd55880e,0x3dc8bd36,0x3cc90ab0,0xbd48fb30,0xbdfab273
.long 0x3d16c32c,0xbd2351cb,0xbdee3876,0xbe44b0b9,0xbcc90ab0,0xbdd53db9,0xbe3b6ecf,0xbe8586ce
.long 0xbdafb680,0xbe2bf804,0xbe7ee6e1,0xbea80b1f,0xbe164083,0xbe6c9a7f,0xbea09ae5,0xbec9b953
.long 0xbe541501,0xbe9620d2,0xbec1071e,0xbeea6681,0xbe888e93,0xbeb554ec,0xbee0924f,0xbf04f484
.long 0xbea68f12,0xbed3c867,0xbeff17b2,0xbf140c5f,0x3ec3ef15,0x3eac7cd4,0x3e94a031,0x3e78cfcc
.long 0x3ea09ae5,0x3e870ada,0x3e5a3997,0x3e25c58c,0x3e78cfcc,0x3e419b37,0x3e09cf86,0x3da3308c
.long 0x3e2f10a2,0x3de7fa9a,0x3d621469,0xbb490fc6,0x3dc8bd36,0x3d16c32c,0xbcc90ab0,0xbdafb680
.long 0x3cc90ab0,0xbd2351cb,0xbdd53db9,0xbe2bf804,0xbd48fb30,0xbdee3876,0xbe3b6ecf,0xbe7ee6e1
.long 0xbdfab273,0xbe44b0b9,0xbe8586ce,0xbea80b1f,0xbe47c5c2,0xbe888e93,0xbeac7cd4,0xbecf7bca
.long 0xbe888e93,0xbeadf73c,0xbed25a09,0xbef58035,0xbeac7cd4,0xbed25a09,0xbef6e0cb,0xbf0cead0
.long 0xbecf7bca,0xbef58035,0xbf0cead0,0xbf1e1e22,0xbef15aea,0xbf0b9a6b,0xbf1d7fd1,0xbf2e3bde
.long 0xbf08f59b,0xbf1ba299,0xbf2d1469,0xbf3d27b8,0xbf187fc0,0xbf2ac082,0xbf3b8f3b,0xbf4ac77f
.long 0xbf273656,0xbf38dd65,0xbf48d8b3,0xbf570348,0x3e47c5c2,0x3e164083,0x3dc8bd36,0x3d48fb30
.long 0x3de1bc2e,0x3d6ea038,0x3bc90f88,0xbd3c6dd5,0x3cc90ab0,0xbcfb49ba,0xbdafb680,0xbe1008b7
.long 0xbd7b2b74,0xbdf475c0,0xbe354098,0xbe6fa8b2,0xbe164083,0xbe541501,0xbe888e93,0xbea68f12
.long 0xbe6c9a7f,0xbe9620d2,0xbeb554ec,0xbed3c867,0xbea09ae5,0xbec1071e,0xbee0924f,0xbeff17b2
.long 0xbec9b953,0xbeea6681,0xbf04f484,0xbf140c5f,0xbef15aea,0xbf08f59b,0xbf187fc0,0xbf273656
.long 0xbf0b9a6b,0xbf1ba299,0xbf2ac082,0xbf38dd65,0xbf1d7fd1,0xbf2d1469,0xbf3b8f3b,0xbf48d8b3
.long 0xbf2e3bde,0xbf3d27b8,0xbf4ac77f,0xbf570348,0xbf3daef9,0xbf4bbbf8,0xbf584853,0xbf633c5a
.long 0xbf4bbbf8,0xbf58b3a1,0xbf63f473,0xbf6d67a1,0xbf584853,0xbf63f473,0xbf6db293,0xbf756d97
.long 0xbf633c5a,0xbf6d67a1,0xbf756d97,0xbf7b3bab,0x3f3504f3,0x3f3daef9,0x3f45e403,0x3f4d9f02
.long 0x3f3daef9,0x3f466354,0x3f4e8d90,0x3f5627fe,0x3f45e403,0x3f4e8d90,0x3f5695e5,0x3f5df6be
.long 0x3f4d9f02,0x3f5627fe,0x3f5df6be,0x3f650479,0x3f54db31,0x3f5d2d53,0x3f64aa59,0x3f6b4b0c
.long 0x3f5b941a,0x3f6398ac,0x3f6aab7b,0x3f70c501,0x3f61c598,0x3f696591,0x3f6ff573,0x3f756d97
.long 0x3f676bd8,0x3f6e8ff8,0x3f748422,0x3f7940c0,0x3f6c835e,0x3f731447,0x3f7853f8,0x3f7c3b28
.long 0x3f710908,0x3f76ef5b,0x3f7b61fc,0x3f7e5a38,0x3f74fa0b,0x3f7a1e84,0x3f7dabcc,0x3f7f9c18
.long 0x3f7853f8,0x3f7c9f8a,0x3f7f2f9d,0x3f7fffb1,0x3f7b14be,0x3f7e70b0,0x3f7fec43,0x3f7f84ab
.long 0x3f7d3aac,0x3f7f90b1,0x3f7fe129,0x3f7e2b72,0x3f7ec46d,0x3f7ffec4,0x3f7f0e58,0x3f7bf531
.long 0x3f7fb10f,0x3f7fba9e,0x3f7d7474,0x3f78e3d6,0x3f54db31,0x3f5b941a,0x3f61c598,0x3f676bd8
.long 0x3f5d2d53,0x3f6398ac,0x3f696591,0x3f6e8ff8,0x3f64aa59,0x3f6aab7b,0x3f6ff573,0x3f748422
.long 0x3f6b4b0c,0x3f70c501,0x3f756d97,0x3f7940c0,0x3f710908,0x3f75dec6,0x3f79c79d,0x3f7cbfc9
.long 0x3f75dec6,0x3f79f35e,0x3f7cfe73,0x3f7efcc9,0x3f79c79d,0x3f7cfe73,0x3f7f0e58,0x3f7ff4e6
.long 0x3f7cbfc9,0x3f7efcc9,0x3f7ff4e6,0x3f7fa6e3,0x3f7ec46d,0x3f7fec43,0x3f7fb10f,0x3f7e1324
.long 0x3f7fd397,0x3f7fcbe2,0x3f7e4323,0x3f7b3bab,0x3f7fec43,0x3f7e9bc9,0x3f7baccd,0x3f772417
.long 0x3f7f0e58,0x3f7c5d3a,0x3f77f110,0x3f71d19f,0x3f7d3aac,0x3f791298,0x3f731447,0x3f6b4b0c
.long 0x3f7a7302,0x3f74bf62,0x3f6d1c1d,0x3f6398ac,0x3f76ba07,0x3f6f6830,0x3f660f88,0x3f5ac450
.long 0x3f721352,0x3f6912ae,0x3f5df6be,0x3f50d937,0x3f6c835e,0x3f710908,0x3f74fa0b,0x3f7853f8
.long 0x3f731447,0x3f76ef5b,0x3f7a1e84,0x3f7c9f8a,0x3f7853f8,0x3f7b61fc,0x3f7dabcc,0x3f7f2f9d
.long 0x3f7c3b28,0x3f7e5a38,0x3f7f9c18,0x3f7fffb1,0x3f7ec46d,0x3f7fd397,0x3f7fec43,0x3f7f0e58
.long 0x3f7fec43,0x3f7fcbe2,0x3f7e9bc9,0x3f7c5d3a,0x3f7fb10f,0x3f7e4323,0x3f7baccd,0x3f77f110
.long 0x3f7e1324,0x3f7b3bab,0x3f772417,0x3f71d19f,0x3f7b14be,0x3f76ba07,0x3f710908,0x3f6a09a7
.long 0x3f76ba07,0x3f70c501,0x3f696591,0x3f60a6cf,0x3f710908,0x3f696591,0x3f604621,0x3f55b993
.long 0x3f6a09a7,0x3f60a6cf,0x3f55b993,0x3f495521,0x3f61c598,0x3f5695e5,0x3f49d112,0x3f3b8f3b
.long 0x3f584853,0x3f4b41fa,0x3f3ca003,0x3f2c800f,0x3f4d9f02,0x3f3ebc1b,0x3f2e3bde,0x3f1c420c
.long 0x3f41d870,0x3f311722,0x3f1ebc12,0x3f0af1b7,0x3f7b14be,0x3f7d3aac,0x3f7ec46d,0x3f7fb10f
.long 0x3f7e70b0,0x3f7f90b1,0x3f7ffec4,0x3f7fba9e,0x3f7fec43,0x3f7fe129,0x3f7f0e58,0x3f7d7474
.long 0x3f7f84ab,0x3f7e2b72,0x3f7bf531,0x3f78e3d6,0x3f7d3aac,0x3f7a7302,0x3f76ba07,0x3f721352
.long 0x3f791298,0x3f74bf62,0x3f6f6830,0x3f6912ae,0x3f731447,0x3f6d1c1d,0x3f660f88,0x3f5df6be
.long 0x3f6b4b0c,0x3f6398ac,0x3f5ac450,0x3f50d937,0x3f61c598,0x3f584853,0x3f4d9f02,0x3f41d870
.long 0x3f5695e5,0x3f4b41fa,0x3f3ebc1b,0x3f311722,0x3f49d112,0x3f3ca003,0x3f2e3bde,0x3f1ebc12
.long 0x3f3b8f3b,0x3f2c800f,0x3f1c420c,0x3f0af1b7,0x3f2beb4a,0x3f1b02c6,0x3f08f59b,0x3eebcbbb
.long 0x3f1b02c6,0x3f084b92,0x3ee900b7,0x3ebf926f,0x3f08f59b,0x3ee900b7,0x3ebe1d4a,0x3e919ddd
.long 0x3eebcbbb,0x3ebf926f,0x3e919ddd,0x3e44b0b9,0x3f800000,0x3f7ec46d,0x3f7b14be,0x3f74fa0b
.long 0x3f800000,0x3f7eb069,0x3f7ac516,0x3f74484b,0x3f800000,0x3f7e9bc9,0x3f7a7302,0x3f73913f
.long 0x3f800000,0x3f7e868b,0x3f7a1e84,0x3f72d4eb,0x3f800000,0x3f7e70b0,0x3f79c79d,0x3f721352
.long 0x3f800000,0x3f7e5a38,0x3f796e4e,0x3f714c7a,0x3f800000,0x3f7e4323,0x3f791298,0x3f708066
.long 0x3f800000,0x3f7e2b72,0x3f78b47b,0x3f6faf1b,0x3f800000,0x3f7e1324,0x3f7853f8,0x3f6ed89e
.long 0x3f800000,0x3f7dfa38,0x3f77f110,0x3f6dfcf2,0x3f800000,0x3f7de0b1,0x3f778bc5,0x3f6d1c1d
.long 0x3f800000,0x3f7dc68c,0x3f772417,0x3f6c3624,0x3f800000,0x3f7dabcc,0x3f76ba07,0x3f6b4b0c
.long 0x3f800000,0x3f7d906e,0x3f764d97,0x3f6a5ad9,0x3f800000,0x3f7d7474,0x3f75dec6,0x3f696591
.long 0x3f800000,0x3f7d57de,0x3f756d97,0x3f686b39,0x3f6c835e,0x3f61c598,0x3f54db31,0x3f45e403
.long 0x3f6b4b0c,0x3f5fe4e9,0x3f5233c6,0x3f425b89,0x3f6a09a7,0x3f5df6be,0x3f4f7a1f,0x3f3ebc1b
.long 0x3f68bf3c,0x3f5bfb34,0x3f4cae79,0x3f3b0629,0x3f676bd8,0x3f59f26a,0x3f49d112,0x3f373a23
.long 0x3f660f88,0x3f57dc7f,0x3f46e22a,0x3f33587a,0x3f64aa59,0x3f55b993,0x3f43e200,0x3f2f61a5
.long 0x3f633c5a,0x3f5389c7,0x3f40d0da,0x3f2b561b,0x3f61c598,0x3f514d3d,0x3f3daef9,0x3f273656
.long 0x3f604621,0x3f4f0417,0x3f3a7ca4,0x3f2302d3,0x3f5ebe05,0x3f4cae79,0x3f373a23,0x3f1ebc12
.long 0x3f5d2d53,0x3f4a4c87,0x3f33e7bc,0x3f1a6293,0x3f5b941a,0x3f47de65,0x3f3085bb,0x3f15f6d9
.long 0x3f59f26a,0x3f456439,0x3f2d1469,0x3f11796b,0x3f584853,0x3f42de29,0x3f299415,0x3f0cead0
.long 0x3f5695e5,0x3f404c5c,0x3f26050a,0x3f084b92,0x3f3504f3,0x3f226799,0x3f0e39da,0x3ef15aea
.long 0x3f3085bb,0x3f1ce11f,0x3f07a136,0x3ee1fb6a,0x3f2beb4a,0x3f173c07,0x3f00e7e4,0x3ed25a09
.long 0x3f273656,0x3f11796b,0x3ef41f07,0x3ec27b55,0x3f226799,0x3f0b9a6b,0x3ee63375,0x3eb263ef
.long 0x3f1d7fd1,0x3f05a02c,0x3ed8106b,0x3ea21887,0x3f187fc0,0x3eff17b2,0x3ec9b953,0x3e919ddd
.long 0x3f13682a,0x3ef2bd43,0x3ebb31a0,0x3e80f8c0,0x3f0e39da,0x3ee63375,0x3eac7cd4,0x3e605c13
.long 0x3f08f59b,0x3ed97cb9,0x3e9d9e78,0x3e3e853e,0x3f039c3d,0x3ecc9b8b,0x3e8e9a22,0x3e1c76de
.long 0x3efc5d27,0x3ebf926f,0x3e7ee6e1,0x3df475c0,0x3ef15aea,0x3eb263ef,0x3e605c13,0x3dafb680
.long 0x3ee63375,0x3ea5129f,0x3e419b37,0x3d55880e,0x3edae880,0x3e97a117,0x3e22abb6,0x3c96c9b6
.long 0x3ecf7bca,0x3e8a11f7,0x3e039502,0xbc7b514b,0x3ec3ef15,0x3e94a031,0x3e47c5c2,0x3dc8bd36
.long 0x3eb263ef,0x3e80f8c0,0x3e1c76de,0x3d55880e,0x3ea09ae5,0x3e5a3997,0x3de1bc2e,0x3bc90f88
.long 0x3e8e9a22,0x3e3228d4,0x3d8a200a,0xbd2351cb,0x3e78cfcc,0x3e09cf86,0x3cc90ab0,0xbdafb680
.long 0x3e541501,0x3dc27c39,0xbc96c9b6,0xbe06b26e,0x3e2f10a2,0x3d621469,0xbd7b2b74,0xbe354098
.long 0x3e09cf86,0x3c7b514b,0xbdd53db9,0xbe636c83,0x3dc8bd36,0xbcc90ab0,0xbe164083,0xbe888e93
.long 0x3d7b2b74,0xbd83db0a,0xbe419b37,0xbe9f1cdf,0x3cc90ab0,0xbdd53db9,0xbe6c9a7f,0xbeb554ec
.long 0xbc490e90,0xbe1324ca,0xbe8b9507,0xbecb2aae,0xbd48fb30,0xbe3b6ecf,0xbea09ae5,0xbee0924f
.long 0xbdafb680,0xbe636c83,0xbeb554ec,0xbef58035,0xbdfab273,0xbe8586ce,0xbec9b953,0xbf04f484
.long 0xbe22abb6,0xbe9920fe,0xbeddbe79,0xbf0ee0db,0x0,0x3dc8bd36,0x3e47c5c2,0x3e94a031
.long 0x0,0x3dcefdb7,0x3e4dee60,0x3e9920fe,0x0,0x3dd53db9,0x3e541501,0x3e9d9e78
.long 0x0,0x3ddb7d37,0x3e5a3997,0x3ea21887,0x0,0x3de1bc2e,0x3e605c13,0x3ea68f12
.long 0x0,0x3de7fa9a,0x3e667c66,0x3eab0201,0x0,0x3dee3876,0x3e6c9a7f,0x3eaf713a
.long 0x0,0x3df475c0,0x3e72b651,0x3eb3dca5,0x0,0x3dfab273,0x3e78cfcc,0x3eb8442a
.long 0x0,0x3e007745,0x3e7ee6e1,0x3ebca7af,0x0,0x3e039502,0x3e827dc0,0x3ec1071e
.long 0x0,0x3e06b26e,0x3e8586ce,0x3ec5625c,0x0,0x3e09cf86,0x3e888e93,0x3ec9b953
.long 0x0,0x3e0cec4a,0x3e8b9507,0x3ece0bea,0x0,0x3e1008b7,0x3e8e9a22,0x3ed25a09
.long 0x0,0x3e1324ca,0x3e919ddd,0x3ed6a399,0x3ec3ef15,0x3ef15aea,0x3f0e39da,0x3f226799
.long 0x3ec9b953,0x3ef840c8,0x3f121eb0,0x3f269de3,0x3ecf7bca,0x3eff17b2,0x3f15f6d9,0x3f2ac082
.long 0x3ed53641,0x3f02ef9f,0x3f19c200,0x3f2ecef7,0x3edae880,0x3f064b82,0x3f1d7fd1,0x3f32c8c9
.long 0x3ee0924f,0x3f099f4e,0x3f212ff9,0x3f36ad7f,0x3ee63375,0x3f0cead0,0x3f24d225,0x3f3a7ca4
.long 0x3eebcbbb,0x3f102dd5,0x3f286605,0x3f3e35c5,0x3ef15aea,0x3f13682a,0x3f2beb4a,0x3f41d870
.long 0x3ef6e0cb,0x3f16999f,0x3f2f61a5,0x3f456439,0x3efc5d27,0x3f19c200,0x3f32c8c9,0x3f48d8b3
.long 0x3f00e7e4,0x3f1ce11f,0x3f36206c,0x3f4c3578,0x3f039c3d,0x3f1ff6cb,0x3f396842,0x3f4f7a1f
.long 0x3f064b82,0x3f2302d3,0x3f3ca003,0x3f52a649,0x3f08f59b,0x3f26050a,0x3f3fc767,0x3f55b993
.long 0x3f0b9a6b,0x3f28fd41,0x3f42de29,0x3f58b3a1,0x3f3504f3,0x3f45e403,0x3f54db31,0x3f61c598
.long 0x3f396842,0x3f4a4c87,0x3f591e6a,0x3f65b710,0x3f3daef9,0x3f4e8d90,0x3f5d2d53,0x3f696591
.long 0x3f41d870,0x3f52a649,0x3f6106f2,0x3f6cd007,0x3f45e403,0x3f5695e5,0x3f64aa59,0x3f6ff573
.long 0x3f49d112,0x3f5a5ba0,0x3f6816a8,0x3f72d4eb,0x3f4d9f02,0x3f5df6be,0x3f6b4b0c,0x3f756d97
.long 0x3f514d3d,0x3f61668a,0x3f6e46be,0x3f77beb7,0x3f54db31,0x3f64aa59,0x3f710908,0x3f79c79d
.long 0x3f584853,0x3f67c187,0x3f73913f,0x3f7b87b2,0x3f5b941a,0x3f6aab7b,0x3f75dec6,0x3f7cfe73
.long 0x3f5ebe05,0x3f6d67a1,0x3f77f110,0x3f7e2b72,0x3f61c598,0x3f6ff573,0x3f79c79d,0x3f7f0e58
.long 0x3f64aa59,0x3f725470,0x3f7b61fc,0x3f7fa6e3,0x3f676bd8,0x3f748422,0x3f7cbfc9,0x3f7ff4e6
.long 0x3f6a09a7,0x3f76841b,0x3f7de0b1,0x3f7ff84a,0x3f6c835e,0x3f74fa0b,0x3f7b14be,0x3f7ec46d
.long 0x3f6ff573,0x3f77beb7,0x3f7cfe73,0x3f7fa6e3,0x3f731447,0x3f7a1e84,0x3f7e70b0,0x3f7ffec4
.long 0x3f75dec6,0x3f7c187a,0x3f7f6ac7,0x3f7fcbe2,0x3f7853f8,0x3f7dabcc,0x3f7fec43,0x3f7f0e58
.long 0x3f7a7302,0x3f7ed7d4,0x3f7ff4e6,0x3f7dc68c,0x3f7c3b28,0x3f7f9c18,0x3f7f84ab,0x3f7bf531
.long 0x3f7dabcc,0x3f7ff84a,0x3f7e9bc9,0x3f799b43,0x3f7ec46d,0x3f7fec43,0x3f7d3aac,0x3f76ba07
.long 0x3f7f84ab,0x3f7f7808,0x3f7b61fc,0x3f73530e,0x3f7fec43,0x3f7e9bc9,0x3f791298,0x3f6f6830
.long 0x3f7ffb11,0x3f7d57de,0x3f764d97,0x3f6afb8c,0x3f7fb10f,0x3f7baccd,0x3f731447,0x3f660f88
.long 0x3f7f0e58,0x3f799b43,0x3f6f6830,0x3f60a6cf,0x3f7e1324,0x3f772417,0x3f6b4b0c,0x3f5ac450
.long 0x3f7cbfc9,0x3f74484b,0x3f66becc,0x3f546b3b,0x248d3132,0xbdc8bd36,0xbe47c5c2,0xbe94a031
.long 0xbd48fb30,0xbe195be0,0xbe7ee6e1,0xbeb0eacb,0xbdc8bd36,0xbe4dee60,0xbe9aa086,0xbecc9b8b
.long 0xbe164083,0xbe80f8c0,0xbeb554ec,0xbee79a5d,0xbe47c5c2,0xbe9aa086,0xbecf7bca,0xbf00e7e4
.long 0xbe78cfcc,0xbeb3dca5,0xbee900b7,0xbf0d9281,0xbe94a031,0xbecc9b8b,0xbf00e7e4,0xbf19c200
.long 0xbeac7cd4,0xbee4cbfe,0xbf0cead0,0xbf256bcb,0xbec3ef15,0xbefc5d27,0xbf187fc0,0xbf3085bb
.long 0xbedae880,0xbf099f4e,0xbf239da9,0xbf3b0629,0xbef15aea,0xbf14b039,0xbf2e3bde,0xbf44e3f5
.long 0xbf039c3d,0xbf1f599f,0xbf385216,0xbf4e1689,0xbf0e39da,0xbf299415,0xbf41d870,0xbf5695e5
.long 0xbf187fc0,0xbf33587a,0xbf4ac77f,0xbf5e5aa6,0xbf226799,0xbf3ca003,0xbf531849,0xbf655e0b
.long 0xbf2beb4a,0xbf456439,0xbf5ac450,0xbf6b99fb,0xbec3ef15,0xbef15aea,0xbf0e39da,0xbf226799
.long 0xbee0924f,0xbf06f686,0xbf1c420c,0xbf2ff3e6,0xbefc5d27,0xbf14b039,0xbf299415,0xbf3ca003
.long 0xbf0b9a6b,0xbf21cbfb,0xbf36206c,0xbf485bca,0xbf187fc0,0xbf2e3bde,0xbf41d870,0xbf531849
.long 0xbf24d225,0xbf39f2ac,0xbf4cae79,0xbf5cc7d1,0xbf3085bb,0xbf44e3f5,0xbf5695e5,0xbf655e0b
.long 0xbf3b8f3b,0xbf4f0417,0xbf5f8327,0xbf6cd007,0xbf45e403,0xbf584853,0xbf676bd8,0xbf731447
.long 0xbf4f7a1f,0xbf60a6cf,0xbf6e46be,0xbf7822d1,0xbf584853,0xbf6816a8,0xbf740bdd,0xbf7bf531
.long 0xbf604621,0xbf6e8ff8,0xbf78b47b,0xbf7e868b,0xbf676bd8,0xbf740bdd,0xbf7c3b28,0xbf7fd397
.long 0xbf6db293,0xbf788486,0xbf7e9bc9,0xbf7fdaaf,0xbf731447,0xbf7bf531,0xbf7fd397,0xbf7e9bc9
.long 0xbf778bc5,0xbf7e5a38,0xbf7fe129,0xbf7c187a,0xbf3504f3,0xbf45e403,0xbf54db31,0xbf61c598
.long 0xbf41d870,0xbf51c0c2,0xbf5f8327,0xbf6afb8c,0xbf4d9f02,0xbf5c61c7,0xbf68bf3c,0xbf7294f8
.long 0xbf584853,0xbf65b710,0xbf708066,0xbf788486,0xbf61c598,0xbf6db293,0xbf76ba07,0xbf7cbfc9
.long 0xbf6a09a7,0xbf74484b,0xbf7b61fc,0xbf7f3f54,0xbf710908,0xbf796e4e,0xbf7e70b0,0xbf7ffec4
.long 0xbf76ba07,0xbf7d1cdd,0xbf7fe129,0xbf7efcc9,0xbf7b14be,0xbf7f4e6d,0xbf7fb10f,0xbf7c3b28
.long 0xbf7e1324,0xbf7fffb1,0xbf7de0b1,0xbf77beb7,0xbf7fb10f,0xbf7f2f9d,0xbf7a7302,0xbf718f57
.long 0xbf7fec43,0xbf7cdf6c,0xbf756d97,0xbf69b7e4,0xbf7ec46d,0xbf791298,0xbf6ed89e,0xbf604621
.long 0xbf7c3b28,0xbf73ced9,0xbf66becc,0xbf554aa4,0xbf7853f8,0xbf6d1c1d,0xbf5d2d53,0xbf48d8b3
.long 0xbf731447,0xbf650479,0xbf5233c6,0xbf3b0629,0xbf6c835e,0xbf74fa0b,0xbf7b14be,0xbf7ec46d
.long 0xbf740bdd,0xbf7a9c59,0xbf7e9bc9,0xbf7fffb1,0xbf79c79d,0xbf7e4323,0xbf7ffb11,0xbf7eea9d
.long 0xbf7dabcc,0xbf7fe705,0xbf7f2f9d,0xbf7b87b2,0xbf7fb10f,0xbf7f84ab,0xbf7c3b28,0xbf75dec6
.long 0xbf7fd397,0xbf7d1cdd,0xbf772417,0xbf6dfcf2,0xbf7e1324,0xbf78b47b,0xbf6ff573,0xbf63f473
.long 0xbf7a7302,0xbf725470,0xbf66becc,0xbf57dc7f,0xbf74fa0b,0xbf6a09a7,0xbf5b941a,0xbf49d112
.long 0xbf6db293,0xbf5fe4e9,0xbf4e8d90,0xbf39f2ac,0xbf64aa59,0xbf53fac3,0xbf3fc767,0xbf286605
.long 0xbf59f26a,0xbf466354,0xbf2f61a5,0xbf1553b7,0xbf4d9f02,0xbf373a23,0xbf1d7fd1,0xbf00e7e4
.long 0xbf3fc767,0xbf269de3,0xbf0a48ad,0xbed6a399,0xbf3085bb,0xbf14b039,0xbeebcbbb,0xbea986c4
.long 0xbf1ff6cb,0xbf019573,0xbec1071e,0xbe75c35a,0x3f800000,0x3f7ec46d,0x3f7b14be,0x3f74fa0b
.long 0x3f7fb10f,0x3f7d1cdd,0x3f77f110,0x3f703b37,0x3f7ec46d,0x3f7ac516,0x3f740bdd,0x3f6aab7b
.long 0x3f7d3aac,0x3f77beb7,0x3f6f6830,0x3f644fac,0x3f7b14be,0x3f740bdd,0x3f6a09a7,0x3f5d2d53
.long 0x3f7853f8,0x3f6faf1b,0x3f63f473,0x3f554aa4,0x3f74fa0b,0x3f6aab7b,0x3f5d2d53,0x3f4cae79
.long 0x3f710908,0x3f650479,0x3f55b993,0x3f436051,0x3f6c835e,0x3f5ebe05,0x3f4d9f02,0x3f396842
.long 0x3f676bd8,0x3f57dc7f,0x3f44e3f5,0x3f2ecef7,0x3f61c598,0x3f5064af,0x3f3b8f3b,0x3f239da9
.long 0x3f5b941a,0x3f485bca,0x3f31a81d,0x3f17de12,0x3f54db31,0x3f3fc767,0x3f273656,0x3f0b9a6b
.long 0x3f4d9f02,0x3f36ad7f,0x3f1c420c,0x3efdbabb,0x3f45e403,0x3f2d1469,0x3f10d3cd,0x3ee363fa
.long 0x3f3daef9,0x3f2302d3,0x3f04f484,0x3ec8477c,0x3f6c835e,0x3f61c598,0x3f54db31,0x3f45e403
.long 0x3f660f88,0x3f5988ad,0x3f4ac77f,0x3f39f2ac,0x3f5ebe05,0x3f5064af,0x3f3fc767,0x3f2d1469
.long 0x3f5695e5,0x3f466354,0x3f33e7bc,0x3f1f599f,0x3f4d9f02,0x3f3b8f3b,0x3f273656,0x3f10d3cd
.long 0x3f43e200,0x3f2ff3e6,0x3f19c200,0x3f019573,0x3f396842,0x3f239da9,0x3f0b9a6b,0x3ee363fa
.long 0x3f2e3bde,0x3f16999f,0x3ef9a02d,0x3ec27b55,0x3f226799,0x3f08f59b,0x3edae880,0x3ea09ae5
.long 0x3f15f6d9,0x3ef58035,0x3ebb31a0,0x3e7bdba4,0x3f08f59b,0x3ed8106b,0x3e9aa086,0x3e354098
.long 0x3ef6e0cb,0x3eb9bb1e,0x3e72b651,0x3ddb7d37,0x3edae880,0x3e9aa086,0x3e2f10a2,0x3d16c32c
.long 0x3ebe1d4a,0x3e75c35a,0x3dd53db9,0xbd0a342f,0x3ea09ae5,0x3e354098,0x3d16c32c,0xbdd53db9
.long 0x3e827dc0,0x3de7fa9a,0xbcfb49ba,0xbe3228d4,0x3f3504f3,0x3f226799,0x3f0e39da,0x3ef15aea
.long 0x3f273656,0x3f12c39a,0x3ef9a02d,0x3ecb2aae,0x3f187fc0,0x3f0242b1,0x3ed53641,0x3ea395c5
.long 0x3f08f59b,0x3ee1fb6a,0x3eaf713a,0x3e75c35a,0x3ef15aea,0x3ebe1d4a,0x3e888e93,0x3e22abb6
.long 0x3ecf7bca,0x3e9920fe,0x3e419b37,0x3d9cecf9,0x3eac7cd4,0x3e667c66,0x3de1bc2e,0xbbc90f88
.long 0x3e888e93,0x3e195be0,0x3cfb49ba,0xbdb5f8da,0x3e47c5c2,0x3d96a905,0xbd48fb30,0xbe2f10a2
.long 0x3dfab273,0xbb490fc6,0xbe039502,0xbe80f8c0,0x3d48fb30,0xbda3308c,0xbe541501,0xbea986c4
.long 0xbcc90ab0,0xbe1f917b,0xbe919ddd,0xbed0eb2a,0xbdc8bd36,0xbe6c9a7f,0xbeb8442a,0xbef6e0cb
.long 0xbe2f10a2,0xbe9c1faf,0xbeddbe79,0xbf0d9281,0xbe78cfcc,0xbec1071e,0xbf00e7e4,0xbf1ebc12
.long 0xbea09ae5,0xbee4cbfe,0xbf121eb0,0xbf2ecef7,0x3ec3ef15,0x3e94a031,0x3e47c5c2,0x3dc8bd36
.long 0x3e9aa086,0x3e5101f1,0x3dd53db9,0x3b490fc6,0x3e605c13,0x3dee3876,0x3c490e90,0xbdbc3ac3
.long 0x3e09cf86,0x3ce22a7a,0xbda3308c,0xbe3e853e,0x3d48fb30,0xbd7b2b74,0xbe2f10a2,0xbe8e9a22
.long 0xbd16c32c,0xbe195be0,0xbe8586ce,0xbebca7af,0xbdfab273,0xbe72b651,0xbeb263ef,0xbee900b7
.long 0xbe541501,0xbea5129f,0xbeddbe79,0xbf099f4e,0xbe94a031,0xbecf7bca,0xbf039c3d,0xbf1d7fd1
.long 0xbebe1d4a,0xbef840c8,0xbf173c07,0xbf2ff3e6,0xbee63375,0xbf0f8784,0xbf299415,0xbf40d0da
.long 0xbf064b82,0xbf21cbfb,0xbf3a7ca4,0xbf4fefa8,0xbf187fc0,0xbf32c8c9,0xbf49d112,0xbf5d2d53
.long 0xbf299415,0xbf425b89,0xbf577026,0xbf686b39,0xbf396842,0xbf5064af,0xbf633c5a,0xbf718f57
.long 0xbf47de65,0xbf5cc7d1,0xbf6d1c1d,0xbf788486,0x3f800000,0x3f800000,0x3f800000,0x3f800000
.long 0x3f7ec46d,0x3f7eb069,0x3f7e9bc9,0x3f7e868b,0x3f7b14be,0x3f7ac516,0x3f7a7302,0x3f7a1e84
.long 0x3f74fa0b,0x3f74484b,0x3f73913f,0x3f72d4eb,0x3f6c835e,0x3f6b4b0c,0x3f6a09a7,0x3f68bf3c
.long 0x3f61c598,0x3f5fe4e9,0x3f5df6be,0x3f5bfb34,0x3f54db31,0x3f5233c6,0x3f4f7a1f,0x3f4cae79
.long 0x3f45e403,0x3f425b89,0x3f3ebc1b,0x3f3b0629,0x3f3504f3,0x3f3085bb,0x3f2beb4a,0x3f273656
.long 0x3f226799,0x3f1ce11f,0x3f173c07,0x3f11796b,0x3f0e39da,0x3f07a136,0x3f00e7e4,0x3ef41f07
.long 0x3ef15aea,0x3ee1fb6a,0x3ed25a09,0x3ec27b55,0x3ec3ef15,0x3eb263ef,0x3ea09ae5,0x3e8e9a22
.long 0x3e94a031,0x3e80f8c0,0x3e5a3997,0x3e3228d4,0x3e47c5c2,0x3e1c76de,0x3de1bc2e,0x3d8a200a
.long 0x3dc8bd36,0x3d55880e,0x3bc90f88,0xbd2351cb,0x3f800000,0x3f800000,0x3f800000,0x3f800000
.long 0x3f7e70b0,0x3f7e5a38,0x3f7e4323,0x3f7e2b72,0x3f79c79d,0x3f796e4e,0x3f791298,0x3f78b47b
.long 0x3f721352,0x3f714c7a,0x3f708066,0x3f6faf1b,0x3f676bd8,0x3f660f88,0x3f64aa59,0x3f633c5a
.long 0x3f59f26a,0x3f57dc7f,0x3f55b993,0x3f5389c7,0x3f49d112,0x3f46e22a,0x3f43e200,0x3f40d0da
.long 0x3f373a23,0x3f33587a,0x3f2f61a5,0x3f2b561b,0x3f226799,0x3f1d7fd1,0x3f187fc0,0x3f13682a
.long 0x3f0b9a6b,0x3f05a02c,0x3eff17b2,0x3ef2bd43,0x3ee63375,0x3ed8106b,0x3ec9b953,0x3ebb31a0
.long 0x3eb263ef,0x3ea21887,0x3e919ddd,0x3e80f8c0,0x3e78cfcc,0x3e541501,0x3e2f10a2,0x3e09cf86
.long 0x3e09cf86,0x3dc27c39,0x3d621469,0x3c7b514b,0x3cc90ab0,0xbc96c9b6,0xbd7b2b74,0xbdd53db9
.long 0xbdafb680,0xbe06b26e,0xbe354098,0xbe636c83,0x3f800000,0x3f800000,0x3f800000,0x3f800000
.long 0x3f7e1324,0x3f7dfa38,0x3f7de0b1,0x3f7dc68c,0x3f7853f8,0x3f77f110,0x3f778bc5,0x3f772417
.long 0x3f6ed89e,0x3f6dfcf2,0x3f6d1c1d,0x3f6c3624,0x3f61c598,0x3f604621,0x3f5ebe05,0x3f5d2d53
.long 0x3f514d3d,0x3f4f0417,0x3f4cae79,0x3f4a4c87,0x3f3daef9,0x3f3a7ca4,0x3f373a23,0x3f33e7bc
.long 0x3f273656,0x3f2302d3,0x3f1ebc12,0x3f1a6293,0x3f0e39da,0x3f08f59b,0x3f039c3d,0x3efc5d27
.long 0x3ee63375,0x3ed97cb9,0x3ecc9b8b,0x3ebf926f,0x3eac7cd4,0x3e9d9e78,0x3e8e9a22,0x3e7ee6e1
.long 0x3e605c13,0x3e3e853e,0x3e1c76de,0x3df475c0,0x3dc8bd36,0x3d7b2b74,0x3cc90ab0,0xbc490e90
.long 0xbcc90ab0,0xbd83db0a,0xbdd53db9,0xbe1324ca,0xbe164083,0xbe419b37,0xbe6c9a7f,0xbe8b9507
.long 0xbe888e93,0xbe9f1cdf,0xbeb554ec,0xbecb2aae,0x3f800000,0x3f800000,0x3f800000,0x3f800000
.long 0x3f7dabcc,0x3f7d906e,0x3f7d7474,0x3f7d57de,0x3f76ba07,0x3f764d97,0x3f75dec6,0x3f756d97
.long 0x3f6b4b0c,0x3f6a5ad9,0x3f696591,0x3f686b39,0x3f5b941a,0x3f59f26a,0x3f584853,0x3f5695e5
.long 0x3f47de65,0x3f456439,0x3f42de29,0x3f404c5c,0x3f3085bb,0x3f2d1469,0x3f299415,0x3f26050a
.long 0x3f15f6d9,0x3f11796b,0x3f0cead0,0x3f084b92,0x3ef15aea,0x3ee63375,0x3edae880,0x3ecf7bca
.long 0x3eb263ef,0x3ea5129f,0x3e97a117,0x3e8a11f7,0x3e605c13,0x3e419b37,0x3e22abb6,0x3e039502
.long 0x3dafb680,0x3d55880e,0x3c96c9b6,0xbc7b514b,0xbd48fb30,0xbdafb680,0xbdfab273,0xbe22abb6
.long 0xbe3b6ecf,0xbe636c83,0xbe8586ce,0xbe9920fe,0xbea09ae5,0xbeb554ec,0xbec9b953,0xbeddbe79
.long 0xbee0924f,0xbef58035,0xbf04f484,0xbf0ee0db,0x0,0x0,0x0,0x0
.long 0x3dc8bd36,0x3dcefdb7,0x3dd53db9,0x3ddb7d37,0x3e47c5c2,0x3e4dee60,0x3e541501,0x3e5a3997
.long 0x3e94a031,0x3e9920fe,0x3e9d9e78,0x3ea21887,0x3ec3ef15,0x3ec9b953,0x3ecf7bca,0x3ed53641
.long 0x3ef15aea,0x3ef840c8,0x3eff17b2,0x3f02ef9f,0x3f0e39da,0x3f121eb0,0x3f15f6d9,0x3f19c200
.long 0x3f226799,0x3f269de3,0x3f2ac082,0x3f2ecef7,0x3f3504f3,0x3f396842,0x3f3daef9,0x3f41d870
.long 0x3f45e403,0x3f4a4c87,0x3f4e8d90,0x3f52a649,0x3f54db31,0x3f591e6a,0x3f5d2d53,0x3f6106f2
.long 0x3f61c598,0x3f65b710,0x3f696591,0x3f6cd007,0x3f6c835e,0x3f6ff573,0x3f731447,0x3f75dec6
.long 0x3f74fa0b,0x3f77beb7,0x3f7a1e84,0x3f7c187a,0x3f7b14be,0x3f7cfe73,0x3f7e70b0,0x3f7f6ac7
.long 0x3f7ec46d,0x3f7fa6e3,0x3f7ffec4,0x3f7fcbe2,0x0,0x0,0x0,0x0
.long 0x3de1bc2e,0x3de7fa9a,0x3dee3876,0x3df475c0,0x3e605c13,0x3e667c66,0x3e6c9a7f,0x3e72b651
.long 0x3ea68f12,0x3eab0201,0x3eaf713a,0x3eb3dca5,0x3edae880,0x3ee0924f,0x3ee63375,0x3eebcbbb
.long 0x3f064b82,0x3f099f4e,0x3f0cead0,0x3f102dd5,0x3f1d7fd1,0x3f212ff9,0x3f24d225,0x3f286605
.long 0x3f32c8c9,0x3f36ad7f,0x3f3a7ca4,0x3f3e35c5,0x3f45e403,0x3f49d112,0x3f4d9f02,0x3f514d3d
.long 0x3f5695e5,0x3f5a5ba0,0x3f5df6be,0x3f61668a,0x3f64aa59,0x3f6816a8,0x3f6b4b0c,0x3f6e46be
.long 0x3f6ff573,0x3f72d4eb,0x3f756d97,0x3f77beb7,0x3f7853f8,0x3f7a7302,0x3f7c3b28,0x3f7dabcc
.long 0x3f7dabcc,0x3f7ed7d4,0x3f7f9c18,0x3f7ff84a,0x3f7fec43,0x3f7ff4e6,0x3f7f84ab,0x3f7e9bc9
.long 0x3f7f0e58,0x3f7dc68c,0x3f7bf531,0x3f799b43,0x0,0x0,0x0,0x0
.long 0x3dfab273,0x3e007745,0x3e039502,0x3e06b26e,0x3e78cfcc,0x3e7ee6e1,0x3e827dc0,0x3e8586ce
.long 0x3eb8442a,0x3ebca7af,0x3ec1071e,0x3ec5625c,0x3ef15aea,0x3ef6e0cb,0x3efc5d27,0x3f00e7e4
.long 0x3f13682a,0x3f16999f,0x3f19c200,0x3f1ce11f,0x3f2beb4a,0x3f2f61a5,0x3f32c8c9,0x3f36206c
.long 0x3f41d870,0x3f456439,0x3f48d8b3,0x3f4c3578,0x3f54db31,0x3f584853,0x3f5b941a,0x3f5ebe05
.long 0x3f64aa59,0x3f67c187,0x3f6aab7b,0x3f6d67a1,0x3f710908,0x3f73913f,0x3f75dec6,0x3f77f110
.long 0x3f79c79d,0x3f7b87b2,0x3f7cfe73,0x3f7e2b72,0x3f7ec46d,0x3f7f84ab,0x3f7fec43,0x3f7ffb11
.long 0x3f7fec43,0x3f7f7808,0x3f7e9bc9,0x3f7d57de,0x3f7d3aac,0x3f7b61fc,0x3f791298,0x3f764d97
.long 0x3f76ba07,0x3f73530e,0x3f6f6830,0x3f6afb8c,0x0,0x0,0x0,0x0
.long 0x3e09cf86,0x3e0cec4a,0x3e1008b7,0x3e1324ca,0x3e888e93,0x3e8b9507,0x3e8e9a22,0x3e919ddd
.long 0x3ec9b953,0x3ece0bea,0x3ed25a09,0x3ed6a399,0x3f039c3d,0x3f064b82,0x3f08f59b,0x3f0b9a6b
.long 0x3f1ff6cb,0x3f2302d3,0x3f26050a,0x3f28fd41,0x3f396842,0x3f3ca003,0x3f3fc767,0x3f42de29
.long 0x3f4f7a1f,0x3f52a649,0x3f55b993,0x3f58b3a1,0x3f61c598,0x3f64aa59,0x3f676bd8,0x3f6a09a7
.long 0x3f6ff573,0x3f725470,0x3f748422,0x3f76841b,0x3f79c79d,0x3f7b61fc,0x3f7cbfc9,0x3f7de0b1
.long 0x3f7f0e58,0x3f7fa6e3,0x3f7ff4e6,0x3f7ff84a,0x3f7fb10f,0x3f7f0e58,0x3f7e1324,0x3f7cbfc9
.long 0x3f7baccd,0x3f799b43,0x3f772417,0x3f74484b,0x3f731447,0x3f6f6830,0x3f6b4b0c,0x3f66becc
.long 0x3f660f88,0x3f60a6cf,0x3f5ac450,0x3f546b3b,0x248d3132,0xbd48fb30,0xbdc8bd36,0xbe164083
.long 0xbdc8bd36,0xbe195be0,0xbe4dee60,0xbe80f8c0,0xbe47c5c2,0xbe7ee6e1,0xbe9aa086,0xbeb554ec
.long 0xbe94a031,0xbeb0eacb,0xbecc9b8b,0xbee79a5d,0xbec3ef15,0xbee0924f,0xbefc5d27,0xbf0b9a6b
.long 0xbef15aea,0xbf06f686,0xbf14b039,0xbf21cbfb,0xbf0e39da,0xbf1c420c,0xbf299415,0xbf36206c
.long 0xbf226799,0xbf2ff3e6,0xbf3ca003,0xbf485bca,0xbf3504f3,0xbf41d870,0xbf4d9f02,0xbf584853
.long 0xbf45e403,0xbf51c0c2,0xbf5c61c7,0xbf65b710,0xbf54db31,0xbf5f8327,0xbf68bf3c,0xbf708066
.long 0xbf61c598,0xbf6afb8c,0xbf7294f8,0xbf788486,0xbf6c835e,0xbf740bdd,0xbf79c79d,0xbf7dabcc
.long 0xbf74fa0b,0xbf7a9c59,0xbf7e4323,0xbf7fe705,0xbf7b14be,0xbf7e9bc9,0xbf7ffb11,0xbf7f2f9d
.long 0xbf7ec46d,0xbf7fffb1,0xbf7eea9d,0xbf7b87b2,0xbe47c5c2,0xbe78cfcc,0xbe94a031,0xbeac7cd4
.long 0xbe9aa086,0xbeb3dca5,0xbecc9b8b,0xbee4cbfe,0xbecf7bca,0xbee900b7,0xbf00e7e4,0xbf0cead0
.long 0xbf00e7e4,0xbf0d9281,0xbf19c200,0xbf256bcb,0xbf187fc0,0xbf24d225,0xbf3085bb,0xbf3b8f3b
.long 0xbf2e3bde,0xbf39f2ac,0xbf44e3f5,0xbf4f0417,0xbf41d870,0xbf4cae79,0xbf5695e5,0xbf5f8327
.long 0xbf531849,0xbf5cc7d1,0xbf655e0b,0xbf6cd007,0xbf61c598,0xbf6a09a7,0xbf710908,0xbf76ba07
.long 0xbf6db293,0xbf74484b,0xbf796e4e,0xbf7d1cdd,0xbf76ba07,0xbf7b61fc,0xbf7e70b0,0xbf7fe129
.long 0xbf7cbfc9,0xbf7f3f54,0xbf7ffec4,0xbf7efcc9,0xbf7fb10f,0xbf7fd397,0xbf7e1324,0xbf7a7302
.long 0xbf7f84ab,0xbf7d1cdd,0xbf78b47b,0xbf725470,0xbf7c3b28,0xbf772417,0xbf6ff573,0xbf66becc
.long 0xbf75dec6,0xbf6dfcf2,0xbf63f473,0xbf57dc7f,0xbec3ef15,0xbedae880,0xbef15aea,0xbf039c3d
.long 0xbefc5d27,0xbf099f4e,0xbf14b039,0xbf1f599f,0xbf187fc0,0xbf239da9,0xbf2e3bde,0xbf385216
.long 0xbf3085bb,0xbf3b0629,0xbf44e3f5,0xbf4e1689,0xbf45e403,0xbf4f7a1f,0xbf584853,0xbf604621
.long 0xbf584853,0xbf60a6cf,0xbf6816a8,0xbf6e8ff8,0xbf676bd8,0xbf6e46be,0xbf740bdd,0xbf78b47b
.long 0xbf731447,0xbf7822d1,0xbf7bf531,0xbf7e868b,0xbf7b14be,0xbf7e1324,0xbf7fb10f,0xbf7fec43
.long 0xbf7f4e6d,0xbf7fffb1,0xbf7f2f9d,0xbf7cdf6c,0xbf7fb10f,0xbf7de0b1,0xbf7a7302,0xbf756d97
.long 0xbf7c3b28,0xbf77beb7,0xbf718f57,0xbf69b7e4,0xbf74fa0b,0xbf6db293,0xbf64aa59,0xbf59f26a
.long 0xbf6a09a7,0xbf5fe4e9,0xbf53fac3,0xbf466354,0xbf5b941a,0xbf4e8d90,0xbf3fc767,0xbf2f61a5
.long 0xbf49d112,0xbf39f2ac,0xbf286605,0xbf1553b7,0xbf0e39da,0xbf187fc0,0xbf226799,0xbf2beb4a
.long 0xbf299415,0xbf33587a,0xbf3ca003,0xbf456439,0xbf41d870,0xbf4ac77f,0xbf531849,0xbf5ac450
.long 0xbf5695e5,0xbf5e5aa6,0xbf655e0b,0xbf6b99fb,0xbf676bd8,0xbf6db293,0xbf731447,0xbf778bc5
.long 0xbf740bdd,0xbf788486,0xbf7bf531,0xbf7e5a38,0xbf7c3b28,0xbf7e9bc9,0xbf7fd397,0xbf7fe129
.long 0xbf7fd397,0xbf7fdaaf,0xbf7e9bc9,0xbf7c187a,0xbf7ec46d,0xbf7c3b28,0xbf7853f8,0xbf731447
.long 0xbf791298,0xbf73ced9,0xbf6d1c1d,0xbf650479,0xbf6ed89e,0xbf66becc,0xbf5d2d53,0xbf5233c6
.long 0xbf604621,0xbf554aa4,0xbf48d8b3,0xbf3b0629,0xbf4d9f02,0xbf3fc767,0xbf3085bb,0xbf1ff6cb
.long 0xbf373a23,0xbf269de3,0xbf14b039,0xbf019573,0xbf1d7fd1,0xbf0a48ad,0xbeebcbbb,0xbec1071e
.long 0xbf00e7e4,0xbed6a399,0xbea986c4,0xbe75c35a,0x3f800000,0x3f7fb10f,0x3f7ec46d,0x3f7d3aac
.long 0x3f7ec46d,0x3f7d1cdd,0x3f7ac516,0x3f77beb7,0x3f7b14be,0x3f77f110,0x3f740bdd,0x3f6f6830
.long 0x3f74fa0b,0x3f703b37,0x3f6aab7b,0x3f644fac,0x3f6c835e,0x3f660f88,0x3f5ebe05,0x3f5695e5
.long 0x3f61c598,0x3f5988ad,0x3f5064af,0x3f466354,0x3f54db31,0x3f4ac77f,0x3f3fc767,0x3f33e7bc
.long 0x3f45e403,0x3f39f2ac,0x3f2d1469,0x3f1f599f,0x3f3504f3,0x3f273656,0x3f187fc0,0x3f08f59b
.long 0x3f226799,0x3f12c39a,0x3f0242b1,0x3ee1fb6a,0x3f0e39da,0x3ef9a02d,0x3ed53641,0x3eaf713a
.long 0x3ef15aea,0x3ecb2aae,0x3ea395c5,0x3e75c35a,0x3ec3ef15,0x3e9aa086,0x3e605c13,0x3e09cf86
.long 0x3e94a031,0x3e5101f1,0x3dee3876,0x3ce22a7a,0x3e47c5c2,0x3dd53db9,0x3c490e90,0xbda3308c
.long 0x3dc8bd36,0x3b490fc6,0xbdbc3ac3,0xbe3e853e,0x3f7b14be,0x3f7853f8,0x3f74fa0b,0x3f710908
.long 0x3f740bdd,0x3f6faf1b,0x3f6aab7b,0x3f650479,0x3f6a09a7,0x3f63f473,0x3f5d2d53,0x3f55b993
.long 0x3f5d2d53,0x3f554aa4,0x3f4cae79,0x3f436051,0x3f4d9f02,0x3f43e200,0x3f396842,0x3f2e3bde
.long 0x3f3b8f3b,0x3f2ff3e6,0x3f239da9,0x3f16999f,0x3f273656,0x3f19c200,0x3f0b9a6b,0x3ef9a02d
.long 0x3f10d3cd,0x3f019573,0x3ee363fa,0x3ec27b55,0x3ef15aea,0x3ecf7bca,0x3eac7cd4,0x3e888e93
.long 0x3ebe1d4a,0x3e9920fe,0x3e667c66,0x3e195be0,0x3e888e93,0x3e419b37,0x3de1bc2e,0x3cfb49ba
.long 0x3e22abb6,0x3d9cecf9,0xbbc90f88,0xbdb5f8da,0x3d48fb30,0xbd16c32c,0xbdfab273,0xbe541501
.long 0xbd7b2b74,0xbe195be0,0xbe72b651,0xbea5129f,0xbe2f10a2,0xbe8586ce,0xbeb263ef,0xbeddbe79
.long 0xbe8e9a22,0xbebca7af,0xbee900b7,0xbf099f4e,0x3f6c835e,0x3f676bd8,0x3f61c598,0x3f5b941a
.long 0x3f5ebe05,0x3f57dc7f,0x3f5064af,0x3f485bca,0x3f4d9f02,0x3f44e3f5,0x3f3b8f3b,0x3f31a81d
.long 0x3f396842,0x3f2ecef7,0x3f239da9,0x3f17de12,0x3f226799,0x3f15f6d9,0x3f08f59b,0x3ef6e0cb
.long 0x3f08f59b,0x3ef58035,0x3ed8106b,0x3eb9bb1e,0x3edae880,0x3ebb31a0,0x3e9aa086,0x3e72b651
.long 0x3ea09ae5,0x3e7bdba4,0x3e354098,0x3ddb7d37,0x3e47c5c2,0x3dfab273,0x3d48fb30,0xbcc90ab0
.long 0x3d96a905,0xbb490fc6,0xbda3308c,0xbe1f917b,0xbd48fb30,0xbe039502,0xbe541501,0xbe919ddd
.long 0xbe2f10a2,0xbe80f8c0,0xbea986c4,0xbed0eb2a,0xbe94a031,0xbebe1d4a,0xbee63375,0xbf064b82
.long 0xbecf7bca,0xbef840c8,0xbf0f8784,0xbf21cbfb,0xbf039c3d,0xbf173c07,0xbf299415,0xbf3a7ca4
.long 0xbf1d7fd1,0xbf2ff3e6,0xbf40d0da,0xbf4fefa8,0x3f54db31,0x3f4d9f02,0x3f45e403,0x3f3daef9
.long 0x3f3fc767,0x3f36ad7f,0x3f2d1469,0x3f2302d3,0x3f273656,0x3f1c420c,0x3f10d3cd,0x3f04f484
.long 0x3f0b9a6b,0x3efdbabb,0x3ee363fa,0x3ec8477c,0x3edae880,0x3ebe1d4a,0x3ea09ae5,0x3e827dc0
.long 0x3e9aa086,0x3e75c35a,0x3e354098,0x3de7fa9a,0x3e2f10a2,0x3dd53db9,0x3d16c32c,0xbcfb49ba
.long 0x3d16c32c,0xbd0a342f,0xbdd53db9,0xbe3228d4,0xbdc8bd36,0xbe2f10a2,0xbe78cfcc,0xbea09ae5
.long 0xbe6c9a7f,0xbe9c1faf,0xbec1071e,0xbee4cbfe,0xbeb8442a,0xbeddbe79,0xbf00e7e4,0xbf121eb0
.long 0xbef6e0cb,0xbf0d9281,0xbf1ebc12,0xbf2ecef7,0xbf187fc0,0xbf299415,0xbf396842,0xbf47de65
.long 0xbf32c8c9,0xbf425b89,0xbf5064af,0xbf5cc7d1,0xbf49d112,0xbf577026,0xbf633c5a,0xbf6d1c1d
.long 0xbf5d2d53,0xbf686b39,0xbf718f57,0xbf788486,0x3f800000,0x3f7d3aac,0x3f74fa0b,0x3f676bd8
.long 0x3f800000,0x3f7d1cdd,0x3f748422,0x3f666771,0x3f800000,0x3f7cfe73,0x3f740bdd,0x3f655e0b
.long 0x3f800000,0x3f7cdf6c,0x3f73913f,0x3f644fac,0x3f800000,0x3f7cbfc9,0x3f731447,0x3f633c5a
.long 0x3f800000,0x3f7c9f8a,0x3f7294f8,0x3f62241a,0x3f800000,0x3f7c7eb0,0x3f721352,0x3f6106f2
.long 0x3f800000,0x3f7c5d3a,0x3f718f57,0x3f5fe4e9,0x3f800000,0x3f7c3b28,0x3f710908,0x3f5ebe05
.long 0x3f800000,0x3f7c187a,0x3f708066,0x3f5d924d,0x3f800000,0x3f7bf531,0x3f6ff573,0x3f5c61c7
.long 0x3f800000,0x3f7bd14d,0x3f6f6830,0x3f5b2c79,0x3f800000,0x3f7baccd,0x3f6ed89e,0x3f59f26a
.long 0x3f800000,0x3f7b87b2,0x3f6e46be,0x3f58b3a1,0x3f800000,0x3f7b61fc,0x3f6db293,0x3f577026
.long 0x3f800000,0x3f7b3bab,0x3f6d1c1d,0x3f5627fe,0x3f54db31,0x3f3daef9,0x3f226799,0x3f039c3d
.long 0x3f531849,0x3f3b0629,0x3f1ebc12,0x3efdbabb,0x3f514d3d,0x3f385216,0x3f1b02c6,0x3ef41f07
.long 0x3f4f7a1f,0x3f3592e7,0x3f173c07,0x3eea6681,0x3f4d9f02,0x3f32c8c9,0x3f13682a,0x3ee0924f
.long 0x3f4bbbf8,0x3f2ff3e6,0x3f0f8784,0x3ed6a399,0x3f49d112,0x3f2d1469,0x3f0b9a6b,0x3ecc9b8b
.long 0x3f47de65,0x3f2a2a80,0x3f07a136,0x3ec27b55,0x3f45e403,0x3f273656,0x3f039c3d,0x3eb8442a
.long 0x3f43e200,0x3f24381a,0x3eff17b2,0x3eadf73c,0x3f41d870,0x3f212ff9,0x3ef6e0cb,0x3ea395c5
.long 0x3f3fc767,0x3f1e1e22,0x3eee9479,0x3e9920fe,0x3f3daef9,0x3f1b02c6,0x3ee63375,0x3e8e9a22
.long 0x3f3b8f3b,0x3f17de12,0x3eddbe79,0x3e840270,0x3f396842,0x3f14b039,0x3ed53641,0x3e72b651
.long 0x3f373a23,0x3f11796b,0x3ecc9b8b,0x3e5d4b1a,0x3ec3ef15,0x3e78cfcc,0x3dc8bd36,0xbd48fb30
.long 0x3eb8442a,0x3e5d4b1a,0x3d8a200a,0xbda973ba,0x3eac7cd4,0x3e419b37,0x3d16c32c,0xbdee3876
.long 0x3ea09ae5,0x3e25c58c,0x3bc90f88,0xbe195be0,0x3e94a031,0x3e09cf86,0xbcc90ab0,0xbe3b6ecf
.long 0x3e888e93,0x3ddb7d37,0xbd621469,0xbe5d4b1a,0x3e78cfcc,0x3da3308c,0xbdafb680,0xbe7ee6e1
.long 0x3e605c13,0x3d55880e,0xbdee3876,0xbe901c2c,0x3e47c5c2,0x3cc90ab0,0xbe164083,0xbea09ae5
.long 0x3e2f10a2,0xbb490fc6,0xbe354098,0xbeb0eacb,0x3e164083,0xbcfb49ba,0xbe541501,0xbec1071e
.long 0x3dfab273,0xbd6ea038,0xbe72b651,0xbed0eb2a,0x3dc8bd36,0xbdafb680,0xbe888e93,0xbee0924f
.long 0x3d96a905,0xbde7fa9a,0xbe97a117,0xbeeff7fb,0x3d48fb30,0xbe1008b7,0xbea68f12,0xbeff17b2
.long 0x3cc90ab0,0xbe2bf804,0xbeb554ec,0xbf06f686,0xbe47c5c2,0xbeac7cd4,0xbef15aea,0xbf187fc0
.long 0xbe6c9a7f,0xbebf926f,0xbf0242b1,0xbf21cbfb,0xbe888e93,0xbed25a09,0xbf0b9a6b,0xbf2ac082
.long 0xbe9aa086,0xbee4cbfe,0xbf14b039,0xbf33587a,0xbeac7cd4,0xbef6e0cb,0xbf1d7fd1,0xbf3b8f3b
.long 0xbebe1d4a,0xbf044889,0xbf26050a,0xbf436051,0xbecf7bca,0xbf0cead0,0xbf2e3bde,0xbf4ac77f
.long 0xbee0924f,0xbf1553b7,0xbf36206c,0xbf51c0c2,0xbef15aea,0xbf1d7fd1,0xbf3daef9,0xbf584853
.long 0xbf00e7e4,0xbf256bcb,0xbf44e3f5,0xbf5e5aa6,0xbf08f59b,0xbf2d1469,0xbf4bbbf8,0xbf63f473
.long 0xbf10d3cd,0xbf34768f,0xbf5233c6,0xbf6912ae,0xbf187fc0,0xbf3b8f3b,0xbf584853,0xbf6db293
.long 0xbf1ff6cb,0xbf425b89,0xbf5df6be,0xbf71d19f,0xbf273656,0xbf48d8b3,0xbf633c5a,0xbf756d97
.long 0xbf2e3bde,0xbf4f0417,0xbf6816a8,0xbf788486,0x0,0x3e164083,0x3e94a031,0x3edae880
.long 0x0,0x3e195be0,0x3e97a117,0x3edf28a9,0x0,0x3e1c76de,0x3e9aa086,0x3ee363fa
.long 0x0,0x3e1f917b,0x3e9d9e78,0x3ee79a5d,0x0,0x3e22abb6,0x3ea09ae5,0x3eebcbbb
.long 0x0,0x3e25c58c,0x3ea395c5,0x3eeff7fb,0x0,0x3e28defc,0x3ea68f12,0x3ef41f07
.long 0x0,0x3e2bf804,0x3ea986c4,0x3ef840c8,0x0,0x3e2f10a2,0x3eac7cd4,0x3efc5d27
.long 0x0,0x3e3228d4,0x3eaf713a,0x3f003a06,0x0,0x3e354098,0x3eb263ef,0x3f0242b1
.long 0x0,0x3e3857ec,0x3eb554ec,0x3f044889,0x0,0x3e3b6ecf,0x3eb8442a,0x3f064b82
.long 0x0,0x3e3e853e,0x3ebb31a0,0x3f084b92,0x0,0x3e419b37,0x3ebe1d4a,0x3f0a48ad
.long 0x0,0x3e44b0b9,0x3ec1071e,0x3f0c42c9,0x3f0e39da,0x3f2beb4a,0x3f45e403,0x3f5b941a
.long 0x3f10d3cd,0x3f2ecef7,0x3f48d8b3,0x3f5e5aa6,0x3f13682a,0x3f31a81d,0x3f4bbbf8,0x3f6106f2
.long 0x3f15f6d9,0x3f34768f,0x3f4e8d90,0x3f6398ac,0x3f187fc0,0x3f373a23,0x3f514d3d,0x3f660f88
.long 0x3f1b02c6,0x3f39f2ac,0x3f53fac3,0x3f686b39,0x3f1d7fd1,0x3f3ca003,0x3f5695e5,0x3f6aab7b
.long 0x3f1ff6cb,0x3f3f41fc,0x3f591e6a,0x3f6cd007,0x3f226799,0x3f41d870,0x3f5b941a,0x3f6ed89e
.long 0x3f24d225,0x3f446337,0x3f5df6be,0x3f70c501,0x3f273656,0x3f46e22a,0x3f604621,0x3f7294f8
.long 0x3f299415,0x3f495521,0x3f628210,0x3f74484b,0x3f2beb4a,0x3f4bbbf8,0x3f64aa59,0x3f75dec6
.long 0x3f2e3bde,0x3f4e1689,0x3f66becc,0x3f77583a,0x3f3085bb,0x3f5064af,0x3f68bf3c,0x3f78b47b
.long 0x3f32c8c9,0x3f52a649,0x3f6aab7b,0x3f79f35e,0x3f6c835e,0x3f7853f8,0x3f7ec46d,0x3f7fb10f
.long 0x3f6ed89e,0x3f79f35e,0x3f7f6ac7,0x3f7f1f49,0x3f710908,0x3f7b61fc,0x3f7fd397,0x3f7e4323
.long 0x3f731447,0x3f7c9f8a,0x3f7ffec4,0x3f7d1cdd,0x3f74fa0b,0x3f7dabcc,0x3f7fec43,0x3f7baccd
.long 0x3f76ba07,0x3f7e868b,0x3f7f9c18,0x3f79f35e,0x3f7853f8,0x3f7f2f9d,0x3f7f0e58,0x3f77f110
.long 0x3f79c79d,0x3f7fa6e3,0x3f7e4323,0x3f75a67b,0x3f7b14be,0x3f7fec43,0x3f7d3aac,0x3f731447
.long 0x3f7c3b28,0x3f7fffb1,0x3f7bf531,0x3f703b37,0x3f7d3aac,0x3f7fe129,0x3f7a7302,0x3f6d1c1d
.long 0x3f7e1324,0x3f7f90b1,0x3f78b47b,0x3f69b7e4,0x3f7ec46d,0x3f7f0e58,0x3f76ba07,0x3f660f88
.long 0x3f7f4e6d,0x3f7e5a38,0x3f748422,0x3f62241a,0x3f7fb10f,0x3f7d7474,0x3f721352,0x3f5df6be
.long 0x3f7fec43,0x3f7c5d3a,0x3f6f6830,0x3f5988ad,0x3f7b14be,0x3f710908,0x3f61c598,0x3f4d9f02
.long 0x3f791298,0x3f6d67a1,0x3f5c61c7,0x3f466354,0x3f76ba07,0x3f696591,0x3f5695e5,0x3f3ebc1b
.long 0x3f740bdd,0x3f650479,0x3f5064af,0x3f36ad7f,0x3f710908,0x3f604621,0x3f49d112,0x3f2e3bde
.long 0x3f6db293,0x3f5b2c79,0x3f42de29,0x3f256bcb,0x3f6a09a7,0x3f55b993,0x3f3b8f3b,0x3f1c420c
.long 0x3f660f88,0x3f4fefa8,0x3f33e7bc,0x3f12c39a,0x3f61c598,0x3f49d112,0x3f2beb4a,0x3f08f59b
.long 0x3f5d2d53,0x3f436051,0x3f239da9,0x3efdbabb,0x3f584853,0x3f3ca003,0x3f1b02c6,0x3ee900b7
.long 0x3f531849,0x3f3592e7,0x3f121eb0,0x3ed3c867,0x3f4d9f02,0x3f2e3bde,0x3f08f59b,0x3ebe1d4a
.long 0x3f47de65,0x3f269de3,0x3eff17b2,0x3ea80b1f,0x3f41d870,0x3f1ebc12,0x3eebcbbb,0x3e919ddd
.long 0x3f3b8f3b,0x3f16999f,0x3ed8106b,0x3e75c35a,0xbf3504f3,0xbf4d9f02,0xbf61c598,0xbf710908
.long 0xbf3daef9,0xbf554aa4,0xbf6816a8,0xbf75a67b,0xbf45e403,0xbf5c61c7,0xbf6db293,0xbf796e4e
.long 0xbf4d9f02,0xbf62df7b,0xbf7294f8,0xbf7c5d3a,0xbf54db31,0xbf68bf3c,0xbf76ba07,0xbf7e70b0
.long 0xbf5b941a,0xbf6dfcf2,0xbf7a1e84,0xbf7fa6e3,0xbf61c598,0xbf7294f8,0xbf7cbfc9,0xbf7ffec4
.long 0xbf676bd8,0xbf76841b,0xbf7e9bc9,0xbf7f7808,0xbf6c835e,0xbf79c79d,0xbf7fb10f,0xbf7e1324
.long 0xbf710908,0xbf7c5d3a,0xbf7ffec4,0xbf7bd14d,0xbf74fa0b,0xbf7e4323,0xbf7f84ab,0xbf78b47b
.long 0xbf7853f8,0xbf7f7808,0xbf7e4323,0xbf74bf62,0xbf7b14be,0xbf7ffb11,0xbf7c3b28,0xbf6ff573
.long 0xbf7d3aac,0xbf7fcbe2,0xbf796e4e,0xbf6a5ad9,0xbf7ec46d,0xbf7eea9d,0xbf75dec6,0xbf63f473
.long 0xbf7fb10f,0xbf7d57de,0xbf718f57,0xbf5cc7d1,0xbf7b14be,0xbf7fb10f,0xbf7ec46d,0xbf7853f8
.long 0xbf7dabcc,0xbf7ff84a,0xbf7c7eb0,0xbf73530e,0xbf7f4e6d,0xbf7f2f9d,0xbf791298,0xbf6d1c1d
.long 0xbf7ffb11,0xbf7d57de,0xbf748422,0xbf65b710,0xbf7fb10f,0xbf7a7302,0xbf6ed89e,0xbf5d2d53
.long 0xbf7e70b0,0xbf76841b,0xbf6816a8,0xbf5389c7,0xbf7c3b28,0xbf718f57,0xbf604621,0xbf48d8b3
.long 0xbf791298,0xbf6b99fb,0xbf577026,0xbf3d27b8,0xbf74fa0b,0xbf64aa59,0xbf4d9f02,0xbf3085bb
.long 0xbf6ff573,0xbf5cc7d1,0xbf42de29,0xbf2302d3,0xbf6a09a7,0xbf53fac3,0xbf373a23,0xbf14b039
.long 0xbf633c5a,0xbf4a4c87,0xbf2ac082,0xbf05a02c,0xbf5b941a,0xbf3fc767,0xbf1d7fd1,0xbeebcbbb
.long 0xbf531849,0xbf34768f,0xbf0f8784,0xbecb2aae,0xbf49d112,0xbf286605,0xbf00e7e4,0xbea986c4
.long 0xbf3fc767,0xbf1ba299,0xbee363fa,0xbe870ada,0xbf6c835e,0xbf5b941a,0xbf45e403,0xbf2beb4a
.long 0xbf64aa59,0xbf50d937,0xbf385216,0xbf1ba299,0xbf5b941a,0xbf44e3f5,0xbf299415,0xbf0a48ad
.long 0xbf514d3d,0xbf37c655,0xbf19c200,0xbeeff7fb,0xbf45e403,0xbf299415,0xbf08f59b,0xbec9b953
.long 0xbf396842,0xbf1a6293,0xbeee9479,0xbea21887,0xbf2beb4a,0xbf0a48ad,0xbec9b953,0xbe72b651
.long 0xbf1d7fd1,0xbef2bd43,0xbea395c5,0xbe1f917b,0xbf0e39da,0xbecf7bca,0xbe78cfcc,0xbd96a905
.long 0xbefc5d27,0xbeab0201,0xbe28defc,0x3c16cb58,0xbedae880,0xbe8586ce,0xbdafb680,0x3dbc3ac3
.long 0xbeb8442a,0xbe3e853e,0xbbc90f88,0x3e3228d4,0xbe94a031,0xbde1bc2e,0x3d96a905,0x3e827dc0
.long 0xbe605c13,0xbd0a342f,0x3e1c76de,0x3eab0201,0xbe164083,0x3d2fe007,0x3e6c9a7f,0x3ed25a09
.long 0xbd96a905,0x3df475c0,0x3e9d9e78,0x3ef840c8,0xbf0e39da,0xbedae880,0xbe94a031,0xbe164083
.long 0xbef6e0cb,0xbeb0eacb,0xbe4dee60,0xbd55880e,0xbecf7bca,0xbe8586ce,0xbde1bc2e,0x3d2fe007
.long 0xbea68f12,0xbe3228d4,0xbc96c9b6,0x3e0cec4a,0xbe78cfcc,0xbdafb680,0x3d96a905,0x3e6c9a7f
.long 0xbe22abb6,0x3b490fc6,0x3e28defc,0x3ea5129f,0xbd96a905,0x3dbc3ac3,0x3e827dc0,0x3ed25a09
.long 0x3c490e90,0x3e3857ec,0x3eaf713a,0x3efdbabb,0x3dc8bd36,0x3e888e93,0x3edae880,0x3f13682a
.long 0x3e3b6ecf,0x3eb3dca5,0x3f0242b1,0x3f269de3,0x3e888e93,0x3eddbe79,0x3f15f6d9,0x3f385216
.long 0x3eb263ef,0x3f02ef9f,0x3f286605,0x3f485bca,0x3edae880,0x3f15f6d9,0x3f396842,0x3f5695e5
.long 0x3f00e7e4,0x3f27ce61,0x3f48d8b3,0x3f62df7b,0x3f13682a,0x3f385216,0x3f5695e5,0x3f6d1c1d
.long 0x3f24d225,0x3f476085,0x3f628210,0x3f75341d,0x3f3504f3,0x3f187fc0,0x3ef15aea,0x3eac7cd4
.long 0x3f2beb4a,0x3f0d9281,0x3ed8106b,0x3e901c2c,0x3f226799,0x3f0242b1,0x3ebe1d4a,0x3e667c66
.long 0x3f187fc0,0x3eed3063,0x3ea395c5,0x3e2bf804,0x3f0e39da,0x3ed53641,0x3e888e93,0x3de1bc2e
.long 0x3f039c3d,0x3ebca7af,0x3e5a3997,0x3d55880e,0x3ef15aea,0x3ea395c5,0x3e22abb6,0xbbc90f88
.long 0x3edae880,0x3e8a11f7,0x3dd53db9,0xbd83db0a,0x3ec3ef15,0x3e605c13,0x3d48fb30,0xbdfab273
.long 0x3eac7cd4,0x3e2bf804,0xbbc90f88,0xbe3857ec,0x3e94a031,0x3dee3876,0xbd7b2b74,0xbe72b651
.long 0x3e78cfcc,0x3d83db0a,0xbdee3876,0xbe9620d2,0x3e47c5c2,0x3c490e90,0xbe2f10a2,0xbeb263ef
.long 0x3e164083,0xbd2351cb,0xbe667c66,0xbece0bea,0x3dc8bd36,0xbdbc3ac3,0xbe8e9a22,0xbee900b7
.long 0x3d48fb30,0xbe1324ca,0xbea986c4,0xbf019573,0x3e47c5c2,0x3d48fb30,0xbdc8bd36,0xbe78cfcc
.long 0x3e09cf86,0xbc7b514b,0xbe28defc,0xbe9f1cdf,0x3d96a905,0xbda3308c,0xbe6c9a7f,0xbec1071e
.long 0x3c490e90,0xbe1324ca,0xbe97a117,0xbee1fb6a,0xbd48fb30,0xbe541501,0xbeb8442a,0xbf00e7e4
.long 0xbde1bc2e,0xbe8a11f7,0xbed8106b,0xbf102dd5,0xbe2f10a2,0xbea986c4,0xbef6e0cb,0xbf1ebc12
.long 0xbe6c9a7f,0xbec8477c,0xbf0a48ad,0xbf2c800f,0xbe94a031,0xbee63375,0xbf187fc0,0xbf396842
.long 0xbeb263ef,0xbf019573,0xbf26050a,0xbf456439,0xbecf7bca,0xbf0f8784,0xbf32c8c9,0xbf5064af
.long 0xbeebcbbb,0xbf1ce11f,0xbf3ebc1b,0xbf5a5ba0,0xbf039c3d,0xbf299415,0xbf49d112,0xbf633c5a
.long 0xbf10d3cd,0xbf3592e7,0xbf53fac3,0xbf6afb8c,0xbf1d7fd1,0xbf40d0da,0xbf5d2d53,0xbf718f57
.long 0xbf299415,0xbf4b41fa,0xbf655e0b,0xbf76ef5b,0xbec3ef15,0xbf039c3d,0xbf226799,0xbf3daef9
.long 0xbee63375,0xbf140c5f,0xbf31a81d,0xbf4b41fa,0xbf039c3d,0xbf239da9,0xbf3fc767,0xbf577026
.long 0xbf13682a,0xbf3238aa,0xbf4cae79,0xbf62241a,0xbf226799,0xbf3fc767,0xbf584853,0xbf6b4b0c
.long 0xbf3085bb,0xbf4c3578,0xbf628210,0xbf72d4eb,0xbf3daef9,0xbf577026,0xbf6b4b0c,0xbf78b47b
.long 0xbf49d112,0xbf61668a,0xbf7294f8,0xbf7cdf6c,0xbf54db31,0xbf6a09a7,0xbf7853f8,0xbf7f4e6d
.long 0xbf5ebe05,0xbf714c7a,0xbf7c7eb0,0xbf7ffd39,0xbf676bd8,0xbf772417,0xbf7f0e58,0xbf7eea9d
.long 0xbf6ed89e,0xbf7b87b2,0xbf7ffec4,0xbf7c187a,0xbf74fa0b,0xbf7e70b0,0xbf7f4e6d,0xbf778bc5
.long 0xbf79c79d,0xbf7fdaaf,0xbf7cfe73,0xbf714c7a,0xbf7d3aac,0xbf7fc38f,0xbf791298,0xbf696591
.long 0xbf7f4e6d,0xbf7e2b72,0xbf73913f,0xbf5fe4e9,0xbf54db31,0xbf676bd8,0xbf74fa0b,0xbf7d3aac
.long 0xbf604621,0xbf703b37,0xbf7ac516,0xbf7fa6e3,0xbf6a09a7,0xbf772417,0xbf7e70b0,0xbf7fc38f
.long 0xbf721352,0xbf7c187a,0xbf7ff4e6,0xbf7d906e,0xbf7853f8,0xbf7f0e58,0xbf7f4e6d,0xbf791298
.long 0xbf7cbfc9,0xbf7fffb1,0xbf7c7eb0,0xbf725470,0xbf7f4e6d,0xbf7eea9d,0xbf778bc5,0xbf696591
.long 0xbf7ffb11,0xbf7bd14d,0xbf708066,0xbf5e5aa6,0xbf7ec46d,0xbf76ba07,0xbf676bd8,0xbf514d3d
.long 0xbf7baccd,0xbf6faf1b,0xbf5c61c7,0xbf425b89,0xbf76ba07,0xbf66becc,0xbf4f7a1f,0xbf31a81d
.long 0xbf6ff573,0xbf5bfb34,0xbf40d0da,0xbf1f599f,0xbf676bd8,0xbf4f7a1f,0xbf3085bb,0xbf0b9a6b
.long 0xbf5d2d53,0xbf4154e1,0xbf1ebc12,0xbeed3063,0xbf514d3d,0xbf31a81d,0xbf0b9a6b,0xbec1071e
.long 0xbf43e200,0xbf209393,0xbeee9479,0xbe931f35,0x3f800000,0x3f800000,0x3f800000,0x3f800000
.long 0x3f7d3aac,0x3f7d1cdd,0x3f7cfe73,0x3f7cdf6c,0x3f74fa0b,0x3f748422,0x3f740bdd,0x3f73913f
.long 0x3f676bd8,0x3f666771,0x3f655e0b,0x3f644fac,0x3f54db31,0x3f531849,0x3f514d3d,0x3f4f7a1f
.long 0x3f3daef9,0x3f3b0629,0x3f385216,0x3f3592e7,0x3f226799,0x3f1ebc12,0x3f1b02c6,0x3f173c07
.long 0x3f039c3d,0x3efdbabb,0x3ef41f07,0x3eea6681,0x3ec3ef15,0x3eb8442a,0x3eac7cd4,0x3ea09ae5
.long 0x3e78cfcc,0x3e5d4b1a,0x3e419b37,0x3e25c58c,0x3dc8bd36,0x3d8a200a,0x3d16c32c,0x3bc90f88
.long 0xbd48fb30,0xbda973ba,0xbdee3876,0xbe195be0,0xbe47c5c2,0xbe6c9a7f,0xbe888e93,0xbe9aa086
.long 0xbeac7cd4,0xbebf926f,0xbed25a09,0xbee4cbfe,0xbef15aea,0xbf0242b1,0xbf0b9a6b,0xbf14b039
.long 0xbf187fc0,0xbf21cbfb,0xbf2ac082,0xbf33587a,0x3f800000,0x3f800000,0x3f800000,0x3f800000
.long 0x3f7cbfc9,0x3f7c9f8a,0x3f7c7eb0,0x3f7c5d3a,0x3f731447,0x3f7294f8,0x3f721352,0x3f718f57
.long 0x3f633c5a,0x3f62241a,0x3f6106f2,0x3f5fe4e9,0x3f4d9f02,0x3f4bbbf8,0x3f49d112,0x3f47de65
.long 0x3f32c8c9,0x3f2ff3e6,0x3f2d1469,0x3f2a2a80,0x3f13682a,0x3f0f8784,0x3f0b9a6b,0x3f07a136
.long 0x3ee0924f,0x3ed6a399,0x3ecc9b8b,0x3ec27b55,0x3e94a031,0x3e888e93,0x3e78cfcc,0x3e605c13
.long 0x3e09cf86,0x3ddb7d37,0x3da3308c,0x3d55880e,0xbcc90ab0,0xbd621469,0xbdafb680,0xbdee3876
.long 0xbe3b6ecf,0xbe5d4b1a,0xbe7ee6e1,0xbe901c2c,0xbeac7cd4,0xbebe1d4a,0xbecf7bca,0xbee0924f
.long 0xbef6e0cb,0xbf044889,0xbf0cead0,0xbf1553b7,0xbf1d7fd1,0xbf26050a,0xbf2e3bde,0xbf36206c
.long 0xbf3b8f3b,0xbf436051,0xbf4ac77f,0xbf51c0c2,0x3f800000,0x3f800000,0x3f800000,0x3f800000
.long 0x3f7c3b28,0x3f7c187a,0x3f7bf531,0x3f7bd14d,0x3f710908,0x3f708066,0x3f6ff573,0x3f6f6830
.long 0x3f5ebe05,0x3f5d924d,0x3f5c61c7,0x3f5b2c79,0x3f45e403,0x3f43e200,0x3f41d870,0x3f3fc767
.long 0x3f273656,0x3f24381a,0x3f212ff9,0x3f1e1e22,0x3f039c3d,0x3eff17b2,0x3ef6e0cb,0x3eee9479
.long 0x3eb8442a,0x3eadf73c,0x3ea395c5,0x3e9920fe,0x3e47c5c2,0x3e2f10a2,0x3e164083,0x3dfab273
.long 0x3cc90ab0,0xbb490fc6,0xbcfb49ba,0xbd6ea038,0xbe164083,0xbe354098,0xbe541501,0xbe72b651
.long 0xbea09ae5,0xbeb0eacb,0xbec1071e,0xbed0eb2a,0xbef15aea,0xbf00e7e4,0xbf08f59b,0xbf10d3cd
.long 0xbf1d7fd1,0xbf256bcb,0xbf2d1469,0xbf34768f,0xbf3daef9,0xbf44e3f5,0xbf4bbbf8,0xbf5233c6
.long 0xbf584853,0xbf5e5aa6,0xbf63f473,0xbf6912ae,0x3f800000,0x3f800000,0x3f800000,0x3f800000
.long 0x3f7baccd,0x3f7b87b2,0x3f7b61fc,0x3f7b3bab,0x3f6ed89e,0x3f6e46be,0x3f6db293,0x3f6d1c1d
.long 0x3f59f26a,0x3f58b3a1,0x3f577026,0x3f5627fe,0x3f3daef9,0x3f3b8f3b,0x3f396842,0x3f373a23
.long 0x3f1b02c6,0x3f17de12,0x3f14b039,0x3f11796b,0x3ee63375,0x3eddbe79,0x3ed53641,0x3ecc9b8b
.long 0x3e8e9a22,0x3e840270,0x3e72b651,0x3e5d4b1a,0x3dc8bd36,0x3d96a905,0x3d48fb30,0x3cc90ab0
.long 0xbdafb680,0xbde7fa9a,0xbe1008b7,0xbe2bf804,0xbe888e93,0xbe97a117,0xbea68f12,0xbeb554ec
.long 0xbee0924f,0xbeeff7fb,0xbeff17b2,0xbf06f686,0xbf187fc0,0xbf1ff6cb,0xbf273656,0xbf2e3bde
.long 0xbf3b8f3b,0xbf425b89,0xbf48d8b3,0xbf4f0417,0xbf584853,0xbf5df6be,0xbf633c5a,0xbf6816a8
.long 0xbf6db293,0xbf71d19f,0xbf756d97,0xbf788486,0x0,0x0,0x0,0x0
.long 0x3e164083,0x3e195be0,0x3e1c76de,0x3e1f917b,0x3e94a031,0x3e97a117,0x3e9aa086,0x3e9d9e78
.long 0x3edae880,0x3edf28a9,0x3ee363fa,0x3ee79a5d,0x3f0e39da,0x3f10d3cd,0x3f13682a,0x3f15f6d9
.long 0x3f2beb4a,0x3f2ecef7,0x3f31a81d,0x3f34768f,0x3f45e403,0x3f48d8b3,0x3f4bbbf8,0x3f4e8d90
.long 0x3f5b941a,0x3f5e5aa6,0x3f6106f2,0x3f6398ac,0x3f6c835e,0x3f6ed89e,0x3f710908,0x3f731447
.long 0x3f7853f8,0x3f79f35e,0x3f7b61fc,0x3f7c9f8a,0x3f7ec46d,0x3f7f6ac7,0x3f7fd397,0x3f7ffec4
.long 0x3f7fb10f,0x3f7f1f49,0x3f7e4323,0x3f7d1cdd,0x3f7b14be,0x3f791298,0x3f76ba07,0x3f740bdd
.long 0x3f710908,0x3f6d67a1,0x3f696591,0x3f650479,0x3f61c598,0x3f5c61c7,0x3f5695e5,0x3f5064af
.long 0x3f4d9f02,0x3f466354,0x3f3ebc1b,0x3f36ad7f,0x0,0x0,0x0,0x0
.long 0x3e22abb6,0x3e25c58c,0x3e28defc,0x3e2bf804,0x3ea09ae5,0x3ea395c5,0x3ea68f12,0x3ea986c4
.long 0x3eebcbbb,0x3eeff7fb,0x3ef41f07,0x3ef840c8,0x3f187fc0,0x3f1b02c6,0x3f1d7fd1,0x3f1ff6cb
.long 0x3f373a23,0x3f39f2ac,0x3f3ca003,0x3f3f41fc,0x3f514d3d,0x3f53fac3,0x3f5695e5,0x3f591e6a
.long 0x3f660f88,0x3f686b39,0x3f6aab7b,0x3f6cd007,0x3f74fa0b,0x3f76ba07,0x3f7853f8,0x3f79c79d
.long 0x3f7dabcc,0x3f7e868b,0x3f7f2f9d,0x3f7fa6e3,0x3f7fec43,0x3f7f9c18,0x3f7f0e58,0x3f7e4323
.long 0x3f7baccd,0x3f79f35e,0x3f77f110,0x3f75a67b,0x3f710908,0x3f6db293,0x3f6a09a7,0x3f660f88
.long 0x3f604621,0x3f5b2c79,0x3f55b993,0x3f4fefa8,0x3f49d112,0x3f42de29,0x3f3b8f3b,0x3f33e7bc
.long 0x3f2e3bde,0x3f256bcb,0x3f1c420c,0x3f12c39a,0x0,0x0,0x0,0x0
.long 0x3e2f10a2,0x3e3228d4,0x3e354098,0x3e3857ec,0x3eac7cd4,0x3eaf713a,0x3eb263ef,0x3eb554ec
.long 0x3efc5d27,0x3f003a06,0x3f0242b1,0x3f044889,0x3f226799,0x3f24d225,0x3f273656,0x3f299415
.long 0x3f41d870,0x3f446337,0x3f46e22a,0x3f495521,0x3f5b941a,0x3f5df6be,0x3f604621,0x3f628210
.long 0x3f6ed89e,0x3f70c501,0x3f7294f8,0x3f74484b,0x3f7b14be,0x3f7c3b28,0x3f7d3aac,0x3f7e1324
.long 0x3f7fec43,0x3f7fffb1,0x3f7fe129,0x3f7f90b1,0x3f7d3aac,0x3f7bf531,0x3f7a7302,0x3f78b47b
.long 0x3f731447,0x3f703b37,0x3f6d1c1d,0x3f69b7e4,0x3f61c598,0x3f5d2d53,0x3f584853,0x3f531849
.long 0x3f49d112,0x3f436051,0x3f3ca003,0x3f3592e7,0x3f2beb4a,0x3f239da9,0x3f1b02c6,0x3f121eb0
.long 0x3f08f59b,0x3efdbabb,0x3ee900b7,0x3ed3c867,0x0,0x0,0x0,0x0
.long 0x3e3b6ecf,0x3e3e853e,0x3e419b37,0x3e44b0b9,0x3eb8442a,0x3ebb31a0,0x3ebe1d4a,0x3ec1071e
.long 0x3f064b82,0x3f084b92,0x3f0a48ad,0x3f0c42c9,0x3f2beb4a,0x3f2e3bde,0x3f3085bb,0x3f32c8c9
.long 0x3f4bbbf8,0x3f4e1689,0x3f5064af,0x3f52a649,0x3f64aa59,0x3f66becc,0x3f68bf3c,0x3f6aab7b
.long 0x3f75dec6,0x3f77583a,0x3f78b47b,0x3f79f35e,0x3f7ec46d,0x3f7f4e6d,0x3f7fb10f,0x3f7fec43
.long 0x3f7f0e58,0x3f7e5a38,0x3f7d7474,0x3f7c5d3a,0x3f76ba07,0x3f748422,0x3f721352,0x3f6f6830
.long 0x3f660f88,0x3f62241a,0x3f5df6be,0x3f5988ad,0x3f4d9f02,0x3f47de65,0x3f41d870,0x3f3b8f3b
.long 0x3f2e3bde,0x3f269de3,0x3f1ebc12,0x3f16999f,0x3f08f59b,0x3eff17b2,0x3eebcbbb,0x3ed8106b
.long 0x3ebe1d4a,0x3ea80b1f,0x3e919ddd,0x3e75c35a,0xbf3504f3,0xbf3daef9,0xbf45e403,0xbf4d9f02
.long 0xbf4d9f02,0xbf554aa4,0xbf5c61c7,0xbf62df7b,0xbf61c598,0xbf6816a8,0xbf6db293,0xbf7294f8
.long 0xbf710908,0xbf75a67b,0xbf796e4e,0xbf7c5d3a,0xbf7b14be,0xbf7dabcc,0xbf7f4e6d,0xbf7ffb11
.long 0xbf7fb10f,0xbf7ff84a,0xbf7f2f9d,0xbf7d57de,0xbf7ec46d,0xbf7c7eb0,0xbf791298,0xbf748422
.long 0xbf7853f8,0xbf73530e,0xbf6d1c1d,0xbf65b710,0xbf6c835e,0xbf64aa59,0xbf5b941a,0xbf514d3d
.long 0xbf5b941a,0xbf50d937,0xbf44e3f5,0xbf37c655,0xbf45e403,0xbf385216,0xbf299415,0xbf19c200
.long 0xbf2beb4a,0xbf1ba299,0xbf0a48ad,0xbeeff7fb,0xbf0e39da,0xbef6e0cb,0xbecf7bca,0xbea68f12
.long 0xbedae880,0xbeb0eacb,0xbe8586ce,0xbe3228d4,0xbe94a031,0xbe4dee60,0xbde1bc2e,0xbc96c9b6
.long 0xbe164083,0xbd55880e,0x3d2fe007,0x3e0cec4a,0xbf54db31,0xbf5b941a,0xbf61c598,0xbf676bd8
.long 0xbf68bf3c,0xbf6dfcf2,0xbf7294f8,0xbf76841b,0xbf76ba07,0xbf7a1e84,0xbf7cbfc9,0xbf7e9bc9
.long 0xbf7e70b0,0xbf7fa6e3,0xbf7ffec4,0xbf7f7808,0xbf7fb10f,0xbf7e70b0,0xbf7c3b28,0xbf791298
.long 0xbf7a7302,0xbf76841b,0xbf718f57,0xbf6b99fb,0xbf6ed89e,0xbf6816a8,0xbf604621,0xbf577026
.long 0xbf5d2d53,0xbf5389c7,0xbf48d8b3,0xbf3d27b8,0xbf45e403,0xbf396842,0xbf2beb4a,0xbf1d7fd1
.long 0xbf299415,0xbf1a6293,0xbf0a48ad,0xbef2bd43,0xbf08f59b,0xbeee9479,0xbec9b953,0xbea395c5
.long 0xbec9b953,0xbea21887,0xbe72b651,0xbe1f917b,0xbe78cfcc,0xbe22abb6,0xbd96a905,0x3c490e90
.long 0xbdafb680,0x3b490fc6,0x3dbc3ac3,0x3e3857ec,0x3d96a905,0x3e28defc,0x3e827dc0,0x3eaf713a
.long 0x3e6c9a7f,0x3ea5129f,0x3ed25a09,0x3efdbabb,0xbf6c835e,0xbf710908,0xbf74fa0b,0xbf7853f8
.long 0xbf79c79d,0xbf7c5d3a,0xbf7e4323,0xbf7f7808,0xbf7fb10f,0xbf7ffec4,0xbf7f84ab,0xbf7e4323
.long 0xbf7e1324,0xbf7bd14d,0xbf78b47b,0xbf74bf62,0xbf74fa0b,0xbf6ff573,0xbf6a09a7,0xbf633c5a
.long 0xbf64aa59,0xbf5cc7d1,0xbf53fac3,0xbf4a4c87,0xbf4d9f02,0xbf42de29,0xbf373a23,0xbf2ac082
.long 0xbf3085bb,0xbf2302d3,0xbf14b039,0xbf05a02c,0xbf0e39da,0xbefc5d27,0xbedae880,0xbeb8442a
.long 0xbecf7bca,0xbeab0201,0xbe8586ce,0xbe3e853e,0xbe78cfcc,0xbe28defc,0xbdafb680,0xbbc90f88
.long 0xbd96a905,0x3c16cb58,0x3dbc3ac3,0x3e3228d4,0x3dc8bd36,0x3e3b6ecf,0x3e888e93,0x3eb263ef
.long 0x3e888e93,0x3eb3dca5,0x3eddbe79,0x3f02ef9f,0x3edae880,0x3f0242b1,0x3f15f6d9,0x3f286605
.long 0x3f13682a,0x3f269de3,0x3f385216,0x3f485bca,0xbf7b14be,0xbf7d3aac,0xbf7ec46d,0xbf7fb10f
.long 0xbf7ffb11,0xbf7fcbe2,0xbf7eea9d,0xbf7d57de,0xbf7c3b28,0xbf796e4e,0xbf75dec6,0xbf718f57
.long 0xbf6ff573,0xbf6a5ad9,0xbf63f473,0xbf5cc7d1,0xbf5b941a,0xbf531849,0xbf49d112,0xbf3fc767
.long 0xbf3fc767,0xbf34768f,0xbf286605,0xbf1ba299,0xbf1d7fd1,0xbf0f8784,0xbf00e7e4,0xbee363fa
.long 0xbeebcbbb,0xbecb2aae,0xbea986c4,0xbe870ada,0xbe94a031,0xbe605c13,0xbe164083,0xbd96a905
.long 0xbde1bc2e,0xbd0a342f,0x3d2fe007,0x3df475c0,0x3d96a905,0x3e1c76de,0x3e6c9a7f,0x3e9d9e78
.long 0x3e827dc0,0x3eab0201,0x3ed25a09,0x3ef840c8,0x3edae880,0x3f00e7e4,0x3f13682a,0x3f24d225
.long 0x3f15f6d9,0x3f27ce61,0x3f385216,0x3f476085,0x3f396842,0x3f48d8b3,0x3f5695e5,0x3f628210
.long 0x3f5695e5,0x3f62df7b,0x3f6d1c1d,0x3f75341d,0x3f3504f3,0x3f2beb4a,0x3f226799,0x3f187fc0
.long 0x3f187fc0,0x3f0d9281,0x3f0242b1,0x3eed3063,0x3ef15aea,0x3ed8106b,0x3ebe1d4a,0x3ea395c5
.long 0x3eac7cd4,0x3e901c2c,0x3e667c66,0x3e2bf804,0x3e47c5c2,0x3e09cf86,0x3d96a905,0x3c490e90
.long 0x3d48fb30,0xbc7b514b,0xbda3308c,0xbe1324ca,0xbdc8bd36,0xbe28defc,0xbe6c9a7f,0xbe97a117
.long 0xbe78cfcc,0xbe9f1cdf,0xbec1071e,0xbee1fb6a,0xbec3ef15,0xbee63375,0xbf039c3d,0xbf13682a
.long 0xbf039c3d,0xbf140c5f,0xbf239da9,0xbf3238aa,0xbf226799,0xbf31a81d,0xbf3fc767,0xbf4cae79
.long 0xbf3daef9,0xbf4b41fa,0xbf577026,0xbf62241a,0xbf54db31,0xbf604621,0xbf6a09a7,0xbf721352
.long 0xbf676bd8,0xbf703b37,0xbf772417,0xbf7c187a,0xbf74fa0b,0xbf7ac516,0xbf7e70b0,0xbf7ff4e6
.long 0xbf7d3aac,0xbf7fa6e3,0xbf7fc38f,0xbf7d906e,0x3f0e39da,0x3f039c3d,0x3ef15aea,0x3edae880
.long 0x3ed53641,0x3ebca7af,0x3ea395c5,0x3e8a11f7,0x3e888e93,0x3e5a3997,0x3e22abb6,0x3dd53db9
.long 0x3de1bc2e,0x3d55880e,0xbbc90f88,0xbd83db0a,0xbd48fb30,0xbde1bc2e,0xbe2f10a2,0xbe6c9a7f
.long 0xbe541501,0xbe8a11f7,0xbea986c4,0xbec8477c,0xbeb8442a,0xbed8106b,0xbef6e0cb,0xbf0a48ad
.long 0xbf00e7e4,0xbf102dd5,0xbf1ebc12,0xbf2c800f,0xbf226799,0xbf3085bb,0xbf3daef9,0xbf49d112
.long 0xbf3fc767,0xbf4c3578,0xbf577026,0xbf61668a,0xbf584853,0xbf628210,0xbf6b4b0c,0xbf7294f8
.long 0xbf6b4b0c,0xbf72d4eb,0xbf78b47b,0xbf7cdf6c,0xbf7853f8,0xbf7cbfc9,0xbf7f4e6d,0xbf7ffb11
.long 0xbf7f0e58,0xbf7fffb1,0xbf7eea9d,0xbf7bd14d,0xbf7f4e6d,0xbf7c7eb0,0xbf778bc5,0xbf708066
.long 0xbf791298,0xbf725470,0xbf696591,0xbf5e5aa6,0x3ec3ef15,0x3eac7cd4,0x3e94a031,0x3e78cfcc
.long 0x3e605c13,0x3e2bf804,0x3dee3876,0x3d83db0a,0x3d48fb30,0xbbc90f88,0xbd7b2b74,0xbdee3876
.long 0xbdfab273,0xbe3857ec,0xbe72b651,0xbe9620d2,0xbe94a031,0xbeb263ef,0xbecf7bca,0xbeebcbbb
.long 0xbee63375,0xbf019573,0xbf0f8784,0xbf1ce11f,0xbf187fc0,0xbf26050a,0xbf32c8c9,0xbf3ebc1b
.long 0xbf396842,0xbf456439,0xbf5064af,0xbf5a5ba0,0xbf54db31,0xbf5ebe05,0xbf676bd8,0xbf6ed89e
.long 0xbf6a09a7,0xbf714c7a,0xbf772417,0xbf7b87b2,0xbf7853f8,0xbf7c7eb0,0xbf7f0e58,0xbf7ffec4
.long 0xbf7f4e6d,0xbf7ffd39,0xbf7eea9d,0xbf7c187a,0xbf7ec46d,0xbf7baccd,0xbf76ba07,0xbf6ff573
.long 0xbf76ba07,0xbf6faf1b,0xbf66becc,0xbf5bfb34,0xbf676bd8,0xbf5c61c7,0xbf4f7a1f,0xbf40d0da
.long 0xbf514d3d,0xbf425b89,0xbf31a81d,0xbf1f599f,0x3e47c5c2,0x3e164083,0x3dc8bd36,0x3d48fb30
.long 0x3c490e90,0xbd2351cb,0xbdbc3ac3,0xbe1324ca,0xbe2f10a2,0xbe667c66,0xbe8e9a22,0xbea986c4
.long 0xbeb263ef,0xbece0bea,0xbee900b7,0xbf019573,0xbf039c3d,0xbf10d3cd,0xbf1d7fd1,0xbf299415
.long 0xbf299415,0xbf3592e7,0xbf40d0da,0xbf4b41fa,0xbf49d112,0xbf53fac3,0xbf5d2d53,0xbf655e0b
.long 0xbf633c5a,0xbf6afb8c,0xbf718f57,0xbf76ef5b,0xbf74fa0b,0xbf79c79d,0xbf7d3aac,0xbf7f4e6d
.long 0xbf7e70b0,0xbf7fdaaf,0xbf7fc38f,0xbf7e2b72,0xbf7f4e6d,0xbf7cfe73,0xbf791298,0xbf73913f
.long 0xbf778bc5,0xbf714c7a,0xbf696591,0xbf5fe4e9,0xbf676bd8,0xbf5d2d53,0xbf514d3d,0xbf43e200
.long 0xbf4f7a1f,0xbf4154e1,0xbf31a81d,0xbf209393,0xbf3085bb,0xbf1ebc12,0xbf0b9a6b,0xbeee9479
.long 0xbf0b9a6b,0xbeed3063,0xbec1071e,0xbe931f35
```
